```python
import torch

def _softmax(x, axis=-1):
    return torch.softmax(x, dim=axis)

def _gelu(x):
    return torch.nn.functional.gelu(x, approximate='tanh')

def _silu(x):
    return torch.nn.functional.silu(x)

def _sigmoid(x):
    return torch.sigmoid(x)

def _layernorm(x, axis=-1, eps=1e-05):
    m = x.mean(dim=axis, keepdim=True)
    v = x.var(dim=axis, keepdim=True, unbiased=False)
    return (x - m) / torch.sqrt(v + eps)

def _scatter_add(tgt, idx, src, axis=0):
    return tgt.clone().index_add_(axis, idx, src)

def _segment_sum(src, seg, n):
    out = torch.zeros((n,) + src.shape[1:], dtype=src.dtype)
    return out.index_add_(0, seg, src)

def _pad(x, pw):
    flat = tuple((v for pair in reversed(pw) for v in pair))
    return torch.nn.functional.pad(x, flat)
kernel_name = 'sequential_preLN__memory_aug_recurrent_mem_tr__dense_activation_silu__prompt'

def setup_inputs():

    _w = lambda a: (lambda t: t.to(torch.bfloat16) if t.is_floating_point() else t)(torch.as_tensor(a))

    def _A_setup():
        B, S, Dm = (1, 2048, 1024)
        H, Dh = (32, 128)
        M, seg = (8, 32)
        seg = min(seg, S)
        S = S // seg * seg
        return {'x': _w((lambda *s: torch.randn(*s, dtype=torch.bfloat16) * 0.05)(B, S, Dm)), 'mem0': _w((lambda *s: torch.randn(*s, dtype=torch.bfloat16) * 0.2)(B, M, Dm)), 'Wq': _w((lambda *s: torch.randn(*s, dtype=torch.bfloat16) * 1.6)(Dm, H, Dh) * Dm ** (-0.5)), 'Wk': _w((lambda *s: torch.randn(*s, dtype=torch.bfloat16) * 1.6)(Dm, H, Dh) * Dm ** (-0.5)), 'Wv': _w((lambda *s: torch.randn(*s, dtype=torch.bfloat16) * 0.2)(Dm, H, Dh) * Dm ** (-0.5)), 'Wo': _w((lambda *s: torch.randn(*s, dtype=torch.bfloat16) * 0.2)(H, Dh, Dm) * (H * Dh) ** (-0.5)), 'seg_len': seg}
    _A_in = _A_setup()

    def _B_setup():
        B, S, D, F = (1, 2048, 1024, 3584)
        return {'x': _w((lambda *s: torch.randn(*s, dtype=torch.bfloat16) * 0.05)(B, S, D)), 'w1': _w((lambda *s: torch.randn(*s, dtype=torch.bfloat16) * 0.8)(D, F) * D ** (-0.5)), 'w2': _w((lambda *s: torch.randn(*s, dtype=torch.bfloat16) * 0.1)(F, D) * F ** (-0.5))}
    _B_in = _B_setup()
    return {'A_x': _A_in['x'], 'A_mem0': _A_in['mem0'], 'A_Wq': _A_in['Wq'], 'A_Wk': _A_in['Wk'], 'A_Wv': _A_in['Wv'], 'A_Wo': _A_in['Wo'], 'A_seg_len': _A_in['seg_len'], 'B_x': _B_in['x'], 'B_w1': _B_in['w1'], 'B_w2': _B_in['w2']}

def reference(A_x, A_mem0, A_Wq, A_Wk, A_Wv, A_Wo, A_seg_len, B_x, B_w1, B_w2):

    def _A_ref(x, mem0, Wq, Wk, Wv, Wo, seg_len):
        B, S, Dm = x.shape
        H, Dh = (Wq.shape[1], Wq.shape[2])
        M = mem0.shape[1]
        scale = Dh ** (-0.5)
        n_seg = S // seg_len
        L = M + seg_len
        idx = torch.arange(L)
        mask = (idx[:, None] < M) | (idx[:, None] >= idx[None, :])
        mem = mem0
        outs = []
        for s in range(n_seg):
            xs = x[:, s * seg_len:(s + 1) * seg_len, :].clone()
            h = torch.concatenate([mem, xs], axis=1)
            q = torch.einsum('btd,dhe->bhte', h, Wq)
            k = torch.einsum('btd,dhe->bhte', h, Wk)
            v = torch.einsum('btd,dhe->bhte', h, Wv)
            scores = torch.einsum('bhqe,bhke->bhqk', q, k) * scale
            scores = torch.where(mask[None, None], scores, -1000000000.0)
            p = _softmax(scores, axis=-1)
            o = torch.einsum('bhqk,bhke->bhqe', p, v)
            o = torch.einsum('bhte,hed->btd', o, Wo)
            mem = o[:, :M, :].clone()
            outs.append(o[:, M:, :])
        return torch.concatenate(outs, axis=1)

    def _B_ref(x, w1, w2):
        h = torch.einsum('bsd,df->bsf', x, w1)
        h = _silu(h)
        out = torch.einsum('bsf,fd->bsd', h, w2)
        return out
    x = A_x
    h = x + _A_ref(_layernorm(x, axis=-1), A_mem0, A_Wq, A_Wk, A_Wv, A_Wo, A_seg_len)
    h2 = h + _B_ref(_layernorm(h, axis=-1), B_w1, B_w2)
    return h2
```

```asm
; @launch kernel=sequential_preLN__memory_aug_recurrent_mem_tr__dense_activation_silu__prompt_kernel grid=(256,1,1) block=(256,1,1) lds=155712
.amdgcn_target "amdgcn-amd-amdhsa--gfx950"
.macro MF c,a,b
 v_mfma_f32_16x16x32_bf16 \c,\a,\b,\c
.endm
.macro TR d,e,a,o
 ds_read_b64_tr_b16 v[\d:\e],v\a offset:\o
.endm
.macro RB d,e,a,o
 ds_read_b128 v[\d:\e],v\a offset:\o
.endm
.macro DM m,c,v,r,s,x:vararg
 s_add_u32 m0,s\m,\c
 s_nop 0
 buffer_load_dwordx4 v\v,\r,s\s offen \x
.endm
.macro CV d,a,b
 v_cvt_pk_bf16_f32 v\d,v\a,v\b
.endm
.macro AR d,a
 v_accvgpr_read_b32 v\d,a\a
.endm
.macro AW a
 v_accvgpr_write_b32 a\a,0
.endm
.text
.globl sequential_preLN__memory_aug_recurrent_mem_tr__dense_activation_silu__prompt_kernel
.p2align 8
.type sequential_preLN__memory_aug_recurrent_mem_tr__dense_activation_silu__prompt_kernel,@function
sequential_preLN__memory_aug_recurrent_mem_tr__dense_activation_silu__prompt_kernel:
 s_cmp_ge_u32 s2, 256
 s_cbranch_scc1 mk_end
 s_getpc_b64 s[30:31]
mk_cpf:
 s_bfe_u32 s32, s2, 0x10003
 s_lshl_b32 s32, s32, 16
 v_lshlrev_b32 v4, 7, v0
 v_add_u32 v4, s32, v4
 v_min_u32 v5, main_tasks-mk_cpf, v4
 v_add_u32 v4, 0x8000, v4
 v_min_u32 v4, main_tasks-mk_cpf, v4
 global_load_dword v6, v5, s[30:31]
 global_load_dword v7, v4, s[30:31]
 s_load_dwordx2 s[4:5], s[0:1], 88
 s_load_dwordx2 s[6:7], s[0:1], 96
 s_load_dwordx4 s[60:63], s[0:1], 16
 s_load_dwordx4 s[8:11], s[0:1], 0
 s_load_dwordx4 s[64:67], s[0:1], 32
 s_getreg_b32 s12, hwreg(HW_REG_XCC_ID)
 s_and_b32 s12, s12, 7
 v_lshrrev_b32 v1, 6, v0
 v_and_b32 v2, 63, v0
 s_nop 1
 v_readfirstlane_b32 s13, v1
 s_waitcnt lgkmcnt(0)
 s_mov_b32 s20, s4
 s_and_b32 s21, s5, 0xffff
 s_mov_b32 s22, 0x100
 s_mov_b32 s23, 0x00020000
 s_mov_b32 s16, s6
 s_and_b32 s17, s7, 0xffff
 s_mov_b32 s18, 0x10000000
 s_mov_b32 s19, 0x00020000
 s_lshl_b32 s56, s12, 2
 s_add_u32 s57, s56, 112
 s_cmp_ge_u32 s12, 4
 s_cselect_b32 s56, s57, s56
 v_mov_b32 v16, s56
 v_mov_b32 v17, 1
 v_mov_b32 v18, 32
 v_mov_b32 v19, 1
 v_cmp_eq_u32 vcc, 0, v0
 s_and_saveexec_b64 s[32:33], vcc
 s_cbranch_execz mk_t0
 buffer_atomic_add v17, v16, s[20:23], 0 offen sc0
mk_t0:
 s_mov_b64 exec, s[32:33]
 s_mov_b32 s24, s8
 s_and_b32 s25, s9, 0xffff
 s_mov_b32 s26, 0x400000
 s_mov_b32 s27, 0x00020000
 s_mov_b32 s36, s10
 s_and_b32 s37, s11, 0xffff
 s_mov_b32 s38, 0x4000
 s_mov_b32 s39, 0x00020000
 v_lshlrev_b32 v3, 4, v2
 v_lshlrev_b32 v44, 4, v0
 v_mov_b32 v40, -1
 v_mov_b32 v41, -1
 v_mov_b32 v42, -1
 v_mov_b32 v43, -1
 s_lshl_b32 s34, s2, 2
 s_add_u32 s34, s34, s13
 s_lshl_b32 s34, s34, 12
 s_add_u32 s35, s34, 0
 s_add_u32 s30, s35, 2048
 buffer_load_dwordx4 v[48:51], v3, s[24:27], s34 offen
 buffer_load_dwordx4 v[52:55], v3, s[24:27], s34 offen offset:1024
 buffer_load_dwordx4 v[56:59], v3, s[24:27], s34 offen offset:2048
 buffer_load_dwordx4 v[60:63], v3, s[24:27], s34 offen offset:3072
 s_cmp_ge_u32 s2, 8
 s_cbranch_scc1 mk_ia1
 v_and_b32 v4, 7, v2
 v_lshlrev_b32 v4, 11, v4
 v_lshrrev_b32 v5, 4, v2
 v_lshl_add_u32 v4, v5, 5, v4
 v_bfe_u32 v5, v2, 3, 1
 v_lshl_add_u32 v4, v5, 4, v4
 v_lshl_add_u32 v4, v1, 7, v4
 buffer_load_dwordx4 v[112:115], v4, s[36:39], 0 offen offset:0
 buffer_load_dwordx4 v[116:119], v4, s[36:39], 0 offen offset:512
 buffer_load_dwordx4 v[120:123], v4, s[36:39], 0 offen offset:1024
 buffer_load_dwordx4 v[124:127], v4, s[36:39], 0 offen offset:1536
mk_ia1:
 s_lshl_b32 s31, s2, 15
 s_add_u32 s31, s31, 84017152
 buffer_store_dwordx4 v[40:43], v44, s[16:19], s31 offen sc1
 s_add_u32 s31, s31, 4096
 buffer_store_dwordx4 v[40:43], v44, s[16:19], s31 offen sc1
 s_add_u32 s31, s31, 4096
 buffer_store_dwordx4 v[40:43], v44, s[16:19], s31 offen sc1
 s_add_u32 s31, s31, 4096
 buffer_store_dwordx4 v[40:43], v44, s[16:19], s31 offen sc1
 s_add_u32 s31, s31, 4096
 buffer_store_dwordx4 v[40:43], v44, s[16:19], s31 offen sc1
 s_add_u32 s31, s31, 4096
 buffer_store_dwordx4 v[40:43], v44, s[16:19], s31 offen sc1
 s_add_u32 s31, s31, 4096
 buffer_store_dwordx4 v[40:43], v44, s[16:19], s31 offen sc1
 s_add_u32 s31, s31, 4096
 buffer_store_dwordx4 v[40:43], v44, s[16:19], s31 offen sc1
 s_add_u32 s31, s31, 4096
 s_waitcnt vmcnt(8)
 s_waitcnt vmcnt(0)
 v_cmp_eq_u32 vcc, 0, v0
 s_and_saveexec_b64 s[32:33], vcc
 s_cbranch_execz mk_t1
 v_mov_b32 v20, 0
 ds_write_b32 v20, v17
 s_waitcnt lgkmcnt(0)
mk_t1:
 s_mov_b64 exec, s[32:33]
 v_lshlrev_b32 v64, 16, v48
 v_and_b32 v65, 0xffff0000, v48
 v_lshlrev_b32 v80, 16, v56
 v_and_b32 v81, 0xffff0000, v56
 v_lshlrev_b32 v66, 16, v49
 v_and_b32 v67, 0xffff0000, v49
 v_lshlrev_b32 v82, 16, v57
 v_and_b32 v83, 0xffff0000, v57
 v_lshlrev_b32 v68, 16, v50
 v_and_b32 v69, 0xffff0000, v50
 v_lshlrev_b32 v84, 16, v58
 v_and_b32 v85, 0xffff0000, v58
 v_lshlrev_b32 v70, 16, v51
 v_and_b32 v71, 0xffff0000, v51
 v_lshlrev_b32 v86, 16, v59
 v_and_b32 v87, 0xffff0000, v59
 v_lshlrev_b32 v72, 16, v52
 v_and_b32 v73, 0xffff0000, v52
 v_lshlrev_b32 v88, 16, v60
 v_and_b32 v89, 0xffff0000, v60
 v_lshlrev_b32 v74, 16, v53
 v_and_b32 v75, 0xffff0000, v53
 v_lshlrev_b32 v90, 16, v61
 v_and_b32 v91, 0xffff0000, v61
 v_lshlrev_b32 v76, 16, v54
 v_and_b32 v77, 0xffff0000, v54
 v_lshlrev_b32 v92, 16, v62
 v_and_b32 v93, 0xffff0000, v62
 v_lshlrev_b32 v78, 16, v55
 v_and_b32 v79, 0xffff0000, v55
 v_lshlrev_b32 v94, 16, v63
 v_and_b32 v95, 0xffff0000, v63
 v_add_f32 v96, v64, v65
 v_add_f32 v100, v80, v81
 v_add_f32 v96, v96, v66
 v_add_f32 v100, v100, v82
 v_add_f32 v96, v96, v67
 v_add_f32 v100, v100, v83
 v_add_f32 v96, v96, v68
 v_add_f32 v100, v100, v84
 v_add_f32 v96, v96, v69
 v_add_f32 v100, v100, v85
 v_add_f32 v96, v96, v70
 v_add_f32 v100, v100, v86
 v_add_f32 v96, v96, v71
 v_add_f32 v100, v100, v87
 v_add_f32 v96, v96, v72
 v_add_f32 v100, v100, v88
 v_add_f32 v96, v96, v73
 v_add_f32 v100, v100, v89
 v_add_f32 v96, v96, v74
 v_add_f32 v100, v100, v90
 v_add_f32 v96, v96, v75
 v_add_f32 v100, v100, v91
 v_add_f32 v96, v96, v76
 v_add_f32 v100, v100, v92
 v_add_f32 v96, v96, v77
 v_add_f32 v100, v100, v93
 v_add_f32 v96, v96, v78
 v_add_f32 v100, v100, v94
 v_add_f32 v96, v96, v79
 v_add_f32 v100, v100, v95
 s_nop 1
 v_add_f32_dpp v96, v96, v96 quad_perm:[1,0,3,2] row_mask:0xf bank_mask:0xf
 v_add_f32_dpp v100, v100, v100 quad_perm:[1,0,3,2] row_mask:0xf bank_mask:0xf
 s_nop 1
 v_add_f32_dpp v96, v96, v96 quad_perm:[2,3,0,1] row_mask:0xf bank_mask:0xf
 v_add_f32_dpp v100, v100, v100 quad_perm:[2,3,0,1] row_mask:0xf bank_mask:0xf
 s_nop 1
 v_add_f32_dpp v96, v96, v96 row_half_mirror row_mask:0xf bank_mask:0xf
 v_add_f32_dpp v100, v100, v100 row_half_mirror row_mask:0xf bank_mask:0xf
 s_nop 1
 v_add_f32_dpp v96, v96, v96 row_mirror row_mask:0xf bank_mask:0xf
 v_add_f32_dpp v100, v100, v100 row_mirror row_mask:0xf bank_mask:0xf
 v_mov_b32 v97, v96
 v_mov_b32 v101, v100
 s_nop 1
 v_permlane16_swap_b32 v96, v97
 v_permlane16_swap_b32 v100, v101
 v_add_f32 v96, v96, v97
 v_add_f32 v100, v100, v101
 v_mov_b32 v97, v96
 v_mov_b32 v101, v100
 s_nop 1
 v_permlane32_swap_b32 v96, v97
 v_permlane32_swap_b32 v100, v101
 v_add_f32 v96, v96, v97
 v_add_f32 v100, v100, v101
 v_mul_f32 v98, 0x3a800000, v96
 v_mul_f32 v102, 0x3a800000, v100
 v_sub_f32 v97, v64, v98
 v_mul_f32 v96, v97, v97
 v_sub_f32 v101, v80, v102
 v_mul_f32 v100, v101, v101
 v_sub_f32 v97, v65, v98
 v_fmac_f32 v96, v97, v97
 v_sub_f32 v101, v81, v102
 v_fmac_f32 v100, v101, v101
 v_sub_f32 v97, v66, v98
 v_fmac_f32 v96, v97, v97
 v_sub_f32 v101, v82, v102
 v_fmac_f32 v100, v101, v101
 v_sub_f32 v97, v67, v98
 v_fmac_f32 v96, v97, v97
 v_sub_f32 v101, v83, v102
 v_fmac_f32 v100, v101, v101
 v_sub_f32 v97, v68, v98
 v_fmac_f32 v96, v97, v97
 v_sub_f32 v101, v84, v102
 v_fmac_f32 v100, v101, v101
 v_sub_f32 v97, v69, v98
 v_fmac_f32 v96, v97, v97
 v_sub_f32 v101, v85, v102
 v_fmac_f32 v100, v101, v101
 v_sub_f32 v97, v70, v98
 v_fmac_f32 v96, v97, v97
 v_sub_f32 v101, v86, v102
 v_fmac_f32 v100, v101, v101
 v_sub_f32 v97, v71, v98
 v_fmac_f32 v96, v97, v97
 v_sub_f32 v101, v87, v102
 v_fmac_f32 v100, v101, v101
 v_sub_f32 v97, v72, v98
 v_fmac_f32 v96, v97, v97
 v_sub_f32 v101, v88, v102
 v_fmac_f32 v100, v101, v101
 v_sub_f32 v97, v73, v98
 v_fmac_f32 v96, v97, v97
 v_sub_f32 v101, v89, v102
 v_fmac_f32 v100, v101, v101
 v_sub_f32 v97, v74, v98
 v_fmac_f32 v96, v97, v97
 v_sub_f32 v101, v90, v102
 v_fmac_f32 v100, v101, v101
 v_sub_f32 v97, v75, v98
 v_fmac_f32 v96, v97, v97
 v_sub_f32 v101, v91, v102
 v_fmac_f32 v100, v101, v101
 v_sub_f32 v97, v76, v98
 v_fmac_f32 v96, v97, v97
 v_sub_f32 v101, v92, v102
 v_fmac_f32 v100, v101, v101
 v_sub_f32 v97, v77, v98
 v_fmac_f32 v96, v97, v97
 v_sub_f32 v101, v93, v102
 v_fmac_f32 v100, v101, v101
 v_sub_f32 v97, v78, v98
 v_fmac_f32 v96, v97, v97
 v_sub_f32 v101, v94, v102
 v_fmac_f32 v100, v101, v101
 v_sub_f32 v97, v79, v98
 v_fmac_f32 v96, v97, v97
 v_sub_f32 v101, v95, v102
 v_fmac_f32 v100, v101, v101
 s_nop 1
 v_add_f32_dpp v96, v96, v96 quad_perm:[1,0,3,2] row_mask:0xf bank_mask:0xf
 v_add_f32_dpp v100, v100, v100 quad_perm:[1,0,3,2] row_mask:0xf bank_mask:0xf
 s_nop 1
 v_add_f32_dpp v96, v96, v96 quad_perm:[2,3,0,1] row_mask:0xf bank_mask:0xf
 v_add_f32_dpp v100, v100, v100 quad_perm:[2,3,0,1] row_mask:0xf bank_mask:0xf
 s_nop 1
 v_add_f32_dpp v96, v96, v96 row_half_mirror row_mask:0xf bank_mask:0xf
 v_add_f32_dpp v100, v100, v100 row_half_mirror row_mask:0xf bank_mask:0xf
 s_nop 1
 v_add_f32_dpp v96, v96, v96 row_mirror row_mask:0xf bank_mask:0xf
 v_add_f32_dpp v100, v100, v100 row_mirror row_mask:0xf bank_mask:0xf
 v_mov_b32 v97, v96
 v_mov_b32 v101, v100
 s_nop 1
 v_permlane16_swap_b32 v96, v97
 v_permlane16_swap_b32 v100, v101
 v_add_f32 v96, v96, v97
 v_add_f32 v100, v100, v101
 v_mov_b32 v97, v96
 v_mov_b32 v101, v100
 s_nop 1
 v_permlane32_swap_b32 v96, v97
 v_permlane32_swap_b32 v100, v101
 v_add_f32 v96, v96, v97
 v_add_f32 v100, v100, v101
 v_mul_f32 v96, 0x3a800000, v96
 v_mul_f32 v100, 0x3a800000, v100
 CV 96,96,96
 CV 100,100,100
 v_and_b32 v96, 0xffff0000, v96
 v_and_b32 v100, 0xffff0000, v100
 CV 98,98,98
 CV 102,102,102
 v_and_b32 v98, 0xffff0000, v98
 v_and_b32 v102, 0xffff0000, v102
 v_add_f32 v96, 0x3727c5ac, v96
 v_add_f32 v100, 0x3727c5ac, v100
 CV 96,96,96
 CV 100,100,100
 v_and_b32 v96, 0xffff0000, v96
 v_and_b32 v100, 0xffff0000, v100
 v_sqrt_f32 v96, v96
 v_sqrt_f32 v100, v100
 s_nop 0
 CV 96,96,96
 CV 100,100,100
 v_and_b32 v96, 0xffff0000, v96
 v_and_b32 v100, 0xffff0000, v100
 v_rcp_f32 v99, v96
 v_rcp_f32 v103, v100
 v_sub_f32 v64, v64, v98
 v_sub_f32 v65, v65, v98
 v_sub_f32 v66, v66, v98
 v_sub_f32 v67, v67, v98
 v_sub_f32 v68, v68, v98
 v_sub_f32 v69, v69, v98
 v_sub_f32 v70, v70, v98
 v_sub_f32 v71, v71, v98
 v_sub_f32 v72, v72, v98
 v_sub_f32 v73, v73, v98
 v_sub_f32 v74, v74, v98
 v_sub_f32 v75, v75, v98
 v_sub_f32 v76, v76, v98
 v_sub_f32 v77, v77, v98
 v_sub_f32 v78, v78, v98
 v_sub_f32 v79, v79, v98
 v_sub_f32 v80, v80, v102
 v_sub_f32 v81, v81, v102
 v_sub_f32 v82, v82, v102
 v_sub_f32 v83, v83, v102
 v_sub_f32 v84, v84, v102
 v_sub_f32 v85, v85, v102
 v_sub_f32 v86, v86, v102
 v_sub_f32 v87, v87, v102
 v_sub_f32 v88, v88, v102
 v_sub_f32 v89, v89, v102
 v_sub_f32 v90, v90, v102
 v_sub_f32 v91, v91, v102
 v_sub_f32 v92, v92, v102
 v_sub_f32 v93, v93, v102
 v_sub_f32 v94, v94, v102
 v_sub_f32 v95, v95, v102
 CV 48,64,65
 v_lshlrev_b32 v64, 16, v48
 v_and_b32 v65, 0xffff0000, v48
 v_mul_f32 v64, v64, v99
 v_mul_f32 v65, v65, v99
 CV 48,64,65
 CV 49,66,67
 v_lshlrev_b32 v66, 16, v49
 v_and_b32 v67, 0xffff0000, v49
 v_mul_f32 v66, v66, v99
 v_mul_f32 v67, v67, v99
 CV 49,66,67
 CV 50,68,69
 v_lshlrev_b32 v68, 16, v50
 v_and_b32 v69, 0xffff0000, v50
 v_mul_f32 v68, v68, v99
 v_mul_f32 v69, v69, v99
 CV 50,68,69
 CV 51,70,71
 v_lshlrev_b32 v70, 16, v51
 v_and_b32 v71, 0xffff0000, v51
 v_mul_f32 v70, v70, v99
 v_mul_f32 v71, v71, v99
 CV 51,70,71
 CV 52,72,73
 v_lshlrev_b32 v72, 16, v52
 v_and_b32 v73, 0xffff0000, v52
 v_mul_f32 v72, v72, v99
 v_mul_f32 v73, v73, v99
 CV 52,72,73
 CV 53,74,75
 v_lshlrev_b32 v74, 16, v53
 v_and_b32 v75, 0xffff0000, v53
 v_mul_f32 v74, v74, v99
 v_mul_f32 v75, v75, v99
 CV 53,74,75
 CV 54,76,77
 v_lshlrev_b32 v76, 16, v54
 v_and_b32 v77, 0xffff0000, v54
 v_mul_f32 v76, v76, v99
 v_mul_f32 v77, v77, v99
 CV 54,76,77
 CV 55,78,79
 v_lshlrev_b32 v78, 16, v55
 v_and_b32 v79, 0xffff0000, v55
 v_mul_f32 v78, v78, v99
 v_mul_f32 v79, v79, v99
 CV 55,78,79
 buffer_store_dwordx4 v[48:51], v3, s[16:19], s35 offen sc1
 buffer_store_dwordx4 v[52:55], v3, s[16:19], s35 offen offset:1024 sc1
 CV 56,80,81
 v_lshlrev_b32 v80, 16, v56
 v_and_b32 v81, 0xffff0000, v56
 v_mul_f32 v80, v80, v103
 v_mul_f32 v81, v81, v103
 CV 56,80,81
 CV 57,82,83
 v_lshlrev_b32 v82, 16, v57
 v_and_b32 v83, 0xffff0000, v57
 v_mul_f32 v82, v82, v103
 v_mul_f32 v83, v83, v103
 CV 57,82,83
 CV 58,84,85
 v_lshlrev_b32 v84, 16, v58
 v_and_b32 v85, 0xffff0000, v58
 v_mul_f32 v84, v84, v103
 v_mul_f32 v85, v85, v103
 CV 58,84,85
 CV 59,86,87
 v_lshlrev_b32 v86, 16, v59
 v_and_b32 v87, 0xffff0000, v59
 v_mul_f32 v86, v86, v103
 v_mul_f32 v87, v87, v103
 CV 59,86,87
 CV 60,88,89
 v_lshlrev_b32 v88, 16, v60
 v_and_b32 v89, 0xffff0000, v60
 v_mul_f32 v88, v88, v103
 v_mul_f32 v89, v89, v103
 CV 60,88,89
 CV 61,90,91
 v_lshlrev_b32 v90, 16, v61
 v_and_b32 v91, 0xffff0000, v61
 v_mul_f32 v90, v90, v103
 v_mul_f32 v91, v91, v103
 CV 61,90,91
 CV 62,92,93
 v_lshlrev_b32 v92, 16, v62
 v_and_b32 v93, 0xffff0000, v62
 v_mul_f32 v92, v92, v103
 v_mul_f32 v93, v93, v103
 CV 62,92,93
 CV 63,94,95
 v_lshlrev_b32 v94, 16, v63
 v_and_b32 v95, 0xffff0000, v63
 v_mul_f32 v94, v94, v103
 v_mul_f32 v95, v95, v103
 CV 63,94,95
 buffer_store_dwordx4 v[56:59], v3, s[16:19], s30 offen sc1
 buffer_store_dwordx4 v[60:63], v3, s[16:19], s30 offen offset:1024 sc1
 s_cmp_eq_u32 s2, 8
 s_cbranch_scc0 mk_in_nz
 v_mov_b32 v8, 0
 v_mov_b32 v9, 0
 v_mov_b32 v10, 0
 v_mov_b32 v11, 0
 s_mov_b32 s31, 81788928
 buffer_store_dwordx4 v[8:11], v44, s[16:19], s31 offen sc1
 s_add_u32 s31, s31, 4096
 buffer_store_dwordx4 v[8:11], v44, s[16:19], s31 offen sc1
 s_add_u32 s31, s31, 4096
 buffer_store_dwordx4 v[8:11], v44, s[16:19], s31 offen sc1
 s_add_u32 s31, s31, 4096
 buffer_store_dwordx4 v[8:11], v44, s[16:19], s31 offen sc1
 s_add_u32 s31, s31, 4096
 buffer_store_dwordx4 v[8:11], v44, s[16:19], s31 offen sc1
 s_add_u32 s31, s31, 4096
 buffer_store_dwordx4 v[8:11], v44, s[16:19], s31 offen sc1
 s_add_u32 s31, s31, 4096
 buffer_store_dwordx4 v[8:11], v44, s[16:19], s31 offen sc1
 s_add_u32 s31, s31, 4096
 buffer_store_dwordx4 v[8:11], v44, s[16:19], s31 offen sc1
 s_add_u32 s31, s31, 4096
 buffer_store_dwordx4 v[8:11], v44, s[16:19], s31 offen sc1
 s_add_u32 s31, s31, 4096
 buffer_store_dwordx4 v[8:11], v44, s[16:19], s31 offen sc1
 s_add_u32 s31, s31, 4096
 buffer_store_dwordx4 v[8:11], v44, s[16:19], s31 offen sc1
 s_add_u32 s31, s31, 4096
 s_waitcnt vmcnt(0)
 v_mov_b32 v8, 0xc000000
 v_mov_b32 v9, 0x0
 v_mov_b32 v10, 0x0
 v_mov_b32 v11, 0x0
 s_mov_b32 s31, 81829888
 v_cmp_eq_u32 vcc, 0, v0
 s_and_b64 exec, exec, vcc
 buffer_store_dwordx4 v[8:11], v44, s[16:19], s31 offen sc1
 s_mov_b64 exec, -1
mk_in_nz:
 s_cmp_ge_u32 s2, 8
 s_cbranch_scc1 mk_in_end
 s_lshl_b32 s31, s2, 14
 s_add_u32 s31, s31, 83886080
 v_min_u32 v112, -2, v112
 v_min_u32 v113, -2, v113
 v_min_u32 v114, -2, v114
 v_min_u32 v115, -2, v115
 v_min_u32 v116, -2, v116
 v_min_u32 v117, -2, v117
 v_min_u32 v118, -2, v118
 v_min_u32 v119, -2, v119
 v_min_u32 v120, -2, v120
 v_min_u32 v121, -2, v121
 v_min_u32 v122, -2, v122
 v_min_u32 v123, -2, v123
 v_min_u32 v124, -2, v124
 v_min_u32 v125, -2, v125
 v_min_u32 v126, -2, v126
 v_min_u32 v127, -2, v127
 buffer_store_dwordx4 v[112:115], v44, s[16:19], s31 offen sc1
 s_add_u32 s31, s31, 4096
 buffer_store_dwordx4 v[116:119], v44, s[16:19], s31 offen sc1
 s_add_u32 s31, s31, 4096
 buffer_store_dwordx4 v[120:123], v44, s[16:19], s31 offen sc1
 s_add_u32 s31, s31, 4096
 buffer_store_dwordx4 v[124:127], v44, s[16:19], s31 offen sc1
 s_add_u32 s31, s31, 4096
mk_in_end:
 s_barrier
 v_mov_b32 v20, 0
 ds_read_b32 v17, v20
 s_waitcnt lgkmcnt(0)
 v_readfirstlane_b32 s15, v17
 s_barrier
 s_mov_b32 s38, 1
 s_mul_i32 s34, s12, 16
 s_add_u32 s34, s34, s15
 s_cmp_lt_u32 s12, 8
 s_cselect_b32 s71, 16, 0
 s_cmp_lt_u32 s15, s71
 s_cbranch_scc1 mk_haverole
 s_sub_u32 s80, s15, s71
 s_and_b32 s14, s80, 15
 s_lshl_b32 s56, s12, 4
 s_add_u32 s14, s14, s56
 s_mov_b32 s81, 1
 s_mov_b32 s71, s12
 s_waitcnt vmcnt(0)
 s_barrier
 s_cmp_lg_u32 s13, 0
 s_cbranch_scc1 mk_ws_s2
 s_mov_b64 exec, 1
 s_cmp_ge_u32 s2, 16
 s_cbranch_scc1 mk_ws_e
 v_mov_b32 v16, 164
 v_mov_b32 v17, 1
 buffer_atomic_add v17, v16, s[20:23], 0 offen sc0
 s_waitcnt vmcnt(0)
 v_readfirstlane_b32 s56, v17
 s_cmp_eq_u32 s56, 15
 s_cbranch_scc0 mk_ws_e
 v_mov_b32 v16, 68
 v_mov_b32 v17, 1
 buffer_store_dword v17, v16, s[20:23], 0 offen sc1
 s_nop 1
mk_ws_e:
 v_mov_b32 v16, 160
 v_mov_b32 v17, 1
 v_mov_b32 v18, 64
 v_mov_b32 v19, 1
 buffer_atomic_add v17, v16, s[20:23], 0 offen sc0
 s_waitcnt vmcnt(0)
 v_readfirstlane_b32 s56, v17
 s_cmp_eq_u32 s56, 255
 s_cbranch_scc0 mk_ws_s1
 buffer_store_dword v19, v18, s[20:23], 0 offen sc1
 s_mov_b64 exec, 15
 v_lshlrev_b32 v16, 2, v2
 s_mov_b32 s56, 0xfc000000
 v_writelane_b32 v17, s56, 0
 s_mov_b32 s56, 0xfff
 v_writelane_b32 v17, s56, 1
 s_mov_b32 s56, 0x0
 v_writelane_b32 v17, s56, 2
 s_mov_b32 s56, 0x1b0000
 v_writelane_b32 v17, s56, 3
 s_mov_b32 s56, 81829888
 buffer_atomic_or v17, v16, s[16:19], s56 offen
mk_ws_s1:
 s_mov_b64 exec, -1
mk_ws_s2:
 s_cmp_lg_u32 s13, 0
 s_cbranch_scc1 mk_i5
 v_mov_b32 v16, 68
 s_mov_b32 s48, 1048576
mk_iw2:
 buffer_load_dword v17, v16, s[20:23], 0 offen sc1
 s_sub_u32 s48, s48, 1
 s_cbranch_scc1 mk_end
 s_waitcnt vmcnt(0)
 v_readfirstlane_b32 s56, v17
 s_cmp_lg_u32 s56, 0
 s_cbranch_scc1 mk_iw2_ok
 s_sleep 4
 s_branch mk_iw2
mk_iw2_ok:
mk_i5:
 s_barrier
mk_wentry:
 s_mov_b32 s76, s20
 s_mov_b32 s77, s21
 s_mov_b32 s78, 256
 s_mov_b32 s79, 0x00020000
 s_getpc_b64 s[100:101]
mk_pc0:
 s_add_u32 s100, s100, main_tasks-mk_pc0
 s_addc_u32 s101, s101, 0
 s_bfe_u32 s88, s14, 0x30004
 s_mul_i32 s99, s14, 512
mk_next:
 s_add_u32 s99, s99, 8
 s_cmp_lg_u32 s13, 0
 s_cbranch_scc1 mk_go2
 s_mov_b32 s29, 1048576
 s_mov_b32 s97, s88
 s_mov_b32 s83, 0
mk_grp:
 s_lshl_b32 s96, s97, 9
 s_add_u32 s96, s96, 81821696
 v_lshlrev_b32 v5, 2, v2
 v_add_u32 v5, 81829888, v5
 s_lshl_b32 s24, s97, 7
 s_add_u32 s24, s24, 96
 s_mov_b64 exec, 0xf00
 v_add_u32 v5, s24, v5
 s_mov_b32 exec_lo, 0xffff0000
 s_mov_b32 exec_hi, 0
 v_lshlrev_b32 v5, 21, v2
 v_add_u32 v5, 0x31dfffc, v5
mk_scan:
 s_mov_b64 exec, -1
 s_cmp_eq_u32 s81, 0
 s_cbranch_scc1 mk_rp_end
 v_lshlrev_b32 v24, 2, v2
 buffer_load_dword v25, v24, s[76:79], 0 offen sc1
 s_waitcnt vmcnt(0)
 s_mov_b32 s24, 0
 v_readlane_b32 s25, v25, 0
 s_add_u32 s24, s24, s25
 v_readlane_b32 s25, v25, 1
 s_add_u32 s24, s24, s25
 v_readlane_b32 s25, v25, 2
 s_add_u32 s24, s24, s25
 v_readlane_b32 s25, v25, 3
 s_add_u32 s24, s24, s25
 v_readlane_b32 s25, v25, 32
 s_add_u32 s24, s24, s25
 v_readlane_b32 s25, v25, 33
 s_add_u32 s24, s24, s25
 v_readlane_b32 s25, v25, 34
 s_add_u32 s24, s24, s25
 v_readlane_b32 s25, v25, 35
 s_add_u32 s24, s24, s25
 s_cmp_lt_u32 s24, 256
 s_cbranch_scc1 mk_rp_end
 s_mov_b32 s81, 0
 s_mov_b32 s25, 0
 s_mov_b32 s26, s80
 v_readlane_b32 s24, v25, 0
 s_max_u32 s27, s24, 16
 s_sub_u32 s27, s27, 16
 s_cmp_gt_u32 s71, 0
 s_cselect_b32 s27, s27, 0
 s_add_u32 s26, s26, s27
 s_min_u32 s24, s24, 16
 s_sub_u32 s24, 16, s24
 s_add_u32 s25, s25, s24
 v_readlane_b32 s24, v25, 1
 s_max_u32 s27, s24, 16
 s_sub_u32 s27, s27, 16
 s_cmp_gt_u32 s71, 1
 s_cselect_b32 s27, s27, 0
 s_add_u32 s26, s26, s27
 s_min_u32 s24, s24, 16
 s_sub_u32 s24, 16, s24
 s_add_u32 s25, s25, s24
 v_readlane_b32 s24, v25, 2
 s_max_u32 s27, s24, 16
 s_sub_u32 s27, s27, 16
 s_cmp_gt_u32 s71, 2
 s_cselect_b32 s27, s27, 0
 s_add_u32 s26, s26, s27
 s_min_u32 s24, s24, 16
 s_sub_u32 s24, 16, s24
 s_add_u32 s25, s25, s24
 v_readlane_b32 s24, v25, 3
 s_max_u32 s27, s24, 16
 s_sub_u32 s27, s27, 16
 s_cmp_gt_u32 s71, 3
 s_cselect_b32 s27, s27, 0
 s_add_u32 s26, s26, s27
 s_min_u32 s24, s24, 16
 s_sub_u32 s24, 16, s24
 s_add_u32 s25, s25, s24
 v_readlane_b32 s24, v25, 32
 s_max_u32 s27, s24, 16
 s_sub_u32 s27, s27, 16
 s_cmp_gt_u32 s71, 4
 s_cselect_b32 s27, s27, 0
 s_add_u32 s26, s26, s27
 s_min_u32 s24, s24, 16
 s_sub_u32 s24, 16, s24
 s_add_u32 s25, s25, s24
 v_readlane_b32 s24, v25, 33
 s_max_u32 s27, s24, 16
 s_sub_u32 s27, s27, 16
 s_cmp_gt_u32 s71, 5
 s_cselect_b32 s27, s27, 0
 s_add_u32 s26, s26, s27
 s_min_u32 s24, s24, 16
 s_sub_u32 s24, 16, s24
 s_add_u32 s25, s25, s24
 v_readlane_b32 s24, v25, 34
 s_max_u32 s27, s24, 16
 s_sub_u32 s27, s27, 16
 s_cmp_gt_u32 s71, 6
 s_cselect_b32 s27, s27, 0
 s_add_u32 s26, s26, s27
 s_min_u32 s24, s24, 16
 s_sub_u32 s24, 16, s24
 s_add_u32 s25, s25, s24
 v_readlane_b32 s24, v25, 35
 s_max_u32 s27, s24, 16
 s_sub_u32 s27, s27, 16
 s_cmp_gt_u32 s71, 7
 s_cselect_b32 s27, s27, 0
 s_add_u32 s26, s26, s27
 s_min_u32 s24, s24, 16
 s_sub_u32 s24, 16, s24
 s_add_u32 s25, s25, s24
 s_cmp_ge_u32 s26, s25
 s_cbranch_scc1 mk_rp_end
 v_readlane_b32 s24, v25, 0
 s_min_u32 s24, s24, 16
 s_add_u32 s8, s24, s26
 s_add_u32 s8, s8, 0
 s_sub_u32 s24, 16, s24
 s_cmp_lt_u32 s26, s24
 s_cbranch_scc1 mk_rp_take
 s_sub_u32 s26, s26, s24
 v_readlane_b32 s24, v25, 1
 s_min_u32 s24, s24, 16
 s_add_u32 s8, s24, s26
 s_add_u32 s8, s8, 16
 s_sub_u32 s24, 16, s24
 s_cmp_lt_u32 s26, s24
 s_cbranch_scc1 mk_rp_take
 s_sub_u32 s26, s26, s24
 v_readlane_b32 s24, v25, 2
 s_min_u32 s24, s24, 16
 s_add_u32 s8, s24, s26
 s_add_u32 s8, s8, 32
 s_sub_u32 s24, 16, s24
 s_cmp_lt_u32 s26, s24
 s_cbranch_scc1 mk_rp_take
 s_sub_u32 s26, s26, s24
 v_readlane_b32 s24, v25, 3
 s_min_u32 s24, s24, 16
 s_add_u32 s8, s24, s26
 s_add_u32 s8, s8, 48
 s_sub_u32 s24, 16, s24
 s_cmp_lt_u32 s26, s24
 s_cbranch_scc1 mk_rp_take
 s_sub_u32 s26, s26, s24
 v_readlane_b32 s24, v25, 32
 s_min_u32 s24, s24, 16
 s_add_u32 s8, s24, s26
 s_add_u32 s8, s8, 64
 s_sub_u32 s24, 16, s24
 s_cmp_lt_u32 s26, s24
 s_cbranch_scc1 mk_rp_take
 s_sub_u32 s26, s26, s24
 v_readlane_b32 s24, v25, 33
 s_min_u32 s24, s24, 16
 s_add_u32 s8, s24, s26
 s_add_u32 s8, s8, 80
 s_sub_u32 s24, 16, s24
 s_cmp_lt_u32 s26, s24
 s_cbranch_scc1 mk_rp_take
 s_sub_u32 s26, s26, s24
 v_readlane_b32 s24, v25, 34
 s_min_u32 s24, s24, 16
 s_add_u32 s8, s24, s26
 s_add_u32 s8, s8, 96
 s_sub_u32 s24, 16, s24
 s_cmp_lt_u32 s26, s24
 s_cbranch_scc1 mk_rp_take
 s_sub_u32 s26, s26, s24
 v_readlane_b32 s24, v25, 35
 s_min_u32 s24, s24, 16
 s_add_u32 s8, s24, s26
 s_add_u32 s8, s8, 112
 s_sub_u32 s24, 16, s24
 s_cmp_lt_u32 s26, s24
 s_cbranch_scc1 mk_rp_take
 s_sub_u32 s26, s26, s24
 s_branch mk_rp_end
mk_rp_take:
 s_lshl_b32 s8, s8, 16
 s_or_b32 s8, s8, 15
 s_branch mk_bc
mk_rp_end:
 s_mov_b32 exec_lo, 0xffff0f0f
 s_mov_b32 exec_hi, 0
 buffer_load_dword v24, v5, s[16:19], 0 offen sc1
 s_waitcnt vmcnt(0)
 v_cmp_eq_u32 vcc, -1, v24
 s_mov_b64 exec, -1
 v_readlane_b32 s24, v24, 0
 v_readlane_b32 s25, v24, 1
 v_readlane_b32 s26, v24, 2
 v_readlane_b32 s27, v24, 3
 v_readlane_b32 s84, v24, 8
 v_readlane_b32 s85, v24, 9
 v_readlane_b32 s86, v24, 10
 v_readlane_b32 s87, v24, 11
 s_or_b32 s86, s86, 0x0
 s_or_b32 s87, s87, 0xfe000000
 s_and_b32 s28, s24, s84
 s_and_b32 s28, s28, 0xffc000
 s_lshl_b32 s28, s28, 2
 s_andn2_b32 s28, s28, s24
 s_lshr_b32 s30, vcc_lo, 16
 s_andn2_b32 s24, s24, s30
 s_andn2_b32 s28, s28, s84
 s_mov_b32 s35, s28
 s_andn2_b64 s[24:25], s[24:25], s[84:85]
 s_andn2_b64 s[26:27], s[26:27], s[86:87]
mk_pick:
 s_ff1_i32_b64 s30, s[24:25]
 s_cmp_lg_u32 s30, -1
 s_cbranch_scc0 mk_pick2
 s_bitset0_b64 s[24:25], s30
 s_branch mk_claim
mk_pick2:
 s_ff1_i32_b64 s30, s[26:27]
 s_cmp_lg_u32 s30, -1
 s_cbranch_scc0 mk_pick3
 s_bitset0_b64 s[26:27], s30
 s_add_u32 s30, s30, 64
 s_branch mk_claim
mk_pick3:
 s_ff1_i32_b32 s30, s35
 s_cmp_lg_u32 s30, -1
 s_cbranch_scc0 mk_idle
 s_bitset0_b32 s35, s30
mk_claim:
 s_lshl_b32 s31, s30, 3
 s_load_dwordx2 s[8:9], s[100:101], s31
 s_lshl_b32 s31, s30, 2
 v_mov_b32 v30, s31
 v_mov_b32 v31, 1
 s_mov_b64 exec, 1
 buffer_atomic_add v31, v30, s[16:19], s96 offen sc0
 s_waitcnt vmcnt(0) lgkmcnt(0)
 s_mov_b64 exec, -1
 v_readfirstlane_b32 s31, v31
 s_lshr_b32 s32, s8, 25
 s_add_u32 s33, s31, 1
 s_cmp_lt_u32 s33, s32
 s_cbranch_scc1 mk_got
mk_ex3:
 s_cmp_lt_u32 s31, s32
 s_cbranch_scc0 mk_pick
 s_lshr_b32 s33, s30, 5
 s_lshl_b32 s33, s33, 2
 s_lshl_b32 s34, s97, 7
 s_add_u32 s33, s33, s34
 s_add_u32 s33, s33, 81830016
 s_lshl_b32 s34, 1, s30
 v_mov_b32 v30, s33
 v_mov_b32 v31, s34
 s_mov_b64 exec, 1
 buffer_atomic_or v31, v30, s[16:19], 0 offen
 s_mov_b64 exec, -1
mk_got:
 s_bfe_u32 s32, s8, 0x40010
 s_lshl_b32 s32, s32, 4
 s_bfe_u32 s33, s8, 0x30014
 s_lshl_b32 s33, s97, s33
 s_add_u32 s32, s32, s33
 s_bfe_u32 s33, s8, 0x20017
 s_lshl_b32 s33, s31, s33
 s_add_u32 s32, s32, s33
 s_and_b32 s8, s8, 0xffff
 s_lshl_b32 s32, s32, 16
 s_or_b32 s8, s8, s32
 s_cmp_ge_u32 s30, 32
 s_cbranch_scc1 mk_bc
 s_bitcmp1_b32 s28, s30
 s_cbranch_scc0 mk_bc
 s_bitset1_b32 s8, 31
 s_lshl_b32 s32, s30, 24
 s_or_b32 s8, s8, s32
 s_branch mk_bc
mk_idle:
 s_and_b64 s[24:25], s[84:85], s[86:87]
 s_cmp_eq_u64 s[24:25], -1
 s_cbranch_scc0 mk_idle2
 s_add_u32 s83, s83, 1
 s_cmp_ge_u32 s83, 8
 s_cbranch_scc1 mk_quit
mk_rot:
 s_add_u32 s97, s97, 1
 s_and_b32 s97, s97, 7
 s_branch mk_grp
mk_idle2:
 s_mov_b32 s83, 0
 s_sleep 3
 s_sub_u32 s29, s29, 1
 s_cbranch_scc1 mk_quit
 s_and_b32 s24, s29, 63
 s_cmp_eq_u32 s24, 0
 s_cbranch_scc1 mk_rot
 s_branch mk_scan
mk_quit:
 s_mov_b32 s8, 0
mk_bc:
 v_mov_b32 v30, 155648
 v_mov_b32 v28, s8
 v_mov_b32 v29, s9
 ds_write_b64 v30, v[28:29]
 s_waitcnt lgkmcnt(0)
mk_go2:
 s_barrier
 v_mov_b32 v30, 155648
 ds_read_b64 v[28:29], v30
 s_waitcnt lgkmcnt(0)
 v_readfirstlane_b32 s8, v28
 v_readfirstlane_b32 s82, v29
 s_and_b32 s12, s8, 15
 s_cmp_eq_u32 s12, 0
 s_cbranch_scc1 mk_end
 s_bfe_u32 s10, s8, 0x40004
 s_bfe_u32 s98, s8, 0x80008
 s_bfe_u32 s11, s8, 0x80010
 s_cmp_eq_u32 s12, 1
 s_cbranch_scc1 mk_j_kvs
 s_cmp_eq_u32 s12, 2
 s_cbranch_scc1 mk_j_kvl
 s_cmp_eq_u32 s12, 4
 s_cbranch_scc1 mk_j_wo
 s_cmp_eq_u32 s12, 6
 s_cbranch_scc1 mk_j_f1
 s_cmp_eq_u32 s12, 7
 s_cbranch_scc1 mk_j_f2
 s_cmp_eq_u32 s12, 8
 s_cbranch_scc1 mk_j_kvl
 s_cmp_eq_u32 s12, 9
 s_cbranch_scc1 mk_j_at
 s_cmp_eq_u32 s12, 10
 s_cbranch_scc1 mk_j_wos
 s_cmp_eq_u32 s12, 11
 s_cbranch_scc1 mk_j_lnr
 s_cmp_eq_u32 s12, 12
 s_cbranch_scc1 mk_j_f1s
 s_cmp_eq_u32 s12, 13
 s_cbranch_scc1 mk_j_f2s
 s_cmp_eq_u32 s12, 14
 s_cbranch_scc1 mk_j_fin
 s_cmp_eq_u32 s12, 3
 s_cbranch_scc1 mk_j_wo8
 s_cmp_eq_u32 s12, 5
 s_cbranch_scc1 mk_j_f28
 s_cmp_eq_u32 s12, 15
 s_cbranch_scc1 mk_j_rep
 s_branch mk_end
mk_j_rep:
 s_mov_b32 s34, s11
 s_mov_b32 s38, 0
 s_mov_b32 s20, s76
 s_mov_b32 s21, s77
 s_mov_b32 s22, 256
 s_mov_b32 s23, 0x00020000
 s_barrier
 s_branch mk_haverole
mk_j_kvs:
 s_branch mk_b_kvs
mk_j_kvl:
 s_branch mk_b_kvl
mk_j_wo:
 s_branch mk_b_wo
mk_j_f1:
 s_branch mk_b_f1
mk_j_f2:
 s_branch mk_b_f2
mk_j_at:
 s_branch mk_b_at
mk_j_wos:
 s_branch mk_b_wos
mk_j_lnr:
 s_branch mk_b_lnr
mk_j_f1s:
 s_branch mk_b_f1s
mk_j_f2s:
 s_branch mk_b_f2s
mk_j_fin:
 s_branch mk_b_fin
mk_j_wo8:
 s_branch mk_b_wo8
mk_j_f28:
 s_branch mk_b_f28
mk_skip:
 s_barrier
 s_branch mk_next
mk_done:
 s_waitcnt vmcnt(0)
 s_barrier
 s_cmp_lg_u32 s13, 1
 s_cbranch_scc1 mk_next
 s_lshl_b32 s24, s98, 7
 s_add_u32 s24, s24, 81788928
 v_mov_b32 v4, 0
 v_mov_b32 v5, 1
 s_mov_b64 exec, 1
 buffer_atomic_add v5, v4, s[16:19], s24 offen sc0
 s_and_b32 s25, s82, 255
 s_bfe_u32 s26, s82, 0x70008
 s_bfe_u32 s27, s82, 0x20010
 s_lshr_b32 s28, s26, 5
 s_lshl_b32 s28, s28, 2
 s_and_b32 s26, s26, 31
 s_lshl_b32 s27, s27, s26
 v_mov_b32 v6, s28
 v_mov_b32 v7, s27
 s_mov_b32 s28, 81829888
 s_waitcnt vmcnt(0)
 v_readfirstlane_b32 s26, v5
 s_add_u32 s26, s26, 1
 s_cmp_eq_u32 s26, s25
 s_cbranch_scc0 mk_nosucc
 buffer_atomic_or v7, v6, s[16:19], s28 offen
mk_nosucc:
 s_mov_b64 exec, -1
 s_branch mk_next
mk_b_wo:
 s_load_dwordx2 s[4:5], s[0:1], 40
 s_mov_b32 s48, 8192
 s_mov_b32 s50, 138412032
 s_mov_b32 s51, 8388608
 s_mul_i32 s24, s10, 1048576
 s_add_u32 s24, s24, 37748736
 s_and_b32 s12, s11, 7
 s_bfe_u32 s29, s11, 0x20003
 s_lshr_b32 s26, s11, 5
 s_lshr_b32 s27, 4096, s26
 s_lshr_b32 s49, s27, 8
 s_sub_u32 s49, s49, 1
 s_mul_i32 s27, s27, s29
 s_lshl_b32 s26, s27, 1
 s_add_u32 s24, s24, s26
 s_lshl_b32 s25, s27, 11
 s_mul_i32 s26, s12, 256
 s_add_u32 s25, s25, s26
 s_branch mk_b_g128
mk_b_f2:
 s_load_dwordx2 s[4:5], s[0:1], 72
 s_mov_b32 s48, 7168
 s_mov_b32 s50, 176160768
 s_mov_b32 s51, 7340032
 s_mul_i32 s24, s10, 917504
 s_add_u32 s24, s24, 62914560
 s_and_b32 s12, s11, 7
 s_bfe_u32 s29, s11, 0x20003
 s_lshr_b32 s26, s11, 5
 s_lshr_b32 s27, 3584, s26
 s_lshr_b32 s49, s27, 8
 s_sub_u32 s49, s49, 1
 s_mul_i32 s27, s27, s29
 s_lshl_b32 s26, s27, 1
 s_add_u32 s24, s24, s26
 s_lshl_b32 s25, s27, 11
 s_mul_i32 s26, s12, 256
 s_add_u32 s25, s25, s26
 s_branch mk_b_g128
mk_b_wos:
 s_load_dwordx2 s[4:5], s[0:1], 40
 s_mov_b32 s48, 8192
 s_mov_b32 s50, 138412032
 s_mov_b32 s51, 8388608
 s_mul_i32 s24, s10, 1048576
 s_add_u32 s24, s24, 37748736
 s_lshr_b32 s12, s11, 3
 s_lshl_b32 s12, s12, 1
 s_and_b32 s26, s11, 1
 s_add_u32 s12, s12, s26
 s_bfe_u32 s29, s11, 0x20001
 s_lshl_b32 s27, s29, 10
 s_mov_b32 s49, 3
 s_lshl_b32 s26, s27, 1
 s_add_u32 s24, s24, s26
 s_lshl_b32 s25, s27, 11
 s_mul_i32 s26, s12, 128
 s_add_u32 s25, s25, s26
 s_branch mk_b_g64
mk_b_f2s:
 s_load_dwordx2 s[4:5], s[0:1], 72
 s_mov_b32 s48, 7168
 s_mov_b32 s50, 176160768
 s_mov_b32 s51, 7340032
 s_mul_i32 s24, s10, 917504
 s_add_u32 s24, s24, 62914560
 s_lshr_b32 s12, s11, 3
 s_lshl_b32 s12, s12, 1
 s_and_b32 s26, s11, 1
 s_add_u32 s12, s12, s26
 s_bfe_u32 s29, s11, 0x20001
 s_lshl_b32 s27, s29, 10
 s_mov_b32 s49, 3
 s_cmp_eq_u32 s29, 3
 s_cselect_b32 s49, 1, s49
 s_lshl_b32 s26, s27, 1
 s_add_u32 s24, s24, s26
 s_lshl_b32 s25, s27, 11
 s_mul_i32 s26, s12, 128
 s_add_u32 s25, s25, s26
 s_branch mk_b_g64
mk_b_wo8:
 s_load_dwordx2 s[4:5], s[0:1], 40
 s_mov_b32 s48, 8192
 s_mov_b32 s50, 138412032
 s_mov_b32 s51, 8388608
 s_mul_i32 s24, s10, 1048576
 s_add_u32 s24, s24, 37748736
 s_lshr_b32 s12, s11, 4
 s_lshl_b32 s12, s12, 1
 s_and_b32 s26, s11, 1
 s_add_u32 s12, s12, s26
 s_bfe_u32 s29, s11, 0x30001
 s_lshl_b32 s27, s29, 9
 s_mov_b32 s49, 1
 s_lshl_b32 s26, s27, 1
 s_add_u32 s24, s24, s26
 s_lshl_b32 s25, s27, 11
 s_mul_i32 s26, s12, 128
 s_add_u32 s25, s25, s26
 s_branch mk_b_g64
mk_b_f28:
 s_load_dwordx2 s[4:5], s[0:1], 72
 s_mov_b32 s48, 7168
 s_mov_b32 s50, 176160768
 s_mov_b32 s51, 7340032
 s_mul_i32 s24, s10, 917504
 s_add_u32 s24, s24, 62914560
 s_lshr_b32 s12, s11, 4
 s_lshl_b32 s12, s12, 1
 s_and_b32 s26, s11, 1
 s_add_u32 s12, s12, s26
 s_bfe_u32 s29, s11, 0x30001
 s_lshl_b32 s27, s29, 9
 s_mov_b32 s49, 1
 s_lshl_b32 s26, s27, 1
 s_add_u32 s24, s24, s26
 s_lshl_b32 s25, s27, 11
 s_mul_i32 s26, s12, 128
 s_add_u32 s25, s25, s26
 s_branch mk_b_g64
mk_b_lnr:
 s_bitcmp1_b32 s82, 24
 s_cbranch_scc1 mk_b_lnr4
 s_load_dwordx2 s[6:7], s[0:1], 0
 v_lshlrev_b32 v3, 4, v2
 v_lshlrev_b32 v1, 5, v2
 s_and_b32 s26, s11, 31
 s_lshr_b32 s35, s11, 5
 s_lshl_b32 s26, s26, 2
 s_add_u32 s26, s26, s13
 s_lshl_b32 s27, s10, 9
 s_add_u32 s27, s27, s26
 s_lshl_b32 s27, s27, 12
 s_add_u32 s27, s27, 138412032
 s_lshl_b32 s32, s10, 7
 s_add_u32 s32, s32, s26
 s_lshl_b32 s32, s32, 11
 s_add_u32 s33, s32, 54525952
 s_add_u32 s34, s32, 58720256
 s_waitcnt lgkmcnt(0)
 s_mov_b32 s28, s6
 s_and_b32 s29, s7, 0xffff
 s_mov_b32 s30, 0x400000
 s_mov_b32 s31, 0x00020000
 v_mov_b32 v48, 0
 v_mov_b32 v49, 0
 v_mov_b32 v50, 0
 v_mov_b32 v51, 0
 v_mov_b32 v52, 0
 v_mov_b32 v53, 0
 v_mov_b32 v54, 0
 v_mov_b32 v55, 0
 v_mov_b32 v56, 0
 v_mov_b32 v57, 0
 v_mov_b32 v58, 0
 v_mov_b32 v59, 0
 v_mov_b32 v60, 0
 v_mov_b32 v61, 0
 v_mov_b32 v62, 0
 v_mov_b32 v63, 0
 v_mov_b32 v64, 0
 v_mov_b32 v65, 0
 v_mov_b32 v66, 0
 v_mov_b32 v67, 0
 v_mov_b32 v68, 0
 v_mov_b32 v69, 0
 v_mov_b32 v70, 0
 v_mov_b32 v71, 0
 v_mov_b32 v72, 0
 v_mov_b32 v73, 0
 v_mov_b32 v74, 0
 v_mov_b32 v75, 0
 v_mov_b32 v76, 0
 v_mov_b32 v77, 0
 v_mov_b32 v78, 0
 v_mov_b32 v79, 0
 v_mov_b32 v80, 0
 v_mov_b32 v81, 0
 v_mov_b32 v82, 0
 v_mov_b32 v83, 0
 v_mov_b32 v84, 0
 v_mov_b32 v85, 0
 v_mov_b32 v86, 0
 v_mov_b32 v87, 0
 v_mov_b32 v88, 0
 v_mov_b32 v89, 0
 v_mov_b32 v90, 0
 v_mov_b32 v91, 0
 v_mov_b32 v92, 0
 v_mov_b32 v93, 0
 v_mov_b32 v94, 0
 v_mov_b32 v95, 0
 v_mov_b32 v96, 0
 v_mov_b32 v97, 0
 v_mov_b32 v98, 0
 v_mov_b32 v99, 0
 v_mov_b32 v100, 0
 v_mov_b32 v101, 0
 v_mov_b32 v102, 0
 v_mov_b32 v103, 0
 v_mov_b32 v104, 0
 v_mov_b32 v105, 0
 v_mov_b32 v106, 0
 v_mov_b32 v107, 0
 v_mov_b32 v108, 0
 v_mov_b32 v109, 0
 v_mov_b32 v110, 0
 v_mov_b32 v111, 0
 v_mov_b32 v112, 0
 v_mov_b32 v113, 0
 v_mov_b32 v114, 0
 v_mov_b32 v115, 0
 v_mov_b32 v116, 0
 v_mov_b32 v117, 0
 v_mov_b32 v118, 0
 v_mov_b32 v119, 0
 v_mov_b32 v120, 0
 v_mov_b32 v121, 0
 v_mov_b32 v122, 0
 v_mov_b32 v123, 0
 v_mov_b32 v124, 0
 v_mov_b32 v125, 0
 v_mov_b32 v126, 0
 v_mov_b32 v127, 0
 v_mov_b32 v128, 0
 v_mov_b32 v129, 0
 v_mov_b32 v130, 0
 v_mov_b32 v131, 0
 v_mov_b32 v132, 0
 v_mov_b32 v133, 0
 v_mov_b32 v134, 0
 v_mov_b32 v135, 0
 v_mov_b32 v136, 0
 v_mov_b32 v137, 0
 v_mov_b32 v138, 0
 v_mov_b32 v139, 0
 v_mov_b32 v140, 0
 v_mov_b32 v141, 0
 v_mov_b32 v142, 0
 v_mov_b32 v143, 0
 v_mov_b32 v144, 0
 v_mov_b32 v145, 0
 v_mov_b32 v146, 0
 v_mov_b32 v147, 0
 v_mov_b32 v148, 0
 v_mov_b32 v149, 0
 v_mov_b32 v150, 0
 v_mov_b32 v151, 0
 v_mov_b32 v152, 0
 v_mov_b32 v153, 0
 v_mov_b32 v154, 0
 v_mov_b32 v155, 0
 v_mov_b32 v156, 0
 v_mov_b32 v157, 0
 v_mov_b32 v158, 0
 v_mov_b32 v159, 0
 s_bitcmp1_b32 s8, 31
 s_cbranch_scc0 mk_lnr_dw2
 s_cmp_lg_u32 s13, 0
 s_cbranch_scc1 mk_lnr_dw1
 s_mov_b32 s52, 81829888
 s_bfe_u32 s53, s8, 0x50018
 s_mov_b32 s54, 1048576
 v_mov_b32 v1, 0
mk_lnr_dw0:
 buffer_load_dword v3, v1, s[16:19], s52 offen sc1
 s_sub_u32 s54, s54, 1
 s_cbranch_scc1 mk_end
 s_waitcnt vmcnt(0)
 v_readfirstlane_b32 s55, v3
 s_bitcmp1_b32 s55, s53
 s_cbranch_scc1 mk_lnr_dw1
 s_sleep 2
 s_branch mk_lnr_dw0
mk_lnr_dw1:
 s_barrier
mk_lnr_dw2:
 v_lshlrev_b32 v3, 4, v2
 v_lshlrev_b32 v1, 5, v2
 buffer_load_dwordx4 v[32:35], v1, s[16:19], s27 offen offset:0 sc1
 buffer_load_dwordx4 v[36:39], v1, s[16:19], s27 offen offset:16 sc1
 buffer_load_dwordx4 v[40:43], v1, s[16:19], s27 offen offset:2048 sc1
 buffer_load_dwordx4 v[44:47], v1, s[16:19], s27 offen offset:2064 sc1
 s_add_u32 s27, s27, 524288
 s_cmp_lt_u32 s35, 1
 s_cbranch_scc1 mk_lnr_np
 buffer_load_dwordx4 v[48:51], v1, s[16:19], s27 offen offset:0 sc1
 buffer_load_dwordx4 v[52:55], v1, s[16:19], s27 offen offset:16 sc1
 buffer_load_dwordx4 v[56:59], v1, s[16:19], s27 offen offset:2048 sc1
 buffer_load_dwordx4 v[60:63], v1, s[16:19], s27 offen offset:2064 sc1
 s_add_u32 s27, s27, 524288
 s_cmp_lt_u32 s35, 2
 s_cbranch_scc1 mk_lnr_np
 buffer_load_dwordx4 v[64:67], v1, s[16:19], s27 offen offset:0 sc1
 buffer_load_dwordx4 v[68:71], v1, s[16:19], s27 offen offset:16 sc1
 buffer_load_dwordx4 v[72:75], v1, s[16:19], s27 offen offset:2048 sc1
 buffer_load_dwordx4 v[76:79], v1, s[16:19], s27 offen offset:2064 sc1
 s_add_u32 s27, s27, 524288
 s_cmp_lt_u32 s35, 3
 s_cbranch_scc1 mk_lnr_np
 buffer_load_dwordx4 v[80:83], v1, s[16:19], s27 offen offset:0 sc1
 buffer_load_dwordx4 v[84:87], v1, s[16:19], s27 offen offset:16 sc1
 buffer_load_dwordx4 v[88:91], v1, s[16:19], s27 offen offset:2048 sc1
 buffer_load_dwordx4 v[92:95], v1, s[16:19], s27 offen offset:2064 sc1
 s_add_u32 s27, s27, 524288
 s_cmp_lt_u32 s35, 4
 s_cbranch_scc1 mk_lnr_np
 buffer_load_dwordx4 v[96:99], v1, s[16:19], s27 offen offset:0 sc1
 buffer_load_dwordx4 v[100:103], v1, s[16:19], s27 offen offset:16 sc1
 buffer_load_dwordx4 v[104:107], v1, s[16:19], s27 offen offset:2048 sc1
 buffer_load_dwordx4 v[108:111], v1, s[16:19], s27 offen offset:2064 sc1
 s_add_u32 s27, s27, 524288
 s_cmp_lt_u32 s35, 5
 s_cbranch_scc1 mk_lnr_np
 buffer_load_dwordx4 v[112:115], v1, s[16:19], s27 offen offset:0 sc1
 buffer_load_dwordx4 v[116:119], v1, s[16:19], s27 offen offset:16 sc1
 buffer_load_dwordx4 v[120:123], v1, s[16:19], s27 offen offset:2048 sc1
 buffer_load_dwordx4 v[124:127], v1, s[16:19], s27 offen offset:2064 sc1
 s_add_u32 s27, s27, 524288
 s_cmp_lt_u32 s35, 6
 s_cbranch_scc1 mk_lnr_np
 buffer_load_dwordx4 v[128:131], v1, s[16:19], s27 offen offset:0 sc1
 buffer_load_dwordx4 v[132:135], v1, s[16:19], s27 offen offset:16 sc1
 buffer_load_dwordx4 v[136:139], v1, s[16:19], s27 offen offset:2048 sc1
 buffer_load_dwordx4 v[140:143], v1, s[16:19], s27 offen offset:2064 sc1
 s_add_u32 s27, s27, 524288
 s_cmp_lt_u32 s35, 7
 s_cbranch_scc1 mk_lnr_np
 buffer_load_dwordx4 v[144:147], v1, s[16:19], s27 offen offset:0 sc1
 buffer_load_dwordx4 v[148:151], v1, s[16:19], s27 offen offset:16 sc1
 buffer_load_dwordx4 v[152:155], v1, s[16:19], s27 offen offset:2048 sc1
 buffer_load_dwordx4 v[156:159], v1, s[16:19], s27 offen offset:2064 sc1
 s_add_u32 s27, s27, 524288
mk_lnr_np:
 buffer_load_dwordx4 v[8:11], v3, s[28:31], s32 offen
 buffer_load_dwordx4 v[12:15], v3, s[28:31], s32 offen offset:1024
 s_waitcnt vmcnt(0)
 s_cmp_lt_u32 s35, 4
 s_cbranch_scc1 mk_lnr_h4
 v_pk_add_f32 v[32:33], v[32:33], v[96:97]
 v_pk_add_f32 v[34:35], v[34:35], v[98:99]
 v_pk_add_f32 v[36:37], v[36:37], v[100:101]
 v_pk_add_f32 v[38:39], v[38:39], v[102:103]
 v_pk_add_f32 v[40:41], v[40:41], v[104:105]
 v_pk_add_f32 v[42:43], v[42:43], v[106:107]
 v_pk_add_f32 v[44:45], v[44:45], v[108:109]
 v_pk_add_f32 v[46:47], v[46:47], v[110:111]
 v_pk_add_f32 v[48:49], v[48:49], v[112:113]
 v_pk_add_f32 v[50:51], v[50:51], v[114:115]
 v_pk_add_f32 v[52:53], v[52:53], v[116:117]
 v_pk_add_f32 v[54:55], v[54:55], v[118:119]
 v_pk_add_f32 v[56:57], v[56:57], v[120:121]
 v_pk_add_f32 v[58:59], v[58:59], v[122:123]
 v_pk_add_f32 v[60:61], v[60:61], v[124:125]
 v_pk_add_f32 v[62:63], v[62:63], v[126:127]
 v_pk_add_f32 v[64:65], v[64:65], v[128:129]
 v_pk_add_f32 v[66:67], v[66:67], v[130:131]
 v_pk_add_f32 v[68:69], v[68:69], v[132:133]
 v_pk_add_f32 v[70:71], v[70:71], v[134:135]
 v_pk_add_f32 v[72:73], v[72:73], v[136:137]
 v_pk_add_f32 v[74:75], v[74:75], v[138:139]
 v_pk_add_f32 v[76:77], v[76:77], v[140:141]
 v_pk_add_f32 v[78:79], v[78:79], v[142:143]
 v_pk_add_f32 v[80:81], v[80:81], v[144:145]
 v_pk_add_f32 v[82:83], v[82:83], v[146:147]
 v_pk_add_f32 v[84:85], v[84:85], v[148:149]
 v_pk_add_f32 v[86:87], v[86:87], v[150:151]
 v_pk_add_f32 v[88:89], v[88:89], v[152:153]
 v_pk_add_f32 v[90:91], v[90:91], v[154:155]
 v_pk_add_f32 v[92:93], v[92:93], v[156:157]
 v_pk_add_f32 v[94:95], v[94:95], v[158:159]
mk_lnr_h4:
 v_pk_add_f32 v[32:33], v[32:33], v[64:65]
 v_pk_add_f32 v[34:35], v[34:35], v[66:67]
 v_pk_add_f32 v[36:37], v[36:37], v[68:69]
 v_pk_add_f32 v[38:39], v[38:39], v[70:71]
 v_pk_add_f32 v[40:41], v[40:41], v[72:73]
 v_pk_add_f32 v[42:43], v[42:43], v[74:75]
 v_pk_add_f32 v[44:45], v[44:45], v[76:77]
 v_pk_add_f32 v[46:47], v[46:47], v[78:79]
 v_pk_add_f32 v[48:49], v[48:49], v[80:81]
 v_pk_add_f32 v[50:51], v[50:51], v[82:83]
 v_pk_add_f32 v[52:53], v[52:53], v[84:85]
 v_pk_add_f32 v[54:55], v[54:55], v[86:87]
 v_pk_add_f32 v[56:57], v[56:57], v[88:89]
 v_pk_add_f32 v[58:59], v[58:59], v[90:91]
 v_pk_add_f32 v[60:61], v[60:61], v[92:93]
 v_pk_add_f32 v[62:63], v[62:63], v[94:95]
 v_pk_add_f32 v[32:33], v[32:33], v[48:49]
 v_pk_add_f32 v[34:35], v[34:35], v[50:51]
 v_pk_add_f32 v[36:37], v[36:37], v[52:53]
 v_pk_add_f32 v[38:39], v[38:39], v[54:55]
 v_pk_add_f32 v[40:41], v[40:41], v[56:57]
 v_pk_add_f32 v[42:43], v[42:43], v[58:59]
 v_pk_add_f32 v[44:45], v[44:45], v[60:61]
 v_pk_add_f32 v[46:47], v[46:47], v[62:63]
 CV 4,32,33
 v_lshlrev_b32 v5, 16, v4
 v_and_b32 v4, 0xffff0000, v4
 v_lshlrev_b32 v6, 16, v8
 v_and_b32 v7, 0xffff0000, v8
 v_add_f32 v5, v5, v6
 v_add_f32 v4, v4, v7
 CV 96,5,4
 v_lshlrev_b32 v16, 16, v96
 v_and_b32 v17, 0xffff0000, v96
 CV 4,34,35
 v_lshlrev_b32 v5, 16, v4
 v_and_b32 v4, 0xffff0000, v4
 v_lshlrev_b32 v6, 16, v9
 v_and_b32 v7, 0xffff0000, v9
 v_add_f32 v5, v5, v6
 v_add_f32 v4, v4, v7
 CV 97,5,4
 v_lshlrev_b32 v18, 16, v97
 v_and_b32 v19, 0xffff0000, v97
 CV 4,36,37
 v_lshlrev_b32 v5, 16, v4
 v_and_b32 v4, 0xffff0000, v4
 v_lshlrev_b32 v6, 16, v10
 v_and_b32 v7, 0xffff0000, v10
 v_add_f32 v5, v5, v6
 v_add_f32 v4, v4, v7
 CV 98,5,4
 v_lshlrev_b32 v20, 16, v98
 v_and_b32 v21, 0xffff0000, v98
 CV 4,38,39
 v_lshlrev_b32 v5, 16, v4
 v_and_b32 v4, 0xffff0000, v4
 v_lshlrev_b32 v6, 16, v11
 v_and_b32 v7, 0xffff0000, v11
 v_add_f32 v5, v5, v6
 v_add_f32 v4, v4, v7
 CV 99,5,4
 v_lshlrev_b32 v22, 16, v99
 v_and_b32 v23, 0xffff0000, v99
 CV 4,40,41
 v_lshlrev_b32 v5, 16, v4
 v_and_b32 v4, 0xffff0000, v4
 v_lshlrev_b32 v6, 16, v12
 v_and_b32 v7, 0xffff0000, v12
 v_add_f32 v5, v5, v6
 v_add_f32 v4, v4, v7
 CV 100,5,4
 v_lshlrev_b32 v24, 16, v100
 v_and_b32 v25, 0xffff0000, v100
 CV 4,42,43
 v_lshlrev_b32 v5, 16, v4
 v_and_b32 v4, 0xffff0000, v4
 v_lshlrev_b32 v6, 16, v13
 v_and_b32 v7, 0xffff0000, v13
 v_add_f32 v5, v5, v6
 v_add_f32 v4, v4, v7
 CV 101,5,4
 v_lshlrev_b32 v26, 16, v101
 v_and_b32 v27, 0xffff0000, v101
 CV 4,44,45
 v_lshlrev_b32 v5, 16, v4
 v_and_b32 v4, 0xffff0000, v4
 v_lshlrev_b32 v6, 16, v14
 v_and_b32 v7, 0xffff0000, v14
 v_add_f32 v5, v5, v6
 v_add_f32 v4, v4, v7
 CV 102,5,4
 v_lshlrev_b32 v28, 16, v102
 v_and_b32 v29, 0xffff0000, v102
 CV 4,46,47
 v_lshlrev_b32 v5, 16, v4
 v_and_b32 v4, 0xffff0000, v4
 v_lshlrev_b32 v6, 16, v15
 v_and_b32 v7, 0xffff0000, v15
 v_add_f32 v5, v5, v6
 v_add_f32 v4, v4, v7
 CV 103,5,4
 v_lshlrev_b32 v30, 16, v103
 v_and_b32 v31, 0xffff0000, v103
 buffer_store_dwordx4 v[96:99], v3, s[16:19], s33 offen sc1
 buffer_store_dwordx4 v[100:103], v3, s[16:19], s33 offen offset:1024 sc1
 v_add_f32 v4, v16, v17
 v_add_f32 v4, v4, v18
 v_add_f32 v4, v4, v19
 v_add_f32 v4, v4, v20
 v_add_f32 v4, v4, v21
 v_add_f32 v4, v4, v22
 v_add_f32 v4, v4, v23
 v_add_f32 v4, v4, v24
 v_add_f32 v4, v4, v25
 v_add_f32 v4, v4, v26
 v_add_f32 v4, v4, v27
 v_add_f32 v4, v4, v28
 v_add_f32 v4, v4, v29
 v_add_f32 v4, v4, v30
 v_add_f32 v4, v4, v31
 s_nop 1
 v_add_f32_dpp v4, v4, v4 quad_perm:[1,0,3,2] row_mask:0xf bank_mask:0xf
 s_nop 1
 v_add_f32_dpp v4, v4, v4 quad_perm:[2,3,0,1] row_mask:0xf bank_mask:0xf
 s_nop 1
 v_add_f32_dpp v4, v4, v4 row_half_mirror row_mask:0xf bank_mask:0xf
 s_nop 1
 v_add_f32_dpp v4, v4, v4 row_mirror row_mask:0xf bank_mask:0xf
 v_mov_b32 v5, v4
 s_nop 1
 v_permlane16_swap_b32 v4, v5
 v_add_f32 v4, v4, v5
 v_mov_b32 v5, v4
 s_nop 1
 v_permlane32_swap_b32 v4, v5
 v_add_f32 v4, v4, v5
 v_mul_f32 v6, 0x3a800000, v4
 v_sub_f32 v5, v16, v6
 v_mul_f32 v4, v5, v5
 v_sub_f32 v5, v17, v6
 v_fmac_f32 v4, v5, v5
 v_sub_f32 v5, v18, v6
 v_fmac_f32 v4, v5, v5
 v_sub_f32 v5, v19, v6
 v_fmac_f32 v4, v5, v5
 v_sub_f32 v5, v20, v6
 v_fmac_f32 v4, v5, v5
 v_sub_f32 v5, v21, v6
 v_fmac_f32 v4, v5, v5
 v_sub_f32 v5, v22, v6
 v_fmac_f32 v4, v5, v5
 v_sub_f32 v5, v23, v6
 v_fmac_f32 v4, v5, v5
 v_sub_f32 v5, v24, v6
 v_fmac_f32 v4, v5, v5
 v_sub_f32 v5, v25, v6
 v_fmac_f32 v4, v5, v5
 v_sub_f32 v5, v26, v6
 v_fmac_f32 v4, v5, v5
 v_sub_f32 v5, v27, v6
 v_fmac_f32 v4, v5, v5
 v_sub_f32 v5, v28, v6
 v_fmac_f32 v4, v5, v5
 v_sub_f32 v5, v29, v6
 v_fmac_f32 v4, v5, v5
 v_sub_f32 v5, v30, v6
 v_fmac_f32 v4, v5, v5
 v_sub_f32 v5, v31, v6
 v_fmac_f32 v4, v5, v5
 s_nop 1
 v_add_f32_dpp v4, v4, v4 quad_perm:[1,0,3,2] row_mask:0xf bank_mask:0xf
 s_nop 1
 v_add_f32_dpp v4, v4, v4 quad_perm:[2,3,0,1] row_mask:0xf bank_mask:0xf
 s_nop 1
 v_add_f32_dpp v4, v4, v4 row_half_mirror row_mask:0xf bank_mask:0xf
 s_nop 1
 v_add_f32_dpp v4, v4, v4 row_mirror row_mask:0xf bank_mask:0xf
 v_mov_b32 v5, v4
 s_nop 1
 v_permlane16_swap_b32 v4, v5
 v_add_f32 v4, v4, v5
 v_mov_b32 v5, v4
 s_nop 1
 v_permlane32_swap_b32 v4, v5
 v_add_f32 v4, v4, v5
 v_mul_f32 v4, 0x3a800000, v4
 CV 4,4,4
 v_and_b32 v4, 0xffff0000, v4
 CV 6,6,6
 v_and_b32 v6, 0xffff0000, v6
 v_add_f32 v4, 0x3727c5ac, v4
 CV 4,4,4
 v_and_b32 v4, 0xffff0000, v4
 v_sqrt_f32 v4, v4
 s_nop 0
 CV 4,4,4
 v_and_b32 v4, 0xffff0000, v4
 v_rcp_f32 v7, v4
 v_sub_f32 v16, v16, v6
 v_sub_f32 v17, v17, v6
 v_sub_f32 v18, v18, v6
 v_sub_f32 v19, v19, v6
 v_sub_f32 v20, v20, v6
 v_sub_f32 v21, v21, v6
 v_sub_f32 v22, v22, v6
 v_sub_f32 v23, v23, v6
 v_sub_f32 v24, v24, v6
 v_sub_f32 v25, v25, v6
 v_sub_f32 v26, v26, v6
 v_sub_f32 v27, v27, v6
 v_sub_f32 v28, v28, v6
 v_sub_f32 v29, v29, v6
 v_sub_f32 v30, v30, v6
 v_sub_f32 v31, v31, v6
 CV 8,16,17
 v_lshlrev_b32 v16, 16, v8
 v_and_b32 v17, 0xffff0000, v8
 v_mul_f32 v16, v16, v7
 v_mul_f32 v17, v17, v7
 CV 8,16,17
 CV 9,18,19
 v_lshlrev_b32 v18, 16, v9
 v_and_b32 v19, 0xffff0000, v9
 v_mul_f32 v18, v18, v7
 v_mul_f32 v19, v19, v7
 CV 9,18,19
 CV 10,20,21
 v_lshlrev_b32 v20, 16, v10
 v_and_b32 v21, 0xffff0000, v10
 v_mul_f32 v20, v20, v7
 v_mul_f32 v21, v21, v7
 CV 10,20,21
 CV 11,22,23
 v_lshlrev_b32 v22, 16, v11
 v_and_b32 v23, 0xffff0000, v11
 v_mul_f32 v22, v22, v7
 v_mul_f32 v23, v23, v7
 CV 11,22,23
 CV 12,24,25
 v_lshlrev_b32 v24, 16, v12
 v_and_b32 v25, 0xffff0000, v12
 v_mul_f32 v24, v24, v7
 v_mul_f32 v25, v25, v7
 CV 12,24,25
 CV 13,26,27
 v_lshlrev_b32 v26, 16, v13
 v_and_b32 v27, 0xffff0000, v13
 v_mul_f32 v26, v26, v7
 v_mul_f32 v27, v27, v7
 CV 13,26,27
 CV 14,28,29
 v_lshlrev_b32 v28, 16, v14
 v_and_b32 v29, 0xffff0000, v14
 v_mul_f32 v28, v28, v7
 v_mul_f32 v29, v29, v7
 CV 14,28,29
 CV 15,30,31
 v_lshlrev_b32 v30, 16, v15
 v_and_b32 v31, 0xffff0000, v15
 v_mul_f32 v30, v30, v7
 v_mul_f32 v31, v31, v7
 CV 15,30,31
 buffer_store_dwordx4 v[8:11], v3, s[16:19], s34 offen sc1
 buffer_store_dwordx4 v[12:15], v3, s[16:19], s34 offen offset:1024 sc1
 s_branch mk_done
mk_b_fin:
 s_bitcmp1_b32 s82, 24
 s_cbranch_scc1 mk_b_fin4
 s_load_dwordx2 s[6:7], s[0:1], 80
 v_lshlrev_b32 v3, 4, v2
 v_lshlrev_b32 v1, 5, v2
 s_and_b32 s26, s11, 31
 s_lshr_b32 s35, s11, 5
 s_lshl_b32 s26, s26, 2
 s_add_u32 s26, s26, s13
 s_lshl_b32 s27, s10, 9
 s_add_u32 s27, s27, s26
 s_lshl_b32 s27, s27, 12
 s_add_u32 s27, s27, 176160768
 s_lshl_b32 s32, s10, 7
 s_add_u32 s32, s32, s26
 s_lshl_b32 s32, s32, 11
 s_add_u32 s33, s32, 54525952
 s_add_u32 s34, s32, 58720256
 s_waitcnt lgkmcnt(0)
 s_mov_b32 s28, s6
 s_and_b32 s29, s7, 0xffff
 s_mov_b32 s30, 0x400000
 s_mov_b32 s31, 0x00020000
 v_mov_b32 v48, 0
 v_mov_b32 v49, 0
 v_mov_b32 v50, 0
 v_mov_b32 v51, 0
 v_mov_b32 v52, 0
 v_mov_b32 v53, 0
 v_mov_b32 v54, 0
 v_mov_b32 v55, 0
 v_mov_b32 v56, 0
 v_mov_b32 v57, 0
 v_mov_b32 v58, 0
 v_mov_b32 v59, 0
 v_mov_b32 v60, 0
 v_mov_b32 v61, 0
 v_mov_b32 v62, 0
 v_mov_b32 v63, 0
 v_mov_b32 v64, 0
 v_mov_b32 v65, 0
 v_mov_b32 v66, 0
 v_mov_b32 v67, 0
 v_mov_b32 v68, 0
 v_mov_b32 v69, 0
 v_mov_b32 v70, 0
 v_mov_b32 v71, 0
 v_mov_b32 v72, 0
 v_mov_b32 v73, 0
 v_mov_b32 v74, 0
 v_mov_b32 v75, 0
 v_mov_b32 v76, 0
 v_mov_b32 v77, 0
 v_mov_b32 v78, 0
 v_mov_b32 v79, 0
 v_mov_b32 v80, 0
 v_mov_b32 v81, 0
 v_mov_b32 v82, 0
 v_mov_b32 v83, 0
 v_mov_b32 v84, 0
 v_mov_b32 v85, 0
 v_mov_b32 v86, 0
 v_mov_b32 v87, 0
 v_mov_b32 v88, 0
 v_mov_b32 v89, 0
 v_mov_b32 v90, 0
 v_mov_b32 v91, 0
 v_mov_b32 v92, 0
 v_mov_b32 v93, 0
 v_mov_b32 v94, 0
 v_mov_b32 v95, 0
 v_mov_b32 v96, 0
 v_mov_b32 v97, 0
 v_mov_b32 v98, 0
 v_mov_b32 v99, 0
 v_mov_b32 v100, 0
 v_mov_b32 v101, 0
 v_mov_b32 v102, 0
 v_mov_b32 v103, 0
 v_mov_b32 v104, 0
 v_mov_b32 v105, 0
 v_mov_b32 v106, 0
 v_mov_b32 v107, 0
 v_mov_b32 v108, 0
 v_mov_b32 v109, 0
 v_mov_b32 v110, 0
 v_mov_b32 v111, 0
 v_mov_b32 v112, 0
 v_mov_b32 v113, 0
 v_mov_b32 v114, 0
 v_mov_b32 v115, 0
 v_mov_b32 v116, 0
 v_mov_b32 v117, 0
 v_mov_b32 v118, 0
 v_mov_b32 v119, 0
 v_mov_b32 v120, 0
 v_mov_b32 v121, 0
 v_mov_b32 v122, 0
 v_mov_b32 v123, 0
 v_mov_b32 v124, 0
 v_mov_b32 v125, 0
 v_mov_b32 v126, 0
 v_mov_b32 v127, 0
 v_mov_b32 v128, 0
 v_mov_b32 v129, 0
 v_mov_b32 v130, 0
 v_mov_b32 v131, 0
 v_mov_b32 v132, 0
 v_mov_b32 v133, 0
 v_mov_b32 v134, 0
 v_mov_b32 v135, 0
 v_mov_b32 v136, 0
 v_mov_b32 v137, 0
 v_mov_b32 v138, 0
 v_mov_b32 v139, 0
 v_mov_b32 v140, 0
 v_mov_b32 v141, 0
 v_mov_b32 v142, 0
 v_mov_b32 v143, 0
 v_mov_b32 v144, 0
 v_mov_b32 v145, 0
 v_mov_b32 v146, 0
 v_mov_b32 v147, 0
 v_mov_b32 v148, 0
 v_mov_b32 v149, 0
 v_mov_b32 v150, 0
 v_mov_b32 v151, 0
 v_mov_b32 v152, 0
 v_mov_b32 v153, 0
 v_mov_b32 v154, 0
 v_mov_b32 v155, 0
 v_mov_b32 v156, 0
 v_mov_b32 v157, 0
 v_mov_b32 v158, 0
 v_mov_b32 v159, 0
 s_bitcmp1_b32 s8, 31
 s_cbranch_scc0 mk_fin_dw2
 s_cmp_lg_u32 s13, 0
 s_cbranch_scc1 mk_fin_dw1
 s_mov_b32 s52, 81829888
 s_bfe_u32 s53, s8, 0x50018
 s_mov_b32 s54, 1048576
 v_mov_b32 v1, 0
mk_fin_dw0:
 buffer_load_dword v3, v1, s[16:19], s52 offen sc1
 s_sub_u32 s54, s54, 1
 s_cbranch_scc1 mk_end
 s_waitcnt vmcnt(0)
 v_readfirstlane_b32 s55, v3
 s_bitcmp1_b32 s55, s53
 s_cbranch_scc1 mk_fin_dw1
 s_sleep 2
 s_branch mk_fin_dw0
mk_fin_dw1:
 s_barrier
mk_fin_dw2:
 v_lshlrev_b32 v3, 4, v2
 v_lshlrev_b32 v1, 5, v2
 buffer_load_dwordx4 v[32:35], v1, s[16:19], s27 offen offset:0 sc1
 buffer_load_dwordx4 v[36:39], v1, s[16:19], s27 offen offset:16 sc1
 buffer_load_dwordx4 v[40:43], v1, s[16:19], s27 offen offset:2048 sc1
 buffer_load_dwordx4 v[44:47], v1, s[16:19], s27 offen offset:2064 sc1
 s_add_u32 s27, s27, 524288
 s_cmp_lt_u32 s35, 1
 s_cbranch_scc1 mk_fin_np
 buffer_load_dwordx4 v[48:51], v1, s[16:19], s27 offen offset:0 sc1
 buffer_load_dwordx4 v[52:55], v1, s[16:19], s27 offen offset:16 sc1
 buffer_load_dwordx4 v[56:59], v1, s[16:19], s27 offen offset:2048 sc1
 buffer_load_dwordx4 v[60:63], v1, s[16:19], s27 offen offset:2064 sc1
 s_add_u32 s27, s27, 524288
 s_cmp_lt_u32 s35, 2
 s_cbranch_scc1 mk_fin_np
 buffer_load_dwordx4 v[64:67], v1, s[16:19], s27 offen offset:0 sc1
 buffer_load_dwordx4 v[68:71], v1, s[16:19], s27 offen offset:16 sc1
 buffer_load_dwordx4 v[72:75], v1, s[16:19], s27 offen offset:2048 sc1
 buffer_load_dwordx4 v[76:79], v1, s[16:19], s27 offen offset:2064 sc1
 s_add_u32 s27, s27, 524288
 s_cmp_lt_u32 s35, 3
 s_cbranch_scc1 mk_fin_np
 buffer_load_dwordx4 v[80:83], v1, s[16:19], s27 offen offset:0 sc1
 buffer_load_dwordx4 v[84:87], v1, s[16:19], s27 offen offset:16 sc1
 buffer_load_dwordx4 v[88:91], v1, s[16:19], s27 offen offset:2048 sc1
 buffer_load_dwordx4 v[92:95], v1, s[16:19], s27 offen offset:2064 sc1
 s_add_u32 s27, s27, 524288
 s_cmp_lt_u32 s35, 4
 s_cbranch_scc1 mk_fin_np
 buffer_load_dwordx4 v[96:99], v1, s[16:19], s27 offen offset:0 sc1
 buffer_load_dwordx4 v[100:103], v1, s[16:19], s27 offen offset:16 sc1
 buffer_load_dwordx4 v[104:107], v1, s[16:19], s27 offen offset:2048 sc1
 buffer_load_dwordx4 v[108:111], v1, s[16:19], s27 offen offset:2064 sc1
 s_add_u32 s27, s27, 524288
 s_cmp_lt_u32 s35, 5
 s_cbranch_scc1 mk_fin_np
 buffer_load_dwordx4 v[112:115], v1, s[16:19], s27 offen offset:0 sc1
 buffer_load_dwordx4 v[116:119], v1, s[16:19], s27 offen offset:16 sc1
 buffer_load_dwordx4 v[120:123], v1, s[16:19], s27 offen offset:2048 sc1
 buffer_load_dwordx4 v[124:127], v1, s[16:19], s27 offen offset:2064 sc1
 s_add_u32 s27, s27, 524288
 s_cmp_lt_u32 s35, 6
 s_cbranch_scc1 mk_fin_np
 buffer_load_dwordx4 v[128:131], v1, s[16:19], s27 offen offset:0 sc1
 buffer_load_dwordx4 v[132:135], v1, s[16:19], s27 offen offset:16 sc1
 buffer_load_dwordx4 v[136:139], v1, s[16:19], s27 offen offset:2048 sc1
 buffer_load_dwordx4 v[140:143], v1, s[16:19], s27 offen offset:2064 sc1
 s_add_u32 s27, s27, 524288
 s_cmp_lt_u32 s35, 7
 s_cbranch_scc1 mk_fin_np
 buffer_load_dwordx4 v[144:147], v1, s[16:19], s27 offen offset:0 sc1
 buffer_load_dwordx4 v[148:151], v1, s[16:19], s27 offen offset:16 sc1
 buffer_load_dwordx4 v[152:155], v1, s[16:19], s27 offen offset:2048 sc1
 buffer_load_dwordx4 v[156:159], v1, s[16:19], s27 offen offset:2064 sc1
 s_add_u32 s27, s27, 524288
mk_fin_np:
 buffer_load_dwordx4 v[8:11], v3, s[16:19], s33 offen sc1
 buffer_load_dwordx4 v[12:15], v3, s[16:19], s33 offen offset:1024 sc1
 s_waitcnt vmcnt(0)
 s_cmp_lt_u32 s35, 4
 s_cbranch_scc1 mk_fin_h4
 v_pk_add_f32 v[32:33], v[32:33], v[96:97]
 v_pk_add_f32 v[34:35], v[34:35], v[98:99]
 v_pk_add_f32 v[36:37], v[36:37], v[100:101]
 v_pk_add_f32 v[38:39], v[38:39], v[102:103]
 v_pk_add_f32 v[40:41], v[40:41], v[104:105]
 v_pk_add_f32 v[42:43], v[42:43], v[106:107]
 v_pk_add_f32 v[44:45], v[44:45], v[108:109]
 v_pk_add_f32 v[46:47], v[46:47], v[110:111]
 v_pk_add_f32 v[48:49], v[48:49], v[112:113]
 v_pk_add_f32 v[50:51], v[50:51], v[114:115]
 v_pk_add_f32 v[52:53], v[52:53], v[116:117]
 v_pk_add_f32 v[54:55], v[54:55], v[118:119]
 v_pk_add_f32 v[56:57], v[56:57], v[120:121]
 v_pk_add_f32 v[58:59], v[58:59], v[122:123]
 v_pk_add_f32 v[60:61], v[60:61], v[124:125]
 v_pk_add_f32 v[62:63], v[62:63], v[126:127]
 v_pk_add_f32 v[64:65], v[64:65], v[128:129]
 v_pk_add_f32 v[66:67], v[66:67], v[130:131]
 v_pk_add_f32 v[68:69], v[68:69], v[132:133]
 v_pk_add_f32 v[70:71], v[70:71], v[134:135]
 v_pk_add_f32 v[72:73], v[72:73], v[136:137]
 v_pk_add_f32 v[74:75], v[74:75], v[138:139]
 v_pk_add_f32 v[76:77], v[76:77], v[140:141]
 v_pk_add_f32 v[78:79], v[78:79], v[142:143]
 v_pk_add_f32 v[80:81], v[80:81], v[144:145]
 v_pk_add_f32 v[82:83], v[82:83], v[146:147]
 v_pk_add_f32 v[84:85], v[84:85], v[148:149]
 v_pk_add_f32 v[86:87], v[86:87], v[150:151]
 v_pk_add_f32 v[88:89], v[88:89], v[152:153]
 v_pk_add_f32 v[90:91], v[90:91], v[154:155]
 v_pk_add_f32 v[92:93], v[92:93], v[156:157]
 v_pk_add_f32 v[94:95], v[94:95], v[158:159]
mk_fin_h4:
 v_pk_add_f32 v[32:33], v[32:33], v[64:65]
 v_pk_add_f32 v[34:35], v[34:35], v[66:67]
 v_pk_add_f32 v[36:37], v[36:37], v[68:69]
 v_pk_add_f32 v[38:39], v[38:39], v[70:71]
 v_pk_add_f32 v[40:41], v[40:41], v[72:73]
 v_pk_add_f32 v[42:43], v[42:43], v[74:75]
 v_pk_add_f32 v[44:45], v[44:45], v[76:77]
 v_pk_add_f32 v[46:47], v[46:47], v[78:79]
 v_pk_add_f32 v[48:49], v[48:49], v[80:81]
 v_pk_add_f32 v[50:51], v[50:51], v[82:83]
 v_pk_add_f32 v[52:53], v[52:53], v[84:85]
 v_pk_add_f32 v[54:55], v[54:55], v[86:87]
 v_pk_add_f32 v[56:57], v[56:57], v[88:89]
 v_pk_add_f32 v[58:59], v[58:59], v[90:91]
 v_pk_add_f32 v[60:61], v[60:61], v[92:93]
 v_pk_add_f32 v[62:63], v[62:63], v[94:95]
 v_pk_add_f32 v[32:33], v[32:33], v[48:49]
 v_pk_add_f32 v[34:35], v[34:35], v[50:51]
 v_pk_add_f32 v[36:37], v[36:37], v[52:53]
 v_pk_add_f32 v[38:39], v[38:39], v[54:55]
 v_pk_add_f32 v[40:41], v[40:41], v[56:57]
 v_pk_add_f32 v[42:43], v[42:43], v[58:59]
 v_pk_add_f32 v[44:45], v[44:45], v[60:61]
 v_pk_add_f32 v[46:47], v[46:47], v[62:63]
 CV 4,32,33
 v_lshlrev_b32 v5, 16, v4
 v_and_b32 v4, 0xffff0000, v4
 v_lshlrev_b32 v6, 16, v8
 v_and_b32 v7, 0xffff0000, v8
 v_add_f32 v5, v5, v6
 v_add_f32 v4, v4, v7
 CV 96,5,4
 CV 4,34,35
 v_lshlrev_b32 v5, 16, v4
 v_and_b32 v4, 0xffff0000, v4
 v_lshlrev_b32 v6, 16, v9
 v_and_b32 v7, 0xffff0000, v9
 v_add_f32 v5, v5, v6
 v_add_f32 v4, v4, v7
 CV 97,5,4
 CV 4,36,37
 v_lshlrev_b32 v5, 16, v4
 v_and_b32 v4, 0xffff0000, v4
 v_lshlrev_b32 v6, 16, v10
 v_and_b32 v7, 0xffff0000, v10
 v_add_f32 v5, v5, v6
 v_add_f32 v4, v4, v7
 CV 98,5,4
 CV 4,38,39
 v_lshlrev_b32 v5, 16, v4
 v_and_b32 v4, 0xffff0000, v4
 v_lshlrev_b32 v6, 16, v11
 v_and_b32 v7, 0xffff0000, v11
 v_add_f32 v5, v5, v6
 v_add_f32 v4, v4, v7
 CV 99,5,4
 CV 4,40,41
 v_lshlrev_b32 v5, 16, v4
 v_and_b32 v4, 0xffff0000, v4
 v_lshlrev_b32 v6, 16, v12
 v_and_b32 v7, 0xffff0000, v12
 v_add_f32 v5, v5, v6
 v_add_f32 v4, v4, v7
 CV 100,5,4
 CV 4,42,43
 v_lshlrev_b32 v5, 16, v4
 v_and_b32 v4, 0xffff0000, v4
 v_lshlrev_b32 v6, 16, v13
 v_and_b32 v7, 0xffff0000, v13
 v_add_f32 v5, v5, v6
 v_add_f32 v4, v4, v7
 CV 101,5,4
 CV 4,44,45
 v_lshlrev_b32 v5, 16, v4
 v_and_b32 v4, 0xffff0000, v4
 v_lshlrev_b32 v6, 16, v14
 v_and_b32 v7, 0xffff0000, v14
 v_add_f32 v5, v5, v6
 v_add_f32 v4, v4, v7
 CV 102,5,4
 CV 4,46,47
 v_lshlrev_b32 v5, 16, v4
 v_and_b32 v4, 0xffff0000, v4
 v_lshlrev_b32 v6, 16, v15
 v_and_b32 v7, 0xffff0000, v15
 v_add_f32 v5, v5, v6
 v_add_f32 v4, v4, v7
 CV 103,5,4
 buffer_store_dwordx4 v[96:99], v3, s[28:31], s32 offen
 buffer_store_dwordx4 v[100:103], v3, s[28:31], s32 offen offset:1024
 s_branch mk_done
mk_b_at:
 s_bitcmp1_b32 s82, 24
 s_cbranch_scc1 mk_b_at2
 s_mul_i32 s11, s11, 1
 v_lshlrev_b32 v156, 4, v2
 v_add_u32 v157, 0x1000, v156
 s_lshl_b32 s26, s10, 2
 s_add_u32 s26, s26, s13
 s_lshl_b32 s27, s26, 5
 s_add_u32 s27, s27, s11
 s_lshl_b32 s27, s27, 13
 s_add_u32 s28, s27, 4194304
 s_add_u32 s29, s27, 20971520
 s_add_u32 s27, s27, 121634816
 s_lshl_b32 s30, s26, 19
 s_lshl_b32 s31, s11, 13
 s_add_u32 s30, s30, s31
 s_add_u32 s30, s30, 84017152
 s_mov_b32 s34, 0x3e0293ee
 s_mov_b32 s36, 0
 s_mov_b32 s37, -1
 s_mov_b32 s38, -1
 s_mov_b32 s39, 0
 s_mul_i32 s31, s13, 10240
 buffer_load_dwordx4 v[124:127], v156, s[16:19], s27 offen offset:0 sc1
 buffer_load_dwordx4 v[128:131], v156, s[16:19], s27 offen offset:1024 sc1
 buffer_load_dwordx4 v[132:135], v156, s[16:19], s27 offen offset:2048 sc1
 buffer_load_dwordx4 v[136:139], v156, s[16:19], s27 offen offset:3072 sc1
 buffer_load_dwordx4 v[140:143], v157, s[16:19], s27 offen offset:0 sc1
 buffer_load_dwordx4 v[144:147], v157, s[16:19], s27 offen offset:1024 sc1
 buffer_load_dwordx4 v[148:151], v157, s[16:19], s27 offen offset:2048 sc1
 buffer_load_dwordx4 v[152:155], v157, s[16:19], s27 offen offset:3072 sc1
 s_add_u32 s27, s27, 8192
 v_and_b32 v163, 15, v2
 v_lshrrev_b32 v164, 4, v2
 v_lshrrev_b32 v165, 1, v164
 v_lshlrev_b32 v158, 12, v165
 v_and_b32 v165, 3, v163
 v_lshl_add_u32 v158, v165, 8, v158
 v_and_b32 v166, 1, v164
 v_lshl_add_u32 v158, v166, 7, v158
 v_lshrrev_b32 v167, 2, v163
 v_lshl_add_u32 v158, v167, 4, v158
 v_add_u32 v158, s31, v158
 v_lshl_add_u32 v159, v166, 2, v167
 v_lshlrev_b32 v159, 8, v159
 v_lshl_add_u32 v159, v165, 4, v159
 v_add_u32 v159, s31, v159
 v_add_u32 v159, 0x2000, v159
 v_lshlrev_b32 v165, 3, v164
 v_sub_u32 v160, v163, v165
 v_lshlrev_b32 v161, 13, v163
 v_lshl_add_u32 v161, v164, 4, v161
 v_mov_b32 v162, 0xff800000
 s_lshl_b32 s32, s26, 18
 s_lshl_b32 s33, s11, 8
 s_add_u32 s32, s32, s33
 s_add_u32 s32, s32, 37748736
 s_add_u32 s33, s32, 131072
 s_add_u32 s33, s30, 7168
 s_mov_b32 s35, 524288
mk_at_w1:
 buffer_load_dwordx4 v[4:7], v156, s[16:19], s33 offen sc1
 s_sub_u32 s35, s35, 1
 s_cbranch_scc1 mk_end
 s_waitcnt vmcnt(0)
 v_cmp_eq_u32 vcc, -1, v7
 s_cbranch_vccz mk_at_w2
 s_sleep 2
 s_branch mk_at_w1
mk_at_w2:
 s_add_u32 s33, s30, 0
 buffer_load_dwordx4 v[108:111], v156, s[16:19], s33 offen offset:0 sc1
 buffer_load_dwordx4 v[112:115], v156, s[16:19], s33 offen offset:1024 sc1
 buffer_load_dwordx4 v[116:119], v156, s[16:19], s33 offen offset:2048 sc1
 buffer_load_dwordx4 v[120:123], v156, s[16:19], s33 offen offset:3072 sc1
 buffer_load_dwordx4 v[4:7], v157, s[16:19], s33 offen offset:2048 sc1
 buffer_load_dwordx4 v[8:11], v157, s[16:19], s33 offen offset:3072 sc1
 s_sub_u32 s35, s35, 1
 s_cbranch_scc1 mk_end
 s_waitcnt vmcnt(0)
 v_max3_u32 v163, v108, v109, v110
 v_max3_u32 v163, v163, v111, v112
 v_max3_u32 v163, v163, v113, v114
 v_max3_u32 v163, v163, v115, v116
 v_max3_u32 v163, v163, v117, v118
 v_max3_u32 v163, v163, v119, v120
 v_max3_u32 v163, v163, v121, v122
 v_max_u32 v163, v163, v123
 s_mov_b32 exec_lo, 0x00ff00ff
 s_mov_b32 exec_hi, 0x00ff00ff
 v_mov_b32 v163, 0
 s_mov_b64 exec, -1
 v_max3_u32 v163, v163, v4, v5
 v_max3_u32 v163, v163, v6, v7
 v_max3_u32 v163, v163, v8, v9
 v_max3_u32 v163, v163, v10, v11
 v_cmp_eq_u32 vcc, -1, v163
 s_cbranch_vccnz mk_at_w2
 s_add_u32 s32, s28, 0
 buffer_load_dwordx4 v[76:79], v156, s[16:19], s32 offen offset:0 sc1
 buffer_load_dwordx4 v[80:83], v156, s[16:19], s32 offen offset:1024 sc1
 buffer_load_dwordx4 v[84:87], v156, s[16:19], s32 offen offset:2048 sc1
 buffer_load_dwordx4 v[88:91], v156, s[16:19], s32 offen offset:3072 sc1
 buffer_load_dwordx4 v[92:95], v157, s[16:19], s32 offen offset:0 sc1
 buffer_load_dwordx4 v[96:99], v157, s[16:19], s32 offen offset:1024 sc1
 buffer_load_dwordx4 v[100:103], v157, s[16:19], s32 offen offset:2048 sc1
 buffer_load_dwordx4 v[104:107], v157, s[16:19], s32 offen offset:3072 sc1
 s_add_u32 m0, s31, 0
 s_add_u32 s35, s29, 0
 buffer_load_dwordx4 v156, s[16:19], s35 offen sc1 lds
 s_add_u32 m0, s31, 1024
 s_add_u32 s35, s29, 1024
 buffer_load_dwordx4 v156, s[16:19], s35 offen sc1 lds
 s_add_u32 m0, s31, 2048
 s_add_u32 s35, s29, 2048
 buffer_load_dwordx4 v156, s[16:19], s35 offen sc1 lds
 s_add_u32 m0, s31, 3072
 s_add_u32 s35, s29, 3072
 buffer_load_dwordx4 v156, s[16:19], s35 offen sc1 lds
 s_add_u32 m0, s31, 4096
 s_add_u32 s35, s29, 4096
 buffer_load_dwordx4 v156, s[16:19], s35 offen sc1 lds
 s_add_u32 m0, s31, 5120
 s_add_u32 s35, s29, 5120
 buffer_load_dwordx4 v156, s[16:19], s35 offen sc1 lds
 s_add_u32 m0, s31, 6144
 s_add_u32 s35, s29, 6144
 buffer_load_dwordx4 v156, s[16:19], s35 offen sc1 lds
 s_add_u32 m0, s31, 7168
 s_add_u32 s35, s29, 7168
 buffer_load_dwordx4 v156, s[16:19], s35 offen sc1 lds
 s_add_u32 m0, s31, 8192
 s_add_u32 s35, s30, 6144
 buffer_load_dwordx4 v156, s[16:19], s35 offen sc1 lds
 s_add_u32 m0, s31, 9216
 s_add_u32 s35, s30, 7168
 buffer_load_dwordx4 v156, s[16:19], s35 offen sc1 lds
 s_lshl_b32 s32, s26, 18
 s_lshl_b32 s33, s11, 8
 s_add_u32 s32, s32, s33
 s_add_u32 s32, s32, 37748736
 s_add_u32 s33, s32, 131072
 s_waitcnt vmcnt(10)
 v_mfma_f32_16x16x32_bf16 v[4:7], v[76:79], v[124:127], 0
 v_mfma_f32_16x16x32_bf16 v[8:11], v[92:95], v[124:127], 0
 v_mfma_f32_16x16x32_bf16 v[12:15], v[108:111], v[124:127], 0
 MF v[4:7],v[80:83],v[128:131]
 MF v[8:11],v[96:99],v[128:131]
 MF v[12:15],v[112:115],v[128:131]
 MF v[4:7],v[84:87],v[132:135]
 MF v[8:11],v[100:103],v[132:135]
 MF v[12:15],v[116:119],v[132:135]
 MF v[4:7],v[88:91],v[136:139]
 MF v[8:11],v[104:107],v[136:139]
 MF v[12:15],v[120:123],v[136:139]
 v_mfma_f32_16x16x32_bf16 v[16:19], v[76:79], v[140:143], 0
 v_mfma_f32_16x16x32_bf16 v[20:23], v[92:95], v[140:143], 0
 v_mfma_f32_16x16x32_bf16 v[24:27], v[108:111], v[140:143], 0
 MF v[16:19],v[80:83],v[144:147]
 MF v[20:23],v[96:99],v[144:147]
 MF v[24:27],v[112:115],v[144:147]
 MF v[16:19],v[84:87],v[148:151]
 MF v[20:23],v[100:103],v[148:151]
 MF v[24:27],v[116:119],v[148:151]
 MF v[16:19],v[88:91],v[152:155]
 MF v[20:23],v[104:107],v[152:155]
 MF v[24:27],v[120:123],v[152:155]
 s_nop 7
 v_cmp_gt_i32 vcc, 0, v160
 s_nop 1
 v_cndmask_b32 v4, v4, v162, vcc
 v_cmp_gt_i32 vcc, 1, v160
 s_nop 1
 v_cndmask_b32 v5, v5, v162, vcc
 v_cmp_gt_i32 vcc, 2, v160
 s_nop 1
 v_cndmask_b32 v6, v6, v162, vcc
 v_cmp_gt_i32 vcc, 3, v160
 s_nop 1
 v_cndmask_b32 v7, v7, v162, vcc
 v_cmp_gt_i32 vcc, 4, v160
 s_nop 1
 v_cndmask_b32 v8, v8, v162, vcc
 v_cmp_gt_i32 vcc, 5, v160
 s_nop 1
 v_cndmask_b32 v9, v9, v162, vcc
 v_cmp_gt_i32 vcc, 6, v160
 s_nop 1
 v_cndmask_b32 v10, v10, v162, vcc
 v_cmp_gt_i32 vcc, 7, v160
 s_nop 1
 v_cndmask_b32 v11, v11, v162, vcc
 v_max3_f32 v163, v4, v5, v6
 v_max3_f32 v163, v163, v7, v8
 v_max3_f32 v163, v163, v9, v10
 v_max_f32 v163, v163, v11
 s_mov_b64 exec, s[36:37]
 v_max3_f32 v163, v163, v12, v13
 v_max3_f32 v163, v163, v14, v15
 s_mov_b64 exec, -1
 v_mov_b32 v164, v163
 s_nop 1
 v_permlane32_swap_b32 v163, v164
 v_max_f32 v163, v163, v164
 v_mov_b32 v164, v163
 s_nop 1
 v_permlane16_swap_b32 v163, v164
 v_max_f32 v163, v163, v164
 v_sub_f32 v4, v4, v163
 v_sub_f32 v5, v5, v163
 v_sub_f32 v6, v6, v163
 v_sub_f32 v7, v7, v163
 v_sub_f32 v8, v8, v163
 v_sub_f32 v9, v9, v163
 v_sub_f32 v10, v10, v163
 v_sub_f32 v11, v11, v163
 v_sub_f32 v12, v12, v163
 v_sub_f32 v13, v13, v163
 v_sub_f32 v14, v14, v163
 v_sub_f32 v15, v15, v163
 v_mul_f32 v4, s34, v4
 v_mul_f32 v5, s34, v5
 v_mul_f32 v6, s34, v6
 v_mul_f32 v7, s34, v7
 v_mul_f32 v8, s34, v8
 v_mul_f32 v9, s34, v9
 v_mul_f32 v10, s34, v10
 v_mul_f32 v11, s34, v11
 v_mul_f32 v12, s34, v12
 v_mul_f32 v13, s34, v13
 v_mul_f32 v14, s34, v14
 v_mul_f32 v15, s34, v15
 v_exp_f32 v4, v4
 v_exp_f32 v5, v5
 v_exp_f32 v6, v6
 v_exp_f32 v7, v7
 v_exp_f32 v8, v8
 v_exp_f32 v9, v9
 v_exp_f32 v10, v10
 v_exp_f32 v11, v11
 v_exp_f32 v12, v12
 v_exp_f32 v13, v13
 v_exp_f32 v14, v14
 v_exp_f32 v15, v15
 s_mov_b64 exec, s[38:39]
 v_mov_b32 v12, 0
 v_mov_b32 v13, 0
 v_mov_b32 v14, 0
 v_mov_b32 v15, 0
 s_mov_b64 exec, -1
 v_add_f32 v165, v4, v5
 v_add_f32 v165, v165, v6
 v_add_f32 v165, v165, v7
 v_add_f32 v165, v165, v8
 v_add_f32 v165, v165, v9
 v_add_f32 v165, v165, v10
 v_add_f32 v165, v165, v11
 v_add_f32 v165, v165, v12
 v_add_f32 v165, v165, v13
 v_add_f32 v165, v165, v14
 v_add_f32 v165, v165, v15
 v_mov_b32 v164, v165
 s_nop 1
 v_permlane32_swap_b32 v165, v164
 v_add_f32 v165, v165, v164
 v_mov_b32 v164, v165
 s_nop 1
 v_permlane16_swap_b32 v165, v164
 v_add_f32 v165, v165, v164
 v_rcp_f32 v165, v165
 s_nop 0
 v_mul_f32 v4, v4, v165
 v_mul_f32 v5, v5, v165
 v_mul_f32 v6, v6, v165
 v_mul_f32 v7, v7, v165
 v_mul_f32 v8, v8, v165
 v_mul_f32 v9, v9, v165
 v_mul_f32 v10, v10, v165
 v_mul_f32 v11, v11, v165
 v_mul_f32 v12, v12, v165
 v_mul_f32 v13, v13, v165
 v_mul_f32 v14, v14, v165
 v_mul_f32 v15, v15, v165
 CV 28,4,5
 CV 29,6,7
 CV 30,8,9
 CV 31,10,11
 CV 32,12,13
 CV 33,14,15
 v_cmp_gt_i32 vcc, -16, v160
 s_nop 1
 v_cndmask_b32 v16, v16, v162, vcc
 v_cmp_gt_i32 vcc, -15, v160
 s_nop 1
 v_cndmask_b32 v17, v17, v162, vcc
 v_cmp_gt_i32 vcc, -14, v160
 s_nop 1
 v_cndmask_b32 v18, v18, v162, vcc
 v_cmp_gt_i32 vcc, -13, v160
 s_nop 1
 v_cndmask_b32 v19, v19, v162, vcc
 v_cmp_gt_i32 vcc, -12, v160
 s_nop 1
 v_cndmask_b32 v20, v20, v162, vcc
 v_cmp_gt_i32 vcc, -11, v160
 s_nop 1
 v_cndmask_b32 v21, v21, v162, vcc
 v_cmp_gt_i32 vcc, -10, v160
 s_nop 1
 v_cndmask_b32 v22, v22, v162, vcc
 v_cmp_gt_i32 vcc, -9, v160
 s_nop 1
 v_cndmask_b32 v23, v23, v162, vcc
 v_max3_f32 v163, v16, v17, v18
 v_max3_f32 v163, v163, v19, v20
 v_max3_f32 v163, v163, v21, v22
 v_max_f32 v163, v163, v23
 s_mov_b64 exec, s[36:37]
 v_max3_f32 v163, v163, v24, v25
 v_max3_f32 v163, v163, v26, v27
 s_mov_b64 exec, -1
 v_mov_b32 v164, v163
 s_nop 1
 v_permlane32_swap_b32 v163, v164
 v_max_f32 v163, v163, v164
 v_mov_b32 v164, v163
 s_nop 1
 v_permlane16_swap_b32 v163, v164
 v_max_f32 v163, v163, v164
 v_sub_f32 v16, v16, v163
 v_sub_f32 v17, v17, v163
 v_sub_f32 v18, v18, v163
 v_sub_f32 v19, v19, v163
 v_sub_f32 v20, v20, v163
 v_sub_f32 v21, v21, v163
 v_sub_f32 v22, v22, v163
 v_sub_f32 v23, v23, v163
 v_sub_f32 v24, v24, v163
 v_sub_f32 v25, v25, v163
 v_sub_f32 v26, v26, v163
 v_sub_f32 v27, v27, v163
 v_mul_f32 v16, s34, v16
 v_mul_f32 v17, s34, v17
 v_mul_f32 v18, s34, v18
 v_mul_f32 v19, s34, v19
 v_mul_f32 v20, s34, v20
 v_mul_f32 v21, s34, v21
 v_mul_f32 v22, s34, v22
 v_mul_f32 v23, s34, v23
 v_mul_f32 v24, s34, v24
 v_mul_f32 v25, s34, v25
 v_mul_f32 v26, s34, v26
 v_mul_f32 v27, s34, v27
 v_exp_f32 v16, v16
 v_exp_f32 v17, v17
 v_exp_f32 v18, v18
 v_exp_f32 v19, v19
 v_exp_f32 v20, v20
 v_exp_f32 v21, v21
 v_exp_f32 v22, v22
 v_exp_f32 v23, v23
 v_exp_f32 v24, v24
 v_exp_f32 v25, v25
 v_exp_f32 v26, v26
 v_exp_f32 v27, v27
 s_mov_b64 exec, s[38:39]
 v_mov_b32 v24, 0
 v_mov_b32 v25, 0
 v_mov_b32 v26, 0
 v_mov_b32 v27, 0
 s_mov_b64 exec, -1
 v_add_f32 v165, v16, v17
 v_add_f32 v165, v165, v18
 v_add_f32 v165, v165, v19
 v_add_f32 v165, v165, v20
 v_add_f32 v165, v165, v21
 v_add_f32 v165, v165, v22
 v_add_f32 v165, v165, v23
 v_add_f32 v165, v165, v24
 v_add_f32 v165, v165, v25
 v_add_f32 v165, v165, v26
 v_add_f32 v165, v165, v27
 v_mov_b32 v164, v165
 s_nop 1
 v_permlane32_swap_b32 v165, v164
 v_add_f32 v165, v165, v164
 v_mov_b32 v164, v165
 s_nop 1
 v_permlane16_swap_b32 v165, v164
 v_add_f32 v165, v165, v164
 v_rcp_f32 v165, v165
 s_nop 0
 v_mul_f32 v16, v16, v165
 v_mul_f32 v17, v17, v165
 v_mul_f32 v18, v18, v165
 v_mul_f32 v19, v19, v165
 v_mul_f32 v20, v20, v165
 v_mul_f32 v21, v21, v165
 v_mul_f32 v22, v22, v165
 v_mul_f32 v23, v23, v165
 v_mul_f32 v24, v24, v165
 v_mul_f32 v25, v25, v165
 v_mul_f32 v26, v26, v165
 v_mul_f32 v27, v27, v165
 CV 36,16,17
 CV 37,18,19
 CV 38,20,21
 CV 39,22,23
 CV 40,24,25
 CV 41,26,27
 s_waitcnt vmcnt(0)
 TR 60,61,158,0
 TR 62,63,158,64
 TR 68,69,159,0
 TR 64,65,158,8
 TR 66,67,158,72
 TR 70,71,159,8
 s_waitcnt lgkmcnt(0)
 v_mfma_f32_16x16x32_bf16 v[44:47], v[60:63], v[28:31], 0
 v_mfma_f32_16x16x32_bf16 v[48:51], v[64:67], v[28:31], 0
 v_mfma_f32_16x16x32_bf16 v[52:55], v[60:63], v[36:39], 0
 v_mfma_f32_16x16x32_bf16 v[56:59], v[64:67], v[36:39], 0
 s_nop 3
 v_mfma_f32_16x16x16_bf16 v[44:47], v[68:69], v[32:33], v[44:47]
 v_mfma_f32_16x16x16_bf16 v[48:51], v[70:71], v[32:33], v[48:51]
 v_mfma_f32_16x16x16_bf16 v[52:55], v[68:69], v[40:41], v[52:55]
 v_mfma_f32_16x16x16_bf16 v[56:59], v[70:71], v[40:41], v[56:59]
 s_nop 7
 CV 4,44,45
 CV 5,46,47
 CV 6,48,49
 CV 7,50,51
 buffer_store_dwordx4 v[4:7], v161, s[16:19], s32 offen offset:0 sc1
 CV 8,52,53
 CV 9,54,55
 CV 10,56,57
 CV 11,58,59
 buffer_store_dwordx4 v[8:11], v161, s[16:19], s33 offen offset:0 sc1
 TR 60,61,158,1024
 TR 62,63,158,1088
 TR 68,69,159,64
 TR 64,65,158,1032
 TR 66,67,158,1096
 TR 70,71,159,72
 s_waitcnt lgkmcnt(0)
 v_mfma_f32_16x16x32_bf16 v[44:47], v[60:63], v[28:31], 0
 v_mfma_f32_16x16x32_bf16 v[48:51], v[64:67], v[28:31], 0
 v_mfma_f32_16x16x32_bf16 v[52:55], v[60:63], v[36:39], 0
 v_mfma_f32_16x16x32_bf16 v[56:59], v[64:67], v[36:39], 0
 s_nop 3
 v_mfma_f32_16x16x16_bf16 v[44:47], v[68:69], v[32:33], v[44:47]
 v_mfma_f32_16x16x16_bf16 v[48:51], v[70:71], v[32:33], v[48:51]
 v_mfma_f32_16x16x16_bf16 v[52:55], v[68:69], v[40:41], v[52:55]
 v_mfma_f32_16x16x16_bf16 v[56:59], v[70:71], v[40:41], v[56:59]
 s_nop 7
 CV 12,44,45
 CV 13,46,47
 CV 14,48,49
 CV 15,50,51
 buffer_store_dwordx4 v[12:15], v161, s[16:19], s32 offen offset:64 sc1
 CV 16,52,53
 CV 17,54,55
 CV 18,56,57
 CV 19,58,59
 buffer_store_dwordx4 v[16:19], v161, s[16:19], s33 offen offset:64 sc1
 TR 60,61,158,2048
 TR 62,63,158,2112
 TR 68,69,159,128
 TR 64,65,158,2056
 TR 66,67,158,2120
 TR 70,71,159,136
 s_waitcnt lgkmcnt(0)
 v_mfma_f32_16x16x32_bf16 v[44:47], v[60:63], v[28:31], 0
 v_mfma_f32_16x16x32_bf16 v[48:51], v[64:67], v[28:31], 0
 v_mfma_f32_16x16x32_bf16 v[52:55], v[60:63], v[36:39], 0
 v_mfma_f32_16x16x32_bf16 v[56:59], v[64:67], v[36:39], 0
 s_nop 3
 v_mfma_f32_16x16x16_bf16 v[44:47], v[68:69], v[32:33], v[44:47]
 v_mfma_f32_16x16x16_bf16 v[48:51], v[70:71], v[32:33], v[48:51]
 v_mfma_f32_16x16x16_bf16 v[52:55], v[68:69], v[40:41], v[52:55]
 v_mfma_f32_16x16x16_bf16 v[56:59], v[70:71], v[40:41], v[56:59]
 s_nop 7
 CV 4,44,45
 CV 5,46,47
 CV 6,48,49
 CV 7,50,51
 buffer_store_dwordx4 v[4:7], v161, s[16:19], s32 offen offset:128 sc1
 CV 8,52,53
 CV 9,54,55
 CV 10,56,57
 CV 11,58,59
 buffer_store_dwordx4 v[8:11], v161, s[16:19], s33 offen offset:128 sc1
 TR 60,61,158,3072
 TR 62,63,158,3136
 TR 68,69,159,192
 TR 64,65,158,3080
 TR 66,67,158,3144
 TR 70,71,159,200
 s_waitcnt lgkmcnt(0)
 v_mfma_f32_16x16x32_bf16 v[44:47], v[60:63], v[28:31], 0
 v_mfma_f32_16x16x32_bf16 v[48:51], v[64:67], v[28:31], 0
 v_mfma_f32_16x16x32_bf16 v[52:55], v[60:63], v[36:39], 0
 v_mfma_f32_16x16x32_bf16 v[56:59], v[64:67], v[36:39], 0
 s_nop 3
 v_mfma_f32_16x16x16_bf16 v[44:47], v[68:69], v[32:33], v[44:47]
 v_mfma_f32_16x16x16_bf16 v[48:51], v[70:71], v[32:33], v[48:51]
 v_mfma_f32_16x16x16_bf16 v[52:55], v[68:69], v[40:41], v[52:55]
 v_mfma_f32_16x16x16_bf16 v[56:59], v[70:71], v[40:41], v[56:59]
 s_nop 7
 CV 12,44,45
 CV 13,46,47
 CV 14,48,49
 CV 15,50,51
 buffer_store_dwordx4 v[12:15], v161, s[16:19], s32 offen offset:192 sc1
 CV 16,52,53
 CV 17,54,55
 CV 18,56,57
 CV 19,58,59
 buffer_store_dwordx4 v[16:19], v161, s[16:19], s33 offen offset:192 sc1
 s_branch mk_done
mk_b_lnr4:
 s_load_dwordx2 s[6:7], s[0:1], 0
 v_lshlrev_b32 v3, 4, v2
 v_lshlrev_b32 v1, 5, v2
 s_and_b32 s26, s11, 31
 s_lshr_b32 s35, s11, 5
 s_lshl_b32 s26, s26, 2
 s_add_u32 s26, s26, s13
 s_lshl_b32 s26, s26, 2
 s_lshl_b32 s27, s10, 9
 s_add_u32 s27, s27, s26
 s_lshl_b32 s27, s27, 12
 s_add_u32 s27, s27, 138412032
 s_lshl_b32 s32, s10, 7
 s_add_u32 s32, s32, s26
 s_lshl_b32 s32, s32, 11
 s_add_u32 s33, s32, 54525952
 s_add_u32 s34, s32, 58720256
 s_waitcnt lgkmcnt(0)
 s_mov_b32 s28, s6
 s_and_b32 s29, s7, 0xffff
 s_mov_b32 s30, 0x400000
 s_mov_b32 s31, 0x00020000
 v_mov_b32 v48, 0
 v_mov_b32 v49, 0
 v_mov_b32 v50, 0
 v_mov_b32 v51, 0
 v_mov_b32 v52, 0
 v_mov_b32 v53, 0
 v_mov_b32 v54, 0
 v_mov_b32 v55, 0
 v_mov_b32 v56, 0
 v_mov_b32 v57, 0
 v_mov_b32 v58, 0
 v_mov_b32 v59, 0
 v_mov_b32 v60, 0
 v_mov_b32 v61, 0
 v_mov_b32 v62, 0
 v_mov_b32 v63, 0
 v_mov_b32 v88, 0
 v_mov_b32 v89, 0
 v_mov_b32 v90, 0
 v_mov_b32 v91, 0
 v_mov_b32 v92, 0
 v_mov_b32 v93, 0
 v_mov_b32 v94, 0
 v_mov_b32 v95, 0
 v_mov_b32 v96, 0
 v_mov_b32 v97, 0
 v_mov_b32 v98, 0
 v_mov_b32 v99, 0
 v_mov_b32 v100, 0
 v_mov_b32 v101, 0
 v_mov_b32 v102, 0
 v_mov_b32 v103, 0
 v_mov_b32 v128, 0
 v_mov_b32 v129, 0
 v_mov_b32 v130, 0
 v_mov_b32 v131, 0
 v_mov_b32 v132, 0
 v_mov_b32 v133, 0
 v_mov_b32 v134, 0
 v_mov_b32 v135, 0
 v_mov_b32 v136, 0
 v_mov_b32 v137, 0
 v_mov_b32 v138, 0
 v_mov_b32 v139, 0
 v_mov_b32 v140, 0
 v_mov_b32 v141, 0
 v_mov_b32 v142, 0
 v_mov_b32 v143, 0
 v_mov_b32 v168, 0
 v_mov_b32 v169, 0
 v_mov_b32 v170, 0
 v_mov_b32 v171, 0
 v_mov_b32 v172, 0
 v_mov_b32 v173, 0
 v_mov_b32 v174, 0
 v_mov_b32 v175, 0
 v_mov_b32 v176, 0
 v_mov_b32 v177, 0
 v_mov_b32 v178, 0
 v_mov_b32 v179, 0
 v_mov_b32 v180, 0
 v_mov_b32 v181, 0
 v_mov_b32 v182, 0
 v_mov_b32 v183, 0
 s_cmp_eq_u32 s35, 0
 s_cbranch_scc1 mk_lnr4_np
 s_add_u32 s36, s27, 524288
 buffer_load_dwordx4 v[48:51], v1, s[16:19], s36 offen offset:0 sc1
 buffer_load_dwordx4 v[52:55], v1, s[16:19], s36 offen offset:16 sc1
 buffer_load_dwordx4 v[56:59], v1, s[16:19], s36 offen offset:2048 sc1
 buffer_load_dwordx4 v[60:63], v1, s[16:19], s36 offen offset:2064 sc1
 s_add_u32 s36, s27, 528384
 buffer_load_dwordx4 v[88:91], v1, s[16:19], s36 offen offset:0 sc1
 buffer_load_dwordx4 v[92:95], v1, s[16:19], s36 offen offset:16 sc1
 buffer_load_dwordx4 v[96:99], v1, s[16:19], s36 offen offset:2048 sc1
 buffer_load_dwordx4 v[100:103], v1, s[16:19], s36 offen offset:2064 sc1
 s_add_u32 s36, s27, 532480
 buffer_load_dwordx4 v[128:131], v1, s[16:19], s36 offen offset:0 sc1
 buffer_load_dwordx4 v[132:135], v1, s[16:19], s36 offen offset:16 sc1
 buffer_load_dwordx4 v[136:139], v1, s[16:19], s36 offen offset:2048 sc1
 buffer_load_dwordx4 v[140:143], v1, s[16:19], s36 offen offset:2064 sc1
 s_add_u32 s36, s27, 536576
 buffer_load_dwordx4 v[168:171], v1, s[16:19], s36 offen offset:0 sc1
 buffer_load_dwordx4 v[172:175], v1, s[16:19], s36 offen offset:16 sc1
 buffer_load_dwordx4 v[176:179], v1, s[16:19], s36 offen offset:2048 sc1
 buffer_load_dwordx4 v[180:183], v1, s[16:19], s36 offen offset:2064 sc1
mk_lnr4_np:
 s_add_u32 s36, s27, 0
 buffer_load_dwordx4 v[32:35], v1, s[16:19], s36 offen offset:0 sc1
 buffer_load_dwordx4 v[36:39], v1, s[16:19], s36 offen offset:16 sc1
 buffer_load_dwordx4 v[40:43], v1, s[16:19], s36 offen offset:2048 sc1
 buffer_load_dwordx4 v[44:47], v1, s[16:19], s36 offen offset:2064 sc1
 s_add_u32 s36, s32, 0
 buffer_load_dwordx4 v[64:67], v3, s[28:31], s36 offen
 buffer_load_dwordx4 v[68:71], v3, s[28:31], s36 offen offset:1024
 s_add_u32 s36, s27, 4096
 buffer_load_dwordx4 v[72:75], v1, s[16:19], s36 offen offset:0 sc1
 buffer_load_dwordx4 v[76:79], v1, s[16:19], s36 offen offset:16 sc1
 buffer_load_dwordx4 v[80:83], v1, s[16:19], s36 offen offset:2048 sc1
 buffer_load_dwordx4 v[84:87], v1, s[16:19], s36 offen offset:2064 sc1
 s_add_u32 s36, s32, 2048
 buffer_load_dwordx4 v[104:107], v3, s[28:31], s36 offen
 buffer_load_dwordx4 v[108:111], v3, s[28:31], s36 offen offset:1024
 s_add_u32 s36, s27, 8192
 buffer_load_dwordx4 v[112:115], v1, s[16:19], s36 offen offset:0 sc1
 buffer_load_dwordx4 v[116:119], v1, s[16:19], s36 offen offset:16 sc1
 buffer_load_dwordx4 v[120:123], v1, s[16:19], s36 offen offset:2048 sc1
 buffer_load_dwordx4 v[124:127], v1, s[16:19], s36 offen offset:2064 sc1
 s_add_u32 s36, s32, 4096
 buffer_load_dwordx4 v[144:147], v3, s[28:31], s36 offen
 buffer_load_dwordx4 v[148:151], v3, s[28:31], s36 offen offset:1024
 s_add_u32 s36, s27, 12288
 buffer_load_dwordx4 v[152:155], v1, s[16:19], s36 offen offset:0 sc1
 buffer_load_dwordx4 v[156:159], v1, s[16:19], s36 offen offset:16 sc1
 buffer_load_dwordx4 v[160:163], v1, s[16:19], s36 offen offset:2048 sc1
 buffer_load_dwordx4 v[164:167], v1, s[16:19], s36 offen offset:2064 sc1
 s_add_u32 s36, s32, 6144
 buffer_load_dwordx4 v[184:187], v3, s[28:31], s36 offen
 buffer_load_dwordx4 v[188:191], v3, s[28:31], s36 offen offset:1024
 s_waitcnt vmcnt(18)
 v_pk_add_f32 v[32:33], v[32:33], v[48:49]
 v_pk_add_f32 v[34:35], v[34:35], v[50:51]
 v_pk_add_f32 v[36:37], v[36:37], v[52:53]
 v_pk_add_f32 v[38:39], v[38:39], v[54:55]
 v_pk_add_f32 v[40:41], v[40:41], v[56:57]
 v_pk_add_f32 v[42:43], v[42:43], v[58:59]
 v_pk_add_f32 v[44:45], v[44:45], v[60:61]
 v_pk_add_f32 v[46:47], v[46:47], v[62:63]
 CV 4,32,33
 v_lshlrev_b32 v5, 16, v4
 v_and_b32 v4, 0xffff0000, v4
 v_lshlrev_b32 v6, 16, v64
 v_and_b32 v7, 0xffff0000, v64
 v_add_f32 v5, v5, v6
 v_add_f32 v4, v4, v7
 CV 48,5,4
 v_lshlrev_b32 v16, 16, v48
 v_and_b32 v17, 0xffff0000, v48
 CV 4,34,35
 v_lshlrev_b32 v5, 16, v4
 v_and_b32 v4, 0xffff0000, v4
 v_lshlrev_b32 v6, 16, v65
 v_and_b32 v7, 0xffff0000, v65
 v_add_f32 v5, v5, v6
 v_add_f32 v4, v4, v7
 CV 49,5,4
 v_lshlrev_b32 v18, 16, v49
 v_and_b32 v19, 0xffff0000, v49
 CV 4,36,37
 v_lshlrev_b32 v5, 16, v4
 v_and_b32 v4, 0xffff0000, v4
 v_lshlrev_b32 v6, 16, v66
 v_and_b32 v7, 0xffff0000, v66
 v_add_f32 v5, v5, v6
 v_add_f32 v4, v4, v7
 CV 50,5,4
 v_lshlrev_b32 v20, 16, v50
 v_and_b32 v21, 0xffff0000, v50
 CV 4,38,39
 v_lshlrev_b32 v5, 16, v4
 v_and_b32 v4, 0xffff0000, v4
 v_lshlrev_b32 v6, 16, v67
 v_and_b32 v7, 0xffff0000, v67
 v_add_f32 v5, v5, v6
 v_add_f32 v4, v4, v7
 CV 51,5,4
 v_lshlrev_b32 v22, 16, v51
 v_and_b32 v23, 0xffff0000, v51
 CV 4,40,41
 v_lshlrev_b32 v5, 16, v4
 v_and_b32 v4, 0xffff0000, v4
 v_lshlrev_b32 v6, 16, v68
 v_and_b32 v7, 0xffff0000, v68
 v_add_f32 v5, v5, v6
 v_add_f32 v4, v4, v7
 CV 52,5,4
 v_lshlrev_b32 v24, 16, v52
 v_and_b32 v25, 0xffff0000, v52
 CV 4,42,43
 v_lshlrev_b32 v5, 16, v4
 v_and_b32 v4, 0xffff0000, v4
 v_lshlrev_b32 v6, 16, v69
 v_and_b32 v7, 0xffff0000, v69
 v_add_f32 v5, v5, v6
 v_add_f32 v4, v4, v7
 CV 53,5,4
 v_lshlrev_b32 v26, 16, v53
 v_and_b32 v27, 0xffff0000, v53
 CV 4,44,45
 v_lshlrev_b32 v5, 16, v4
 v_and_b32 v4, 0xffff0000, v4
 v_lshlrev_b32 v6, 16, v70
 v_and_b32 v7, 0xffff0000, v70
 v_add_f32 v5, v5, v6
 v_add_f32 v4, v4, v7
 CV 54,5,4
 v_lshlrev_b32 v28, 16, v54
 v_and_b32 v29, 0xffff0000, v54
 CV 4,46,47
 v_lshlrev_b32 v5, 16, v4
 v_and_b32 v4, 0xffff0000, v4
 v_lshlrev_b32 v6, 16, v71
 v_and_b32 v7, 0xffff0000, v71
 v_add_f32 v5, v5, v6
 v_add_f32 v4, v4, v7
 CV 55,5,4
 v_lshlrev_b32 v30, 16, v55
 v_and_b32 v31, 0xffff0000, v55
 buffer_store_dwordx4 v[48:51], v3, s[16:19], s33 offen sc1
 buffer_store_dwordx4 v[52:55], v3, s[16:19], s33 offen offset:1024 sc1
 v_add_f32 v4, v16, v17
 v_add_f32 v4, v4, v18
 v_add_f32 v4, v4, v19
 v_add_f32 v4, v4, v20
 v_add_f32 v4, v4, v21
 v_add_f32 v4, v4, v22
 v_add_f32 v4, v4, v23
 v_add_f32 v4, v4, v24
 v_add_f32 v4, v4, v25
 v_add_f32 v4, v4, v26
 v_add_f32 v4, v4, v27
 v_add_f32 v4, v4, v28
 v_add_f32 v4, v4, v29
 v_add_f32 v4, v4, v30
 v_add_f32 v4, v4, v31
 s_nop 1
 v_add_f32_dpp v4, v4, v4 quad_perm:[1,0,3,2] row_mask:0xf bank_mask:0xf
 s_nop 1
 v_add_f32_dpp v4, v4, v4 quad_perm:[2,3,0,1] row_mask:0xf bank_mask:0xf
 s_nop 1
 v_add_f32_dpp v4, v4, v4 row_half_mirror row_mask:0xf bank_mask:0xf
 s_nop 1
 v_add_f32_dpp v4, v4, v4 row_mirror row_mask:0xf bank_mask:0xf
 v_mov_b32 v5, v4
 s_nop 1
 v_permlane16_swap_b32 v4, v5
 v_add_f32 v4, v4, v5
 v_mov_b32 v5, v4
 s_nop 1
 v_permlane32_swap_b32 v4, v5
 v_add_f32 v4, v4, v5
 v_mul_f32 v6, 0x3a800000, v4
 v_sub_f32 v5, v16, v6
 v_mul_f32 v4, v5, v5
 v_sub_f32 v5, v17, v6
 v_fmac_f32 v4, v5, v5
 v_sub_f32 v5, v18, v6
 v_fmac_f32 v4, v5, v5
 v_sub_f32 v5, v19, v6
 v_fmac_f32 v4, v5, v5
 v_sub_f32 v5, v20, v6
 v_fmac_f32 v4, v5, v5
 v_sub_f32 v5, v21, v6
 v_fmac_f32 v4, v5, v5
 v_sub_f32 v5, v22, v6
 v_fmac_f32 v4, v5, v5
 v_sub_f32 v5, v23, v6
 v_fmac_f32 v4, v5, v5
 v_sub_f32 v5, v24, v6
 v_fmac_f32 v4, v5, v5
 v_sub_f32 v5, v25, v6
 v_fmac_f32 v4, v5, v5
 v_sub_f32 v5, v26, v6
 v_fmac_f32 v4, v5, v5
 v_sub_f32 v5, v27, v6
 v_fmac_f32 v4, v5, v5
 v_sub_f32 v5, v28, v6
 v_fmac_f32 v4, v5, v5
 v_sub_f32 v5, v29, v6
 v_fmac_f32 v4, v5, v5
 v_sub_f32 v5, v30, v6
 v_fmac_f32 v4, v5, v5
 v_sub_f32 v5, v31, v6
 v_fmac_f32 v4, v5, v5
 s_nop 1
 v_add_f32_dpp v4, v4, v4 quad_perm:[1,0,3,2] row_mask:0xf bank_mask:0xf
 s_nop 1
 v_add_f32_dpp v4, v4, v4 quad_perm:[2,3,0,1] row_mask:0xf bank_mask:0xf
 s_nop 1
 v_add_f32_dpp v4, v4, v4 row_half_mirror row_mask:0xf bank_mask:0xf
 s_nop 1
 v_add_f32_dpp v4, v4, v4 row_mirror row_mask:0xf bank_mask:0xf
 v_mov_b32 v5, v4
 s_nop 1
 v_permlane16_swap_b32 v4, v5
 v_add_f32 v4, v4, v5
 v_mov_b32 v5, v4
 s_nop 1
 v_permlane32_swap_b32 v4, v5
 v_add_f32 v4, v4, v5
 v_mul_f32 v4, 0x3a800000, v4
 CV 4,4,4
 v_and_b32 v4, 0xffff0000, v4
 CV 6,6,6
 v_and_b32 v6, 0xffff0000, v6
 v_add_f32 v4, 0x3727c5ac, v4
 CV 4,4,4
 v_and_b32 v4, 0xffff0000, v4
 v_sqrt_f32 v4, v4
 s_nop 0
 CV 4,4,4
 v_and_b32 v4, 0xffff0000, v4
 v_rcp_f32 v7, v4
 v_sub_f32 v16, v16, v6
 v_sub_f32 v17, v17, v6
 v_sub_f32 v18, v18, v6
 v_sub_f32 v19, v19, v6
 v_sub_f32 v20, v20, v6
 v_sub_f32 v21, v21, v6
 v_sub_f32 v22, v22, v6
 v_sub_f32 v23, v23, v6
 v_sub_f32 v24, v24, v6
 v_sub_f32 v25, v25, v6
 v_sub_f32 v26, v26, v6
 v_sub_f32 v27, v27, v6
 v_sub_f32 v28, v28, v6
 v_sub_f32 v29, v29, v6
 v_sub_f32 v30, v30, v6
 v_sub_f32 v31, v31, v6
 CV 8,16,17
 v_lshlrev_b32 v16, 16, v8
 v_and_b32 v17, 0xffff0000, v8
 v_mul_f32 v16, v16, v7
 v_mul_f32 v17, v17, v7
 CV 8,16,17
 CV 9,18,19
 v_lshlrev_b32 v18, 16, v9
 v_and_b32 v19, 0xffff0000, v9
 v_mul_f32 v18, v18, v7
 v_mul_f32 v19, v19, v7
 CV 9,18,19
 CV 10,20,21
 v_lshlrev_b32 v20, 16, v10
 v_and_b32 v21, 0xffff0000, v10
 v_mul_f32 v20, v20, v7
 v_mul_f32 v21, v21, v7
 CV 10,20,21
 CV 11,22,23
 v_lshlrev_b32 v22, 16, v11
 v_and_b32 v23, 0xffff0000, v11
 v_mul_f32 v22, v22, v7
 v_mul_f32 v23, v23, v7
 CV 11,22,23
 CV 12,24,25
 v_lshlrev_b32 v24, 16, v12
 v_and_b32 v25, 0xffff0000, v12
 v_mul_f32 v24, v24, v7
 v_mul_f32 v25, v25, v7
 CV 12,24,25
 CV 13,26,27
 v_lshlrev_b32 v26, 16, v13
 v_and_b32 v27, 0xffff0000, v13
 v_mul_f32 v26, v26, v7
 v_mul_f32 v27, v27, v7
 CV 13,26,27
 CV 14,28,29
 v_lshlrev_b32 v28, 16, v14
 v_and_b32 v29, 0xffff0000, v14
 v_mul_f32 v28, v28, v7
 v_mul_f32 v29, v29, v7
 CV 14,28,29
 CV 15,30,31
 v_lshlrev_b32 v30, 16, v15
 v_and_b32 v31, 0xffff0000, v15
 v_mul_f32 v30, v30, v7
 v_mul_f32 v31, v31, v7
 CV 15,30,31
 buffer_store_dwordx4 v[8:11], v3, s[16:19], s34 offen sc1
 buffer_store_dwordx4 v[12:15], v3, s[16:19], s34 offen offset:1024 sc1
 s_add_u32 s33, s33, 2048
 s_add_u32 s34, s34, 2048
 s_nop 1
 s_waitcnt vmcnt(16)
 v_pk_add_f32 v[72:73], v[72:73], v[88:89]
 v_pk_add_f32 v[74:75], v[74:75], v[90:91]
 v_pk_add_f32 v[76:77], v[76:77], v[92:93]
 v_pk_add_f32 v[78:79], v[78:79], v[94:95]
 v_pk_add_f32 v[80:81], v[80:81], v[96:97]
 v_pk_add_f32 v[82:83], v[82:83], v[98:99]
 v_pk_add_f32 v[84:85], v[84:85], v[100:101]
 v_pk_add_f32 v[86:87], v[86:87], v[102:103]
 CV 4,72,73
 v_lshlrev_b32 v5, 16, v4
 v_and_b32 v4, 0xffff0000, v4
 v_lshlrev_b32 v6, 16, v104
 v_and_b32 v7, 0xffff0000, v104
 v_add_f32 v5, v5, v6
 v_add_f32 v4, v4, v7
 CV 88,5,4
 v_lshlrev_b32 v16, 16, v88
 v_and_b32 v17, 0xffff0000, v88
 CV 4,74,75
 v_lshlrev_b32 v5, 16, v4
 v_and_b32 v4, 0xffff0000, v4
 v_lshlrev_b32 v6, 16, v105
 v_and_b32 v7, 0xffff0000, v105
 v_add_f32 v5, v5, v6
 v_add_f32 v4, v4, v7
 CV 89,5,4
 v_lshlrev_b32 v18, 16, v89
 v_and_b32 v19, 0xffff0000, v89
 CV 4,76,77
 v_lshlrev_b32 v5, 16, v4
 v_and_b32 v4, 0xffff0000, v4
 v_lshlrev_b32 v6, 16, v106
 v_and_b32 v7, 0xffff0000, v106
 v_add_f32 v5, v5, v6
 v_add_f32 v4, v4, v7
 CV 90,5,4
 v_lshlrev_b32 v20, 16, v90
 v_and_b32 v21, 0xffff0000, v90
 CV 4,78,79
 v_lshlrev_b32 v5, 16, v4
 v_and_b32 v4, 0xffff0000, v4
 v_lshlrev_b32 v6, 16, v107
 v_and_b32 v7, 0xffff0000, v107
 v_add_f32 v5, v5, v6
 v_add_f32 v4, v4, v7
 CV 91,5,4
 v_lshlrev_b32 v22, 16, v91
 v_and_b32 v23, 0xffff0000, v91
 CV 4,80,81
 v_lshlrev_b32 v5, 16, v4
 v_and_b32 v4, 0xffff0000, v4
 v_lshlrev_b32 v6, 16, v108
 v_and_b32 v7, 0xffff0000, v108
 v_add_f32 v5, v5, v6
 v_add_f32 v4, v4, v7
 CV 92,5,4
 v_lshlrev_b32 v24, 16, v92
 v_and_b32 v25, 0xffff0000, v92
 CV 4,82,83
 v_lshlrev_b32 v5, 16, v4
 v_and_b32 v4, 0xffff0000, v4
 v_lshlrev_b32 v6, 16, v109
 v_and_b32 v7, 0xffff0000, v109
 v_add_f32 v5, v5, v6
 v_add_f32 v4, v4, v7
 CV 93,5,4
 v_lshlrev_b32 v26, 16, v93
 v_and_b32 v27, 0xffff0000, v93
 CV 4,84,85
 v_lshlrev_b32 v5, 16, v4
 v_and_b32 v4, 0xffff0000, v4
 v_lshlrev_b32 v6, 16, v110
 v_and_b32 v7, 0xffff0000, v110
 v_add_f32 v5, v5, v6
 v_add_f32 v4, v4, v7
 CV 94,5,4
 v_lshlrev_b32 v28, 16, v94
 v_and_b32 v29, 0xffff0000, v94
 CV 4,86,87
 v_lshlrev_b32 v5, 16, v4
 v_and_b32 v4, 0xffff0000, v4
 v_lshlrev_b32 v6, 16, v111
 v_and_b32 v7, 0xffff0000, v111
 v_add_f32 v5, v5, v6
 v_add_f32 v4, v4, v7
 CV 95,5,4
 v_lshlrev_b32 v30, 16, v95
 v_and_b32 v31, 0xffff0000, v95
 buffer_store_dwordx4 v[88:91], v3, s[16:19], s33 offen sc1
 buffer_store_dwordx4 v[92:95], v3, s[16:19], s33 offen offset:1024 sc1
 v_add_f32 v4, v16, v17
 v_add_f32 v4, v4, v18
 v_add_f32 v4, v4, v19
 v_add_f32 v4, v4, v20
 v_add_f32 v4, v4, v21
 v_add_f32 v4, v4, v22
 v_add_f32 v4, v4, v23
 v_add_f32 v4, v4, v24
 v_add_f32 v4, v4, v25
 v_add_f32 v4, v4, v26
 v_add_f32 v4, v4, v27
 v_add_f32 v4, v4, v28
 v_add_f32 v4, v4, v29
 v_add_f32 v4, v4, v30
 v_add_f32 v4, v4, v31
 s_nop 1
 v_add_f32_dpp v4, v4, v4 quad_perm:[1,0,3,2] row_mask:0xf bank_mask:0xf
 s_nop 1
 v_add_f32_dpp v4, v4, v4 quad_perm:[2,3,0,1] row_mask:0xf bank_mask:0xf
 s_nop 1
 v_add_f32_dpp v4, v4, v4 row_half_mirror row_mask:0xf bank_mask:0xf
 s_nop 1
 v_add_f32_dpp v4, v4, v4 row_mirror row_mask:0xf bank_mask:0xf
 v_mov_b32 v5, v4
 s_nop 1
 v_permlane16_swap_b32 v4, v5
 v_add_f32 v4, v4, v5
 v_mov_b32 v5, v4
 s_nop 1
 v_permlane32_swap_b32 v4, v5
 v_add_f32 v4, v4, v5
 v_mul_f32 v6, 0x3a800000, v4
 v_sub_f32 v5, v16, v6
 v_mul_f32 v4, v5, v5
 v_sub_f32 v5, v17, v6
 v_fmac_f32 v4, v5, v5
 v_sub_f32 v5, v18, v6
 v_fmac_f32 v4, v5, v5
 v_sub_f32 v5, v19, v6
 v_fmac_f32 v4, v5, v5
 v_sub_f32 v5, v20, v6
 v_fmac_f32 v4, v5, v5
 v_sub_f32 v5, v21, v6
 v_fmac_f32 v4, v5, v5
 v_sub_f32 v5, v22, v6
 v_fmac_f32 v4, v5, v5
 v_sub_f32 v5, v23, v6
 v_fmac_f32 v4, v5, v5
 v_sub_f32 v5, v24, v6
 v_fmac_f32 v4, v5, v5
 v_sub_f32 v5, v25, v6
 v_fmac_f32 v4, v5, v5
 v_sub_f32 v5, v26, v6
 v_fmac_f32 v4, v5, v5
 v_sub_f32 v5, v27, v6
 v_fmac_f32 v4, v5, v5
 v_sub_f32 v5, v28, v6
 v_fmac_f32 v4, v5, v5
 v_sub_f32 v5, v29, v6
 v_fmac_f32 v4, v5, v5
 v_sub_f32 v5, v30, v6
 v_fmac_f32 v4, v5, v5
 v_sub_f32 v5, v31, v6
 v_fmac_f32 v4, v5, v5
 s_nop 1
 v_add_f32_dpp v4, v4, v4 quad_perm:[1,0,3,2] row_mask:0xf bank_mask:0xf
 s_nop 1
 v_add_f32_dpp v4, v4, v4 quad_perm:[2,3,0,1] row_mask:0xf bank_mask:0xf
 s_nop 1
 v_add_f32_dpp v4, v4, v4 row_half_mirror row_mask:0xf bank_mask:0xf
 s_nop 1
 v_add_f32_dpp v4, v4, v4 row_mirror row_mask:0xf bank_mask:0xf
 v_mov_b32 v5, v4
 s_nop 1
 v_permlane16_swap_b32 v4, v5
 v_add_f32 v4, v4, v5
 v_mov_b32 v5, v4
 s_nop 1
 v_permlane32_swap_b32 v4, v5
 v_add_f32 v4, v4, v5
 v_mul_f32 v4, 0x3a800000, v4
 CV 4,4,4
 v_and_b32 v4, 0xffff0000, v4
 CV 6,6,6
 v_and_b32 v6, 0xffff0000, v6
 v_add_f32 v4, 0x3727c5ac, v4
 CV 4,4,4
 v_and_b32 v4, 0xffff0000, v4
 v_sqrt_f32 v4, v4
 s_nop 0
 CV 4,4,4
 v_and_b32 v4, 0xffff0000, v4
 v_rcp_f32 v7, v4
 v_sub_f32 v16, v16, v6
 v_sub_f32 v17, v17, v6
 v_sub_f32 v18, v18, v6
 v_sub_f32 v19, v19, v6
 v_sub_f32 v20, v20, v6
 v_sub_f32 v21, v21, v6
 v_sub_f32 v22, v22, v6
 v_sub_f32 v23, v23, v6
 v_sub_f32 v24, v24, v6
 v_sub_f32 v25, v25, v6
 v_sub_f32 v26, v26, v6
 v_sub_f32 v27, v27, v6
 v_sub_f32 v28, v28, v6
 v_sub_f32 v29, v29, v6
 v_sub_f32 v30, v30, v6
 v_sub_f32 v31, v31, v6
 CV 8,16,17
 v_lshlrev_b32 v16, 16, v8
 v_and_b32 v17, 0xffff0000, v8
 v_mul_f32 v16, v16, v7
 v_mul_f32 v17, v17, v7
 CV 8,16,17
 CV 9,18,19
 v_lshlrev_b32 v18, 16, v9
 v_and_b32 v19, 0xffff0000, v9
 v_mul_f32 v18, v18, v7
 v_mul_f32 v19, v19, v7
 CV 9,18,19
 CV 10,20,21
 v_lshlrev_b32 v20, 16, v10
 v_and_b32 v21, 0xffff0000, v10
 v_mul_f32 v20, v20, v7
 v_mul_f32 v21, v21, v7
 CV 10,20,21
 CV 11,22,23
 v_lshlrev_b32 v22, 16, v11
 v_and_b32 v23, 0xffff0000, v11
 v_mul_f32 v22, v22, v7
 v_mul_f32 v23, v23, v7
 CV 11,22,23
 CV 12,24,25
 v_lshlrev_b32 v24, 16, v12
 v_and_b32 v25, 0xffff0000, v12
 v_mul_f32 v24, v24, v7
 v_mul_f32 v25, v25, v7
 CV 12,24,25
 CV 13,26,27
 v_lshlrev_b32 v26, 16, v13
 v_and_b32 v27, 0xffff0000, v13
 v_mul_f32 v26, v26, v7
 v_mul_f32 v27, v27, v7
 CV 13,26,27
 CV 14,28,29
 v_lshlrev_b32 v28, 16, v14
 v_and_b32 v29, 0xffff0000, v14
 v_mul_f32 v28, v28, v7
 v_mul_f32 v29, v29, v7
 CV 14,28,29
 CV 15,30,31
 v_lshlrev_b32 v30, 16, v15
 v_and_b32 v31, 0xffff0000, v15
 v_mul_f32 v30, v30, v7
 v_mul_f32 v31, v31, v7
 CV 15,30,31
 buffer_store_dwordx4 v[8:11], v3, s[16:19], s34 offen sc1
 buffer_store_dwordx4 v[12:15], v3, s[16:19], s34 offen offset:1024 sc1
 s_add_u32 s33, s33, 2048
 s_add_u32 s34, s34, 2048
 s_nop 1
 s_waitcnt vmcnt(14)
 v_pk_add_f32 v[112:113], v[112:113], v[128:129]
 v_pk_add_f32 v[114:115], v[114:115], v[130:131]
 v_pk_add_f32 v[116:117], v[116:117], v[132:133]
 v_pk_add_f32 v[118:119], v[118:119], v[134:135]
 v_pk_add_f32 v[120:121], v[120:121], v[136:137]
 v_pk_add_f32 v[122:123], v[122:123], v[138:139]
 v_pk_add_f32 v[124:125], v[124:125], v[140:141]
 v_pk_add_f32 v[126:127], v[126:127], v[142:143]
 CV 4,112,113
 v_lshlrev_b32 v5, 16, v4
 v_and_b32 v4, 0xffff0000, v4
 v_lshlrev_b32 v6, 16, v144
 v_and_b32 v7, 0xffff0000, v144
 v_add_f32 v5, v5, v6
 v_add_f32 v4, v4, v7
 CV 128,5,4
 v_lshlrev_b32 v16, 16, v128
 v_and_b32 v17, 0xffff0000, v128
 CV 4,114,115
 v_lshlrev_b32 v5, 16, v4
 v_and_b32 v4, 0xffff0000, v4
 v_lshlrev_b32 v6, 16, v145
 v_and_b32 v7, 0xffff0000, v145
 v_add_f32 v5, v5, v6
 v_add_f32 v4, v4, v7
 CV 129,5,4
 v_lshlrev_b32 v18, 16, v129
 v_and_b32 v19, 0xffff0000, v129
 CV 4,116,117
 v_lshlrev_b32 v5, 16, v4
 v_and_b32 v4, 0xffff0000, v4
 v_lshlrev_b32 v6, 16, v146
 v_and_b32 v7, 0xffff0000, v146
 v_add_f32 v5, v5, v6
 v_add_f32 v4, v4, v7
 CV 130,5,4
 v_lshlrev_b32 v20, 16, v130
 v_and_b32 v21, 0xffff0000, v130
 CV 4,118,119
 v_lshlrev_b32 v5, 16, v4
 v_and_b32 v4, 0xffff0000, v4
 v_lshlrev_b32 v6, 16, v147
 v_and_b32 v7, 0xffff0000, v147
 v_add_f32 v5, v5, v6
 v_add_f32 v4, v4, v7
 CV 131,5,4
 v_lshlrev_b32 v22, 16, v131
 v_and_b32 v23, 0xffff0000, v131
 CV 4,120,121
 v_lshlrev_b32 v5, 16, v4
 v_and_b32 v4, 0xffff0000, v4
 v_lshlrev_b32 v6, 16, v148
 v_and_b32 v7, 0xffff0000, v148
 v_add_f32 v5, v5, v6
 v_add_f32 v4, v4, v7
 CV 132,5,4
 v_lshlrev_b32 v24, 16, v132
 v_and_b32 v25, 0xffff0000, v132
 CV 4,122,123
 v_lshlrev_b32 v5, 16, v4
 v_and_b32 v4, 0xffff0000, v4
 v_lshlrev_b32 v6, 16, v149
 v_and_b32 v7, 0xffff0000, v149
 v_add_f32 v5, v5, v6
 v_add_f32 v4, v4, v7
 CV 133,5,4
 v_lshlrev_b32 v26, 16, v133
 v_and_b32 v27, 0xffff0000, v133
 CV 4,124,125
 v_lshlrev_b32 v5, 16, v4
 v_and_b32 v4, 0xffff0000, v4
 v_lshlrev_b32 v6, 16, v150
 v_and_b32 v7, 0xffff0000, v150
 v_add_f32 v5, v5, v6
 v_add_f32 v4, v4, v7
 CV 134,5,4
 v_lshlrev_b32 v28, 16, v134
 v_and_b32 v29, 0xffff0000, v134
 CV 4,126,127
 v_lshlrev_b32 v5, 16, v4
 v_and_b32 v4, 0xffff0000, v4
 v_lshlrev_b32 v6, 16, v151
 v_and_b32 v7, 0xffff0000, v151
 v_add_f32 v5, v5, v6
 v_add_f32 v4, v4, v7
 CV 135,5,4
 v_lshlrev_b32 v30, 16, v135
 v_and_b32 v31, 0xffff0000, v135
 buffer_store_dwordx4 v[128:131], v3, s[16:19], s33 offen sc1
 buffer_store_dwordx4 v[132:135], v3, s[16:19], s33 offen offset:1024 sc1
 v_add_f32 v4, v16, v17
 v_add_f32 v4, v4, v18
 v_add_f32 v4, v4, v19
 v_add_f32 v4, v4, v20
 v_add_f32 v4, v4, v21
 v_add_f32 v4, v4, v22
 v_add_f32 v4, v4, v23
 v_add_f32 v4, v4, v24
 v_add_f32 v4, v4, v25
 v_add_f32 v4, v4, v26
 v_add_f32 v4, v4, v27
 v_add_f32 v4, v4, v28
 v_add_f32 v4, v4, v29
 v_add_f32 v4, v4, v30
 v_add_f32 v4, v4, v31
 s_nop 1
 v_add_f32_dpp v4, v4, v4 quad_perm:[1,0,3,2] row_mask:0xf bank_mask:0xf
 s_nop 1
 v_add_f32_dpp v4, v4, v4 quad_perm:[2,3,0,1] row_mask:0xf bank_mask:0xf
 s_nop 1
 v_add_f32_dpp v4, v4, v4 row_half_mirror row_mask:0xf bank_mask:0xf
 s_nop 1
 v_add_f32_dpp v4, v4, v4 row_mirror row_mask:0xf bank_mask:0xf
 v_mov_b32 v5, v4
 s_nop 1
 v_permlane16_swap_b32 v4, v5
 v_add_f32 v4, v4, v5
 v_mov_b32 v5, v4
 s_nop 1
 v_permlane32_swap_b32 v4, v5
 v_add_f32 v4, v4, v5
 v_mul_f32 v6, 0x3a800000, v4
 v_sub_f32 v5, v16, v6
 v_mul_f32 v4, v5, v5
 v_sub_f32 v5, v17, v6
 v_fmac_f32 v4, v5, v5
 v_sub_f32 v5, v18, v6
 v_fmac_f32 v4, v5, v5
 v_sub_f32 v5, v19, v6
 v_fmac_f32 v4, v5, v5
 v_sub_f32 v5, v20, v6
 v_fmac_f32 v4, v5, v5
 v_sub_f32 v5, v21, v6
 v_fmac_f32 v4, v5, v5
 v_sub_f32 v5, v22, v6
 v_fmac_f32 v4, v5, v5
 v_sub_f32 v5, v23, v6
 v_fmac_f32 v4, v5, v5
 v_sub_f32 v5, v24, v6
 v_fmac_f32 v4, v5, v5
 v_sub_f32 v5, v25, v6
 v_fmac_f32 v4, v5, v5
 v_sub_f32 v5, v26, v6
 v_fmac_f32 v4, v5, v5
 v_sub_f32 v5, v27, v6
 v_fmac_f32 v4, v5, v5
 v_sub_f32 v5, v28, v6
 v_fmac_f32 v4, v5, v5
 v_sub_f32 v5, v29, v6
 v_fmac_f32 v4, v5, v5
 v_sub_f32 v5, v30, v6
 v_fmac_f32 v4, v5, v5
 v_sub_f32 v5, v31, v6
 v_fmac_f32 v4, v5, v5
 s_nop 1
 v_add_f32_dpp v4, v4, v4 quad_perm:[1,0,3,2] row_mask:0xf bank_mask:0xf
 s_nop 1
 v_add_f32_dpp v4, v4, v4 quad_perm:[2,3,0,1] row_mask:0xf bank_mask:0xf
 s_nop 1
 v_add_f32_dpp v4, v4, v4 row_half_mirror row_mask:0xf bank_mask:0xf
 s_nop 1
 v_add_f32_dpp v4, v4, v4 row_mirror row_mask:0xf bank_mask:0xf
 v_mov_b32 v5, v4
 s_nop 1
 v_permlane16_swap_b32 v4, v5
 v_add_f32 v4, v4, v5
 v_mov_b32 v5, v4
 s_nop 1
 v_permlane32_swap_b32 v4, v5
 v_add_f32 v4, v4, v5
 v_mul_f32 v4, 0x3a800000, v4
 CV 4,4,4
 v_and_b32 v4, 0xffff0000, v4
 CV 6,6,6
 v_and_b32 v6, 0xffff0000, v6
 v_add_f32 v4, 0x3727c5ac, v4
 CV 4,4,4
 v_and_b32 v4, 0xffff0000, v4
 v_sqrt_f32 v4, v4
 s_nop 0
 CV 4,4,4
 v_and_b32 v4, 0xffff0000, v4
 v_rcp_f32 v7, v4
 v_sub_f32 v16, v16, v6
 v_sub_f32 v17, v17, v6
 v_sub_f32 v18, v18, v6
 v_sub_f32 v19, v19, v6
 v_sub_f32 v20, v20, v6
 v_sub_f32 v21, v21, v6
 v_sub_f32 v22, v22, v6
 v_sub_f32 v23, v23, v6
 v_sub_f32 v24, v24, v6
 v_sub_f32 v25, v25, v6
 v_sub_f32 v26, v26, v6
 v_sub_f32 v27, v27, v6
 v_sub_f32 v28, v28, v6
 v_sub_f32 v29, v29, v6
 v_sub_f32 v30, v30, v6
 v_sub_f32 v31, v31, v6
 CV 8,16,17
 v_lshlrev_b32 v16, 16, v8
 v_and_b32 v17, 0xffff0000, v8
 v_mul_f32 v16, v16, v7
 v_mul_f32 v17, v17, v7
 CV 8,16,17
 CV 9,18,19
 v_lshlrev_b32 v18, 16, v9
 v_and_b32 v19, 0xffff0000, v9
 v_mul_f32 v18, v18, v7
 v_mul_f32 v19, v19, v7
 CV 9,18,19
 CV 10,20,21
 v_lshlrev_b32 v20, 16, v10
 v_and_b32 v21, 0xffff0000, v10
 v_mul_f32 v20, v20, v7
 v_mul_f32 v21, v21, v7
 CV 10,20,21
 CV 11,22,23
 v_lshlrev_b32 v22, 16, v11
 v_and_b32 v23, 0xffff0000, v11
 v_mul_f32 v22, v22, v7
 v_mul_f32 v23, v23, v7
 CV 11,22,23
 CV 12,24,25
 v_lshlrev_b32 v24, 16, v12
 v_and_b32 v25, 0xffff0000, v12
 v_mul_f32 v24, v24, v7
 v_mul_f32 v25, v25, v7
 CV 12,24,25
 CV 13,26,27
 v_lshlrev_b32 v26, 16, v13
 v_and_b32 v27, 0xffff0000, v13
 v_mul_f32 v26, v26, v7
 v_mul_f32 v27, v27, v7
 CV 13,26,27
 CV 14,28,29
 v_lshlrev_b32 v28, 16, v14
 v_and_b32 v29, 0xffff0000, v14
 v_mul_f32 v28, v28, v7
 v_mul_f32 v29, v29, v7
 CV 14,28,29
 CV 15,30,31
 v_lshlrev_b32 v30, 16, v15
 v_and_b32 v31, 0xffff0000, v15
 v_mul_f32 v30, v30, v7
 v_mul_f32 v31, v31, v7
 CV 15,30,31
 buffer_store_dwordx4 v[8:11], v3, s[16:19], s34 offen sc1
 buffer_store_dwordx4 v[12:15], v3, s[16:19], s34 offen offset:1024 sc1
 s_add_u32 s33, s33, 2048
 s_add_u32 s34, s34, 2048
 s_nop 1
 s_waitcnt vmcnt(12)
 v_pk_add_f32 v[152:153], v[152:153], v[168:169]
 v_pk_add_f32 v[154:155], v[154:155], v[170:171]
 v_pk_add_f32 v[156:157], v[156:157], v[172:173]
 v_pk_add_f32 v[158:159], v[158:159], v[174:175]
 v_pk_add_f32 v[160:161], v[160:161], v[176:177]
 v_pk_add_f32 v[162:163], v[162:163], v[178:179]
 v_pk_add_f32 v[164:165], v[164:165], v[180:181]
 v_pk_add_f32 v[166:167], v[166:167], v[182:183]
 CV 4,152,153
 v_lshlrev_b32 v5, 16, v4
 v_and_b32 v4, 0xffff0000, v4
 v_lshlrev_b32 v6, 16, v184
 v_and_b32 v7, 0xffff0000, v184
 v_add_f32 v5, v5, v6
 v_add_f32 v4, v4, v7
 CV 168,5,4
 v_lshlrev_b32 v16, 16, v168
 v_and_b32 v17, 0xffff0000, v168
 CV 4,154,155
 v_lshlrev_b32 v5, 16, v4
 v_and_b32 v4, 0xffff0000, v4
 v_lshlrev_b32 v6, 16, v185
 v_and_b32 v7, 0xffff0000, v185
 v_add_f32 v5, v5, v6
 v_add_f32 v4, v4, v7
 CV 169,5,4
 v_lshlrev_b32 v18, 16, v169
 v_and_b32 v19, 0xffff0000, v169
 CV 4,156,157
 v_lshlrev_b32 v5, 16, v4
 v_and_b32 v4, 0xffff0000, v4
 v_lshlrev_b32 v6, 16, v186
 v_and_b32 v7, 0xffff0000, v186
 v_add_f32 v5, v5, v6
 v_add_f32 v4, v4, v7
 CV 170,5,4
 v_lshlrev_b32 v20, 16, v170
 v_and_b32 v21, 0xffff0000, v170
 CV 4,158,159
 v_lshlrev_b32 v5, 16, v4
 v_and_b32 v4, 0xffff0000, v4
 v_lshlrev_b32 v6, 16, v187
 v_and_b32 v7, 0xffff0000, v187
 v_add_f32 v5, v5, v6
 v_add_f32 v4, v4, v7
 CV 171,5,4
 v_lshlrev_b32 v22, 16, v171
 v_and_b32 v23, 0xffff0000, v171
 CV 4,160,161
 v_lshlrev_b32 v5, 16, v4
 v_and_b32 v4, 0xffff0000, v4
 v_lshlrev_b32 v6, 16, v188
 v_and_b32 v7, 0xffff0000, v188
 v_add_f32 v5, v5, v6
 v_add_f32 v4, v4, v7
 CV 172,5,4
 v_lshlrev_b32 v24, 16, v172
 v_and_b32 v25, 0xffff0000, v172
 CV 4,162,163
 v_lshlrev_b32 v5, 16, v4
 v_and_b32 v4, 0xffff0000, v4
 v_lshlrev_b32 v6, 16, v189
 v_and_b32 v7, 0xffff0000, v189
 v_add_f32 v5, v5, v6
 v_add_f32 v4, v4, v7
 CV 173,5,4
 v_lshlrev_b32 v26, 16, v173
 v_and_b32 v27, 0xffff0000, v173
 CV 4,164,165
 v_lshlrev_b32 v5, 16, v4
 v_and_b32 v4, 0xffff0000, v4
 v_lshlrev_b32 v6, 16, v190
 v_and_b32 v7, 0xffff0000, v190
 v_add_f32 v5, v5, v6
 v_add_f32 v4, v4, v7
 CV 174,5,4
 v_lshlrev_b32 v28, 16, v174
 v_and_b32 v29, 0xffff0000, v174
 CV 4,166,167
 v_lshlrev_b32 v5, 16, v4
 v_and_b32 v4, 0xffff0000, v4
 v_lshlrev_b32 v6, 16, v191
 v_and_b32 v7, 0xffff0000, v191
 v_add_f32 v5, v5, v6
 v_add_f32 v4, v4, v7
 CV 175,5,4
 v_lshlrev_b32 v30, 16, v175
 v_and_b32 v31, 0xffff0000, v175
 buffer_store_dwordx4 v[168:171], v3, s[16:19], s33 offen sc1
 buffer_store_dwordx4 v[172:175], v3, s[16:19], s33 offen offset:1024 sc1
 v_add_f32 v4, v16, v17
 v_add_f32 v4, v4, v18
 v_add_f32 v4, v4, v19
 v_add_f32 v4, v4, v20
 v_add_f32 v4, v4, v21
 v_add_f32 v4, v4, v22
 v_add_f32 v4, v4, v23
 v_add_f32 v4, v4, v24
 v_add_f32 v4, v4, v25
 v_add_f32 v4, v4, v26
 v_add_f32 v4, v4, v27
 v_add_f32 v4, v4, v28
 v_add_f32 v4, v4, v29
 v_add_f32 v4, v4, v30
 v_add_f32 v4, v4, v31
 s_nop 1
 v_add_f32_dpp v4, v4, v4 quad_perm:[1,0,3,2] row_mask:0xf bank_mask:0xf
 s_nop 1
 v_add_f32_dpp v4, v4, v4 quad_perm:[2,3,0,1] row_mask:0xf bank_mask:0xf
 s_nop 1
 v_add_f32_dpp v4, v4, v4 row_half_mirror row_mask:0xf bank_mask:0xf
 s_nop 1
 v_add_f32_dpp v4, v4, v4 row_mirror row_mask:0xf bank_mask:0xf
 v_mov_b32 v5, v4
 s_nop 1
 v_permlane16_swap_b32 v4, v5
 v_add_f32 v4, v4, v5
 v_mov_b32 v5, v4
 s_nop 1
 v_permlane32_swap_b32 v4, v5
 v_add_f32 v4, v4, v5
 v_mul_f32 v6, 0x3a800000, v4
 v_sub_f32 v5, v16, v6
 v_mul_f32 v4, v5, v5
 v_sub_f32 v5, v17, v6
 v_fmac_f32 v4, v5, v5
 v_sub_f32 v5, v18, v6
 v_fmac_f32 v4, v5, v5
 v_sub_f32 v5, v19, v6
 v_fmac_f32 v4, v5, v5
 v_sub_f32 v5, v20, v6
 v_fmac_f32 v4, v5, v5
 v_sub_f32 v5, v21, v6
 v_fmac_f32 v4, v5, v5
 v_sub_f32 v5, v22, v6
 v_fmac_f32 v4, v5, v5
 v_sub_f32 v5, v23, v6
 v_fmac_f32 v4, v5, v5
 v_sub_f32 v5, v24, v6
 v_fmac_f32 v4, v5, v5
 v_sub_f32 v5, v25, v6
 v_fmac_f32 v4, v5, v5
 v_sub_f32 v5, v26, v6
 v_fmac_f32 v4, v5, v5
 v_sub_f32 v5, v27, v6
 v_fmac_f32 v4, v5, v5
 v_sub_f32 v5, v28, v6
 v_fmac_f32 v4, v5, v5
 v_sub_f32 v5, v29, v6
 v_fmac_f32 v4, v5, v5
 v_sub_f32 v5, v30, v6
 v_fmac_f32 v4, v5, v5
 v_sub_f32 v5, v31, v6
 v_fmac_f32 v4, v5, v5
 s_nop 1
 v_add_f32_dpp v4, v4, v4 quad_perm:[1,0,3,2] row_mask:0xf bank_mask:0xf
 s_nop 1
 v_add_f32_dpp v4, v4, v4 quad_perm:[2,3,0,1] row_mask:0xf bank_mask:0xf
 s_nop 1
 v_add_f32_dpp v4, v4, v4 row_half_mirror row_mask:0xf bank_mask:0xf
 s_nop 1
 v_add_f32_dpp v4, v4, v4 row_mirror row_mask:0xf bank_mask:0xf
 v_mov_b32 v5, v4
 s_nop 1
 v_permlane16_swap_b32 v4, v5
 v_add_f32 v4, v4, v5
 v_mov_b32 v5, v4
 s_nop 1
 v_permlane32_swap_b32 v4, v5
 v_add_f32 v4, v4, v5
 v_mul_f32 v4, 0x3a800000, v4
 CV 4,4,4
 v_and_b32 v4, 0xffff0000, v4
 CV 6,6,6
 v_and_b32 v6, 0xffff0000, v6
 v_add_f32 v4, 0x3727c5ac, v4
 CV 4,4,4
 v_and_b32 v4, 0xffff0000, v4
 v_sqrt_f32 v4, v4
 s_nop 0
 CV 4,4,4
 v_and_b32 v4, 0xffff0000, v4
 v_rcp_f32 v7, v4
 v_sub_f32 v16, v16, v6
 v_sub_f32 v17, v17, v6
 v_sub_f32 v18, v18, v6
 v_sub_f32 v19, v19, v6
 v_sub_f32 v20, v20, v6
 v_sub_f32 v21, v21, v6
 v_sub_f32 v22, v22, v6
 v_sub_f32 v23, v23, v6
 v_sub_f32 v24, v24, v6
 v_sub_f32 v25, v25, v6
 v_sub_f32 v26, v26, v6
 v_sub_f32 v27, v27, v6
 v_sub_f32 v28, v28, v6
 v_sub_f32 v29, v29, v6
 v_sub_f32 v30, v30, v6
 v_sub_f32 v31, v31, v6
 CV 8,16,17
 v_lshlrev_b32 v16, 16, v8
 v_and_b32 v17, 0xffff0000, v8
 v_mul_f32 v16, v16, v7
 v_mul_f32 v17, v17, v7
 CV 8,16,17
 CV 9,18,19
 v_lshlrev_b32 v18, 16, v9
 v_and_b32 v19, 0xffff0000, v9
 v_mul_f32 v18, v18, v7
 v_mul_f32 v19, v19, v7
 CV 9,18,19
 CV 10,20,21
 v_lshlrev_b32 v20, 16, v10
 v_and_b32 v21, 0xffff0000, v10
 v_mul_f32 v20, v20, v7
 v_mul_f32 v21, v21, v7
 CV 10,20,21
 CV 11,22,23
 v_lshlrev_b32 v22, 16, v11
 v_and_b32 v23, 0xffff0000, v11
 v_mul_f32 v22, v22, v7
 v_mul_f32 v23, v23, v7
 CV 11,22,23
 CV 12,24,25
 v_lshlrev_b32 v24, 16, v12
 v_and_b32 v25, 0xffff0000, v12
 v_mul_f32 v24, v24, v7
 v_mul_f32 v25, v25, v7
 CV 12,24,25
 CV 13,26,27
 v_lshlrev_b32 v26, 16, v13
 v_and_b32 v27, 0xffff0000, v13
 v_mul_f32 v26, v26, v7
 v_mul_f32 v27, v27, v7
 CV 13,26,27
 CV 14,28,29
 v_lshlrev_b32 v28, 16, v14
 v_and_b32 v29, 0xffff0000, v14
 v_mul_f32 v28, v28, v7
 v_mul_f32 v29, v29, v7
 CV 14,28,29
 CV 15,30,31
 v_lshlrev_b32 v30, 16, v15
 v_and_b32 v31, 0xffff0000, v15
 v_mul_f32 v30, v30, v7
 v_mul_f32 v31, v31, v7
 CV 15,30,31
 buffer_store_dwordx4 v[8:11], v3, s[16:19], s34 offen sc1
 buffer_store_dwordx4 v[12:15], v3, s[16:19], s34 offen offset:1024 sc1
 s_add_u32 s33, s33, 2048
 s_add_u32 s34, s34, 2048
 s_nop 1
 s_branch mk_done
mk_b_fin4:
 s_load_dwordx2 s[6:7], s[0:1], 80
 v_lshlrev_b32 v3, 4, v2
 v_lshlrev_b32 v1, 5, v2
 s_and_b32 s26, s11, 31
 s_lshr_b32 s35, s11, 5
 s_lshl_b32 s26, s26, 2
 s_add_u32 s26, s26, s13
 s_lshl_b32 s26, s26, 2
 s_lshl_b32 s27, s10, 9
 s_add_u32 s27, s27, s26
 s_lshl_b32 s27, s27, 12
 s_add_u32 s27, s27, 176160768
 s_lshl_b32 s32, s10, 7
 s_add_u32 s32, s32, s26
 s_lshl_b32 s32, s32, 11
 s_add_u32 s33, s32, 54525952
 s_add_u32 s34, s32, 58720256
 s_waitcnt lgkmcnt(0)
 s_mov_b32 s28, s6
 s_and_b32 s29, s7, 0xffff
 s_mov_b32 s30, 0x400000
 s_mov_b32 s31, 0x00020000
 v_mov_b32 v48, 0
 v_mov_b32 v49, 0
 v_mov_b32 v50, 0
 v_mov_b32 v51, 0
 v_mov_b32 v52, 0
 v_mov_b32 v53, 0
 v_mov_b32 v54, 0
 v_mov_b32 v55, 0
 v_mov_b32 v56, 0
 v_mov_b32 v57, 0
 v_mov_b32 v58, 0
 v_mov_b32 v59, 0
 v_mov_b32 v60, 0
 v_mov_b32 v61, 0
 v_mov_b32 v62, 0
 v_mov_b32 v63, 0
 v_mov_b32 v88, 0
 v_mov_b32 v89, 0
 v_mov_b32 v90, 0
 v_mov_b32 v91, 0
 v_mov_b32 v92, 0
 v_mov_b32 v93, 0
 v_mov_b32 v94, 0
 v_mov_b32 v95, 0
 v_mov_b32 v96, 0
 v_mov_b32 v97, 0
 v_mov_b32 v98, 0
 v_mov_b32 v99, 0
 v_mov_b32 v100, 0
 v_mov_b32 v101, 0
 v_mov_b32 v102, 0
 v_mov_b32 v103, 0
 v_mov_b32 v128, 0
 v_mov_b32 v129, 0
 v_mov_b32 v130, 0
 v_mov_b32 v131, 0
 v_mov_b32 v132, 0
 v_mov_b32 v133, 0
 v_mov_b32 v134, 0
 v_mov_b32 v135, 0
 v_mov_b32 v136, 0
 v_mov_b32 v137, 0
 v_mov_b32 v138, 0
 v_mov_b32 v139, 0
 v_mov_b32 v140, 0
 v_mov_b32 v141, 0
 v_mov_b32 v142, 0
 v_mov_b32 v143, 0
 v_mov_b32 v168, 0
 v_mov_b32 v169, 0
 v_mov_b32 v170, 0
 v_mov_b32 v171, 0
 v_mov_b32 v172, 0
 v_mov_b32 v173, 0
 v_mov_b32 v174, 0
 v_mov_b32 v175, 0
 v_mov_b32 v176, 0
 v_mov_b32 v177, 0
 v_mov_b32 v178, 0
 v_mov_b32 v179, 0
 v_mov_b32 v180, 0
 v_mov_b32 v181, 0
 v_mov_b32 v182, 0
 v_mov_b32 v183, 0
 s_cmp_eq_u32 s35, 0
 s_cbranch_scc1 mk_fin4_np
 s_add_u32 s36, s27, 524288
 buffer_load_dwordx4 v[48:51], v1, s[16:19], s36 offen offset:0 sc1
 buffer_load_dwordx4 v[52:55], v1, s[16:19], s36 offen offset:16 sc1
 buffer_load_dwordx4 v[56:59], v1, s[16:19], s36 offen offset:2048 sc1
 buffer_load_dwordx4 v[60:63], v1, s[16:19], s36 offen offset:2064 sc1
 s_add_u32 s36, s27, 528384
 buffer_load_dwordx4 v[88:91], v1, s[16:19], s36 offen offset:0 sc1
 buffer_load_dwordx4 v[92:95], v1, s[16:19], s36 offen offset:16 sc1
 buffer_load_dwordx4 v[96:99], v1, s[16:19], s36 offen offset:2048 sc1
 buffer_load_dwordx4 v[100:103], v1, s[16:19], s36 offen offset:2064 sc1
 s_add_u32 s36, s27, 532480
 buffer_load_dwordx4 v[128:131], v1, s[16:19], s36 offen offset:0 sc1
 buffer_load_dwordx4 v[132:135], v1, s[16:19], s36 offen offset:16 sc1
 buffer_load_dwordx4 v[136:139], v1, s[16:19], s36 offen offset:2048 sc1
 buffer_load_dwordx4 v[140:143], v1, s[16:19], s36 offen offset:2064 sc1
 s_add_u32 s36, s27, 536576
 buffer_load_dwordx4 v[168:171], v1, s[16:19], s36 offen offset:0 sc1
 buffer_load_dwordx4 v[172:175], v1, s[16:19], s36 offen offset:16 sc1
 buffer_load_dwordx4 v[176:179], v1, s[16:19], s36 offen offset:2048 sc1
 buffer_load_dwordx4 v[180:183], v1, s[16:19], s36 offen offset:2064 sc1
mk_fin4_np:
 s_add_u32 s36, s27, 0
 buffer_load_dwordx4 v[32:35], v1, s[16:19], s36 offen offset:0 sc1
 buffer_load_dwordx4 v[36:39], v1, s[16:19], s36 offen offset:16 sc1
 buffer_load_dwordx4 v[40:43], v1, s[16:19], s36 offen offset:2048 sc1
 buffer_load_dwordx4 v[44:47], v1, s[16:19], s36 offen offset:2064 sc1
 s_add_u32 s36, s33, 0
 buffer_load_dwordx4 v[64:67], v3, s[16:19], s36 offen sc1
 buffer_load_dwordx4 v[68:71], v3, s[16:19], s36 offen offset:1024 sc1
 s_add_u32 s36, s27, 4096
 buffer_load_dwordx4 v[72:75], v1, s[16:19], s36 offen offset:0 sc1
 buffer_load_dwordx4 v[76:79], v1, s[16:19], s36 offen offset:16 sc1
 buffer_load_dwordx4 v[80:83], v1, s[16:19], s36 offen offset:2048 sc1
 buffer_load_dwordx4 v[84:87], v1, s[16:19], s36 offen offset:2064 sc1
 s_add_u32 s36, s33, 2048
 buffer_load_dwordx4 v[104:107], v3, s[16:19], s36 offen sc1
 buffer_load_dwordx4 v[108:111], v3, s[16:19], s36 offen offset:1024 sc1
 s_add_u32 s36, s27, 8192
 buffer_load_dwordx4 v[112:115], v1, s[16:19], s36 offen offset:0 sc1
 buffer_load_dwordx4 v[116:119], v1, s[16:19], s36 offen offset:16 sc1
 buffer_load_dwordx4 v[120:123], v1, s[16:19], s36 offen offset:2048 sc1
 buffer_load_dwordx4 v[124:127], v1, s[16:19], s36 offen offset:2064 sc1
 s_add_u32 s36, s33, 4096
 buffer_load_dwordx4 v[144:147], v3, s[16:19], s36 offen sc1
 buffer_load_dwordx4 v[148:151], v3, s[16:19], s36 offen offset:1024 sc1
 s_add_u32 s36, s27, 12288
 buffer_load_dwordx4 v[152:155], v1, s[16:19], s36 offen offset:0 sc1
 buffer_load_dwordx4 v[156:159], v1, s[16:19], s36 offen offset:16 sc1
 buffer_load_dwordx4 v[160:163], v1, s[16:19], s36 offen offset:2048 sc1
 buffer_load_dwordx4 v[164:167], v1, s[16:19], s36 offen offset:2064 sc1
 s_add_u32 s36, s33, 6144
 buffer_load_dwordx4 v[184:187], v3, s[16:19], s36 offen sc1
 buffer_load_dwordx4 v[188:191], v3, s[16:19], s36 offen offset:1024 sc1
 s_waitcnt vmcnt(18)
 v_pk_add_f32 v[32:33], v[32:33], v[48:49]
 v_pk_add_f32 v[34:35], v[34:35], v[50:51]
 v_pk_add_f32 v[36:37], v[36:37], v[52:53]
 v_pk_add_f32 v[38:39], v[38:39], v[54:55]
 v_pk_add_f32 v[40:41], v[40:41], v[56:57]
 v_pk_add_f32 v[42:43], v[42:43], v[58:59]
 v_pk_add_f32 v[44:45], v[44:45], v[60:61]
 v_pk_add_f32 v[46:47], v[46:47], v[62:63]
 CV 4,32,33
 v_lshlrev_b32 v5, 16, v4
 v_and_b32 v4, 0xffff0000, v4
 v_lshlrev_b32 v6, 16, v64
 v_and_b32 v7, 0xffff0000, v64
 v_add_f32 v5, v5, v6
 v_add_f32 v4, v4, v7
 CV 48,5,4
 CV 4,34,35
 v_lshlrev_b32 v5, 16, v4
 v_and_b32 v4, 0xffff0000, v4
 v_lshlrev_b32 v6, 16, v65
 v_and_b32 v7, 0xffff0000, v65
 v_add_f32 v5, v5, v6
 v_add_f32 v4, v4, v7
 CV 49,5,4
 CV 4,36,37
 v_lshlrev_b32 v5, 16, v4
 v_and_b32 v4, 0xffff0000, v4
 v_lshlrev_b32 v6, 16, v66
 v_and_b32 v7, 0xffff0000, v66
 v_add_f32 v5, v5, v6
 v_add_f32 v4, v4, v7
 CV 50,5,4
 CV 4,38,39
 v_lshlrev_b32 v5, 16, v4
 v_and_b32 v4, 0xffff0000, v4
 v_lshlrev_b32 v6, 16, v67
 v_and_b32 v7, 0xffff0000, v67
 v_add_f32 v5, v5, v6
 v_add_f32 v4, v4, v7
 CV 51,5,4
 CV 4,40,41
 v_lshlrev_b32 v5, 16, v4
 v_and_b32 v4, 0xffff0000, v4
 v_lshlrev_b32 v6, 16, v68
 v_and_b32 v7, 0xffff0000, v68
 v_add_f32 v5, v5, v6
 v_add_f32 v4, v4, v7
 CV 52,5,4
 CV 4,42,43
 v_lshlrev_b32 v5, 16, v4
 v_and_b32 v4, 0xffff0000, v4
 v_lshlrev_b32 v6, 16, v69
 v_and_b32 v7, 0xffff0000, v69
 v_add_f32 v5, v5, v6
 v_add_f32 v4, v4, v7
 CV 53,5,4
 CV 4,44,45
 v_lshlrev_b32 v5, 16, v4
 v_and_b32 v4, 0xffff0000, v4
 v_lshlrev_b32 v6, 16, v70
 v_and_b32 v7, 0xffff0000, v70
 v_add_f32 v5, v5, v6
 v_add_f32 v4, v4, v7
 CV 54,5,4
 CV 4,46,47
 v_lshlrev_b32 v5, 16, v4
 v_and_b32 v4, 0xffff0000, v4
 v_lshlrev_b32 v6, 16, v71
 v_and_b32 v7, 0xffff0000, v71
 v_add_f32 v5, v5, v6
 v_add_f32 v4, v4, v7
 CV 55,5,4
 buffer_store_dwordx4 v[48:51], v3, s[28:31], s32 offen
 buffer_store_dwordx4 v[52:55], v3, s[28:31], s32 offen offset:1024
 s_add_u32 s32, s32, 2048
 s_waitcnt vmcnt(14)
 v_pk_add_f32 v[72:73], v[72:73], v[88:89]
 v_pk_add_f32 v[74:75], v[74:75], v[90:91]
 v_pk_add_f32 v[76:77], v[76:77], v[92:93]
 v_pk_add_f32 v[78:79], v[78:79], v[94:95]
 v_pk_add_f32 v[80:81], v[80:81], v[96:97]
 v_pk_add_f32 v[82:83], v[82:83], v[98:99]
 v_pk_add_f32 v[84:85], v[84:85], v[100:101]
 v_pk_add_f32 v[86:87], v[86:87], v[102:103]
 CV 4,72,73
 v_lshlrev_b32 v5, 16, v4
 v_and_b32 v4, 0xffff0000, v4
 v_lshlrev_b32 v6, 16, v104
 v_and_b32 v7, 0xffff0000, v104
 v_add_f32 v5, v5, v6
 v_add_f32 v4, v4, v7
 CV 88,5,4
 CV 4,74,75
 v_lshlrev_b32 v5, 16, v4
 v_and_b32 v4, 0xffff0000, v4
 v_lshlrev_b32 v6, 16, v105
 v_and_b32 v7, 0xffff0000, v105
 v_add_f32 v5, v5, v6
 v_add_f32 v4, v4, v7
 CV 89,5,4
 CV 4,76,77
 v_lshlrev_b32 v5, 16, v4
 v_and_b32 v4, 0xffff0000, v4
 v_lshlrev_b32 v6, 16, v106
 v_and_b32 v7, 0xffff0000, v106
 v_add_f32 v5, v5, v6
 v_add_f32 v4, v4, v7
 CV 90,5,4
 CV 4,78,79
 v_lshlrev_b32 v5, 16, v4
 v_and_b32 v4, 0xffff0000, v4
 v_lshlrev_b32 v6, 16, v107
 v_and_b32 v7, 0xffff0000, v107
 v_add_f32 v5, v5, v6
 v_add_f32 v4, v4, v7
 CV 91,5,4
 CV 4,80,81
 v_lshlrev_b32 v5, 16, v4
 v_and_b32 v4, 0xffff0000, v4
 v_lshlrev_b32 v6, 16, v108
 v_and_b32 v7, 0xffff0000, v108
 v_add_f32 v5, v5, v6
 v_add_f32 v4, v4, v7
 CV 92,5,4
 CV 4,82,83
 v_lshlrev_b32 v5, 16, v4
 v_and_b32 v4, 0xffff0000, v4
 v_lshlrev_b32 v6, 16, v109
 v_and_b32 v7, 0xffff0000, v109
 v_add_f32 v5, v5, v6
 v_add_f32 v4, v4, v7
 CV 93,5,4
 CV 4,84,85
 v_lshlrev_b32 v5, 16, v4
 v_and_b32 v4, 0xffff0000, v4
 v_lshlrev_b32 v6, 16, v110
 v_and_b32 v7, 0xffff0000, v110
 v_add_f32 v5, v5, v6
 v_add_f32 v4, v4, v7
 CV 94,5,4
 CV 4,86,87
 v_lshlrev_b32 v5, 16, v4
 v_and_b32 v4, 0xffff0000, v4
 v_lshlrev_b32 v6, 16, v111
 v_and_b32 v7, 0xffff0000, v111
 v_add_f32 v5, v5, v6
 v_add_f32 v4, v4, v7
 CV 95,5,4
 buffer_store_dwordx4 v[88:91], v3, s[28:31], s32 offen
 buffer_store_dwordx4 v[92:95], v3, s[28:31], s32 offen offset:1024
 s_add_u32 s32, s32, 2048
 s_waitcnt vmcnt(10)
 v_pk_add_f32 v[112:113], v[112:113], v[128:129]
 v_pk_add_f32 v[114:115], v[114:115], v[130:131]
 v_pk_add_f32 v[116:117], v[116:117], v[132:133]
 v_pk_add_f32 v[118:119], v[118:119], v[134:135]
 v_pk_add_f32 v[120:121], v[120:121], v[136:137]
 v_pk_add_f32 v[122:123], v[122:123], v[138:139]
 v_pk_add_f32 v[124:125], v[124:125], v[140:141]
 v_pk_add_f32 v[126:127], v[126:127], v[142:143]
 CV 4,112,113
 v_lshlrev_b32 v5, 16, v4
 v_and_b32 v4, 0xffff0000, v4
 v_lshlrev_b32 v6, 16, v144
 v_and_b32 v7, 0xffff0000, v144
 v_add_f32 v5, v5, v6
 v_add_f32 v4, v4, v7
 CV 128,5,4
 CV 4,114,115
 v_lshlrev_b32 v5, 16, v4
 v_and_b32 v4, 0xffff0000, v4
 v_lshlrev_b32 v6, 16, v145
 v_and_b32 v7, 0xffff0000, v145
 v_add_f32 v5, v5, v6
 v_add_f32 v4, v4, v7
 CV 129,5,4
 CV 4,116,117
 v_lshlrev_b32 v5, 16, v4
 v_and_b32 v4, 0xffff0000, v4
 v_lshlrev_b32 v6, 16, v146
 v_and_b32 v7, 0xffff0000, v146
 v_add_f32 v5, v5, v6
 v_add_f32 v4, v4, v7
 CV 130,5,4
 CV 4,118,119
 v_lshlrev_b32 v5, 16, v4
 v_and_b32 v4, 0xffff0000, v4
 v_lshlrev_b32 v6, 16, v147
 v_and_b32 v7, 0xffff0000, v147
 v_add_f32 v5, v5, v6
 v_add_f32 v4, v4, v7
 CV 131,5,4
 CV 4,120,121
 v_lshlrev_b32 v5, 16, v4
 v_and_b32 v4, 0xffff0000, v4
 v_lshlrev_b32 v6, 16, v148
 v_and_b32 v7, 0xffff0000, v148
 v_add_f32 v5, v5, v6
 v_add_f32 v4, v4, v7
 CV 132,5,4
 CV 4,122,123
 v_lshlrev_b32 v5, 16, v4
 v_and_b32 v4, 0xffff0000, v4
 v_lshlrev_b32 v6, 16, v149
 v_and_b32 v7, 0xffff0000, v149
 v_add_f32 v5, v5, v6
 v_add_f32 v4, v4, v7
 CV 133,5,4
 CV 4,124,125
 v_lshlrev_b32 v5, 16, v4
 v_and_b32 v4, 0xffff0000, v4
 v_lshlrev_b32 v6, 16, v150
 v_and_b32 v7, 0xffff0000, v150
 v_add_f32 v5, v5, v6
 v_add_f32 v4, v4, v7
 CV 134,5,4
 CV 4,126,127
 v_lshlrev_b32 v5, 16, v4
 v_and_b32 v4, 0xffff0000, v4
 v_lshlrev_b32 v6, 16, v151
 v_and_b32 v7, 0xffff0000, v151
 v_add_f32 v5, v5, v6
 v_add_f32 v4, v4, v7
 CV 135,5,4
 buffer_store_dwordx4 v[128:131], v3, s[28:31], s32 offen
 buffer_store_dwordx4 v[132:135], v3, s[28:31], s32 offen offset:1024
 s_add_u32 s32, s32, 2048
 s_waitcnt vmcnt(6)
 v_pk_add_f32 v[152:153], v[152:153], v[168:169]
 v_pk_add_f32 v[154:155], v[154:155], v[170:171]
 v_pk_add_f32 v[156:157], v[156:157], v[172:173]
 v_pk_add_f32 v[158:159], v[158:159], v[174:175]
 v_pk_add_f32 v[160:161], v[160:161], v[176:177]
 v_pk_add_f32 v[162:163], v[162:163], v[178:179]
 v_pk_add_f32 v[164:165], v[164:165], v[180:181]
 v_pk_add_f32 v[166:167], v[166:167], v[182:183]
 CV 4,152,153
 v_lshlrev_b32 v5, 16, v4
 v_and_b32 v4, 0xffff0000, v4
 v_lshlrev_b32 v6, 16, v184
 v_and_b32 v7, 0xffff0000, v184
 v_add_f32 v5, v5, v6
 v_add_f32 v4, v4, v7
 CV 168,5,4
 CV 4,154,155
 v_lshlrev_b32 v5, 16, v4
 v_and_b32 v4, 0xffff0000, v4
 v_lshlrev_b32 v6, 16, v185
 v_and_b32 v7, 0xffff0000, v185
 v_add_f32 v5, v5, v6
 v_add_f32 v4, v4, v7
 CV 169,5,4
 CV 4,156,157
 v_lshlrev_b32 v5, 16, v4
 v_and_b32 v4, 0xffff0000, v4
 v_lshlrev_b32 v6, 16, v186
 v_and_b32 v7, 0xffff0000, v186
 v_add_f32 v5, v5, v6
 v_add_f32 v4, v4, v7
 CV 170,5,4
 CV 4,158,159
 v_lshlrev_b32 v5, 16, v4
 v_and_b32 v4, 0xffff0000, v4
 v_lshlrev_b32 v6, 16, v187
 v_and_b32 v7, 0xffff0000, v187
 v_add_f32 v5, v5, v6
 v_add_f32 v4, v4, v7
 CV 171,5,4
 CV 4,160,161
 v_lshlrev_b32 v5, 16, v4
 v_and_b32 v4, 0xffff0000, v4
 v_lshlrev_b32 v6, 16, v188
 v_and_b32 v7, 0xffff0000, v188
 v_add_f32 v5, v5, v6
 v_add_f32 v4, v4, v7
 CV 172,5,4
 CV 4,162,163
 v_lshlrev_b32 v5, 16, v4
 v_and_b32 v4, 0xffff0000, v4
 v_lshlrev_b32 v6, 16, v189
 v_and_b32 v7, 0xffff0000, v189
 v_add_f32 v5, v5, v6
 v_add_f32 v4, v4, v7
 CV 173,5,4
 CV 4,164,165
 v_lshlrev_b32 v5, 16, v4
 v_and_b32 v4, 0xffff0000, v4
 v_lshlrev_b32 v6, 16, v190
 v_and_b32 v7, 0xffff0000, v190
 v_add_f32 v5, v5, v6
 v_add_f32 v4, v4, v7
 CV 174,5,4
 CV 4,166,167
 v_lshlrev_b32 v5, 16, v4
 v_and_b32 v4, 0xffff0000, v4
 v_lshlrev_b32 v6, 16, v191
 v_and_b32 v7, 0xffff0000, v191
 v_add_f32 v5, v5, v6
 v_add_f32 v4, v4, v7
 CV 175,5,4
 buffer_store_dwordx4 v[168:171], v3, s[28:31], s32 offen
 buffer_store_dwordx4 v[172:175], v3, s[28:31], s32 offen offset:1024
 s_add_u32 s32, s32, 2048
 s_branch mk_done
mk_b_at2:
 s_mul_i32 s11, s11, 2
 v_lshlrev_b32 v236, 4, v2
 v_add_u32 v237, 0x1000, v236
 s_lshl_b32 s26, s10, 2
 s_add_u32 s26, s26, s13
 s_lshl_b32 s27, s26, 5
 s_add_u32 s27, s27, s11
 s_lshl_b32 s27, s27, 13
 s_add_u32 s28, s27, 4194304
 s_add_u32 s29, s27, 20971520
 s_add_u32 s27, s27, 121634816
 s_lshl_b32 s30, s26, 19
 s_lshl_b32 s31, s11, 13
 s_add_u32 s30, s30, s31
 s_add_u32 s30, s30, 84017152
 s_mov_b32 s34, 0x3e0293ee
 s_mov_b32 s36, 0
 s_mov_b32 s37, -1
 s_mov_b32 s38, -1
 s_mov_b32 s39, 0
 s_mul_i32 s31, s13, 20480
 buffer_load_dwordx4 v[124:127], v236, s[16:19], s27 offen offset:0 sc1
 buffer_load_dwordx4 v[128:131], v236, s[16:19], s27 offen offset:1024 sc1
 buffer_load_dwordx4 v[132:135], v236, s[16:19], s27 offen offset:2048 sc1
 buffer_load_dwordx4 v[136:139], v236, s[16:19], s27 offen offset:3072 sc1
 buffer_load_dwordx4 v[140:143], v237, s[16:19], s27 offen offset:0 sc1
 buffer_load_dwordx4 v[144:147], v237, s[16:19], s27 offen offset:1024 sc1
 buffer_load_dwordx4 v[148:151], v237, s[16:19], s27 offen offset:2048 sc1
 buffer_load_dwordx4 v[152:155], v237, s[16:19], s27 offen offset:3072 sc1
 s_add_u32 s27, s27, 8192
 buffer_load_dwordx4 v[204:207], v236, s[16:19], s27 offen offset:0 sc1
 buffer_load_dwordx4 v[208:211], v236, s[16:19], s27 offen offset:1024 sc1
 buffer_load_dwordx4 v[212:215], v236, s[16:19], s27 offen offset:2048 sc1
 buffer_load_dwordx4 v[216:219], v236, s[16:19], s27 offen offset:3072 sc1
 buffer_load_dwordx4 v[220:223], v237, s[16:19], s27 offen offset:0 sc1
 buffer_load_dwordx4 v[224:227], v237, s[16:19], s27 offen offset:1024 sc1
 buffer_load_dwordx4 v[228:231], v237, s[16:19], s27 offen offset:2048 sc1
 buffer_load_dwordx4 v[232:235], v237, s[16:19], s27 offen offset:3072 sc1
 s_add_u32 s27, s27, 8192
 v_and_b32 v243, 15, v2
 v_lshrrev_b32 v244, 4, v2
 v_lshrrev_b32 v245, 1, v244
 v_lshlrev_b32 v238, 12, v245
 v_and_b32 v245, 3, v243
 v_lshl_add_u32 v238, v245, 8, v238
 v_and_b32 v246, 1, v244
 v_lshl_add_u32 v238, v246, 7, v238
 v_lshrrev_b32 v247, 2, v243
 v_lshl_add_u32 v238, v247, 4, v238
 v_add_u32 v238, s31, v238
 v_lshl_add_u32 v239, v246, 2, v247
 v_lshlrev_b32 v239, 8, v239
 v_lshl_add_u32 v239, v245, 4, v239
 v_add_u32 v239, s31, v239
 v_add_u32 v239, 0x2000, v239
 v_lshlrev_b32 v245, 3, v244
 v_sub_u32 v240, v243, v245
 v_lshlrev_b32 v241, 13, v243
 v_lshl_add_u32 v241, v244, 4, v241
 v_mov_b32 v242, 0xff800000
 s_lshl_b32 s32, s26, 18
 s_lshl_b32 s33, s11, 8
 s_add_u32 s32, s32, s33
 s_add_u32 s32, s32, 37748736
 s_add_u32 s33, s32, 131072
 s_add_u32 s33, s30, 15360
 s_mov_b32 s35, 524288
mk_at2_w1:
 buffer_load_dwordx4 v[4:7], v236, s[16:19], s33 offen sc1
 s_sub_u32 s35, s35, 1
 s_cbranch_scc1 mk_end
 s_waitcnt vmcnt(0)
 v_cmp_eq_u32 vcc, -1, v7
 s_cbranch_vccz mk_at2_w2
 s_sleep 2
 s_branch mk_at2_w1
mk_at2_w2:
 s_add_u32 s33, s30, 0
 buffer_load_dwordx4 v[108:111], v236, s[16:19], s33 offen offset:0 sc1
 buffer_load_dwordx4 v[112:115], v236, s[16:19], s33 offen offset:1024 sc1
 buffer_load_dwordx4 v[116:119], v236, s[16:19], s33 offen offset:2048 sc1
 buffer_load_dwordx4 v[120:123], v236, s[16:19], s33 offen offset:3072 sc1
 buffer_load_dwordx4 v[4:7], v237, s[16:19], s33 offen offset:2048 sc1
 buffer_load_dwordx4 v[8:11], v237, s[16:19], s33 offen offset:3072 sc1
 s_add_u32 s33, s30, 8192
 buffer_load_dwordx4 v[188:191], v236, s[16:19], s33 offen offset:0 sc1
 buffer_load_dwordx4 v[192:195], v236, s[16:19], s33 offen offset:1024 sc1
 buffer_load_dwordx4 v[196:199], v236, s[16:19], s33 offen offset:2048 sc1
 buffer_load_dwordx4 v[200:203], v236, s[16:19], s33 offen offset:3072 sc1
 buffer_load_dwordx4 v[12:15], v237, s[16:19], s33 offen offset:2048 sc1
 buffer_load_dwordx4 v[16:19], v237, s[16:19], s33 offen offset:3072 sc1
 s_sub_u32 s35, s35, 1
 s_cbranch_scc1 mk_end
 s_waitcnt vmcnt(0)
 v_max3_u32 v243, v108, v109, v110
 v_max3_u32 v243, v243, v111, v112
 v_max3_u32 v243, v243, v113, v114
 v_max3_u32 v243, v243, v115, v116
 v_max3_u32 v243, v243, v117, v118
 v_max3_u32 v243, v243, v119, v120
 v_max3_u32 v243, v243, v121, v122
 v_max3_u32 v243, v243, v123, v188
 v_max3_u32 v243, v243, v189, v190
 v_max3_u32 v243, v243, v191, v192
 v_max3_u32 v243, v243, v193, v194
 v_max3_u32 v243, v243, v195, v196
 v_max3_u32 v243, v243, v197, v198
 v_max3_u32 v243, v243, v199, v200
 v_max3_u32 v243, v243, v201, v202
 v_max_u32 v243, v243, v203
 s_mov_b32 exec_lo, 0x00ff00ff
 s_mov_b32 exec_hi, 0x00ff00ff
 v_mov_b32 v243, 0
 s_mov_b64 exec, -1
 v_max3_u32 v243, v243, v4, v5
 v_max3_u32 v243, v243, v6, v7
 v_max3_u32 v243, v243, v8, v9
 v_max3_u32 v243, v243, v10, v11
 v_max3_u32 v243, v243, v12, v13
 v_max3_u32 v243, v243, v14, v15
 v_max3_u32 v243, v243, v16, v17
 v_max3_u32 v243, v243, v18, v19
 v_cmp_eq_u32 vcc, -1, v243
 s_cbranch_vccnz mk_at2_w2
 s_add_u32 s32, s28, 0
 buffer_load_dwordx4 v[76:79], v236, s[16:19], s32 offen offset:0 sc1
 buffer_load_dwordx4 v[80:83], v236, s[16:19], s32 offen offset:1024 sc1
 buffer_load_dwordx4 v[84:87], v236, s[16:19], s32 offen offset:2048 sc1
 buffer_load_dwordx4 v[88:91], v236, s[16:19], s32 offen offset:3072 sc1
 buffer_load_dwordx4 v[92:95], v237, s[16:19], s32 offen offset:0 sc1
 buffer_load_dwordx4 v[96:99], v237, s[16:19], s32 offen offset:1024 sc1
 buffer_load_dwordx4 v[100:103], v237, s[16:19], s32 offen offset:2048 sc1
 buffer_load_dwordx4 v[104:107], v237, s[16:19], s32 offen offset:3072 sc1
 s_add_u32 s32, s28, 8192
 buffer_load_dwordx4 v[156:159], v236, s[16:19], s32 offen offset:0 sc1
 buffer_load_dwordx4 v[160:163], v236, s[16:19], s32 offen offset:1024 sc1
 buffer_load_dwordx4 v[164:167], v236, s[16:19], s32 offen offset:2048 sc1
 buffer_load_dwordx4 v[168:171], v236, s[16:19], s32 offen offset:3072 sc1
 buffer_load_dwordx4 v[172:175], v237, s[16:19], s32 offen offset:0 sc1
 buffer_load_dwordx4 v[176:179], v237, s[16:19], s32 offen offset:1024 sc1
 buffer_load_dwordx4 v[180:183], v237, s[16:19], s32 offen offset:2048 sc1
 buffer_load_dwordx4 v[184:187], v237, s[16:19], s32 offen offset:3072 sc1
 s_add_u32 m0, s31, 0
 s_add_u32 s35, s29, 0
 buffer_load_dwordx4 v236, s[16:19], s35 offen sc1 lds
 s_add_u32 m0, s31, 1024
 s_add_u32 s35, s29, 1024
 buffer_load_dwordx4 v236, s[16:19], s35 offen sc1 lds
 s_add_u32 m0, s31, 2048
 s_add_u32 s35, s29, 2048
 buffer_load_dwordx4 v236, s[16:19], s35 offen sc1 lds
 s_add_u32 m0, s31, 3072
 s_add_u32 s35, s29, 3072
 buffer_load_dwordx4 v236, s[16:19], s35 offen sc1 lds
 s_add_u32 m0, s31, 4096
 s_add_u32 s35, s29, 4096
 buffer_load_dwordx4 v236, s[16:19], s35 offen sc1 lds
 s_add_u32 m0, s31, 5120
 s_add_u32 s35, s29, 5120
 buffer_load_dwordx4 v236, s[16:19], s35 offen sc1 lds
 s_add_u32 m0, s31, 6144
 s_add_u32 s35, s29, 6144
 buffer_load_dwordx4 v236, s[16:19], s35 offen sc1 lds
 s_add_u32 m0, s31, 7168
 s_add_u32 s35, s29, 7168
 buffer_load_dwordx4 v236, s[16:19], s35 offen sc1 lds
 s_add_u32 m0, s31, 8192
 s_add_u32 s35, s30, 6144
 buffer_load_dwordx4 v236, s[16:19], s35 offen sc1 lds
 s_add_u32 m0, s31, 9216
 s_add_u32 s35, s30, 7168
 buffer_load_dwordx4 v236, s[16:19], s35 offen sc1 lds
 s_add_u32 m0, s31, 10240
 s_add_u32 s35, s29, 8192
 buffer_load_dwordx4 v236, s[16:19], s35 offen sc1 lds
 s_add_u32 m0, s31, 11264
 s_add_u32 s35, s29, 9216
 buffer_load_dwordx4 v236, s[16:19], s35 offen sc1 lds
 s_add_u32 m0, s31, 12288
 s_add_u32 s35, s29, 10240
 buffer_load_dwordx4 v236, s[16:19], s35 offen sc1 lds
 s_add_u32 m0, s31, 13312
 s_add_u32 s35, s29, 11264
 buffer_load_dwordx4 v236, s[16:19], s35 offen sc1 lds
 s_add_u32 m0, s31, 14336
 s_add_u32 s35, s29, 12288
 buffer_load_dwordx4 v236, s[16:19], s35 offen sc1 lds
 s_add_u32 m0, s31, 15360
 s_add_u32 s35, s29, 13312
 buffer_load_dwordx4 v236, s[16:19], s35 offen sc1 lds
 s_add_u32 m0, s31, 16384
 s_add_u32 s35, s29, 14336
 buffer_load_dwordx4 v236, s[16:19], s35 offen sc1 lds
 s_add_u32 m0, s31, 17408
 s_add_u32 s35, s29, 15360
 buffer_load_dwordx4 v236, s[16:19], s35 offen sc1 lds
 s_add_u32 m0, s31, 18432
 s_add_u32 s35, s30, 14336
 buffer_load_dwordx4 v236, s[16:19], s35 offen sc1 lds
 s_add_u32 m0, s31, 19456
 s_add_u32 s35, s30, 15360
 buffer_load_dwordx4 v236, s[16:19], s35 offen sc1 lds
 s_lshl_b32 s32, s26, 18
 s_lshl_b32 s33, s11, 8
 s_add_u32 s32, s32, s33
 s_add_u32 s32, s32, 37748736
 s_add_u32 s33, s32, 131072
 s_waitcnt vmcnt(20)
 v_mfma_f32_16x16x32_bf16 v[4:7], v[76:79], v[124:127], 0
 v_mfma_f32_16x16x32_bf16 v[8:11], v[92:95], v[124:127], 0
 v_mfma_f32_16x16x32_bf16 v[12:15], v[108:111], v[124:127], 0
 MF v[4:7],v[80:83],v[128:131]
 MF v[8:11],v[96:99],v[128:131]
 MF v[12:15],v[112:115],v[128:131]
 MF v[4:7],v[84:87],v[132:135]
 MF v[8:11],v[100:103],v[132:135]
 MF v[12:15],v[116:119],v[132:135]
 MF v[4:7],v[88:91],v[136:139]
 MF v[8:11],v[104:107],v[136:139]
 MF v[12:15],v[120:123],v[136:139]
 v_mfma_f32_16x16x32_bf16 v[16:19], v[76:79], v[140:143], 0
 v_mfma_f32_16x16x32_bf16 v[20:23], v[92:95], v[140:143], 0
 v_mfma_f32_16x16x32_bf16 v[24:27], v[108:111], v[140:143], 0
 MF v[16:19],v[80:83],v[144:147]
 MF v[20:23],v[96:99],v[144:147]
 MF v[24:27],v[112:115],v[144:147]
 MF v[16:19],v[84:87],v[148:151]
 MF v[20:23],v[100:103],v[148:151]
 MF v[24:27],v[116:119],v[148:151]
 MF v[16:19],v[88:91],v[152:155]
 MF v[20:23],v[104:107],v[152:155]
 MF v[24:27],v[120:123],v[152:155]
 s_nop 7
 v_cmp_gt_i32 vcc, 0, v240
 s_nop 1
 v_cndmask_b32 v4, v4, v242, vcc
 v_cmp_gt_i32 vcc, 1, v240
 s_nop 1
 v_cndmask_b32 v5, v5, v242, vcc
 v_cmp_gt_i32 vcc, 2, v240
 s_nop 1
 v_cndmask_b32 v6, v6, v242, vcc
 v_cmp_gt_i32 vcc, 3, v240
 s_nop 1
 v_cndmask_b32 v7, v7, v242, vcc
 v_cmp_gt_i32 vcc, 4, v240
 s_nop 1
 v_cndmask_b32 v8, v8, v242, vcc
 v_cmp_gt_i32 vcc, 5, v240
 s_nop 1
 v_cndmask_b32 v9, v9, v242, vcc
 v_cmp_gt_i32 vcc, 6, v240
 s_nop 1
 v_cndmask_b32 v10, v10, v242, vcc
 v_cmp_gt_i32 vcc, 7, v240
 s_nop 1
 v_cndmask_b32 v11, v11, v242, vcc
 v_max3_f32 v243, v4, v5, v6
 v_max3_f32 v243, v243, v7, v8
 v_max3_f32 v243, v243, v9, v10
 v_max_f32 v243, v243, v11
 s_mov_b64 exec, s[36:37]
 v_max3_f32 v243, v243, v12, v13
 v_max3_f32 v243, v243, v14, v15
 s_mov_b64 exec, -1
 v_mov_b32 v244, v243
 s_nop 1
 v_permlane32_swap_b32 v243, v244
 v_max_f32 v243, v243, v244
 v_mov_b32 v244, v243
 s_nop 1
 v_permlane16_swap_b32 v243, v244
 v_max_f32 v243, v243, v244
 v_sub_f32 v4, v4, v243
 v_sub_f32 v5, v5, v243
 v_sub_f32 v6, v6, v243
 v_sub_f32 v7, v7, v243
 v_sub_f32 v8, v8, v243
 v_sub_f32 v9, v9, v243
 v_sub_f32 v10, v10, v243
 v_sub_f32 v11, v11, v243
 v_sub_f32 v12, v12, v243
 v_sub_f32 v13, v13, v243
 v_sub_f32 v14, v14, v243
 v_sub_f32 v15, v15, v243
 v_mul_f32 v4, s34, v4
 v_mul_f32 v5, s34, v5
 v_mul_f32 v6, s34, v6
 v_mul_f32 v7, s34, v7
 v_mul_f32 v8, s34, v8
 v_mul_f32 v9, s34, v9
 v_mul_f32 v10, s34, v10
 v_mul_f32 v11, s34, v11
 v_mul_f32 v12, s34, v12
 v_mul_f32 v13, s34, v13
 v_mul_f32 v14, s34, v14
 v_mul_f32 v15, s34, v15
 v_exp_f32 v4, v4
 v_exp_f32 v5, v5
 v_exp_f32 v6, v6
 v_exp_f32 v7, v7
 v_exp_f32 v8, v8
 v_exp_f32 v9, v9
 v_exp_f32 v10, v10
 v_exp_f32 v11, v11
 v_exp_f32 v12, v12
 v_exp_f32 v13, v13
 v_exp_f32 v14, v14
 v_exp_f32 v15, v15
 s_mov_b64 exec, s[38:39]
 v_mov_b32 v12, 0
 v_mov_b32 v13, 0
 v_mov_b32 v14, 0
 v_mov_b32 v15, 0
 s_mov_b64 exec, -1
 v_add_f32 v245, v4, v5
 v_add_f32 v245, v245, v6
 v_add_f32 v245, v245, v7
 v_add_f32 v245, v245, v8
 v_add_f32 v245, v245, v9
 v_add_f32 v245, v245, v10
 v_add_f32 v245, v245, v11
 v_add_f32 v245, v245, v12
 v_add_f32 v245, v245, v13
 v_add_f32 v245, v245, v14
 v_add_f32 v245, v245, v15
 v_mov_b32 v244, v245
 s_nop 1
 v_permlane32_swap_b32 v245, v244
 v_add_f32 v245, v245, v244
 v_mov_b32 v244, v245
 s_nop 1
 v_permlane16_swap_b32 v245, v244
 v_add_f32 v245, v245, v244
 v_rcp_f32 v245, v245
 s_nop 0
 v_mul_f32 v4, v4, v245
 v_mul_f32 v5, v5, v245
 v_mul_f32 v6, v6, v245
 v_mul_f32 v7, v7, v245
 v_mul_f32 v8, v8, v245
 v_mul_f32 v9, v9, v245
 v_mul_f32 v10, v10, v245
 v_mul_f32 v11, v11, v245
 v_mul_f32 v12, v12, v245
 v_mul_f32 v13, v13, v245
 v_mul_f32 v14, v14, v245
 v_mul_f32 v15, v15, v245
 CV 28,4,5
 CV 29,6,7
 CV 30,8,9
 CV 31,10,11
 CV 32,12,13
 CV 33,14,15
 v_cmp_gt_i32 vcc, -16, v240
 s_nop 1
 v_cndmask_b32 v16, v16, v242, vcc
 v_cmp_gt_i32 vcc, -15, v240
 s_nop 1
 v_cndmask_b32 v17, v17, v242, vcc
 v_cmp_gt_i32 vcc, -14, v240
 s_nop 1
 v_cndmask_b32 v18, v18, v242, vcc
 v_cmp_gt_i32 vcc, -13, v240
 s_nop 1
 v_cndmask_b32 v19, v19, v242, vcc
 v_cmp_gt_i32 vcc, -12, v240
 s_nop 1
 v_cndmask_b32 v20, v20, v242, vcc
 v_cmp_gt_i32 vcc, -11, v240
 s_nop 1
 v_cndmask_b32 v21, v21, v242, vcc
 v_cmp_gt_i32 vcc, -10, v240
 s_nop 1
 v_cndmask_b32 v22, v22, v242, vcc
 v_cmp_gt_i32 vcc, -9, v240
 s_nop 1
 v_cndmask_b32 v23, v23, v242, vcc
 v_max3_f32 v243, v16, v17, v18
 v_max3_f32 v243, v243, v19, v20
 v_max3_f32 v243, v243, v21, v22
 v_max_f32 v243, v243, v23
 s_mov_b64 exec, s[36:37]
 v_max3_f32 v243, v243, v24, v25
 v_max3_f32 v243, v243, v26, v27
 s_mov_b64 exec, -1
 v_mov_b32 v244, v243
 s_nop 1
 v_permlane32_swap_b32 v243, v244
 v_max_f32 v243, v243, v244
 v_mov_b32 v244, v243
 s_nop 1
 v_permlane16_swap_b32 v243, v244
 v_max_f32 v243, v243, v244
 v_sub_f32 v16, v16, v243
 v_sub_f32 v17, v17, v243
 v_sub_f32 v18, v18, v243
 v_sub_f32 v19, v19, v243
 v_sub_f32 v20, v20, v243
 v_sub_f32 v21, v21, v243
 v_sub_f32 v22, v22, v243
 v_sub_f32 v23, v23, v243
 v_sub_f32 v24, v24, v243
 v_sub_f32 v25, v25, v243
 v_sub_f32 v26, v26, v243
 v_sub_f32 v27, v27, v243
 v_mul_f32 v16, s34, v16
 v_mul_f32 v17, s34, v17
 v_mul_f32 v18, s34, v18
 v_mul_f32 v19, s34, v19
 v_mul_f32 v20, s34, v20
 v_mul_f32 v21, s34, v21
 v_mul_f32 v22, s34, v22
 v_mul_f32 v23, s34, v23
 v_mul_f32 v24, s34, v24
 v_mul_f32 v25, s34, v25
 v_mul_f32 v26, s34, v26
 v_mul_f32 v27, s34, v27
 v_exp_f32 v16, v16
 v_exp_f32 v17, v17
 v_exp_f32 v18, v18
 v_exp_f32 v19, v19
 v_exp_f32 v20, v20
 v_exp_f32 v21, v21
 v_exp_f32 v22, v22
 v_exp_f32 v23, v23
 v_exp_f32 v24, v24
 v_exp_f32 v25, v25
 v_exp_f32 v26, v26
 v_exp_f32 v27, v27
 s_mov_b64 exec, s[38:39]
 v_mov_b32 v24, 0
 v_mov_b32 v25, 0
 v_mov_b32 v26, 0
 v_mov_b32 v27, 0
 s_mov_b64 exec, -1
 v_add_f32 v245, v16, v17
 v_add_f32 v245, v245, v18
 v_add_f32 v245, v245, v19
 v_add_f32 v245, v245, v20
 v_add_f32 v245, v245, v21
 v_add_f32 v245, v245, v22
 v_add_f32 v245, v245, v23
 v_add_f32 v245, v245, v24
 v_add_f32 v245, v245, v25
 v_add_f32 v245, v245, v26
 v_add_f32 v245, v245, v27
 v_mov_b32 v244, v245
 s_nop 1
 v_permlane32_swap_b32 v245, v244
 v_add_f32 v245, v245, v244
 v_mov_b32 v244, v245
 s_nop 1
 v_permlane16_swap_b32 v245, v244
 v_add_f32 v245, v245, v244
 v_rcp_f32 v245, v245
 s_nop 0
 v_mul_f32 v16, v16, v245
 v_mul_f32 v17, v17, v245
 v_mul_f32 v18, v18, v245
 v_mul_f32 v19, v19, v245
 v_mul_f32 v20, v20, v245
 v_mul_f32 v21, v21, v245
 v_mul_f32 v22, v22, v245
 v_mul_f32 v23, v23, v245
 v_mul_f32 v24, v24, v245
 v_mul_f32 v25, v25, v245
 v_mul_f32 v26, v26, v245
 v_mul_f32 v27, v27, v245
 CV 36,16,17
 CV 37,18,19
 CV 38,20,21
 CV 39,22,23
 CV 40,24,25
 CV 41,26,27
 s_waitcnt vmcnt(10)
 TR 60,61,238,0
 TR 62,63,238,64
 TR 68,69,239,0
 TR 64,65,238,8
 TR 66,67,238,72
 TR 70,71,239,8
 s_waitcnt lgkmcnt(0)
 v_mfma_f32_16x16x32_bf16 v[44:47], v[60:63], v[28:31], 0
 v_mfma_f32_16x16x32_bf16 v[48:51], v[64:67], v[28:31], 0
 v_mfma_f32_16x16x32_bf16 v[52:55], v[60:63], v[36:39], 0
 v_mfma_f32_16x16x32_bf16 v[56:59], v[64:67], v[36:39], 0
 s_nop 3
 v_mfma_f32_16x16x16_bf16 v[44:47], v[68:69], v[32:33], v[44:47]
 v_mfma_f32_16x16x16_bf16 v[48:51], v[70:71], v[32:33], v[48:51]
 v_mfma_f32_16x16x16_bf16 v[52:55], v[68:69], v[40:41], v[52:55]
 v_mfma_f32_16x16x16_bf16 v[56:59], v[70:71], v[40:41], v[56:59]
 s_nop 7
 CV 4,44,45
 CV 5,46,47
 CV 6,48,49
 CV 7,50,51
 buffer_store_dwordx4 v[4:7], v241, s[16:19], s32 offen offset:0 sc1
 CV 8,52,53
 CV 9,54,55
 CV 10,56,57
 CV 11,58,59
 buffer_store_dwordx4 v[8:11], v241, s[16:19], s33 offen offset:0 sc1
 TR 60,61,238,1024
 TR 62,63,238,1088
 TR 68,69,239,64
 TR 64,65,238,1032
 TR 66,67,238,1096
 TR 70,71,239,72
 s_waitcnt lgkmcnt(0)
 v_mfma_f32_16x16x32_bf16 v[44:47], v[60:63], v[28:31], 0
 v_mfma_f32_16x16x32_bf16 v[48:51], v[64:67], v[28:31], 0
 v_mfma_f32_16x16x32_bf16 v[52:55], v[60:63], v[36:39], 0
 v_mfma_f32_16x16x32_bf16 v[56:59], v[64:67], v[36:39], 0
 s_nop 3
 v_mfma_f32_16x16x16_bf16 v[44:47], v[68:69], v[32:33], v[44:47]
 v_mfma_f32_16x16x16_bf16 v[48:51], v[70:71], v[32:33], v[48:51]
 v_mfma_f32_16x16x16_bf16 v[52:55], v[68:69], v[40:41], v[52:55]
 v_mfma_f32_16x16x16_bf16 v[56:59], v[70:71], v[40:41], v[56:59]
 s_nop 7
 CV 12,44,45
 CV 13,46,47
 CV 14,48,49
 CV 15,50,51
 buffer_store_dwordx4 v[12:15], v241, s[16:19], s32 offen offset:64 sc1
 CV 16,52,53
 CV 17,54,55
 CV 18,56,57
 CV 19,58,59
 buffer_store_dwordx4 v[16:19], v241, s[16:19], s33 offen offset:64 sc1
 TR 60,61,238,2048
 TR 62,63,238,2112
 TR 68,69,239,128
 TR 64,65,238,2056
 TR 66,67,238,2120
 TR 70,71,239,136
 s_waitcnt lgkmcnt(0)
 v_mfma_f32_16x16x32_bf16 v[44:47], v[60:63], v[28:31], 0
 v_mfma_f32_16x16x32_bf16 v[48:51], v[64:67], v[28:31], 0
 v_mfma_f32_16x16x32_bf16 v[52:55], v[60:63], v[36:39], 0
 v_mfma_f32_16x16x32_bf16 v[56:59], v[64:67], v[36:39], 0
 s_nop 3
 v_mfma_f32_16x16x16_bf16 v[44:47], v[68:69], v[32:33], v[44:47]
 v_mfma_f32_16x16x16_bf16 v[48:51], v[70:71], v[32:33], v[48:51]
 v_mfma_f32_16x16x16_bf16 v[52:55], v[68:69], v[40:41], v[52:55]
 v_mfma_f32_16x16x16_bf16 v[56:59], v[70:71], v[40:41], v[56:59]
 s_nop 7
 CV 4,44,45
 CV 5,46,47
 CV 6,48,49
 CV 7,50,51
 buffer_store_dwordx4 v[4:7], v241, s[16:19], s32 offen offset:128 sc1
 CV 8,52,53
 CV 9,54,55
 CV 10,56,57
 CV 11,58,59
 buffer_store_dwordx4 v[8:11], v241, s[16:19], s33 offen offset:128 sc1
 TR 60,61,238,3072
 TR 62,63,238,3136
 TR 68,69,239,192
 TR 64,65,238,3080
 TR 66,67,238,3144
 TR 70,71,239,200
 s_waitcnt lgkmcnt(0)
 v_mfma_f32_16x16x32_bf16 v[44:47], v[60:63], v[28:31], 0
 v_mfma_f32_16x16x32_bf16 v[48:51], v[64:67], v[28:31], 0
 v_mfma_f32_16x16x32_bf16 v[52:55], v[60:63], v[36:39], 0
 v_mfma_f32_16x16x32_bf16 v[56:59], v[64:67], v[36:39], 0
 s_nop 3
 v_mfma_f32_16x16x16_bf16 v[44:47], v[68:69], v[32:33], v[44:47]
 v_mfma_f32_16x16x16_bf16 v[48:51], v[70:71], v[32:33], v[48:51]
 v_mfma_f32_16x16x16_bf16 v[52:55], v[68:69], v[40:41], v[52:55]
 v_mfma_f32_16x16x16_bf16 v[56:59], v[70:71], v[40:41], v[56:59]
 s_nop 7
 CV 12,44,45
 CV 13,46,47
 CV 14,48,49
 CV 15,50,51
 buffer_store_dwordx4 v[12:15], v241, s[16:19], s32 offen offset:192 sc1
 CV 16,52,53
 CV 17,54,55
 CV 18,56,57
 CV 19,58,59
 buffer_store_dwordx4 v[16:19], v241, s[16:19], s33 offen offset:192 sc1
 s_add_u32 s32, s32, 256
 s_add_u32 s33, s33, 256
 v_mfma_f32_16x16x32_bf16 v[4:7], v[156:159], v[204:207], 0
 v_mfma_f32_16x16x32_bf16 v[8:11], v[172:175], v[204:207], 0
 v_mfma_f32_16x16x32_bf16 v[12:15], v[188:191], v[204:207], 0
 MF v[4:7],v[160:163],v[208:211]
 MF v[8:11],v[176:179],v[208:211]
 MF v[12:15],v[192:195],v[208:211]
 MF v[4:7],v[164:167],v[212:215]
 MF v[8:11],v[180:183],v[212:215]
 MF v[12:15],v[196:199],v[212:215]
 MF v[4:7],v[168:171],v[216:219]
 MF v[8:11],v[184:187],v[216:219]
 MF v[12:15],v[200:203],v[216:219]
 v_mfma_f32_16x16x32_bf16 v[16:19], v[156:159], v[220:223], 0
 v_mfma_f32_16x16x32_bf16 v[20:23], v[172:175], v[220:223], 0
 v_mfma_f32_16x16x32_bf16 v[24:27], v[188:191], v[220:223], 0
 MF v[16:19],v[160:163],v[224:227]
 MF v[20:23],v[176:179],v[224:227]
 MF v[24:27],v[192:195],v[224:227]
 MF v[16:19],v[164:167],v[228:231]
 MF v[20:23],v[180:183],v[228:231]
 MF v[24:27],v[196:199],v[228:231]
 MF v[16:19],v[168:171],v[232:235]
 MF v[20:23],v[184:187],v[232:235]
 MF v[24:27],v[200:203],v[232:235]
 s_nop 7
 v_cmp_gt_i32 vcc, 0, v240
 s_nop 1
 v_cndmask_b32 v4, v4, v242, vcc
 v_cmp_gt_i32 vcc, 1, v240
 s_nop 1
 v_cndmask_b32 v5, v5, v242, vcc
 v_cmp_gt_i32 vcc, 2, v240
 s_nop 1
 v_cndmask_b32 v6, v6, v242, vcc
 v_cmp_gt_i32 vcc, 3, v240
 s_nop 1
 v_cndmask_b32 v7, v7, v242, vcc
 v_cmp_gt_i32 vcc, 4, v240
 s_nop 1
 v_cndmask_b32 v8, v8, v242, vcc
 v_cmp_gt_i32 vcc, 5, v240
 s_nop 1
 v_cndmask_b32 v9, v9, v242, vcc
 v_cmp_gt_i32 vcc, 6, v240
 s_nop 1
 v_cndmask_b32 v10, v10, v242, vcc
 v_cmp_gt_i32 vcc, 7, v240
 s_nop 1
 v_cndmask_b32 v11, v11, v242, vcc
 v_max3_f32 v243, v4, v5, v6
 v_max3_f32 v243, v243, v7, v8
 v_max3_f32 v243, v243, v9, v10
 v_max_f32 v243, v243, v11
 s_mov_b64 exec, s[36:37]
 v_max3_f32 v243, v243, v12, v13
 v_max3_f32 v243, v243, v14, v15
 s_mov_b64 exec, -1
 v_mov_b32 v244, v243
 s_nop 1
 v_permlane32_swap_b32 v243, v244
 v_max_f32 v243, v243, v244
 v_mov_b32 v244, v243
 s_nop 1
 v_permlane16_swap_b32 v243, v244
 v_max_f32 v243, v243, v244
 v_sub_f32 v4, v4, v243
 v_sub_f32 v5, v5, v243
 v_sub_f32 v6, v6, v243
 v_sub_f32 v7, v7, v243
 v_sub_f32 v8, v8, v243
 v_sub_f32 v9, v9, v243
 v_sub_f32 v10, v10, v243
 v_sub_f32 v11, v11, v243
 v_sub_f32 v12, v12, v243
 v_sub_f32 v13, v13, v243
 v_sub_f32 v14, v14, v243
 v_sub_f32 v15, v15, v243
 v_mul_f32 v4, s34, v4
 v_mul_f32 v5, s34, v5
 v_mul_f32 v6, s34, v6
 v_mul_f32 v7, s34, v7
 v_mul_f32 v8, s34, v8
 v_mul_f32 v9, s34, v9
 v_mul_f32 v10, s34, v10
 v_mul_f32 v11, s34, v11
 v_mul_f32 v12, s34, v12
 v_mul_f32 v13, s34, v13
 v_mul_f32 v14, s34, v14
 v_mul_f32 v15, s34, v15
 v_exp_f32 v4, v4
 v_exp_f32 v5, v5
 v_exp_f32 v6, v6
 v_exp_f32 v7, v7
 v_exp_f32 v8, v8
 v_exp_f32 v9, v9
 v_exp_f32 v10, v10
 v_exp_f32 v11, v11
 v_exp_f32 v12, v12
 v_exp_f32 v13, v13
 v_exp_f32 v14, v14
 v_exp_f32 v15, v15
 s_mov_b64 exec, s[38:39]
 v_mov_b32 v12, 0
 v_mov_b32 v13, 0
 v_mov_b32 v14, 0
 v_mov_b32 v15, 0
 s_mov_b64 exec, -1
 v_add_f32 v245, v4, v5
 v_add_f32 v245, v245, v6
 v_add_f32 v245, v245, v7
 v_add_f32 v245, v245, v8
 v_add_f32 v245, v245, v9
 v_add_f32 v245, v245, v10
 v_add_f32 v245, v245, v11
 v_add_f32 v245, v245, v12
 v_add_f32 v245, v245, v13
 v_add_f32 v245, v245, v14
 v_add_f32 v245, v245, v15
 v_mov_b32 v244, v245
 s_nop 1
 v_permlane32_swap_b32 v245, v244
 v_add_f32 v245, v245, v244
 v_mov_b32 v244, v245
 s_nop 1
 v_permlane16_swap_b32 v245, v244
 v_add_f32 v245, v245, v244
 v_rcp_f32 v245, v245
 s_nop 0
 v_mul_f32 v4, v4, v245
 v_mul_f32 v5, v5, v245
 v_mul_f32 v6, v6, v245
 v_mul_f32 v7, v7, v245
 v_mul_f32 v8, v8, v245
 v_mul_f32 v9, v9, v245
 v_mul_f32 v10, v10, v245
 v_mul_f32 v11, v11, v245
 v_mul_f32 v12, v12, v245
 v_mul_f32 v13, v13, v245
 v_mul_f32 v14, v14, v245
 v_mul_f32 v15, v15, v245
 CV 28,4,5
 CV 29,6,7
 CV 30,8,9
 CV 31,10,11
 CV 32,12,13
 CV 33,14,15
 v_cmp_gt_i32 vcc, -16, v240
 s_nop 1
 v_cndmask_b32 v16, v16, v242, vcc
 v_cmp_gt_i32 vcc, -15, v240
 s_nop 1
 v_cndmask_b32 v17, v17, v242, vcc
 v_cmp_gt_i32 vcc, -14, v240
 s_nop 1
 v_cndmask_b32 v18, v18, v242, vcc
 v_cmp_gt_i32 vcc, -13, v240
 s_nop 1
 v_cndmask_b32 v19, v19, v242, vcc
 v_cmp_gt_i32 vcc, -12, v240
 s_nop 1
 v_cndmask_b32 v20, v20, v242, vcc
 v_cmp_gt_i32 vcc, -11, v240
 s_nop 1
 v_cndmask_b32 v21, v21, v242, vcc
 v_cmp_gt_i32 vcc, -10, v240
 s_nop 1
 v_cndmask_b32 v22, v22, v242, vcc
 v_cmp_gt_i32 vcc, -9, v240
 s_nop 1
 v_cndmask_b32 v23, v23, v242, vcc
 v_max3_f32 v243, v16, v17, v18
 v_max3_f32 v243, v243, v19, v20
 v_max3_f32 v243, v243, v21, v22
 v_max_f32 v243, v243, v23
 s_mov_b64 exec, s[36:37]
 v_max3_f32 v243, v243, v24, v25
 v_max3_f32 v243, v243, v26, v27
 s_mov_b64 exec, -1
 v_mov_b32 v244, v243
 s_nop 1
 v_permlane32_swap_b32 v243, v244
 v_max_f32 v243, v243, v244
 v_mov_b32 v244, v243
 s_nop 1
 v_permlane16_swap_b32 v243, v244
 v_max_f32 v243, v243, v244
 v_sub_f32 v16, v16, v243
 v_sub_f32 v17, v17, v243
 v_sub_f32 v18, v18, v243
 v_sub_f32 v19, v19, v243
 v_sub_f32 v20, v20, v243
 v_sub_f32 v21, v21, v243
 v_sub_f32 v22, v22, v243
 v_sub_f32 v23, v23, v243
 v_sub_f32 v24, v24, v243
 v_sub_f32 v25, v25, v243
 v_sub_f32 v26, v26, v243
 v_sub_f32 v27, v27, v243
 v_mul_f32 v16, s34, v16
 v_mul_f32 v17, s34, v17
 v_mul_f32 v18, s34, v18
 v_mul_f32 v19, s34, v19
 v_mul_f32 v20, s34, v20
 v_mul_f32 v21, s34, v21
 v_mul_f32 v22, s34, v22
 v_mul_f32 v23, s34, v23
 v_mul_f32 v24, s34, v24
 v_mul_f32 v25, s34, v25
 v_mul_f32 v26, s34, v26
 v_mul_f32 v27, s34, v27
 v_exp_f32 v16, v16
 v_exp_f32 v17, v17
 v_exp_f32 v18, v18
 v_exp_f32 v19, v19
 v_exp_f32 v20, v20
 v_exp_f32 v21, v21
 v_exp_f32 v22, v22
 v_exp_f32 v23, v23
 v_exp_f32 v24, v24
 v_exp_f32 v25, v25
 v_exp_f32 v26, v26
 v_exp_f32 v27, v27
 s_mov_b64 exec, s[38:39]
 v_mov_b32 v24, 0
 v_mov_b32 v25, 0
 v_mov_b32 v26, 0
 v_mov_b32 v27, 0
 s_mov_b64 exec, -1
 v_add_f32 v245, v16, v17
 v_add_f32 v245, v245, v18
 v_add_f32 v245, v245, v19
 v_add_f32 v245, v245, v20
 v_add_f32 v245, v245, v21
 v_add_f32 v245, v245, v22
 v_add_f32 v245, v245, v23
 v_add_f32 v245, v245, v24
 v_add_f32 v245, v245, v25
 v_add_f32 v245, v245, v26
 v_add_f32 v245, v245, v27
 v_mov_b32 v244, v245
 s_nop 1
 v_permlane32_swap_b32 v245, v244
 v_add_f32 v245, v245, v244
 v_mov_b32 v244, v245
 s_nop 1
 v_permlane16_swap_b32 v245, v244
 v_add_f32 v245, v245, v244
 v_rcp_f32 v245, v245
 s_nop 0
 v_mul_f32 v16, v16, v245
 v_mul_f32 v17, v17, v245
 v_mul_f32 v18, v18, v245
 v_mul_f32 v19, v19, v245
 v_mul_f32 v20, v20, v245
 v_mul_f32 v21, v21, v245
 v_mul_f32 v22, v22, v245
 v_mul_f32 v23, v23, v245
 v_mul_f32 v24, v24, v245
 v_mul_f32 v25, v25, v245
 v_mul_f32 v26, v26, v245
 v_mul_f32 v27, v27, v245
 CV 36,16,17
 CV 37,18,19
 CV 38,20,21
 CV 39,22,23
 CV 40,24,25
 CV 41,26,27
 s_waitcnt vmcnt(8)
 TR 60,61,238,10240
 TR 62,63,238,10304
 TR 68,69,239,10240
 TR 64,65,238,10248
 TR 66,67,238,10312
 TR 70,71,239,10248
 s_waitcnt lgkmcnt(0)
 v_mfma_f32_16x16x32_bf16 v[44:47], v[60:63], v[28:31], 0
 v_mfma_f32_16x16x32_bf16 v[48:51], v[64:67], v[28:31], 0
 v_mfma_f32_16x16x32_bf16 v[52:55], v[60:63], v[36:39], 0
 v_mfma_f32_16x16x32_bf16 v[56:59], v[64:67], v[36:39], 0
 s_nop 3
 v_mfma_f32_16x16x16_bf16 v[44:47], v[68:69], v[32:33], v[44:47]
 v_mfma_f32_16x16x16_bf16 v[48:51], v[70:71], v[32:33], v[48:51]
 v_mfma_f32_16x16x16_bf16 v[52:55], v[68:69], v[40:41], v[52:55]
 v_mfma_f32_16x16x16_bf16 v[56:59], v[70:71], v[40:41], v[56:59]
 s_nop 7
 CV 4,44,45
 CV 5,46,47
 CV 6,48,49
 CV 7,50,51
 buffer_store_dwordx4 v[4:7], v241, s[16:19], s32 offen offset:0 sc1
 CV 8,52,53
 CV 9,54,55
 CV 10,56,57
 CV 11,58,59
 buffer_store_dwordx4 v[8:11], v241, s[16:19], s33 offen offset:0 sc1
 TR 60,61,238,11264
 TR 62,63,238,11328
 TR 68,69,239,10304
 TR 64,65,238,11272
 TR 66,67,238,11336
 TR 70,71,239,10312
 s_waitcnt lgkmcnt(0)
 v_mfma_f32_16x16x32_bf16 v[44:47], v[60:63], v[28:31], 0
 v_mfma_f32_16x16x32_bf16 v[48:51], v[64:67], v[28:31], 0
 v_mfma_f32_16x16x32_bf16 v[52:55], v[60:63], v[36:39], 0
 v_mfma_f32_16x16x32_bf16 v[56:59], v[64:67], v[36:39], 0
 s_nop 3
 v_mfma_f32_16x16x16_bf16 v[44:47], v[68:69], v[32:33], v[44:47]
 v_mfma_f32_16x16x16_bf16 v[48:51], v[70:71], v[32:33], v[48:51]
 v_mfma_f32_16x16x16_bf16 v[52:55], v[68:69], v[40:41], v[52:55]
 v_mfma_f32_16x16x16_bf16 v[56:59], v[70:71], v[40:41], v[56:59]
 s_nop 7
 CV 12,44,45
 CV 13,46,47
 CV 14,48,49
 CV 15,50,51
 buffer_store_dwordx4 v[12:15], v241, s[16:19], s32 offen offset:64 sc1
 CV 16,52,53
 CV 17,54,55
 CV 18,56,57
 CV 19,58,59
 buffer_store_dwordx4 v[16:19], v241, s[16:19], s33 offen offset:64 sc1
 TR 60,61,238,12288
 TR 62,63,238,12352
 TR 68,69,239,10368
 TR 64,65,238,12296
 TR 66,67,238,12360
 TR 70,71,239,10376
 s_waitcnt lgkmcnt(0)
 v_mfma_f32_16x16x32_bf16 v[44:47], v[60:63], v[28:31], 0
 v_mfma_f32_16x16x32_bf16 v[48:51], v[64:67], v[28:31], 0
 v_mfma_f32_16x16x32_bf16 v[52:55], v[60:63], v[36:39], 0
 v_mfma_f32_16x16x32_bf16 v[56:59], v[64:67], v[36:39], 0
 s_nop 3
 v_mfma_f32_16x16x16_bf16 v[44:47], v[68:69], v[32:33], v[44:47]
 v_mfma_f32_16x16x16_bf16 v[48:51], v[70:71], v[32:33], v[48:51]
 v_mfma_f32_16x16x16_bf16 v[52:55], v[68:69], v[40:41], v[52:55]
 v_mfma_f32_16x16x16_bf16 v[56:59], v[70:71], v[40:41], v[56:59]
 s_nop 7
 CV 4,44,45
 CV 5,46,47
 CV 6,48,49
 CV 7,50,51
 buffer_store_dwordx4 v[4:7], v241, s[16:19], s32 offen offset:128 sc1
 CV 8,52,53
 CV 9,54,55
 CV 10,56,57
 CV 11,58,59
 buffer_store_dwordx4 v[8:11], v241, s[16:19], s33 offen offset:128 sc1
 TR 60,61,238,13312
 TR 62,63,238,13376
 TR 68,69,239,10432
 TR 64,65,238,13320
 TR 66,67,238,13384
 TR 70,71,239,10440
 s_waitcnt lgkmcnt(0)
 v_mfma_f32_16x16x32_bf16 v[44:47], v[60:63], v[28:31], 0
 v_mfma_f32_16x16x32_bf16 v[48:51], v[64:67], v[28:31], 0
 v_mfma_f32_16x16x32_bf16 v[52:55], v[60:63], v[36:39], 0
 v_mfma_f32_16x16x32_bf16 v[56:59], v[64:67], v[36:39], 0
 s_nop 3
 v_mfma_f32_16x16x16_bf16 v[44:47], v[68:69], v[32:33], v[44:47]
 v_mfma_f32_16x16x16_bf16 v[48:51], v[70:71], v[32:33], v[48:51]
 v_mfma_f32_16x16x16_bf16 v[52:55], v[68:69], v[40:41], v[52:55]
 v_mfma_f32_16x16x16_bf16 v[56:59], v[70:71], v[40:41], v[56:59]
 s_nop 7
 CV 12,44,45
 CV 13,46,47
 CV 14,48,49
 CV 15,50,51
 buffer_store_dwordx4 v[12:15], v241, s[16:19], s32 offen offset:192 sc1
 CV 16,52,53
 CV 17,54,55
 CV 18,56,57
 CV 19,58,59
 buffer_store_dwordx4 v[16:19], v241, s[16:19], s33 offen offset:192 sc1
 s_branch mk_done
mk_b_f1l:
 s_cmp_ge_u32 s11, 28
 s_cbranch_scc1 mk_skip
 s_load_dwordx2 s[4:5], s[0:1], 64
 s_waitcnt lgkmcnt(0)
 s_mov_b32 s20, s4
 s_and_b32 s21, s5, 0xffff
 s_mov_b32 s22, 0x700000
 s_mov_b32 s23, 0x00020000
 s_mul_i32 s24, s10, 524288
 s_add_u32 s24, s24, 58720256
 s_mul_i32 s25, s11, 256
 s_lshr_b32 s43, s13, 1
 s_and_b32 s44, s13, 1
 v_and_b32 v248, 15, v2
 v_lshrrev_b32 v249, 4, v2
 v_lshrrev_b32 v250, 1, v248
 v_xor_b32 v250, v250, v249
 v_mov_b32 v251, v248
 s_mul_i32 s45, s43, 16384
 s_add_u32 s45, s45, 0
 v_lshlrev_b32 v251, 7, v251
 v_add_u32 v251, s45, v251
 v_lshlrev_b32 v252, 4, v250
 v_add_u32 v228, v251, v252
 v_xor_b32 v252, 64, v252
 v_add_u32 v229, v251, v252
 v_add_u32 v230, 0x10000, v228
 v_add_u32 v231, 0x10000, v229
 v_lshrrev_b32 v250, 2, v248
 v_and_b32 v251, 3, v2
 v_and_b32 v252, 1, v249
 v_lshlrev_b32 v252, 2, v252
 v_or_b32 v252, v252, v250
 v_lshlrev_b32 v249, 3, v249
 v_add_u32 v249, v249, v250
 v_mul_u32_u24 v249, 256, v249
 v_lshlrev_b32 v251, 3, v251
 v_add_u32 v249, v249, v251
 v_add_u32 v249, 98304, v249
 s_mul_i32 s45, s44, 4
 s_add_u32 s46, s45, 0
 v_xor_b32 v250, s46, v252
 v_lshlrev_b32 v250, 5, v250
 v_add_u32 v232, v249, v250
 s_add_u32 s46, s45, 1
 v_xor_b32 v250, s46, v252
 v_lshlrev_b32 v250, 5, v250
 v_add_u32 v233, v249, v250
 s_add_u32 s46, s45, 2
 v_xor_b32 v250, s46, v252
 v_lshlrev_b32 v250, 5, v250
 v_add_u32 v234, v249, v250
 s_add_u32 s46, s45, 3
 v_xor_b32 v250, s46, v252
 v_lshlrev_b32 v250, 5, v250
 v_add_u32 v235, v249, v250
 v_lshrrev_b32 v248, 3, v2
 v_and_b32 v249, 7, v2
 s_mul_i32 s45, s13, 8
 s_add_u32 s46, s45, 0
 s_lshl_b32 s47, s46, 3
 v_add_u32 v250, s47, v248
 v_bfe_u32 v251, v250, 1, 3
 v_xor_b32 v251, v251, v249
 v_lshlrev_b32 v251, 4, v251
 v_mul_u32_u24 v250, 2048, v250
 v_add_u32 v236, v250, v251
 s_add_u32 s46, s45, 1
 s_lshl_b32 s47, s46, 3
 v_add_u32 v250, s47, v248
 v_bfe_u32 v251, v250, 1, 3
 v_xor_b32 v251, v251, v249
 v_lshlrev_b32 v251, 4, v251
 v_mul_u32_u24 v250, 2048, v250
 v_add_u32 v237, v250, v251
 s_add_u32 s46, s45, 2
 s_lshl_b32 s47, s46, 3
 v_add_u32 v250, s47, v248
 v_bfe_u32 v251, v250, 1, 3
 v_xor_b32 v251, v251, v249
 v_lshlrev_b32 v251, 4, v251
 v_mul_u32_u24 v250, 2048, v250
 v_add_u32 v238, v250, v251
 s_add_u32 s46, s45, 3
 s_lshl_b32 s47, s46, 3
 v_add_u32 v250, s47, v248
 v_bfe_u32 v251, v250, 1, 3
 v_xor_b32 v251, v251, v249
 v_lshlrev_b32 v251, 4, v251
 v_mul_u32_u24 v250, 2048, v250
 v_add_u32 v239, v250, v251
 s_add_u32 s46, s45, 4
 s_lshl_b32 s47, s46, 3
 v_add_u32 v250, s47, v248
 v_bfe_u32 v251, v250, 1, 3
 v_xor_b32 v251, v251, v249
 v_lshlrev_b32 v251, 4, v251
 v_mul_u32_u24 v250, 2048, v250
 v_add_u32 v240, v250, v251
 s_add_u32 s46, s45, 5
 s_lshl_b32 s47, s46, 3
 v_add_u32 v250, s47, v248
 v_bfe_u32 v251, v250, 1, 3
 v_xor_b32 v251, v251, v249
 v_lshlrev_b32 v251, 4, v251
 v_mul_u32_u24 v250, 2048, v250
 v_add_u32 v241, v250, v251
 s_add_u32 s46, s45, 6
 s_lshl_b32 s47, s46, 3
 v_add_u32 v250, s47, v248
 v_bfe_u32 v251, v250, 1, 3
 v_xor_b32 v251, v251, v249
 v_lshlrev_b32 v251, 4, v251
 v_mul_u32_u24 v250, 2048, v250
 v_add_u32 v242, v250, v251
 s_add_u32 s46, s45, 7
 s_lshl_b32 s47, s46, 3
 v_add_u32 v250, s47, v248
 v_bfe_u32 v251, v250, 1, 3
 v_xor_b32 v251, v251, v249
 v_lshlrev_b32 v251, 4, v251
 v_mul_u32_u24 v250, 2048, v250
 v_add_u32 v243, v250, v251
 s_mul_i32 s40, s13, 8192
 s_add_u32 s40, s40, 0
 v_lshlrev_b32 v248, 4, v2
 s_mul_i32 s45, s13, 4096
 s_add_u32 s46, s45, 0
 v_add_u32 v249, s46, v248
 v_lshrrev_b32 v250, 8, v249
 v_and_b32 v249, 255, v249
 v_bfe_u32 v252, v250, 3, 1
 v_and_b32 v251, 3, v250
 v_lshlrev_b32 v252, 2, v252
 v_or_b32 v251, v251, v252
 v_lshlrev_b32 v251, 5, v251
 v_xor_b32 v249, v249, v251
 v_mul_u32_u24 v250, 7168, v250
 v_add_u32 v244, v250, v249
 s_add_u32 s46, s45, 1024
 v_add_u32 v249, s46, v248
 v_lshrrev_b32 v250, 8, v249
 v_and_b32 v249, 255, v249
 v_bfe_u32 v252, v250, 3, 1
 v_and_b32 v251, 3, v250
 v_lshlrev_b32 v252, 2, v252
 v_or_b32 v251, v251, v252
 v_lshlrev_b32 v251, 5, v251
 v_xor_b32 v249, v249, v251
 v_mul_u32_u24 v250, 7168, v250
 v_add_u32 v245, v250, v249
 s_add_u32 s46, s45, 2048
 v_add_u32 v249, s46, v248
 v_lshrrev_b32 v250, 8, v249
 v_and_b32 v249, 255, v249
 v_bfe_u32 v252, v250, 3, 1
 v_and_b32 v251, 3, v250
 v_lshlrev_b32 v252, 2, v252
 v_or_b32 v251, v251, v252
 v_lshlrev_b32 v251, 5, v251
 v_xor_b32 v249, v249, v251
 v_mul_u32_u24 v250, 7168, v250
 v_add_u32 v246, v250, v249
 s_add_u32 s46, s45, 3072
 v_add_u32 v249, s46, v248
 v_lshrrev_b32 v250, 8, v249
 v_and_b32 v249, 255, v249
 v_bfe_u32 v252, v250, 3, 1
 v_and_b32 v251, 3, v250
 v_lshlrev_b32 v252, 2, v252
 v_or_b32 v251, v251, v252
 v_lshlrev_b32 v251, 5, v251
 v_xor_b32 v249, v249, v251
 v_mul_u32_u24 v250, 7168, v250
 v_add_u32 v247, v250, v249
 s_mul_i32 s41, s13, 4096
 s_add_u32 s41, s41, 98304
 v_mov_b32 v4, 0
 v_mov_b32 v5, 0
 v_mov_b32 v6, 0
 v_mov_b32 v7, 0
 v_mov_b32 v8, 0
 v_mov_b32 v9, 0
 v_mov_b32 v10, 0
 v_mov_b32 v11, 0
 v_mov_b32 v12, 0
 v_mov_b32 v13, 0
 v_mov_b32 v14, 0
 v_mov_b32 v15, 0
 v_mov_b32 v16, 0
 v_mov_b32 v17, 0
 v_mov_b32 v18, 0
 v_mov_b32 v19, 0
 v_mov_b32 v20, 0
 v_mov_b32 v21, 0
 v_mov_b32 v22, 0
 v_mov_b32 v23, 0
 v_mov_b32 v24, 0
 v_mov_b32 v25, 0
 v_mov_b32 v26, 0
 v_mov_b32 v27, 0
 v_mov_b32 v28, 0
 v_mov_b32 v29, 0
 v_mov_b32 v30, 0
 v_mov_b32 v31, 0
 v_mov_b32 v32, 0
 v_mov_b32 v33, 0
 v_mov_b32 v34, 0
 v_mov_b32 v35, 0
 v_mov_b32 v36, 0
 v_mov_b32 v37, 0
 v_mov_b32 v38, 0
 v_mov_b32 v39, 0
 v_mov_b32 v40, 0
 v_mov_b32 v41, 0
 v_mov_b32 v42, 0
 v_mov_b32 v43, 0
 v_mov_b32 v44, 0
 v_mov_b32 v45, 0
 v_mov_b32 v46, 0
 v_mov_b32 v47, 0
 v_mov_b32 v48, 0
 v_mov_b32 v49, 0
 v_mov_b32 v50, 0
 v_mov_b32 v51, 0
 v_mov_b32 v52, 0
 v_mov_b32 v53, 0
 v_mov_b32 v54, 0
 v_mov_b32 v55, 0
 v_mov_b32 v56, 0
 v_mov_b32 v57, 0
 v_mov_b32 v58, 0
 v_mov_b32 v59, 0
 v_mov_b32 v60, 0
 v_mov_b32 v61, 0
 v_mov_b32 v62, 0
 v_mov_b32 v63, 0
 v_mov_b32 v64, 0
 v_mov_b32 v65, 0
 v_mov_b32 v66, 0
 v_mov_b32 v67, 0
 v_mov_b32 v68, 0
 v_mov_b32 v69, 0
 v_mov_b32 v70, 0
 v_mov_b32 v71, 0
 v_mov_b32 v72, 0
 v_mov_b32 v73, 0
 v_mov_b32 v74, 0
 v_mov_b32 v75, 0
 v_mov_b32 v76, 0
 v_mov_b32 v77, 0
 v_mov_b32 v78, 0
 v_mov_b32 v79, 0
 v_mov_b32 v80, 0
 v_mov_b32 v81, 0
 v_mov_b32 v82, 0
 v_mov_b32 v83, 0
 v_mov_b32 v84, 0
 v_mov_b32 v85, 0
 v_mov_b32 v86, 0
 v_mov_b32 v87, 0
 v_mov_b32 v88, 0
 v_mov_b32 v89, 0
 v_mov_b32 v90, 0
 v_mov_b32 v91, 0
 v_mov_b32 v92, 0
 v_mov_b32 v93, 0
 v_mov_b32 v94, 0
 v_mov_b32 v95, 0
 v_mov_b32 v96, 0
 v_mov_b32 v97, 0
 v_mov_b32 v98, 0
 v_mov_b32 v99, 0
 v_mov_b32 v100, 0
 v_mov_b32 v101, 0
 v_mov_b32 v102, 0
 v_mov_b32 v103, 0
 v_mov_b32 v104, 0
 v_mov_b32 v105, 0
 v_mov_b32 v106, 0
 v_mov_b32 v107, 0
 v_mov_b32 v108, 0
 v_mov_b32 v109, 0
 v_mov_b32 v110, 0
 v_mov_b32 v111, 0
 v_mov_b32 v112, 0
 v_mov_b32 v113, 0
 v_mov_b32 v114, 0
 v_mov_b32 v115, 0
 v_mov_b32 v116, 0
 v_mov_b32 v117, 0
 v_mov_b32 v118, 0
 v_mov_b32 v119, 0
 v_mov_b32 v120, 0
 v_mov_b32 v121, 0
 v_mov_b32 v122, 0
 v_mov_b32 v123, 0
 v_mov_b32 v124, 0
 v_mov_b32 v125, 0
 v_mov_b32 v126, 0
 v_mov_b32 v127, 0
 v_mov_b32 v128, 0
 v_mov_b32 v129, 0
 v_mov_b32 v130, 0
 v_mov_b32 v131, 0
 DM 40,0,236,s[16:19],24,sc1 lds
 DM 40,1024,237,s[16:19],24,sc1 lds
 DM 40,2048,238,s[16:19],24,sc1 lds
 DM 40,3072,239,s[16:19],24,sc1 lds
 DM 40,4096,240,s[16:19],24,sc1 lds
 DM 40,5120,241,s[16:19],24,sc1 lds
 DM 40,6144,242,s[16:19],24,sc1 lds
 DM 40,7168,243,s[16:19],24,sc1 lds
 DM 41,0,244,s[20:23],25,lds
 DM 41,1024,245,s[20:23],25,lds
 DM 41,2048,246,s[20:23],25,lds
 DM 41,3072,247,s[20:23],25,lds
 s_add_u32 s24, s24, 128
 s_add_u32 s25, s25, 458752
 DM 40,32768,236,s[16:19],24,sc1 lds
 DM 40,33792,237,s[16:19],24,sc1 lds
 DM 40,34816,238,s[16:19],24,sc1 lds
 DM 40,35840,239,s[16:19],24,sc1 lds
 DM 40,36864,240,s[16:19],24,sc1 lds
 DM 40,37888,241,s[16:19],24,sc1 lds
 DM 40,38912,242,s[16:19],24,sc1 lds
 DM 40,39936,243,s[16:19],24,sc1 lds
 DM 41,16384,244,s[20:23],25,lds
 DM 41,17408,245,s[20:23],25,lds
 DM 41,18432,246,s[20:23],25,lds
 DM 41,19456,247,s[20:23],25,lds
 s_add_u32 s24, s24, 128
 s_add_u32 s25, s25, 458752
 DM 40,65536,236,s[16:19],24,sc1 lds
 DM 40,66560,237,s[16:19],24,sc1 lds
 DM 40,67584,238,s[16:19],24,sc1 lds
 DM 40,68608,239,s[16:19],24,sc1 lds
 DM 40,69632,240,s[16:19],24,sc1 lds
 DM 40,70656,241,s[16:19],24,sc1 lds
 DM 40,71680,242,s[16:19],24,sc1 lds
 DM 40,72704,243,s[16:19],24,sc1 lds
 DM 41,32768,244,s[20:23],25,lds
 DM 41,33792,245,s[20:23],25,lds
 DM 41,34816,246,s[20:23],25,lds
 DM 41,35840,247,s[20:23],25,lds
 s_add_u32 s24, s24, 128
 s_add_u32 s25, s25, 458752
 s_waitcnt vmcnt(24)
 s_barrier
 RB 164,167,228,0
 RB 168,171,228,2048
 RB 172,175,228,4096
 RB 176,179,228,6144
 RB 180,183,228,8192
 RB 184,187,228,10240
 RB 188,191,228,12288
 RB 192,195,228,14336
 TR 132,133,232,0
 TR 134,135,232,1024
 TR 136,137,233,0
 TR 138,139,233,1024
 TR 140,141,234,0
 TR 142,143,234,1024
 TR 144,145,235,0
 TR 146,147,235,1024
 s_waitcnt lgkmcnt(0)
 MF v[4:7],v[132:135],v[164:167]
 RB 196,199,229,0
 MF v[8:11],v[132:135],v[168:171]
 RB 200,203,229,2048
 MF v[12:15],v[132:135],v[172:175]
 RB 204,207,229,4096
 MF v[16:19],v[132:135],v[176:179]
 RB 208,211,229,6144
 MF v[20:23],v[132:135],v[180:183]
 RB 212,215,229,8192
 MF v[24:27],v[132:135],v[184:187]
 RB 216,219,229,10240
 MF v[28:31],v[132:135],v[188:191]
 RB 220,223,229,12288
 MF v[32:35],v[132:135],v[192:195]
 RB 224,227,229,14336
 MF v[36:39],v[136:139],v[164:167]
 TR 148,149,232,8192
 MF v[40:43],v[136:139],v[168:171]
 TR 150,151,232,9216
 MF v[44:47],v[136:139],v[172:175]
 TR 152,153,233,8192
 MF v[48:51],v[136:139],v[176:179]
 TR 154,155,233,9216
 MF v[52:55],v[136:139],v[180:183]
 TR 156,157,234,8192
 MF v[56:59],v[136:139],v[184:187]
 TR 158,159,234,9216
 MF v[60:63],v[136:139],v[188:191]
 TR 160,161,235,8192
 MF v[64:67],v[136:139],v[192:195]
 TR 162,163,235,9216
 MF v[68:71],v[140:143],v[164:167]
 MF v[72:75],v[140:143],v[168:171]
 MF v[76:79],v[140:143],v[172:175]
 MF v[80:83],v[140:143],v[176:179]
 MF v[84:87],v[140:143],v[180:183]
 MF v[88:91],v[140:143],v[184:187]
 MF v[92:95],v[140:143],v[188:191]
 MF v[96:99],v[140:143],v[192:195]
 MF v[100:103],v[144:147],v[164:167]
 MF v[104:107],v[144:147],v[168:171]
 MF v[108:111],v[144:147],v[172:175]
 MF v[112:115],v[144:147],v[176:179]
 MF v[116:119],v[144:147],v[180:183]
 MF v[120:123],v[144:147],v[184:187]
 MF v[124:127],v[144:147],v[188:191]
 MF v[128:131],v[144:147],v[192:195]
 s_waitcnt lgkmcnt(0)
 s_waitcnt vmcnt(12)
 s_barrier
 MF v[4:7],v[148:151],v[196:199]
 RB 164,167,228,32768
 MF v[8:11],v[148:151],v[200:203]
 RB 168,171,228,34816
 MF v[12:15],v[148:151],v[204:207]
 RB 172,175,228,36864
 DM 40,0,236,s[16:19],24,sc1 lds
 MF v[16:19],v[148:151],v[208:211]
 RB 176,179,228,38912
 MF v[20:23],v[148:151],v[212:215]
 RB 180,183,228,40960
 MF v[24:27],v[148:151],v[216:219]
 RB 184,187,228,43008
 MF v[28:31],v[148:151],v[220:223]
 RB 188,191,228,45056
 MF v[32:35],v[148:151],v[224:227]
 RB 192,195,228,47104
 MF v[36:39],v[152:155],v[196:199]
 TR 132,133,232,16384
 DM 40,1024,237,s[16:19],24,sc1 lds
 MF v[40:43],v[152:155],v[200:203]
 TR 134,135,232,17408
 MF v[44:47],v[152:155],v[204:207]
 TR 136,137,233,16384
 MF v[48:51],v[152:155],v[208:211]
 TR 138,139,233,17408
 MF v[52:55],v[152:155],v[212:215]
 TR 140,141,234,16384
 MF v[56:59],v[152:155],v[216:219]
 TR 142,143,234,17408
 DM 40,2048,238,s[16:19],24,sc1 lds
 MF v[60:63],v[152:155],v[220:223]
 TR 144,145,235,16384
 MF v[64:67],v[152:155],v[224:227]
 TR 146,147,235,17408
 MF v[68:71],v[156:159],v[196:199]
 MF v[72:75],v[156:159],v[200:203]
 MF v[76:79],v[156:159],v[204:207]
 DM 40,3072,239,s[16:19],24,sc1 lds
 MF v[80:83],v[156:159],v[208:211]
 MF v[84:87],v[156:159],v[212:215]
 MF v[88:91],v[156:159],v[216:219]
 MF v[92:95],v[156:159],v[220:223]
 MF v[96:99],v[156:159],v[224:227]
 MF v[100:103],v[160:163],v[196:199]
 DM 40,4096,240,s[16:19],24,sc1 lds
 MF v[104:107],v[160:163],v[200:203]
 MF v[108:111],v[160:163],v[204:207]
 MF v[112:115],v[160:163],v[208:211]
 MF v[116:119],v[160:163],v[212:215]
 MF v[120:123],v[160:163],v[216:219]
 DM 40,5120,241,s[16:19],24,sc1 lds
 MF v[124:127],v[160:163],v[220:223]
 MF v[128:131],v[160:163],v[224:227]
 s_waitcnt lgkmcnt(0)
 MF v[4:7],v[132:135],v[164:167]
 RB 196,199,229,32768
 MF v[8:11],v[132:135],v[168:171]
 RB 200,203,229,34816
 MF v[12:15],v[132:135],v[172:175]
 RB 204,207,229,36864
 DM 40,6144,242,s[16:19],24,sc1 lds
 MF v[16:19],v[132:135],v[176:179]
 RB 208,211,229,38912
 MF v[20:23],v[132:135],v[180:183]
 RB 212,215,229,40960
 MF v[24:27],v[132:135],v[184:187]
 RB 216,219,229,43008
 MF v[28:31],v[132:135],v[188:191]
 RB 220,223,229,45056
 MF v[32:35],v[132:135],v[192:195]
 RB 224,227,229,47104
 MF v[36:39],v[136:139],v[164:167]
 TR 148,149,232,24576
 DM 40,7168,243,s[16:19],24,sc1 lds
 MF v[40:43],v[136:139],v[168:171]
 TR 150,151,232,25600
 MF v[44:47],v[136:139],v[172:175]
 TR 152,153,233,24576
 MF v[48:51],v[136:139],v[176:179]
 TR 154,155,233,25600
 MF v[52:55],v[136:139],v[180:183]
 TR 156,157,234,24576
 MF v[56:59],v[136:139],v[184:187]
 TR 158,159,234,25600
 DM 41,0,244,s[20:23],25,lds
 MF v[60:63],v[136:139],v[188:191]
 TR 160,161,235,24576
 MF v[64:67],v[136:139],v[192:195]
 TR 162,163,235,25600
 MF v[68:71],v[140:143],v[164:167]
 MF v[72:75],v[140:143],v[168:171]
 MF v[76:79],v[140:143],v[172:175]
 DM 41,1024,245,s[20:23],25,lds
 MF v[80:83],v[140:143],v[176:179]
 MF v[84:87],v[140:143],v[180:183]
 MF v[88:91],v[140:143],v[184:187]
 MF v[92:95],v[140:143],v[188:191]
 MF v[96:99],v[140:143],v[192:195]
 MF v[100:103],v[144:147],v[164:167]
 DM 41,2048,246,s[20:23],25,lds
 MF v[104:107],v[144:147],v[168:171]
 MF v[108:111],v[144:147],v[172:175]
 MF v[112:115],v[144:147],v[176:179]
 MF v[116:119],v[144:147],v[180:183]
 MF v[120:123],v[144:147],v[184:187]
 DM 41,3072,247,s[20:23],25,lds
 s_add_u32 s24, s24, 128
 s_add_u32 s25, s25, 458752
 MF v[124:127],v[144:147],v[188:191]
 MF v[128:131],v[144:147],v[192:195]
 s_waitcnt lgkmcnt(0)
 s_waitcnt vmcnt(12)
 s_barrier
 MF v[4:7],v[148:151],v[196:199]
 RB 164,167,230,0
 MF v[8:11],v[148:151],v[200:203]
 RB 168,171,230,2048
 MF v[12:15],v[148:151],v[204:207]
 RB 172,175,230,4096
 DM 40,32768,236,s[16:19],24,sc1 lds
 MF v[16:19],v[148:151],v[208:211]
 RB 176,179,230,6144
 MF v[20:23],v[148:151],v[212:215]
 RB 180,183,230,8192
 MF v[24:27],v[148:151],v[216:219]
 RB 184,187,230,10240
 MF v[28:31],v[148:151],v[220:223]
 RB 188,191,230,12288
 MF v[32:35],v[148:151],v[224:227]
 RB 192,195,230,14336
 MF v[36:39],v[152:155],v[196:199]
 TR 132,133,232,32768
 DM 40,33792,237,s[16:19],24,sc1 lds
 MF v[40:43],v[152:155],v[200:203]
 TR 134,135,232,33792
 MF v[44:47],v[152:155],v[204:207]
 TR 136,137,233,32768
 MF v[48:51],v[152:155],v[208:211]
 TR 138,139,233,33792
 MF v[52:55],v[152:155],v[212:215]
 TR 140,141,234,32768
 MF v[56:59],v[152:155],v[216:219]
 TR 142,143,234,33792
 DM 40,34816,238,s[16:19],24,sc1 lds
 MF v[60:63],v[152:155],v[220:223]
 TR 144,145,235,32768
 MF v[64:67],v[152:155],v[224:227]
 TR 146,147,235,33792
 MF v[68:71],v[156:159],v[196:199]
 MF v[72:75],v[156:159],v[200:203]
 MF v[76:79],v[156:159],v[204:207]
 DM 40,35840,239,s[16:19],24,sc1 lds
 MF v[80:83],v[156:159],v[208:211]
 MF v[84:87],v[156:159],v[212:215]
 MF v[88:91],v[156:159],v[216:219]
 MF v[92:95],v[156:159],v[220:223]
 MF v[96:99],v[156:159],v[224:227]
 MF v[100:103],v[160:163],v[196:199]
 DM 40,36864,240,s[16:19],24,sc1 lds
 MF v[104:107],v[160:163],v[200:203]
 MF v[108:111],v[160:163],v[204:207]
 MF v[112:115],v[160:163],v[208:211]
 MF v[116:119],v[160:163],v[212:215]
 MF v[120:123],v[160:163],v[216:219]
 DM 40,37888,241,s[16:19],24,sc1 lds
 MF v[124:127],v[160:163],v[220:223]
 MF v[128:131],v[160:163],v[224:227]
 s_waitcnt lgkmcnt(0)
 MF v[4:7],v[132:135],v[164:167]
 RB 196,199,231,0
 MF v[8:11],v[132:135],v[168:171]
 RB 200,203,231,2048
 MF v[12:15],v[132:135],v[172:175]
 RB 204,207,231,4096
 DM 40,38912,242,s[16:19],24,sc1 lds
 MF v[16:19],v[132:135],v[176:179]
 RB 208,211,231,6144
 MF v[20:23],v[132:135],v[180:183]
 RB 212,215,231,8192
 MF v[24:27],v[132:135],v[184:187]
 RB 216,219,231,10240
 MF v[28:31],v[132:135],v[188:191]
 RB 220,223,231,12288
 MF v[32:35],v[132:135],v[192:195]
 RB 224,227,231,14336
 MF v[36:39],v[136:139],v[164:167]
 TR 148,149,232,40960
 DM 40,39936,243,s[16:19],24,sc1 lds
 MF v[40:43],v[136:139],v[168:171]
 TR 150,151,232,41984
 MF v[44:47],v[136:139],v[172:175]
 TR 152,153,233,40960
 MF v[48:51],v[136:139],v[176:179]
 TR 154,155,233,41984
 MF v[52:55],v[136:139],v[180:183]
 TR 156,157,234,40960
 MF v[56:59],v[136:139],v[184:187]
 TR 158,159,234,41984
 DM 41,16384,244,s[20:23],25,lds
 MF v[60:63],v[136:139],v[188:191]
 TR 160,161,235,40960
 MF v[64:67],v[136:139],v[192:195]
 TR 162,163,235,41984
 MF v[68:71],v[140:143],v[164:167]
 MF v[72:75],v[140:143],v[168:171]
 MF v[76:79],v[140:143],v[172:175]
 DM 41,17408,245,s[20:23],25,lds
 MF v[80:83],v[140:143],v[176:179]
 MF v[84:87],v[140:143],v[180:183]
 MF v[88:91],v[140:143],v[184:187]
 MF v[92:95],v[140:143],v[188:191]
 MF v[96:99],v[140:143],v[192:195]
 MF v[100:103],v[144:147],v[164:167]
 DM 41,18432,246,s[20:23],25,lds
 MF v[104:107],v[144:147],v[168:171]
 MF v[108:111],v[144:147],v[172:175]
 MF v[112:115],v[144:147],v[176:179]
 MF v[116:119],v[144:147],v[180:183]
 MF v[120:123],v[144:147],v[184:187]
 DM 41,19456,247,s[20:23],25,lds
 s_add_u32 s24, s24, 128
 s_add_u32 s25, s25, 458752
 MF v[124:127],v[144:147],v[188:191]
 MF v[128:131],v[144:147],v[192:195]
 s_waitcnt lgkmcnt(0)
 s_waitcnt vmcnt(12)
 s_barrier
 MF v[4:7],v[148:151],v[196:199]
 RB 164,167,228,0
 MF v[8:11],v[148:151],v[200:203]
 RB 168,171,228,2048
 MF v[12:15],v[148:151],v[204:207]
 RB 172,175,228,4096
 DM 40,65536,236,s[16:19],24,sc1 lds
 MF v[16:19],v[148:151],v[208:211]
 RB 176,179,228,6144
 MF v[20:23],v[148:151],v[212:215]
 RB 180,183,228,8192
 MF v[24:27],v[148:151],v[216:219]
 RB 184,187,228,10240
 MF v[28:31],v[148:151],v[220:223]
 RB 188,191,228,12288
 MF v[32:35],v[148:151],v[224:227]
 RB 192,195,228,14336
 MF v[36:39],v[152:155],v[196:199]
 TR 132,133,232,0
 DM 40,66560,237,s[16:19],24,sc1 lds
 MF v[40:43],v[152:155],v[200:203]
 TR 134,135,232,1024
 MF v[44:47],v[152:155],v[204:207]
 TR 136,137,233,0
 MF v[48:51],v[152:155],v[208:211]
 TR 138,139,233,1024
 MF v[52:55],v[152:155],v[212:215]
 TR 140,141,234,0
 MF v[56:59],v[152:155],v[216:219]
 TR 142,143,234,1024
 DM 40,67584,238,s[16:19],24,sc1 lds
 MF v[60:63],v[152:155],v[220:223]
 TR 144,145,235,0
 MF v[64:67],v[152:155],v[224:227]
 TR 146,147,235,1024
 MF v[68:71],v[156:159],v[196:199]
 MF v[72:75],v[156:159],v[200:203]
 MF v[76:79],v[156:159],v[204:207]
 DM 40,68608,239,s[16:19],24,sc1 lds
 MF v[80:83],v[156:159],v[208:211]
 MF v[84:87],v[156:159],v[212:215]
 MF v[88:91],v[156:159],v[216:219]
 MF v[92:95],v[156:159],v[220:223]
 MF v[96:99],v[156:159],v[224:227]
 MF v[100:103],v[160:163],v[196:199]
 DM 40,69632,240,s[16:19],24,sc1 lds
 MF v[104:107],v[160:163],v[200:203]
 MF v[108:111],v[160:163],v[204:207]
 MF v[112:115],v[160:163],v[208:211]
 MF v[116:119],v[160:163],v[212:215]
 MF v[120:123],v[160:163],v[216:219]
 DM 40,70656,241,s[16:19],24,sc1 lds
 MF v[124:127],v[160:163],v[220:223]
 MF v[128:131],v[160:163],v[224:227]
 s_waitcnt lgkmcnt(0)
 s_mov_b32 s42, 3
f1l_loop_1:
 MF v[4:7],v[132:135],v[164:167]
 RB 196,199,229,0
 MF v[8:11],v[132:135],v[168:171]
 RB 200,203,229,2048
 MF v[12:15],v[132:135],v[172:175]
 RB 204,207,229,4096
 DM 40,71680,242,s[16:19],24,sc1 lds
 MF v[16:19],v[132:135],v[176:179]
 RB 208,211,229,6144
 MF v[20:23],v[132:135],v[180:183]
 RB 212,215,229,8192
 MF v[24:27],v[132:135],v[184:187]
 RB 216,219,229,10240
 MF v[28:31],v[132:135],v[188:191]
 RB 220,223,229,12288
 MF v[32:35],v[132:135],v[192:195]
 RB 224,227,229,14336
 MF v[36:39],v[136:139],v[164:167]
 TR 148,149,232,8192
 DM 40,72704,243,s[16:19],24,sc1 lds
 MF v[40:43],v[136:139],v[168:171]
 TR 150,151,232,9216
 MF v[44:47],v[136:139],v[172:175]
 TR 152,153,233,8192
 MF v[48:51],v[136:139],v[176:179]
 TR 154,155,233,9216
 MF v[52:55],v[136:139],v[180:183]
 TR 156,157,234,8192
 MF v[56:59],v[136:139],v[184:187]
 TR 158,159,234,9216
 DM 41,32768,244,s[20:23],25,lds
 MF v[60:63],v[136:139],v[188:191]
 TR 160,161,235,8192
 MF v[64:67],v[136:139],v[192:195]
 TR 162,163,235,9216
 MF v[68:71],v[140:143],v[164:167]
 MF v[72:75],v[140:143],v[168:171]
 MF v[76:79],v[140:143],v[172:175]
 DM 41,33792,245,s[20:23],25,lds
 MF v[80:83],v[140:143],v[176:179]
 MF v[84:87],v[140:143],v[180:183]
 MF v[88:91],v[140:143],v[184:187]
 MF v[92:95],v[140:143],v[188:191]
 MF v[96:99],v[140:143],v[192:195]
 MF v[100:103],v[144:147],v[164:167]
 DM 41,34816,246,s[20:23],25,lds
 MF v[104:107],v[144:147],v[168:171]
 MF v[108:111],v[144:147],v[172:175]
 MF v[112:115],v[144:147],v[176:179]
 MF v[116:119],v[144:147],v[180:183]
 MF v[120:123],v[144:147],v[184:187]
 DM 41,35840,247,s[20:23],25,lds
 s_add_u32 s24, s24, 128
 s_add_u32 s25, s25, 458752
 MF v[124:127],v[144:147],v[188:191]
 MF v[128:131],v[144:147],v[192:195]
 s_waitcnt lgkmcnt(0)
 s_waitcnt vmcnt(12)
 s_barrier
 MF v[4:7],v[148:151],v[196:199]
 RB 164,167,228,32768
 MF v[8:11],v[148:151],v[200:203]
 RB 168,171,228,34816
 MF v[12:15],v[148:151],v[204:207]
 RB 172,175,228,36864
 DM 40,0,236,s[16:19],24,sc1 lds
 MF v[16:19],v[148:151],v[208:211]
 RB 176,179,228,38912
 MF v[20:23],v[148:151],v[212:215]
 RB 180,183,228,40960
 MF v[24:27],v[148:151],v[216:219]
 RB 184,187,228,43008
 MF v[28:31],v[148:151],v[220:223]
 RB 188,191,228,45056
 MF v[32:35],v[148:151],v[224:227]
 RB 192,195,228,47104
 MF v[36:39],v[152:155],v[196:199]
 TR 132,133,232,16384
 DM 40,1024,237,s[16:19],24,sc1 lds
 MF v[40:43],v[152:155],v[200:203]
 TR 134,135,232,17408
 MF v[44:47],v[152:155],v[204:207]
 TR 136,137,233,16384
 MF v[48:51],v[152:155],v[208:211]
 TR 138,139,233,17408
 MF v[52:55],v[152:155],v[212:215]
 TR 140,141,234,16384
 MF v[56:59],v[152:155],v[216:219]
 TR 142,143,234,17408
 DM 40,2048,238,s[16:19],24,sc1 lds
 MF v[60:63],v[152:155],v[220:223]
 TR 144,145,235,16384
 MF v[64:67],v[152:155],v[224:227]
 TR 146,147,235,17408
 MF v[68:71],v[156:159],v[196:199]
 MF v[72:75],v[156:159],v[200:203]
 MF v[76:79],v[156:159],v[204:207]
 DM 40,3072,239,s[16:19],24,sc1 lds
 MF v[80:83],v[156:159],v[208:211]
 MF v[84:87],v[156:159],v[212:215]
 MF v[88:91],v[156:159],v[216:219]
 MF v[92:95],v[156:159],v[220:223]
 MF v[96:99],v[156:159],v[224:227]
 MF v[100:103],v[160:163],v[196:199]
 DM 40,4096,240,s[16:19],24,sc1 lds
 MF v[104:107],v[160:163],v[200:203]
 MF v[108:111],v[160:163],v[204:207]
 MF v[112:115],v[160:163],v[208:211]
 MF v[116:119],v[160:163],v[212:215]
 MF v[120:123],v[160:163],v[216:219]
 DM 40,5120,241,s[16:19],24,sc1 lds
 MF v[124:127],v[160:163],v[220:223]
 MF v[128:131],v[160:163],v[224:227]
 s_waitcnt lgkmcnt(0)
 MF v[4:7],v[132:135],v[164:167]
 RB 196,199,229,32768
 MF v[8:11],v[132:135],v[168:171]
 RB 200,203,229,34816
 MF v[12:15],v[132:135],v[172:175]
 RB 204,207,229,36864
 DM 40,6144,242,s[16:19],24,sc1 lds
 MF v[16:19],v[132:135],v[176:179]
 RB 208,211,229,38912
 MF v[20:23],v[132:135],v[180:183]
 RB 212,215,229,40960
 MF v[24:27],v[132:135],v[184:187]
 RB 216,219,229,43008
 MF v[28:31],v[132:135],v[188:191]
 RB 220,223,229,45056
 MF v[32:35],v[132:135],v[192:195]
 RB 224,227,229,47104
 MF v[36:39],v[136:139],v[164:167]
 TR 148,149,232,24576
 DM 40,7168,243,s[16:19],24,sc1 lds
 MF v[40:43],v[136:139],v[168:171]
 TR 150,151,232,25600
 MF v[44:47],v[136:139],v[172:175]
 TR 152,153,233,24576
 MF v[48:51],v[136:139],v[176:179]
 TR 154,155,233,25600
 MF v[52:55],v[136:139],v[180:183]
 TR 156,157,234,24576
 MF v[56:59],v[136:139],v[184:187]
 TR 158,159,234,25600
 DM 41,0,244,s[20:23],25,lds
 MF v[60:63],v[136:139],v[188:191]
 TR 160,161,235,24576
 MF v[64:67],v[136:139],v[192:195]
 TR 162,163,235,25600
 MF v[68:71],v[140:143],v[164:167]
 MF v[72:75],v[140:143],v[168:171]
 MF v[76:79],v[140:143],v[172:175]
 DM 41,1024,245,s[20:23],25,lds
 MF v[80:83],v[140:143],v[176:179]
 MF v[84:87],v[140:143],v[180:183]
 MF v[88:91],v[140:143],v[184:187]
 MF v[92:95],v[140:143],v[188:191]
 MF v[96:99],v[140:143],v[192:195]
 MF v[100:103],v[144:147],v[164:167]
 DM 41,2048,246,s[20:23],25,lds
 MF v[104:107],v[144:147],v[168:171]
 MF v[108:111],v[144:147],v[172:175]
 MF v[112:115],v[144:147],v[176:179]
 MF v[116:119],v[144:147],v[180:183]
 MF v[120:123],v[144:147],v[184:187]
 DM 41,3072,247,s[20:23],25,lds
 s_add_u32 s24, s24, 128
 s_add_u32 s25, s25, 458752
 MF v[124:127],v[144:147],v[188:191]
 MF v[128:131],v[144:147],v[192:195]
 s_waitcnt lgkmcnt(0)
 s_waitcnt vmcnt(12)
 s_barrier
 MF v[4:7],v[148:151],v[196:199]
 RB 164,167,230,0
 MF v[8:11],v[148:151],v[200:203]
 RB 168,171,230,2048
 MF v[12:15],v[148:151],v[204:207]
 RB 172,175,230,4096
 DM 40,32768,236,s[16:19],24,sc1 lds
 MF v[16:19],v[148:151],v[208:211]
 RB 176,179,230,6144
 MF v[20:23],v[148:151],v[212:215]
 RB 180,183,230,8192
 MF v[24:27],v[148:151],v[216:219]
 RB 184,187,230,10240
 MF v[28:31],v[148:151],v[220:223]
 RB 188,191,230,12288
 MF v[32:35],v[148:151],v[224:227]
 RB 192,195,230,14336
 MF v[36:39],v[152:155],v[196:199]
 TR 132,133,232,32768
 DM 40,33792,237,s[16:19],24,sc1 lds
 MF v[40:43],v[152:155],v[200:203]
 TR 134,135,232,33792
 MF v[44:47],v[152:155],v[204:207]
 TR 136,137,233,32768
 MF v[48:51],v[152:155],v[208:211]
 TR 138,139,233,33792
 MF v[52:55],v[152:155],v[212:215]
 TR 140,141,234,32768
 MF v[56:59],v[152:155],v[216:219]
 TR 142,143,234,33792
 DM 40,34816,238,s[16:19],24,sc1 lds
 MF v[60:63],v[152:155],v[220:223]
 TR 144,145,235,32768
 MF v[64:67],v[152:155],v[224:227]
 TR 146,147,235,33792
 MF v[68:71],v[156:159],v[196:199]
 MF v[72:75],v[156:159],v[200:203]
 MF v[76:79],v[156:159],v[204:207]
 DM 40,35840,239,s[16:19],24,sc1 lds
 MF v[80:83],v[156:159],v[208:211]
 MF v[84:87],v[156:159],v[212:215]
 MF v[88:91],v[156:159],v[216:219]
 MF v[92:95],v[156:159],v[220:223]
 MF v[96:99],v[156:159],v[224:227]
 MF v[100:103],v[160:163],v[196:199]
 DM 40,36864,240,s[16:19],24,sc1 lds
 MF v[104:107],v[160:163],v[200:203]
 MF v[108:111],v[160:163],v[204:207]
 MF v[112:115],v[160:163],v[208:211]
 MF v[116:119],v[160:163],v[212:215]
 MF v[120:123],v[160:163],v[216:219]
 DM 40,37888,241,s[16:19],24,sc1 lds
 MF v[124:127],v[160:163],v[220:223]
 MF v[128:131],v[160:163],v[224:227]
 s_waitcnt lgkmcnt(0)
 MF v[4:7],v[132:135],v[164:167]
 RB 196,199,231,0
 MF v[8:11],v[132:135],v[168:171]
 RB 200,203,231,2048
 MF v[12:15],v[132:135],v[172:175]
 RB 204,207,231,4096
 DM 40,38912,242,s[16:19],24,sc1 lds
 MF v[16:19],v[132:135],v[176:179]
 RB 208,211,231,6144
 MF v[20:23],v[132:135],v[180:183]
 RB 212,215,231,8192
 MF v[24:27],v[132:135],v[184:187]
 RB 216,219,231,10240
 MF v[28:31],v[132:135],v[188:191]
 RB 220,223,231,12288
 MF v[32:35],v[132:135],v[192:195]
 RB 224,227,231,14336
 MF v[36:39],v[136:139],v[164:167]
 TR 148,149,232,40960
 DM 40,39936,243,s[16:19],24,sc1 lds
 MF v[40:43],v[136:139],v[168:171]
 TR 150,151,232,41984
 MF v[44:47],v[136:139],v[172:175]
 TR 152,153,233,40960
 MF v[48:51],v[136:139],v[176:179]
 TR 154,155,233,41984
 MF v[52:55],v[136:139],v[180:183]
 TR 156,157,234,40960
 MF v[56:59],v[136:139],v[184:187]
 TR 158,159,234,41984
 DM 41,16384,244,s[20:23],25,lds
 MF v[60:63],v[136:139],v[188:191]
 TR 160,161,235,40960
 MF v[64:67],v[136:139],v[192:195]
 TR 162,163,235,41984
 MF v[68:71],v[140:143],v[164:167]
 MF v[72:75],v[140:143],v[168:171]
 MF v[76:79],v[140:143],v[172:175]
 DM 41,17408,245,s[20:23],25,lds
 MF v[80:83],v[140:143],v[176:179]
 MF v[84:87],v[140:143],v[180:183]
 MF v[88:91],v[140:143],v[184:187]
 MF v[92:95],v[140:143],v[188:191]
 MF v[96:99],v[140:143],v[192:195]
 MF v[100:103],v[144:147],v[164:167]
 DM 41,18432,246,s[20:23],25,lds
 MF v[104:107],v[144:147],v[168:171]
 MF v[108:111],v[144:147],v[172:175]
 MF v[112:115],v[144:147],v[176:179]
 MF v[116:119],v[144:147],v[180:183]
 MF v[120:123],v[144:147],v[184:187]
 DM 41,19456,247,s[20:23],25,lds
 s_add_u32 s24, s24, 128
 s_add_u32 s25, s25, 458752
 MF v[124:127],v[144:147],v[188:191]
 MF v[128:131],v[144:147],v[192:195]
 s_waitcnt lgkmcnt(0)
 s_waitcnt vmcnt(12)
 s_barrier
 MF v[4:7],v[148:151],v[196:199]
 RB 164,167,228,0
 MF v[8:11],v[148:151],v[200:203]
 RB 168,171,228,2048
 MF v[12:15],v[148:151],v[204:207]
 RB 172,175,228,4096
 DM 40,65536,236,s[16:19],24,sc1 lds
 MF v[16:19],v[148:151],v[208:211]
 RB 176,179,228,6144
 MF v[20:23],v[148:151],v[212:215]
 RB 180,183,228,8192
 MF v[24:27],v[148:151],v[216:219]
 RB 184,187,228,10240
 MF v[28:31],v[148:151],v[220:223]
 RB 188,191,228,12288
 MF v[32:35],v[148:151],v[224:227]
 RB 192,195,228,14336
 MF v[36:39],v[152:155],v[196:199]
 TR 132,133,232,0
 DM 40,66560,237,s[16:19],24,sc1 lds
 MF v[40:43],v[152:155],v[200:203]
 TR 134,135,232,1024
 MF v[44:47],v[152:155],v[204:207]
 TR 136,137,233,0
 MF v[48:51],v[152:155],v[208:211]
 TR 138,139,233,1024
 MF v[52:55],v[152:155],v[212:215]
 TR 140,141,234,0
 MF v[56:59],v[152:155],v[216:219]
 TR 142,143,234,1024
 DM 40,67584,238,s[16:19],24,sc1 lds
 MF v[60:63],v[152:155],v[220:223]
 TR 144,145,235,0
 MF v[64:67],v[152:155],v[224:227]
 TR 146,147,235,1024
 MF v[68:71],v[156:159],v[196:199]
 MF v[72:75],v[156:159],v[200:203]
 MF v[76:79],v[156:159],v[204:207]
 DM 40,68608,239,s[16:19],24,sc1 lds
 MF v[80:83],v[156:159],v[208:211]
 MF v[84:87],v[156:159],v[212:215]
 MF v[88:91],v[156:159],v[216:219]
 MF v[92:95],v[156:159],v[220:223]
 MF v[96:99],v[156:159],v[224:227]
 MF v[100:103],v[160:163],v[196:199]
 DM 40,69632,240,s[16:19],24,sc1 lds
 MF v[104:107],v[160:163],v[200:203]
 MF v[108:111],v[160:163],v[204:207]
 MF v[112:115],v[160:163],v[208:211]
 MF v[116:119],v[160:163],v[212:215]
 MF v[120:123],v[160:163],v[216:219]
 DM 40,70656,241,s[16:19],24,sc1 lds
 MF v[124:127],v[160:163],v[220:223]
 MF v[128:131],v[160:163],v[224:227]
 s_waitcnt lgkmcnt(0)
 s_sub_u32 s42, s42, 1
 s_cmp_lg_u32 s42, 0
 s_cbranch_scc1 f1l_loop_1
 MF v[4:7],v[132:135],v[164:167]
 RB 196,199,229,0
 MF v[8:11],v[132:135],v[168:171]
 RB 200,203,229,2048
 MF v[12:15],v[132:135],v[172:175]
 RB 204,207,229,4096
 DM 40,71680,242,s[16:19],24,sc1 lds
 MF v[16:19],v[132:135],v[176:179]
 RB 208,211,229,6144
 MF v[20:23],v[132:135],v[180:183]
 RB 212,215,229,8192
 MF v[24:27],v[132:135],v[184:187]
 RB 216,219,229,10240
 MF v[28:31],v[132:135],v[188:191]
 RB 220,223,229,12288
 MF v[32:35],v[132:135],v[192:195]
 RB 224,227,229,14336
 MF v[36:39],v[136:139],v[164:167]
 TR 148,149,232,8192
 DM 40,72704,243,s[16:19],24,sc1 lds
 MF v[40:43],v[136:139],v[168:171]
 TR 150,151,232,9216
 MF v[44:47],v[136:139],v[172:175]
 TR 152,153,233,8192
 MF v[48:51],v[136:139],v[176:179]
 TR 154,155,233,9216
 MF v[52:55],v[136:139],v[180:183]
 TR 156,157,234,8192
 MF v[56:59],v[136:139],v[184:187]
 TR 158,159,234,9216
 DM 41,32768,244,s[20:23],25,lds
 MF v[60:63],v[136:139],v[188:191]
 TR 160,161,235,8192
 MF v[64:67],v[136:139],v[192:195]
 TR 162,163,235,9216
 MF v[68:71],v[140:143],v[164:167]
 MF v[72:75],v[140:143],v[168:171]
 MF v[76:79],v[140:143],v[172:175]
 DM 41,33792,245,s[20:23],25,lds
 MF v[80:83],v[140:143],v[176:179]
 MF v[84:87],v[140:143],v[180:183]
 MF v[88:91],v[140:143],v[184:187]
 MF v[92:95],v[140:143],v[188:191]
 MF v[96:99],v[140:143],v[192:195]
 MF v[100:103],v[144:147],v[164:167]
 DM 41,34816,246,s[20:23],25,lds
 MF v[104:107],v[144:147],v[168:171]
 MF v[108:111],v[144:147],v[172:175]
 MF v[112:115],v[144:147],v[176:179]
 MF v[116:119],v[144:147],v[180:183]
 MF v[120:123],v[144:147],v[184:187]
 DM 41,35840,247,s[20:23],25,lds
 s_add_u32 s24, s24, 128
 s_add_u32 s25, s25, 458752
 MF v[124:127],v[144:147],v[188:191]
 MF v[128:131],v[144:147],v[192:195]
 s_waitcnt lgkmcnt(0)
 s_waitcnt vmcnt(12)
 s_barrier
 MF v[4:7],v[148:151],v[196:199]
 RB 164,167,228,32768
 MF v[8:11],v[148:151],v[200:203]
 RB 168,171,228,34816
 MF v[12:15],v[148:151],v[204:207]
 RB 172,175,228,36864
 DM 40,0,236,s[16:19],24,sc1 lds
 MF v[16:19],v[148:151],v[208:211]
 RB 176,179,228,38912
 MF v[20:23],v[148:151],v[212:215]
 RB 180,183,228,40960
 MF v[24:27],v[148:151],v[216:219]
 RB 184,187,228,43008
 MF v[28:31],v[148:151],v[220:223]
 RB 188,191,228,45056
 MF v[32:35],v[148:151],v[224:227]
 RB 192,195,228,47104
 MF v[36:39],v[152:155],v[196:199]
 TR 132,133,232,16384
 DM 40,1024,237,s[16:19],24,sc1 lds
 MF v[40:43],v[152:155],v[200:203]
 TR 134,135,232,17408
 MF v[44:47],v[152:155],v[204:207]
 TR 136,137,233,16384
 MF v[48:51],v[152:155],v[208:211]
 TR 138,139,233,17408
 MF v[52:55],v[152:155],v[212:215]
 TR 140,141,234,16384
 MF v[56:59],v[152:155],v[216:219]
 TR 142,143,234,17408
 DM 40,2048,238,s[16:19],24,sc1 lds
 MF v[60:63],v[152:155],v[220:223]
 TR 144,145,235,16384
 MF v[64:67],v[152:155],v[224:227]
 TR 146,147,235,17408
 MF v[68:71],v[156:159],v[196:199]
 MF v[72:75],v[156:159],v[200:203]
 MF v[76:79],v[156:159],v[204:207]
 DM 40,3072,239,s[16:19],24,sc1 lds
 MF v[80:83],v[156:159],v[208:211]
 MF v[84:87],v[156:159],v[212:215]
 MF v[88:91],v[156:159],v[216:219]
 MF v[92:95],v[156:159],v[220:223]
 MF v[96:99],v[156:159],v[224:227]
 MF v[100:103],v[160:163],v[196:199]
 DM 40,4096,240,s[16:19],24,sc1 lds
 MF v[104:107],v[160:163],v[200:203]
 MF v[108:111],v[160:163],v[204:207]
 MF v[112:115],v[160:163],v[208:211]
 MF v[116:119],v[160:163],v[212:215]
 MF v[120:123],v[160:163],v[216:219]
 DM 40,5120,241,s[16:19],24,sc1 lds
 MF v[124:127],v[160:163],v[220:223]
 MF v[128:131],v[160:163],v[224:227]
 s_waitcnt lgkmcnt(0)
 MF v[4:7],v[132:135],v[164:167]
 RB 196,199,229,32768
 MF v[8:11],v[132:135],v[168:171]
 RB 200,203,229,34816
 MF v[12:15],v[132:135],v[172:175]
 RB 204,207,229,36864
 DM 40,6144,242,s[16:19],24,sc1 lds
 MF v[16:19],v[132:135],v[176:179]
 RB 208,211,229,38912
 MF v[20:23],v[132:135],v[180:183]
 RB 212,215,229,40960
 MF v[24:27],v[132:135],v[184:187]
 RB 216,219,229,43008
 MF v[28:31],v[132:135],v[188:191]
 RB 220,223,229,45056
 MF v[32:35],v[132:135],v[192:195]
 RB 224,227,229,47104
 MF v[36:39],v[136:139],v[164:167]
 TR 148,149,232,24576
 DM 40,7168,243,s[16:19],24,sc1 lds
 MF v[40:43],v[136:139],v[168:171]
 TR 150,151,232,25600
 MF v[44:47],v[136:139],v[172:175]
 TR 152,153,233,24576
 MF v[48:51],v[136:139],v[176:179]
 TR 154,155,233,25600
 MF v[52:55],v[136:139],v[180:183]
 TR 156,157,234,24576
 MF v[56:59],v[136:139],v[184:187]
 TR 158,159,234,25600
 DM 41,0,244,s[20:23],25,lds
 MF v[60:63],v[136:139],v[188:191]
 TR 160,161,235,24576
 MF v[64:67],v[136:139],v[192:195]
 TR 162,163,235,25600
 MF v[68:71],v[140:143],v[164:167]
 MF v[72:75],v[140:143],v[168:171]
 MF v[76:79],v[140:143],v[172:175]
 DM 41,1024,245,s[20:23],25,lds
 MF v[80:83],v[140:143],v[176:179]
 MF v[84:87],v[140:143],v[180:183]
 MF v[88:91],v[140:143],v[184:187]
 MF v[92:95],v[140:143],v[188:191]
 MF v[96:99],v[140:143],v[192:195]
 MF v[100:103],v[144:147],v[164:167]
 DM 41,2048,246,s[20:23],25,lds
 MF v[104:107],v[144:147],v[168:171]
 MF v[108:111],v[144:147],v[172:175]
 MF v[112:115],v[144:147],v[176:179]
 MF v[116:119],v[144:147],v[180:183]
 MF v[120:123],v[144:147],v[184:187]
 DM 41,3072,247,s[20:23],25,lds
 s_add_u32 s24, s24, 128
 s_add_u32 s25, s25, 458752
 MF v[124:127],v[144:147],v[188:191]
 MF v[128:131],v[144:147],v[192:195]
 s_waitcnt lgkmcnt(0)
 s_waitcnt vmcnt(12)
 s_barrier
 MF v[4:7],v[148:151],v[196:199]
 RB 164,167,230,0
 MF v[8:11],v[148:151],v[200:203]
 RB 168,171,230,2048
 MF v[12:15],v[148:151],v[204:207]
 RB 172,175,230,4096
 MF v[16:19],v[148:151],v[208:211]
 RB 176,179,230,6144
 MF v[20:23],v[148:151],v[212:215]
 RB 180,183,230,8192
 MF v[24:27],v[148:151],v[216:219]
 RB 184,187,230,10240
 MF v[28:31],v[148:151],v[220:223]
 RB 188,191,230,12288
 MF v[32:35],v[148:151],v[224:227]
 RB 192,195,230,14336
 MF v[36:39],v[152:155],v[196:199]
 TR 132,133,232,32768
 MF v[40:43],v[152:155],v[200:203]
 TR 134,135,232,33792
 MF v[44:47],v[152:155],v[204:207]
 TR 136,137,233,32768
 MF v[48:51],v[152:155],v[208:211]
 TR 138,139,233,33792
 MF v[52:55],v[152:155],v[212:215]
 TR 140,141,234,32768
 MF v[56:59],v[152:155],v[216:219]
 TR 142,143,234,33792
 MF v[60:63],v[152:155],v[220:223]
 TR 144,145,235,32768
 MF v[64:67],v[152:155],v[224:227]
 TR 146,147,235,33792
 MF v[68:71],v[156:159],v[196:199]
 MF v[72:75],v[156:159],v[200:203]
 MF v[76:79],v[156:159],v[204:207]
 MF v[80:83],v[156:159],v[208:211]
 MF v[84:87],v[156:159],v[212:215]
 MF v[88:91],v[156:159],v[216:219]
 MF v[92:95],v[156:159],v[220:223]
 MF v[96:99],v[156:159],v[224:227]
 MF v[100:103],v[160:163],v[196:199]
 MF v[104:107],v[160:163],v[200:203]
 MF v[108:111],v[160:163],v[204:207]
 MF v[112:115],v[160:163],v[208:211]
 MF v[116:119],v[160:163],v[212:215]
 MF v[120:123],v[160:163],v[216:219]
 MF v[124:127],v[160:163],v[220:223]
 MF v[128:131],v[160:163],v[224:227]
 s_waitcnt lgkmcnt(0)
 MF v[4:7],v[132:135],v[164:167]
 RB 196,199,231,0
 MF v[8:11],v[132:135],v[168:171]
 RB 200,203,231,2048
 MF v[12:15],v[132:135],v[172:175]
 RB 204,207,231,4096
 MF v[16:19],v[132:135],v[176:179]
 RB 208,211,231,6144
 MF v[20:23],v[132:135],v[180:183]
 RB 212,215,231,8192
 MF v[24:27],v[132:135],v[184:187]
 RB 216,219,231,10240
 MF v[28:31],v[132:135],v[188:191]
 RB 220,223,231,12288
 MF v[32:35],v[132:135],v[192:195]
 RB 224,227,231,14336
 MF v[36:39],v[136:139],v[164:167]
 TR 148,149,232,40960
 MF v[40:43],v[136:139],v[168:171]
 TR 150,151,232,41984
 MF v[44:47],v[136:139],v[172:175]
 TR 152,153,233,40960
 MF v[48:51],v[136:139],v[176:179]
 TR 154,155,233,41984
 MF v[52:55],v[136:139],v[180:183]
 TR 156,157,234,40960
 MF v[56:59],v[136:139],v[184:187]
 TR 158,159,234,41984
 MF v[60:63],v[136:139],v[188:191]
 TR 160,161,235,40960
 MF v[64:67],v[136:139],v[192:195]
 TR 162,163,235,41984
 MF v[68:71],v[140:143],v[164:167]
 MF v[72:75],v[140:143],v[168:171]
 MF v[76:79],v[140:143],v[172:175]
 MF v[80:83],v[140:143],v[176:179]
 MF v[84:87],v[140:143],v[180:183]
 MF v[88:91],v[140:143],v[184:187]
 MF v[92:95],v[140:143],v[188:191]
 MF v[96:99],v[140:143],v[192:195]
 MF v[100:103],v[144:147],v[164:167]
 MF v[104:107],v[144:147],v[168:171]
 MF v[108:111],v[144:147],v[172:175]
 MF v[112:115],v[144:147],v[176:179]
 MF v[116:119],v[144:147],v[180:183]
 MF v[120:123],v[144:147],v[184:187]
 MF v[124:127],v[144:147],v[188:191]
 MF v[128:131],v[144:147],v[192:195]
 s_waitcnt lgkmcnt(0)
 s_waitcnt vmcnt(0)
 s_barrier
 MF v[4:7],v[148:151],v[196:199]
 RB 164,167,228,0
 MF v[8:11],v[148:151],v[200:203]
 RB 168,171,228,2048
 MF v[12:15],v[148:151],v[204:207]
 RB 172,175,228,4096
 MF v[16:19],v[148:151],v[208:211]
 RB 176,179,228,6144
 MF v[20:23],v[148:151],v[212:215]
 RB 180,183,228,8192
 MF v[24:27],v[148:151],v[216:219]
 RB 184,187,228,10240
 MF v[28:31],v[148:151],v[220:223]
 RB 188,191,228,12288
 MF v[32:35],v[148:151],v[224:227]
 RB 192,195,228,14336
 MF v[36:39],v[152:155],v[196:199]
 TR 132,133,232,0
 MF v[40:43],v[152:155],v[200:203]
 TR 134,135,232,1024
 MF v[44:47],v[152:155],v[204:207]
 TR 136,137,233,0
 MF v[48:51],v[152:155],v[208:211]
 TR 138,139,233,1024
 MF v[52:55],v[152:155],v[212:215]
 TR 140,141,234,0
 MF v[56:59],v[152:155],v[216:219]
 TR 142,143,234,1024
 MF v[60:63],v[152:155],v[220:223]
 TR 144,145,235,0
 MF v[64:67],v[152:155],v[224:227]
 TR 146,147,235,1024
 MF v[68:71],v[156:159],v[196:199]
 MF v[72:75],v[156:159],v[200:203]
 MF v[76:79],v[156:159],v[204:207]
 MF v[80:83],v[156:159],v[208:211]
 MF v[84:87],v[156:159],v[212:215]
 MF v[88:91],v[156:159],v[216:219]
 MF v[92:95],v[156:159],v[220:223]
 MF v[96:99],v[156:159],v[224:227]
 MF v[100:103],v[160:163],v[196:199]
 MF v[104:107],v[160:163],v[200:203]
 MF v[108:111],v[160:163],v[204:207]
 MF v[112:115],v[160:163],v[208:211]
 MF v[116:119],v[160:163],v[212:215]
 MF v[120:123],v[160:163],v[216:219]
 MF v[124:127],v[160:163],v[220:223]
 MF v[128:131],v[160:163],v[224:227]
 s_waitcnt lgkmcnt(0)
 MF v[4:7],v[132:135],v[164:167]
 RB 196,199,229,0
 MF v[8:11],v[132:135],v[168:171]
 RB 200,203,229,2048
 MF v[12:15],v[132:135],v[172:175]
 RB 204,207,229,4096
 MF v[16:19],v[132:135],v[176:179]
 RB 208,211,229,6144
 MF v[20:23],v[132:135],v[180:183]
 RB 212,215,229,8192
 MF v[24:27],v[132:135],v[184:187]
 RB 216,219,229,10240
 MF v[28:31],v[132:135],v[188:191]
 RB 220,223,229,12288
 MF v[32:35],v[132:135],v[192:195]
 RB 224,227,229,14336
 MF v[36:39],v[136:139],v[164:167]
 TR 148,149,232,8192
 MF v[40:43],v[136:139],v[168:171]
 TR 150,151,232,9216
 MF v[44:47],v[136:139],v[172:175]
 TR 152,153,233,8192
 MF v[48:51],v[136:139],v[176:179]
 TR 154,155,233,9216
 MF v[52:55],v[136:139],v[180:183]
 TR 156,157,234,8192
 MF v[56:59],v[136:139],v[184:187]
 TR 158,159,234,9216
 MF v[60:63],v[136:139],v[188:191]
 TR 160,161,235,8192
 MF v[64:67],v[136:139],v[192:195]
 TR 162,163,235,9216
 MF v[68:71],v[140:143],v[164:167]
 MF v[72:75],v[140:143],v[168:171]
 MF v[76:79],v[140:143],v[172:175]
 MF v[80:83],v[140:143],v[176:179]
 MF v[84:87],v[140:143],v[180:183]
 MF v[88:91],v[140:143],v[184:187]
 MF v[92:95],v[140:143],v[188:191]
 MF v[96:99],v[140:143],v[192:195]
 MF v[100:103],v[144:147],v[164:167]
 MF v[104:107],v[144:147],v[168:171]
 MF v[108:111],v[144:147],v[172:175]
 MF v[112:115],v[144:147],v[176:179]
 MF v[116:119],v[144:147],v[180:183]
 MF v[120:123],v[144:147],v[184:187]
 MF v[124:127],v[144:147],v[188:191]
 MF v[128:131],v[144:147],v[192:195]
 s_waitcnt lgkmcnt(0)
 MF v[4:7],v[148:151],v[196:199]
 MF v[8:11],v[148:151],v[200:203]
 MF v[12:15],v[148:151],v[204:207]
 MF v[16:19],v[148:151],v[208:211]
 MF v[20:23],v[148:151],v[212:215]
 MF v[24:27],v[148:151],v[216:219]
 MF v[28:31],v[148:151],v[220:223]
 MF v[32:35],v[148:151],v[224:227]
 MF v[36:39],v[152:155],v[196:199]
 MF v[40:43],v[152:155],v[200:203]
 MF v[44:47],v[152:155],v[204:207]
 MF v[48:51],v[152:155],v[208:211]
 MF v[52:55],v[152:155],v[212:215]
 MF v[56:59],v[152:155],v[216:219]
 MF v[60:63],v[152:155],v[220:223]
 MF v[64:67],v[152:155],v[224:227]
 MF v[68:71],v[156:159],v[196:199]
 MF v[72:75],v[156:159],v[200:203]
 MF v[76:79],v[156:159],v[204:207]
 MF v[80:83],v[156:159],v[208:211]
 MF v[84:87],v[156:159],v[212:215]
 MF v[88:91],v[156:159],v[216:219]
 MF v[92:95],v[156:159],v[220:223]
 MF v[96:99],v[156:159],v[224:227]
 MF v[100:103],v[160:163],v[196:199]
 MF v[104:107],v[160:163],v[200:203]
 MF v[108:111],v[160:163],v[204:207]
 MF v[112:115],v[160:163],v[208:211]
 MF v[116:119],v[160:163],v[212:215]
 MF v[120:123],v[160:163],v[216:219]
 MF v[124:127],v[160:163],v[220:223]
 MF v[128:131],v[160:163],v[224:227]
 v_and_b32 v3, 15, v2
 v_mul_u32_u24 v3, 7168, v3
 v_lshrrev_b32 v1, 4, v2
 v_lshl_add_u32 v3, v1, 4, v3
 s_mul_i32 s26, s10, 256
 s_mul_i32 s27, s43, 128
 s_add_u32 s26, s26, s27
 s_mul_i32 s26, s26, 7168
 s_mul_i32 s27, s11, 256
 s_add_u32 s26, s26, s27
 s_mul_i32 s27, s44, 128
 s_add_u32 s26, s26, s27
 s_add_u32 s26, s26, 62914560
 s_mov_b32 s28, 0xbfb8aa3b
 s_nop 4
 CV 164,4,5
 v_lshlrev_b32 v4, 16, v164
 v_and_b32 v5, 0xffff0000, v164
 CV 164,6,7
 v_lshlrev_b32 v6, 16, v164
 v_and_b32 v7, 0xffff0000, v164
 v_mul_f32 v164, s28, v4
 v_mul_f32 v165, s28, v5
 v_mul_f32 v166, s28, v6
 v_mul_f32 v167, s28, v7
 v_exp_f32 v164, v164
 v_exp_f32 v165, v165
 v_exp_f32 v166, v166
 v_exp_f32 v167, v167
 s_nop 0
 v_add_f32 v164, 1.0, v164
 v_add_f32 v165, 1.0, v165
 v_add_f32 v166, 1.0, v166
 v_add_f32 v167, 1.0, v167
 v_rcp_f32 v164, v164
 v_rcp_f32 v165, v165
 v_rcp_f32 v166, v166
 v_rcp_f32 v167, v167
 s_nop 0
 v_mul_f32 v4, v4, v164
 v_mul_f32 v5, v5, v165
 v_mul_f32 v6, v6, v166
 v_mul_f32 v7, v7, v167
 CV 132,4,5
 CV 133,6,7
 CV 164,36,37
 v_lshlrev_b32 v36, 16, v164
 v_and_b32 v37, 0xffff0000, v164
 CV 164,38,39
 v_lshlrev_b32 v38, 16, v164
 v_and_b32 v39, 0xffff0000, v164
 v_mul_f32 v164, s28, v36
 v_mul_f32 v165, s28, v37
 v_mul_f32 v166, s28, v38
 v_mul_f32 v167, s28, v39
 v_exp_f32 v164, v164
 v_exp_f32 v165, v165
 v_exp_f32 v166, v166
 v_exp_f32 v167, v167
 s_nop 0
 v_add_f32 v164, 1.0, v164
 v_add_f32 v165, 1.0, v165
 v_add_f32 v166, 1.0, v166
 v_add_f32 v167, 1.0, v167
 v_rcp_f32 v164, v164
 v_rcp_f32 v165, v165
 v_rcp_f32 v166, v166
 v_rcp_f32 v167, v167
 s_nop 0
 v_mul_f32 v36, v36, v164
 v_mul_f32 v37, v37, v165
 v_mul_f32 v38, v38, v166
 v_mul_f32 v39, v39, v167
 CV 134,36,37
 CV 135,38,39
 buffer_store_dwordx4 v[132:135], v3, s[16:19], s26 offen offset:0 sc1
 CV 164,68,69
 v_lshlrev_b32 v68, 16, v164
 v_and_b32 v69, 0xffff0000, v164
 CV 164,70,71
 v_lshlrev_b32 v70, 16, v164
 v_and_b32 v71, 0xffff0000, v164
 v_mul_f32 v164, s28, v68
 v_mul_f32 v165, s28, v69
 v_mul_f32 v166, s28, v70
 v_mul_f32 v167, s28, v71
 v_exp_f32 v164, v164
 v_exp_f32 v165, v165
 v_exp_f32 v166, v166
 v_exp_f32 v167, v167
 s_nop 0
 v_add_f32 v164, 1.0, v164
 v_add_f32 v165, 1.0, v165
 v_add_f32 v166, 1.0, v166
 v_add_f32 v167, 1.0, v167
 v_rcp_f32 v164, v164
 v_rcp_f32 v165, v165
 v_rcp_f32 v166, v166
 v_rcp_f32 v167, v167
 s_nop 0
 v_mul_f32 v68, v68, v164
 v_mul_f32 v69, v69, v165
 v_mul_f32 v70, v70, v166
 v_mul_f32 v71, v71, v167
 CV 136,68,69
 CV 137,70,71
 CV 164,100,101
 v_lshlrev_b32 v100, 16, v164
 v_and_b32 v101, 0xffff0000, v164
 CV 164,102,103
 v_lshlrev_b32 v102, 16, v164
 v_and_b32 v103, 0xffff0000, v164
 v_mul_f32 v164, s28, v100
 v_mul_f32 v165, s28, v101
 v_mul_f32 v166, s28, v102
 v_mul_f32 v167, s28, v103
 v_exp_f32 v164, v164
 v_exp_f32 v165, v165
 v_exp_f32 v166, v166
 v_exp_f32 v167, v167
 s_nop 0
 v_add_f32 v164, 1.0, v164
 v_add_f32 v165, 1.0, v165
 v_add_f32 v166, 1.0, v166
 v_add_f32 v167, 1.0, v167
 v_rcp_f32 v164, v164
 v_rcp_f32 v165, v165
 v_rcp_f32 v166, v166
 v_rcp_f32 v167, v167
 s_nop 0
 v_mul_f32 v100, v100, v164
 v_mul_f32 v101, v101, v165
 v_mul_f32 v102, v102, v166
 v_mul_f32 v103, v103, v167
 CV 138,100,101
 CV 139,102,103
 buffer_store_dwordx4 v[136:139], v3, s[16:19], s26 offen offset:64 sc1
 s_add_u32 s26, s26, 114688
 CV 164,8,9
 v_lshlrev_b32 v8, 16, v164
 v_and_b32 v9, 0xffff0000, v164
 CV 164,10,11
 v_lshlrev_b32 v10, 16, v164
 v_and_b32 v11, 0xffff0000, v164
 v_mul_f32 v164, s28, v8
 v_mul_f32 v165, s28, v9
 v_mul_f32 v166, s28, v10
 v_mul_f32 v167, s28, v11
 v_exp_f32 v164, v164
 v_exp_f32 v165, v165
 v_exp_f32 v166, v166
 v_exp_f32 v167, v167
 s_nop 0
 v_add_f32 v164, 1.0, v164
 v_add_f32 v165, 1.0, v165
 v_add_f32 v166, 1.0, v166
 v_add_f32 v167, 1.0, v167
 v_rcp_f32 v164, v164
 v_rcp_f32 v165, v165
 v_rcp_f32 v166, v166
 v_rcp_f32 v167, v167
 s_nop 0
 v_mul_f32 v8, v8, v164
 v_mul_f32 v9, v9, v165
 v_mul_f32 v10, v10, v166
 v_mul_f32 v11, v11, v167
 CV 140,8,9
 CV 141,10,11
 CV 164,40,41
 v_lshlrev_b32 v40, 16, v164
 v_and_b32 v41, 0xffff0000, v164
 CV 164,42,43
 v_lshlrev_b32 v42, 16, v164
 v_and_b32 v43, 0xffff0000, v164
 v_mul_f32 v164, s28, v40
 v_mul_f32 v165, s28, v41
 v_mul_f32 v166, s28, v42
 v_mul_f32 v167, s28, v43
 v_exp_f32 v164, v164
 v_exp_f32 v165, v165
 v_exp_f32 v166, v166
 v_exp_f32 v167, v167
 s_nop 0
 v_add_f32 v164, 1.0, v164
 v_add_f32 v165, 1.0, v165
 v_add_f32 v166, 1.0, v166
 v_add_f32 v167, 1.0, v167
 v_rcp_f32 v164, v164
 v_rcp_f32 v165, v165
 v_rcp_f32 v166, v166
 v_rcp_f32 v167, v167
 s_nop 0
 v_mul_f32 v40, v40, v164
 v_mul_f32 v41, v41, v165
 v_mul_f32 v42, v42, v166
 v_mul_f32 v43, v43, v167
 CV 142,40,41
 CV 143,42,43
 buffer_store_dwordx4 v[140:143], v3, s[16:19], s26 offen offset:0 sc1
 CV 164,72,73
 v_lshlrev_b32 v72, 16, v164
 v_and_b32 v73, 0xffff0000, v164
 CV 164,74,75
 v_lshlrev_b32 v74, 16, v164
 v_and_b32 v75, 0xffff0000, v164
 v_mul_f32 v164, s28, v72
 v_mul_f32 v165, s28, v73
 v_mul_f32 v166, s28, v74
 v_mul_f32 v167, s28, v75
 v_exp_f32 v164, v164
 v_exp_f32 v165, v165
 v_exp_f32 v166, v166
 v_exp_f32 v167, v167
 s_nop 0
 v_add_f32 v164, 1.0, v164
 v_add_f32 v165, 1.0, v165
 v_add_f32 v166, 1.0, v166
 v_add_f32 v167, 1.0, v167
 v_rcp_f32 v164, v164
 v_rcp_f32 v165, v165
 v_rcp_f32 v166, v166
 v_rcp_f32 v167, v167
 s_nop 0
 v_mul_f32 v72, v72, v164
 v_mul_f32 v73, v73, v165
 v_mul_f32 v74, v74, v166
 v_mul_f32 v75, v75, v167
 CV 144,72,73
 CV 145,74,75
 CV 164,104,105
 v_lshlrev_b32 v104, 16, v164
 v_and_b32 v105, 0xffff0000, v164
 CV 164,106,107
 v_lshlrev_b32 v106, 16, v164
 v_and_b32 v107, 0xffff0000, v164
 v_mul_f32 v164, s28, v104
 v_mul_f32 v165, s28, v105
 v_mul_f32 v166, s28, v106
 v_mul_f32 v167, s28, v107
 v_exp_f32 v164, v164
 v_exp_f32 v165, v165
 v_exp_f32 v166, v166
 v_exp_f32 v167, v167
 s_nop 0
 v_add_f32 v164, 1.0, v164
 v_add_f32 v165, 1.0, v165
 v_add_f32 v166, 1.0, v166
 v_add_f32 v167, 1.0, v167
 v_rcp_f32 v164, v164
 v_rcp_f32 v165, v165
 v_rcp_f32 v166, v166
 v_rcp_f32 v167, v167
 s_nop 0
 v_mul_f32 v104, v104, v164
 v_mul_f32 v105, v105, v165
 v_mul_f32 v106, v106, v166
 v_mul_f32 v107, v107, v167
 CV 146,104,105
 CV 147,106,107
 buffer_store_dwordx4 v[144:147], v3, s[16:19], s26 offen offset:64 sc1
 s_add_u32 s26, s26, 114688
 CV 164,12,13
 v_lshlrev_b32 v12, 16, v164
 v_and_b32 v13, 0xffff0000, v164
 CV 164,14,15
 v_lshlrev_b32 v14, 16, v164
 v_and_b32 v15, 0xffff0000, v164
 v_mul_f32 v164, s28, v12
 v_mul_f32 v165, s28, v13
 v_mul_f32 v166, s28, v14
 v_mul_f32 v167, s28, v15
 v_exp_f32 v164, v164
 v_exp_f32 v165, v165
 v_exp_f32 v166, v166
 v_exp_f32 v167, v167
 s_nop 0
 v_add_f32 v164, 1.0, v164
 v_add_f32 v165, 1.0, v165
 v_add_f32 v166, 1.0, v166
 v_add_f32 v167, 1.0, v167
 v_rcp_f32 v164, v164
 v_rcp_f32 v165, v165
 v_rcp_f32 v166, v166
 v_rcp_f32 v167, v167
 s_nop 0
 v_mul_f32 v12, v12, v164
 v_mul_f32 v13, v13, v165
 v_mul_f32 v14, v14, v166
 v_mul_f32 v15, v15, v167
 CV 132,12,13
 CV 133,14,15
 CV 164,44,45
 v_lshlrev_b32 v44, 16, v164
 v_and_b32 v45, 0xffff0000, v164
 CV 164,46,47
 v_lshlrev_b32 v46, 16, v164
 v_and_b32 v47, 0xffff0000, v164
 v_mul_f32 v164, s28, v44
 v_mul_f32 v165, s28, v45
 v_mul_f32 v166, s28, v46
 v_mul_f32 v167, s28, v47
 v_exp_f32 v164, v164
 v_exp_f32 v165, v165
 v_exp_f32 v166, v166
 v_exp_f32 v167, v167
 s_nop 0
 v_add_f32 v164, 1.0, v164
 v_add_f32 v165, 1.0, v165
 v_add_f32 v166, 1.0, v166
 v_add_f32 v167, 1.0, v167
 v_rcp_f32 v164, v164
 v_rcp_f32 v165, v165
 v_rcp_f32 v166, v166
 v_rcp_f32 v167, v167
 s_nop 0
 v_mul_f32 v44, v44, v164
 v_mul_f32 v45, v45, v165
 v_mul_f32 v46, v46, v166
 v_mul_f32 v47, v47, v167
 CV 134,44,45
 CV 135,46,47
 buffer_store_dwordx4 v[132:135], v3, s[16:19], s26 offen offset:0 sc1
 CV 164,76,77
 v_lshlrev_b32 v76, 16, v164
 v_and_b32 v77, 0xffff0000, v164
 CV 164,78,79
 v_lshlrev_b32 v78, 16, v164
 v_and_b32 v79, 0xffff0000, v164
 v_mul_f32 v164, s28, v76
 v_mul_f32 v165, s28, v77
 v_mul_f32 v166, s28, v78
 v_mul_f32 v167, s28, v79
 v_exp_f32 v164, v164
 v_exp_f32 v165, v165
 v_exp_f32 v166, v166
 v_exp_f32 v167, v167
 s_nop 0
 v_add_f32 v164, 1.0, v164
 v_add_f32 v165, 1.0, v165
 v_add_f32 v166, 1.0, v166
 v_add_f32 v167, 1.0, v167
 v_rcp_f32 v164, v164
 v_rcp_f32 v165, v165
 v_rcp_f32 v166, v166
 v_rcp_f32 v167, v167
 s_nop 0
 v_mul_f32 v76, v76, v164
 v_mul_f32 v77, v77, v165
 v_mul_f32 v78, v78, v166
 v_mul_f32 v79, v79, v167
 CV 136,76,77
 CV 137,78,79
 CV 164,108,109
 v_lshlrev_b32 v108, 16, v164
 v_and_b32 v109, 0xffff0000, v164
 CV 164,110,111
 v_lshlrev_b32 v110, 16, v164
 v_and_b32 v111, 0xffff0000, v164
 v_mul_f32 v164, s28, v108
 v_mul_f32 v165, s28, v109
 v_mul_f32 v166, s28, v110
 v_mul_f32 v167, s28, v111
 v_exp_f32 v164, v164
 v_exp_f32 v165, v165
 v_exp_f32 v166, v166
 v_exp_f32 v167, v167
 s_nop 0
 v_add_f32 v164, 1.0, v164
 v_add_f32 v165, 1.0, v165
 v_add_f32 v166, 1.0, v166
 v_add_f32 v167, 1.0, v167
 v_rcp_f32 v164, v164
 v_rcp_f32 v165, v165
 v_rcp_f32 v166, v166
 v_rcp_f32 v167, v167
 s_nop 0
 v_mul_f32 v108, v108, v164
 v_mul_f32 v109, v109, v165
 v_mul_f32 v110, v110, v166
 v_mul_f32 v111, v111, v167
 CV 138,108,109
 CV 139,110,111
 buffer_store_dwordx4 v[136:139], v3, s[16:19], s26 offen offset:64 sc1
 s_add_u32 s26, s26, 114688
 CV 164,16,17
 v_lshlrev_b32 v16, 16, v164
 v_and_b32 v17, 0xffff0000, v164
 CV 164,18,19
 v_lshlrev_b32 v18, 16, v164
 v_and_b32 v19, 0xffff0000, v164
 v_mul_f32 v164, s28, v16
 v_mul_f32 v165, s28, v17
 v_mul_f32 v166, s28, v18
 v_mul_f32 v167, s28, v19
 v_exp_f32 v164, v164
 v_exp_f32 v165, v165
 v_exp_f32 v166, v166
 v_exp_f32 v167, v167
 s_nop 0
 v_add_f32 v164, 1.0, v164
 v_add_f32 v165, 1.0, v165
 v_add_f32 v166, 1.0, v166
 v_add_f32 v167, 1.0, v167
 v_rcp_f32 v164, v164
 v_rcp_f32 v165, v165
 v_rcp_f32 v166, v166
 v_rcp_f32 v167, v167
 s_nop 0
 v_mul_f32 v16, v16, v164
 v_mul_f32 v17, v17, v165
 v_mul_f32 v18, v18, v166
 v_mul_f32 v19, v19, v167
 CV 140,16,17
 CV 141,18,19
 CV 164,48,49
 v_lshlrev_b32 v48, 16, v164
 v_and_b32 v49, 0xffff0000, v164
 CV 164,50,51
 v_lshlrev_b32 v50, 16, v164
 v_and_b32 v51, 0xffff0000, v164
 v_mul_f32 v164, s28, v48
 v_mul_f32 v165, s28, v49
 v_mul_f32 v166, s28, v50
 v_mul_f32 v167, s28, v51
 v_exp_f32 v164, v164
 v_exp_f32 v165, v165
 v_exp_f32 v166, v166
 v_exp_f32 v167, v167
 s_nop 0
 v_add_f32 v164, 1.0, v164
 v_add_f32 v165, 1.0, v165
 v_add_f32 v166, 1.0, v166
 v_add_f32 v167, 1.0, v167
 v_rcp_f32 v164, v164
 v_rcp_f32 v165, v165
 v_rcp_f32 v166, v166
 v_rcp_f32 v167, v167
 s_nop 0
 v_mul_f32 v48, v48, v164
 v_mul_f32 v49, v49, v165
 v_mul_f32 v50, v50, v166
 v_mul_f32 v51, v51, v167
 CV 142,48,49
 CV 143,50,51
 buffer_store_dwordx4 v[140:143], v3, s[16:19], s26 offen offset:0 sc1
 CV 164,80,81
 v_lshlrev_b32 v80, 16, v164
 v_and_b32 v81, 0xffff0000, v164
 CV 164,82,83
 v_lshlrev_b32 v82, 16, v164
 v_and_b32 v83, 0xffff0000, v164
 v_mul_f32 v164, s28, v80
 v_mul_f32 v165, s28, v81
 v_mul_f32 v166, s28, v82
 v_mul_f32 v167, s28, v83
 v_exp_f32 v164, v164
 v_exp_f32 v165, v165
 v_exp_f32 v166, v166
 v_exp_f32 v167, v167
 s_nop 0
 v_add_f32 v164, 1.0, v164
 v_add_f32 v165, 1.0, v165
 v_add_f32 v166, 1.0, v166
 v_add_f32 v167, 1.0, v167
 v_rcp_f32 v164, v164
 v_rcp_f32 v165, v165
 v_rcp_f32 v166, v166
 v_rcp_f32 v167, v167
 s_nop 0
 v_mul_f32 v80, v80, v164
 v_mul_f32 v81, v81, v165
 v_mul_f32 v82, v82, v166
 v_mul_f32 v83, v83, v167
 CV 144,80,81
 CV 145,82,83
 CV 164,112,113
 v_lshlrev_b32 v112, 16, v164
 v_and_b32 v113, 0xffff0000, v164
 CV 164,114,115
 v_lshlrev_b32 v114, 16, v164
 v_and_b32 v115, 0xffff0000, v164
 v_mul_f32 v164, s28, v112
 v_mul_f32 v165, s28, v113
 v_mul_f32 v166, s28, v114
 v_mul_f32 v167, s28, v115
 v_exp_f32 v164, v164
 v_exp_f32 v165, v165
 v_exp_f32 v166, v166
 v_exp_f32 v167, v167
 s_nop 0
 v_add_f32 v164, 1.0, v164
 v_add_f32 v165, 1.0, v165
 v_add_f32 v166, 1.0, v166
 v_add_f32 v167, 1.0, v167
 v_rcp_f32 v164, v164
 v_rcp_f32 v165, v165
 v_rcp_f32 v166, v166
 v_rcp_f32 v167, v167
 s_nop 0
 v_mul_f32 v112, v112, v164
 v_mul_f32 v113, v113, v165
 v_mul_f32 v114, v114, v166
 v_mul_f32 v115, v115, v167
 CV 146,112,113
 CV 147,114,115
 buffer_store_dwordx4 v[144:147], v3, s[16:19], s26 offen offset:64 sc1
 s_add_u32 s26, s26, 114688
 CV 164,20,21
 v_lshlrev_b32 v20, 16, v164
 v_and_b32 v21, 0xffff0000, v164
 CV 164,22,23
 v_lshlrev_b32 v22, 16, v164
 v_and_b32 v23, 0xffff0000, v164
 v_mul_f32 v164, s28, v20
 v_mul_f32 v165, s28, v21
 v_mul_f32 v166, s28, v22
 v_mul_f32 v167, s28, v23
 v_exp_f32 v164, v164
 v_exp_f32 v165, v165
 v_exp_f32 v166, v166
 v_exp_f32 v167, v167
 s_nop 0
 v_add_f32 v164, 1.0, v164
 v_add_f32 v165, 1.0, v165
 v_add_f32 v166, 1.0, v166
 v_add_f32 v167, 1.0, v167
 v_rcp_f32 v164, v164
 v_rcp_f32 v165, v165
 v_rcp_f32 v166, v166
 v_rcp_f32 v167, v167
 s_nop 0
 v_mul_f32 v20, v20, v164
 v_mul_f32 v21, v21, v165
 v_mul_f32 v22, v22, v166
 v_mul_f32 v23, v23, v167
 CV 132,20,21
 CV 133,22,23
 CV 164,52,53
 v_lshlrev_b32 v52, 16, v164
 v_and_b32 v53, 0xffff0000, v164
 CV 164,54,55
 v_lshlrev_b32 v54, 16, v164
 v_and_b32 v55, 0xffff0000, v164
 v_mul_f32 v164, s28, v52
 v_mul_f32 v165, s28, v53
 v_mul_f32 v166, s28, v54
 v_mul_f32 v167, s28, v55
 v_exp_f32 v164, v164
 v_exp_f32 v165, v165
 v_exp_f32 v166, v166
 v_exp_f32 v167, v167
 s_nop 0
 v_add_f32 v164, 1.0, v164
 v_add_f32 v165, 1.0, v165
 v_add_f32 v166, 1.0, v166
 v_add_f32 v167, 1.0, v167
 v_rcp_f32 v164, v164
 v_rcp_f32 v165, v165
 v_rcp_f32 v166, v166
 v_rcp_f32 v167, v167
 s_nop 0
 v_mul_f32 v52, v52, v164
 v_mul_f32 v53, v53, v165
 v_mul_f32 v54, v54, v166
 v_mul_f32 v55, v55, v167
 CV 134,52,53
 CV 135,54,55
 buffer_store_dwordx4 v[132:135], v3, s[16:19], s26 offen offset:0 sc1
 CV 164,84,85
 v_lshlrev_b32 v84, 16, v164
 v_and_b32 v85, 0xffff0000, v164
 CV 164,86,87
 v_lshlrev_b32 v86, 16, v164
 v_and_b32 v87, 0xffff0000, v164
 v_mul_f32 v164, s28, v84
 v_mul_f32 v165, s28, v85
 v_mul_f32 v166, s28, v86
 v_mul_f32 v167, s28, v87
 v_exp_f32 v164, v164
 v_exp_f32 v165, v165
 v_exp_f32 v166, v166
 v_exp_f32 v167, v167
 s_nop 0
 v_add_f32 v164, 1.0, v164
 v_add_f32 v165, 1.0, v165
 v_add_f32 v166, 1.0, v166
 v_add_f32 v167, 1.0, v167
 v_rcp_f32 v164, v164
 v_rcp_f32 v165, v165
 v_rcp_f32 v166, v166
 v_rcp_f32 v167, v167
 s_nop 0
 v_mul_f32 v84, v84, v164
 v_mul_f32 v85, v85, v165
 v_mul_f32 v86, v86, v166
 v_mul_f32 v87, v87, v167
 CV 136,84,85
 CV 137,86,87
 CV 164,116,117
 v_lshlrev_b32 v116, 16, v164
 v_and_b32 v117, 0xffff0000, v164
 CV 164,118,119
 v_lshlrev_b32 v118, 16, v164
 v_and_b32 v119, 0xffff0000, v164
 v_mul_f32 v164, s28, v116
 v_mul_f32 v165, s28, v117
 v_mul_f32 v166, s28, v118
 v_mul_f32 v167, s28, v119
 v_exp_f32 v164, v164
 v_exp_f32 v165, v165
 v_exp_f32 v166, v166
 v_exp_f32 v167, v167
 s_nop 0
 v_add_f32 v164, 1.0, v164
 v_add_f32 v165, 1.0, v165
 v_add_f32 v166, 1.0, v166
 v_add_f32 v167, 1.0, v167
 v_rcp_f32 v164, v164
 v_rcp_f32 v165, v165
 v_rcp_f32 v166, v166
 v_rcp_f32 v167, v167
 s_nop 0
 v_mul_f32 v116, v116, v164
 v_mul_f32 v117, v117, v165
 v_mul_f32 v118, v118, v166
 v_mul_f32 v119, v119, v167
 CV 138,116,117
 CV 139,118,119
 buffer_store_dwordx4 v[136:139], v3, s[16:19], s26 offen offset:64 sc1
 s_add_u32 s26, s26, 114688
 CV 164,24,25
 v_lshlrev_b32 v24, 16, v164
 v_and_b32 v25, 0xffff0000, v164
 CV 164,26,27
 v_lshlrev_b32 v26, 16, v164
 v_and_b32 v27, 0xffff0000, v164
 v_mul_f32 v164, s28, v24
 v_mul_f32 v165, s28, v25
 v_mul_f32 v166, s28, v26
 v_mul_f32 v167, s28, v27
 v_exp_f32 v164, v164
 v_exp_f32 v165, v165
 v_exp_f32 v166, v166
 v_exp_f32 v167, v167
 s_nop 0
 v_add_f32 v164, 1.0, v164
 v_add_f32 v165, 1.0, v165
 v_add_f32 v166, 1.0, v166
 v_add_f32 v167, 1.0, v167
 v_rcp_f32 v164, v164
 v_rcp_f32 v165, v165
 v_rcp_f32 v166, v166
 v_rcp_f32 v167, v167
 s_nop 0
 v_mul_f32 v24, v24, v164
 v_mul_f32 v25, v25, v165
 v_mul_f32 v26, v26, v166
 v_mul_f32 v27, v27, v167
 CV 140,24,25
 CV 141,26,27
 CV 164,56,57
 v_lshlrev_b32 v56, 16, v164
 v_and_b32 v57, 0xffff0000, v164
 CV 164,58,59
 v_lshlrev_b32 v58, 16, v164
 v_and_b32 v59, 0xffff0000, v164
 v_mul_f32 v164, s28, v56
 v_mul_f32 v165, s28, v57
 v_mul_f32 v166, s28, v58
 v_mul_f32 v167, s28, v59
 v_exp_f32 v164, v164
 v_exp_f32 v165, v165
 v_exp_f32 v166, v166
 v_exp_f32 v167, v167
 s_nop 0
 v_add_f32 v164, 1.0, v164
 v_add_f32 v165, 1.0, v165
 v_add_f32 v166, 1.0, v166
 v_add_f32 v167, 1.0, v167
 v_rcp_f32 v164, v164
 v_rcp_f32 v165, v165
 v_rcp_f32 v166, v166
 v_rcp_f32 v167, v167
 s_nop 0
 v_mul_f32 v56, v56, v164
 v_mul_f32 v57, v57, v165
 v_mul_f32 v58, v58, v166
 v_mul_f32 v59, v59, v167
 CV 142,56,57
 CV 143,58,59
 buffer_store_dwordx4 v[140:143], v3, s[16:19], s26 offen offset:0 sc1
 CV 164,88,89
 v_lshlrev_b32 v88, 16, v164
 v_and_b32 v89, 0xffff0000, v164
 CV 164,90,91
 v_lshlrev_b32 v90, 16, v164
 v_and_b32 v91, 0xffff0000, v164
 v_mul_f32 v164, s28, v88
 v_mul_f32 v165, s28, v89
 v_mul_f32 v166, s28, v90
 v_mul_f32 v167, s28, v91
 v_exp_f32 v164, v164
 v_exp_f32 v165, v165
 v_exp_f32 v166, v166
 v_exp_f32 v167, v167
 s_nop 0
 v_add_f32 v164, 1.0, v164
 v_add_f32 v165, 1.0, v165
 v_add_f32 v166, 1.0, v166
 v_add_f32 v167, 1.0, v167
 v_rcp_f32 v164, v164
 v_rcp_f32 v165, v165
 v_rcp_f32 v166, v166
 v_rcp_f32 v167, v167
 s_nop 0
 v_mul_f32 v88, v88, v164
 v_mul_f32 v89, v89, v165
 v_mul_f32 v90, v90, v166
 v_mul_f32 v91, v91, v167
 CV 144,88,89
 CV 145,90,91
 CV 164,120,121
 v_lshlrev_b32 v120, 16, v164
 v_and_b32 v121, 0xffff0000, v164
 CV 164,122,123
 v_lshlrev_b32 v122, 16, v164
 v_and_b32 v123, 0xffff0000, v164
 v_mul_f32 v164, s28, v120
 v_mul_f32 v165, s28, v121
 v_mul_f32 v166, s28, v122
 v_mul_f32 v167, s28, v123
 v_exp_f32 v164, v164
 v_exp_f32 v165, v165
 v_exp_f32 v166, v166
 v_exp_f32 v167, v167
 s_nop 0
 v_add_f32 v164, 1.0, v164
 v_add_f32 v165, 1.0, v165
 v_add_f32 v166, 1.0, v166
 v_add_f32 v167, 1.0, v167
 v_rcp_f32 v164, v164
 v_rcp_f32 v165, v165
 v_rcp_f32 v166, v166
 v_rcp_f32 v167, v167
 s_nop 0
 v_mul_f32 v120, v120, v164
 v_mul_f32 v121, v121, v165
 v_mul_f32 v122, v122, v166
 v_mul_f32 v123, v123, v167
 CV 146,120,121
 CV 147,122,123
 buffer_store_dwordx4 v[144:147], v3, s[16:19], s26 offen offset:64 sc1
 s_add_u32 s26, s26, 114688
 CV 164,28,29
 v_lshlrev_b32 v28, 16, v164
 v_and_b32 v29, 0xffff0000, v164
 CV 164,30,31
 v_lshlrev_b32 v30, 16, v164
 v_and_b32 v31, 0xffff0000, v164
 v_mul_f32 v164, s28, v28
 v_mul_f32 v165, s28, v29
 v_mul_f32 v166, s28, v30
 v_mul_f32 v167, s28, v31
 v_exp_f32 v164, v164
 v_exp_f32 v165, v165
 v_exp_f32 v166, v166
 v_exp_f32 v167, v167
 s_nop 0
 v_add_f32 v164, 1.0, v164
 v_add_f32 v165, 1.0, v165
 v_add_f32 v166, 1.0, v166
 v_add_f32 v167, 1.0, v167
 v_rcp_f32 v164, v164
 v_rcp_f32 v165, v165
 v_rcp_f32 v166, v166
 v_rcp_f32 v167, v167
 s_nop 0
 v_mul_f32 v28, v28, v164
 v_mul_f32 v29, v29, v165
 v_mul_f32 v30, v30, v166
 v_mul_f32 v31, v31, v167
 CV 132,28,29
 CV 133,30,31
 CV 164,60,61
 v_lshlrev_b32 v60, 16, v164
 v_and_b32 v61, 0xffff0000, v164
 CV 164,62,63
 v_lshlrev_b32 v62, 16, v164
 v_and_b32 v63, 0xffff0000, v164
 v_mul_f32 v164, s28, v60
 v_mul_f32 v165, s28, v61
 v_mul_f32 v166, s28, v62
 v_mul_f32 v167, s28, v63
 v_exp_f32 v164, v164
 v_exp_f32 v165, v165
 v_exp_f32 v166, v166
 v_exp_f32 v167, v167
 s_nop 0
 v_add_f32 v164, 1.0, v164
 v_add_f32 v165, 1.0, v165
 v_add_f32 v166, 1.0, v166
 v_add_f32 v167, 1.0, v167
 v_rcp_f32 v164, v164
 v_rcp_f32 v165, v165
 v_rcp_f32 v166, v166
 v_rcp_f32 v167, v167
 s_nop 0
 v_mul_f32 v60, v60, v164
 v_mul_f32 v61, v61, v165
 v_mul_f32 v62, v62, v166
 v_mul_f32 v63, v63, v167
 CV 134,60,61
 CV 135,62,63
 buffer_store_dwordx4 v[132:135], v3, s[16:19], s26 offen offset:0 sc1
 CV 164,92,93
 v_lshlrev_b32 v92, 16, v164
 v_and_b32 v93, 0xffff0000, v164
 CV 164,94,95
 v_lshlrev_b32 v94, 16, v164
 v_and_b32 v95, 0xffff0000, v164
 v_mul_f32 v164, s28, v92
 v_mul_f32 v165, s28, v93
 v_mul_f32 v166, s28, v94
 v_mul_f32 v167, s28, v95
 v_exp_f32 v164, v164
 v_exp_f32 v165, v165
 v_exp_f32 v166, v166
 v_exp_f32 v167, v167
 s_nop 0
 v_add_f32 v164, 1.0, v164
 v_add_f32 v165, 1.0, v165
 v_add_f32 v166, 1.0, v166
 v_add_f32 v167, 1.0, v167
 v_rcp_f32 v164, v164
 v_rcp_f32 v165, v165
 v_rcp_f32 v166, v166
 v_rcp_f32 v167, v167
 s_nop 0
 v_mul_f32 v92, v92, v164
 v_mul_f32 v93, v93, v165
 v_mul_f32 v94, v94, v166
 v_mul_f32 v95, v95, v167
 CV 136,92,93
 CV 137,94,95
 CV 164,124,125
 v_lshlrev_b32 v124, 16, v164
 v_and_b32 v125, 0xffff0000, v164
 CV 164,126,127
 v_lshlrev_b32 v126, 16, v164
 v_and_b32 v127, 0xffff0000, v164
 v_mul_f32 v164, s28, v124
 v_mul_f32 v165, s28, v125
 v_mul_f32 v166, s28, v126
 v_mul_f32 v167, s28, v127
 v_exp_f32 v164, v164
 v_exp_f32 v165, v165
 v_exp_f32 v166, v166
 v_exp_f32 v167, v167
 s_nop 0
 v_add_f32 v164, 1.0, v164
 v_add_f32 v165, 1.0, v165
 v_add_f32 v166, 1.0, v166
 v_add_f32 v167, 1.0, v167
 v_rcp_f32 v164, v164
 v_rcp_f32 v165, v165
 v_rcp_f32 v166, v166
 v_rcp_f32 v167, v167
 s_nop 0
 v_mul_f32 v124, v124, v164
 v_mul_f32 v125, v125, v165
 v_mul_f32 v126, v126, v166
 v_mul_f32 v127, v127, v167
 CV 138,124,125
 CV 139,126,127
 buffer_store_dwordx4 v[136:139], v3, s[16:19], s26 offen offset:64 sc1
 s_add_u32 s26, s26, 114688
 CV 164,32,33
 v_lshlrev_b32 v32, 16, v164
 v_and_b32 v33, 0xffff0000, v164
 CV 164,34,35
 v_lshlrev_b32 v34, 16, v164
 v_and_b32 v35, 0xffff0000, v164
 v_mul_f32 v164, s28, v32
 v_mul_f32 v165, s28, v33
 v_mul_f32 v166, s28, v34
 v_mul_f32 v167, s28, v35
 v_exp_f32 v164, v164
 v_exp_f32 v165, v165
 v_exp_f32 v166, v166
 v_exp_f32 v167, v167
 s_nop 0
 v_add_f32 v164, 1.0, v164
 v_add_f32 v165, 1.0, v165
 v_add_f32 v166, 1.0, v166
 v_add_f32 v167, 1.0, v167
 v_rcp_f32 v164, v164
 v_rcp_f32 v165, v165
 v_rcp_f32 v166, v166
 v_rcp_f32 v167, v167
 s_nop 0
 v_mul_f32 v32, v32, v164
 v_mul_f32 v33, v33, v165
 v_mul_f32 v34, v34, v166
 v_mul_f32 v35, v35, v167
 CV 140,32,33
 CV 141,34,35
 CV 164,64,65
 v_lshlrev_b32 v64, 16, v164
 v_and_b32 v65, 0xffff0000, v164
 CV 164,66,67
 v_lshlrev_b32 v66, 16, v164
 v_and_b32 v67, 0xffff0000, v164
 v_mul_f32 v164, s28, v64
 v_mul_f32 v165, s28, v65
 v_mul_f32 v166, s28, v66
 v_mul_f32 v167, s28, v67
 v_exp_f32 v164, v164
 v_exp_f32 v165, v165
 v_exp_f32 v166, v166
 v_exp_f32 v167, v167
 s_nop 0
 v_add_f32 v164, 1.0, v164
 v_add_f32 v165, 1.0, v165
 v_add_f32 v166, 1.0, v166
 v_add_f32 v167, 1.0, v167
 v_rcp_f32 v164, v164
 v_rcp_f32 v165, v165
 v_rcp_f32 v166, v166
 v_rcp_f32 v167, v167
 s_nop 0
 v_mul_f32 v64, v64, v164
 v_mul_f32 v65, v65, v165
 v_mul_f32 v66, v66, v166
 v_mul_f32 v67, v67, v167
 CV 142,64,65
 CV 143,66,67
 buffer_store_dwordx4 v[140:143], v3, s[16:19], s26 offen offset:0 sc1
 CV 164,96,97
 v_lshlrev_b32 v96, 16, v164
 v_and_b32 v97, 0xffff0000, v164
 CV 164,98,99
 v_lshlrev_b32 v98, 16, v164
 v_and_b32 v99, 0xffff0000, v164
 v_mul_f32 v164, s28, v96
 v_mul_f32 v165, s28, v97
 v_mul_f32 v166, s28, v98
 v_mul_f32 v167, s28, v99
 v_exp_f32 v164, v164
 v_exp_f32 v165, v165
 v_exp_f32 v166, v166
 v_exp_f32 v167, v167
 s_nop 0
 v_add_f32 v164, 1.0, v164
 v_add_f32 v165, 1.0, v165
 v_add_f32 v166, 1.0, v166
 v_add_f32 v167, 1.0, v167
 v_rcp_f32 v164, v164
 v_rcp_f32 v165, v165
 v_rcp_f32 v166, v166
 v_rcp_f32 v167, v167
 s_nop 0
 v_mul_f32 v96, v96, v164
 v_mul_f32 v97, v97, v165
 v_mul_f32 v98, v98, v166
 v_mul_f32 v99, v99, v167
 CV 144,96,97
 CV 145,98,99
 CV 164,128,129
 v_lshlrev_b32 v128, 16, v164
 v_and_b32 v129, 0xffff0000, v164
 CV 164,130,131
 v_lshlrev_b32 v130, 16, v164
 v_and_b32 v131, 0xffff0000, v164
 v_mul_f32 v164, s28, v128
 v_mul_f32 v165, s28, v129
 v_mul_f32 v166, s28, v130
 v_mul_f32 v167, s28, v131
 v_exp_f32 v164, v164
 v_exp_f32 v165, v165
 v_exp_f32 v166, v166
 v_exp_f32 v167, v167
 s_nop 0
 v_add_f32 v164, 1.0, v164
 v_add_f32 v165, 1.0, v165
 v_add_f32 v166, 1.0, v166
 v_add_f32 v167, 1.0, v167
 v_rcp_f32 v164, v164
 v_rcp_f32 v165, v165
 v_rcp_f32 v166, v166
 v_rcp_f32 v167, v167
 s_nop 0
 v_mul_f32 v128, v128, v164
 v_mul_f32 v129, v129, v165
 v_mul_f32 v130, v130, v166
 v_mul_f32 v131, v131, v167
 CV 146,128,129
 CV 147,130,131
 buffer_store_dwordx4 v[144:147], v3, s[16:19], s26 offen offset:64 sc1
 s_add_u32 s26, s26, 114688
 s_branch mk_done
mk_b_g64:
 s_waitcnt lgkmcnt(0)
 s_mov_b32 s20, s4
 s_and_b32 s21, s5, 0xffff
 s_mov_b32 s22, s51
 s_mov_b32 s23, 0x00020000
 s_lshr_b32 s43, s13, 1
 s_and_b32 s44, s13, 1
 v_and_b32 v96, 15, v2
 v_lshrrev_b32 v97, 4, v2
 v_lshrrev_b32 v98, 1, v96
 v_xor_b32 v98, v98, v97
 v_mov_b32 v99, v96
 s_mul_i32 s45, s43, 8192
 s_add_u32 s45, s45, 0
 v_lshlrev_b32 v99, 7, v99
 v_add_u32 v99, s45, v99
 v_lshlrev_b32 v100, 4, v98
 v_add_u32 v84, v99, v100
 v_xor_b32 v100, 64, v100
 v_add_u32 v85, v99, v100
 v_lshrrev_b32 v98, 2, v96
 v_and_b32 v99, 3, v2
 v_and_b32 v100, 1, v97
 v_lshlrev_b32 v100, 1, v100
 v_lshrrev_b32 v101, 1, v98
 v_or_b32 v100, v100, v101
 v_lshlrev_b32 v97, 3, v97
 v_add_u32 v97, v97, v98
 v_mul_u32_u24 v97, 128, v97
 v_lshlrev_b32 v99, 3, v99
 v_add_u32 v97, v97, v99
 v_add_u32 v97, 65536, v97
 s_mul_i32 s45, s44, 2
 s_add_u32 s46, s45, 0
 v_xor_b32 v98, s46, v100
 v_lshlrev_b32 v98, 5, v98
 v_add_u32 v88, v97, v98
 s_add_u32 s46, s45, 1
 v_xor_b32 v98, s46, v100
 v_lshlrev_b32 v98, 5, v98
 v_add_u32 v89, v97, v98
 v_lshrrev_b32 v96, 3, v2
 v_and_b32 v97, 7, v2
 s_mul_i32 s45, s13, 4
 s_add_u32 s46, s45, 0
 s_lshl_b32 s47, s46, 3
 v_add_u32 v98, s47, v96
 v_bfe_u32 v99, v98, 1, 3
 v_xor_b32 v99, v99, v97
 v_lshlrev_b32 v99, 4, v99
 v_mul_u32_u24 v98, s48, v98
 v_add_u32 v90, v98, v99
 s_add_u32 s46, s45, 1
 s_lshl_b32 s47, s46, 3
 v_add_u32 v98, s47, v96
 v_bfe_u32 v99, v98, 1, 3
 v_xor_b32 v99, v99, v97
 v_lshlrev_b32 v99, 4, v99
 v_mul_u32_u24 v98, s48, v98
 v_add_u32 v91, v98, v99
 s_add_u32 s46, s45, 2
 s_lshl_b32 s47, s46, 3
 v_add_u32 v98, s47, v96
 v_bfe_u32 v99, v98, 1, 3
 v_xor_b32 v99, v99, v97
 v_lshlrev_b32 v99, 4, v99
 v_mul_u32_u24 v98, s48, v98
 v_add_u32 v92, v98, v99
 s_add_u32 s46, s45, 3
 s_lshl_b32 s47, s46, 3
 v_add_u32 v98, s47, v96
 v_bfe_u32 v99, v98, 1, 3
 v_xor_b32 v99, v99, v97
 v_lshlrev_b32 v99, 4, v99
 v_mul_u32_u24 v98, s48, v98
 v_add_u32 v93, v98, v99
 s_mul_i32 s40, s13, 4096
 s_add_u32 s40, s40, 0
 v_lshlrev_b32 v96, 4, v2
 s_mul_i32 s45, s13, 2048
 s_add_u32 s46, s45, 0
 v_add_u32 v97, s46, v96
 v_lshrrev_b32 v98, 7, v97
 v_and_b32 v97, 127, v97
 v_bfe_u32 v100, v98, 3, 1
 v_bfe_u32 v99, v98, 1, 1
 v_lshlrev_b32 v100, 1, v100
 v_or_b32 v99, v99, v100
 v_lshlrev_b32 v99, 5, v99
 v_xor_b32 v97, v97, v99
 v_bfe_u32 v99, v98, 3, 2
 v_bfe_u32 v100, v98, 2, 1
 v_and_b32 v98, 0x23, v98
 v_lshlrev_b32 v99, 2, v99
 v_lshlrev_b32 v100, 4, v100
 v_or_b32 v98, v98, v99
 v_or_b32 v98, v98, v100
 v_mul_u32_u24 v98, 2048, v98
 v_add_u32 v94, v98, v97
 s_add_u32 s46, s45, 1024
 v_add_u32 v97, s46, v96
 v_lshrrev_b32 v98, 7, v97
 v_and_b32 v97, 127, v97
 v_bfe_u32 v100, v98, 3, 1
 v_bfe_u32 v99, v98, 1, 1
 v_lshlrev_b32 v100, 1, v100
 v_or_b32 v99, v99, v100
 v_lshlrev_b32 v99, 5, v99
 v_xor_b32 v97, v97, v99
 v_bfe_u32 v99, v98, 3, 2
 v_bfe_u32 v100, v98, 2, 1
 v_and_b32 v98, 0x23, v98
 v_lshlrev_b32 v99, 2, v99
 v_lshlrev_b32 v100, 4, v100
 v_or_b32 v98, v98, v99
 v_or_b32 v98, v98, v100
 v_mul_u32_u24 v98, 2048, v98
 v_add_u32 v95, v98, v97
 s_mul_i32 s41, s13, 2048
 s_add_u32 s41, s41, 65536
 v_mov_b32 v4, 0
 v_mov_b32 v5, 0
 v_mov_b32 v6, 0
 v_mov_b32 v7, 0
 v_mov_b32 v8, 0
 v_mov_b32 v9, 0
 v_mov_b32 v10, 0
 v_mov_b32 v11, 0
 v_mov_b32 v12, 0
 v_mov_b32 v13, 0
 v_mov_b32 v14, 0
 v_mov_b32 v15, 0
 v_mov_b32 v16, 0
 v_mov_b32 v17, 0
 v_mov_b32 v18, 0
 v_mov_b32 v19, 0
 v_mov_b32 v20, 0
 v_mov_b32 v21, 0
 v_mov_b32 v22, 0
 v_mov_b32 v23, 0
 v_mov_b32 v24, 0
 v_mov_b32 v25, 0
 v_mov_b32 v26, 0
 v_mov_b32 v27, 0
 v_mov_b32 v28, 0
 v_mov_b32 v29, 0
 v_mov_b32 v30, 0
 v_mov_b32 v31, 0
 v_mov_b32 v32, 0
 v_mov_b32 v33, 0
 v_mov_b32 v34, 0
 v_mov_b32 v35, 0
 DM 41,0,94,s[20:23],25,lds
 DM 41,1024,95,s[20:23],25,lds
 s_add_u32 s25, s25, 131072
 DM 41,8192,94,s[20:23],25,lds
 DM 41,9216,95,s[20:23],25,lds
 s_add_u32 s25, s25, 131072
 DM 41,16384,94,s[20:23],25,lds
 DM 41,17408,95,s[20:23],25,lds
 s_add_u32 s25, s25, 131072
 DM 41,24576,94,s[20:23],25,lds
 DM 41,25600,95,s[20:23],25,lds
 s_add_u32 s25, s25, 131072
 s_bitcmp1_b32 s8, 31
 s_cbranch_scc0 mk_g64_dw2
 s_cmp_lg_u32 s13, 0
 s_cbranch_scc1 mk_g64_dw1
 s_mov_b32 s52, 81829888
 s_bfe_u32 s53, s8, 0x50018
 s_mov_b32 s54, 1048576
 v_mov_b32 v1, 0
mk_g64_dw0:
 buffer_load_dword v3, v1, s[16:19], s52 offen sc1
 s_sub_u32 s54, s54, 1
 s_cbranch_scc1 mk_end
 s_waitcnt vmcnt(0)
 v_readfirstlane_b32 s55, v3
 s_bitcmp1_b32 s55, s53
 s_cbranch_scc1 mk_g64_dw1
 s_sleep 2
 s_branch mk_g64_dw0
mk_g64_dw1:
 s_barrier
mk_g64_dw2:
 DM 40,0,90,s[16:19],24,sc1 lds
 DM 40,1024,91,s[16:19],24,sc1 lds
 DM 40,2048,92,s[16:19],24,sc1 lds
 DM 40,3072,93,s[16:19],24,sc1 lds
 s_add_u32 s24, s24, 128
 DM 40,16384,90,s[16:19],24,sc1 lds
 DM 40,17408,91,s[16:19],24,sc1 lds
 DM 40,18432,92,s[16:19],24,sc1 lds
 DM 40,19456,93,s[16:19],24,sc1 lds
 s_add_u32 s24, s24, 128
 DM 40,32768,90,s[16:19],24,sc1 lds
 DM 40,33792,91,s[16:19],24,sc1 lds
 DM 40,34816,92,s[16:19],24,sc1 lds
 DM 40,35840,93,s[16:19],24,sc1 lds
 s_add_u32 s24, s24, 128
 DM 40,49152,90,s[16:19],24,sc1 lds
 DM 40,50176,91,s[16:19],24,sc1 lds
 DM 40,51200,92,s[16:19],24,sc1 lds
 DM 40,52224,93,s[16:19],24,sc1 lds
 s_add_u32 s24, s24, 128
 s_waitcnt vmcnt(12)
 s_barrier
 RB 52,55,84,0
 RB 56,59,84,2048
 RB 60,63,84,4096
 RB 64,67,84,6144
 TR 36,37,88,0
 TR 38,39,88,512
 TR 40,41,89,0
 TR 42,43,89,512
 s_waitcnt lgkmcnt(0)
 MF v[4:7],v[36:39],v[52:55]
 RB 68,71,85,0
 MF v[8:11],v[36:39],v[56:59]
 RB 72,75,85,2048
 MF v[12:15],v[36:39],v[60:63]
 RB 76,79,85,4096
 MF v[16:19],v[36:39],v[64:67]
 RB 80,83,85,6144
 MF v[20:23],v[40:43],v[52:55]
 TR 44,45,88,4096
 MF v[24:27],v[40:43],v[56:59]
 TR 46,47,88,4608
 MF v[28:31],v[40:43],v[60:63]
 TR 48,49,89,4096
 MF v[32:35],v[40:43],v[64:67]
 TR 50,51,89,4608
 s_waitcnt lgkmcnt(0)
 s_waitcnt vmcnt(8)
 s_barrier
 MF v[4:7],v[44:47],v[68:71]
 RB 52,55,84,16384
 MF v[8:11],v[44:47],v[72:75]
 RB 56,59,84,18432
 DM 40,0,90,s[16:19],24,sc1 lds
 MF v[12:15],v[44:47],v[76:79]
 RB 60,63,84,20480
 MF v[16:19],v[44:47],v[80:83]
 RB 64,67,84,22528
 MF v[20:23],v[48:51],v[68:71]
 TR 36,37,88,8192
 DM 40,1024,91,s[16:19],24,sc1 lds
 MF v[24:27],v[48:51],v[72:75]
 TR 38,39,88,8704
 MF v[28:31],v[48:51],v[76:79]
 TR 40,41,89,8192
 DM 40,2048,92,s[16:19],24,sc1 lds
 MF v[32:35],v[48:51],v[80:83]
 TR 42,43,89,8704
 s_waitcnt lgkmcnt(0)
 MF v[4:7],v[36:39],v[52:55]
 RB 68,71,85,16384
 MF v[8:11],v[36:39],v[56:59]
 RB 72,75,85,18432
 DM 40,3072,93,s[16:19],24,sc1 lds
 MF v[12:15],v[36:39],v[60:63]
 RB 76,79,85,20480
 MF v[16:19],v[36:39],v[64:67]
 RB 80,83,85,22528
 MF v[20:23],v[40:43],v[52:55]
 TR 44,45,88,12288
 DM 41,0,94,s[20:23],25,lds
 MF v[24:27],v[40:43],v[56:59]
 TR 46,47,88,12800
 MF v[28:31],v[40:43],v[60:63]
 TR 48,49,89,12288
 DM 41,1024,95,s[20:23],25,lds
 s_add_u32 s24, s24, 128
 s_add_u32 s25, s25, 131072
 MF v[32:35],v[40:43],v[64:67]
 TR 50,51,89,12800
 s_waitcnt lgkmcnt(0)
 s_waitcnt vmcnt(10)
 s_barrier
 MF v[4:7],v[44:47],v[68:71]
 RB 52,55,84,32768
 MF v[8:11],v[44:47],v[72:75]
 RB 56,59,84,34816
 DM 40,16384,90,s[16:19],24,sc1 lds
 MF v[12:15],v[44:47],v[76:79]
 RB 60,63,84,36864
 MF v[16:19],v[44:47],v[80:83]
 RB 64,67,84,38912
 MF v[20:23],v[48:51],v[68:71]
 TR 36,37,88,16384
 DM 40,17408,91,s[16:19],24,sc1 lds
 MF v[24:27],v[48:51],v[72:75]
 TR 38,39,88,16896
 MF v[28:31],v[48:51],v[76:79]
 TR 40,41,89,16384
 DM 40,18432,92,s[16:19],24,sc1 lds
 MF v[32:35],v[48:51],v[80:83]
 TR 42,43,89,16896
 s_waitcnt lgkmcnt(0)
 MF v[4:7],v[36:39],v[52:55]
 RB 68,71,85,32768
 MF v[8:11],v[36:39],v[56:59]
 RB 72,75,85,34816
 DM 40,19456,93,s[16:19],24,sc1 lds
 MF v[12:15],v[36:39],v[60:63]
 RB 76,79,85,36864
 MF v[16:19],v[36:39],v[64:67]
 RB 80,83,85,38912
 MF v[20:23],v[40:43],v[52:55]
 TR 44,45,88,20480
 DM 41,8192,94,s[20:23],25,lds
 MF v[24:27],v[40:43],v[56:59]
 TR 46,47,88,20992
 MF v[28:31],v[40:43],v[60:63]
 TR 48,49,89,20480
 DM 41,9216,95,s[20:23],25,lds
 s_add_u32 s24, s24, 128
 s_add_u32 s25, s25, 131072
 MF v[32:35],v[40:43],v[64:67]
 TR 50,51,89,20992
 s_waitcnt lgkmcnt(0)
 s_waitcnt vmcnt(12)
 s_barrier
 MF v[4:7],v[44:47],v[68:71]
 RB 52,55,84,49152
 MF v[8:11],v[44:47],v[72:75]
 RB 56,59,84,51200
 DM 40,32768,90,s[16:19],24,sc1 lds
 MF v[12:15],v[44:47],v[76:79]
 RB 60,63,84,53248
 MF v[16:19],v[44:47],v[80:83]
 RB 64,67,84,55296
 MF v[20:23],v[48:51],v[68:71]
 TR 36,37,88,24576
 DM 40,33792,91,s[16:19],24,sc1 lds
 MF v[24:27],v[48:51],v[72:75]
 TR 38,39,88,25088
 MF v[28:31],v[48:51],v[76:79]
 TR 40,41,89,24576
 DM 40,34816,92,s[16:19],24,sc1 lds
 MF v[32:35],v[48:51],v[80:83]
 TR 42,43,89,25088
 s_waitcnt lgkmcnt(0)
 MF v[4:7],v[36:39],v[52:55]
 RB 68,71,85,49152
 MF v[8:11],v[36:39],v[56:59]
 RB 72,75,85,51200
 DM 40,35840,93,s[16:19],24,sc1 lds
 MF v[12:15],v[36:39],v[60:63]
 RB 76,79,85,53248
 MF v[16:19],v[36:39],v[64:67]
 RB 80,83,85,55296
 MF v[20:23],v[40:43],v[52:55]
 TR 44,45,88,28672
 DM 41,16384,94,s[20:23],25,lds
 MF v[24:27],v[40:43],v[56:59]
 TR 46,47,88,29184
 MF v[28:31],v[40:43],v[60:63]
 TR 48,49,89,28672
 DM 41,17408,95,s[20:23],25,lds
 s_add_u32 s24, s24, 128
 s_add_u32 s25, s25, 131072
 MF v[32:35],v[40:43],v[64:67]
 TR 50,51,89,29184
 s_waitcnt lgkmcnt(0)
 s_waitcnt vmcnt(12)
 s_barrier
 MF v[4:7],v[44:47],v[68:71]
 RB 52,55,84,0
 MF v[8:11],v[44:47],v[72:75]
 RB 56,59,84,2048
 DM 40,49152,90,s[16:19],24,sc1 lds
 MF v[12:15],v[44:47],v[76:79]
 RB 60,63,84,4096
 MF v[16:19],v[44:47],v[80:83]
 RB 64,67,84,6144
 MF v[20:23],v[48:51],v[68:71]
 TR 36,37,88,0
 DM 40,50176,91,s[16:19],24,sc1 lds
 MF v[24:27],v[48:51],v[72:75]
 TR 38,39,88,512
 MF v[28:31],v[48:51],v[76:79]
 TR 40,41,89,0
 DM 40,51200,92,s[16:19],24,sc1 lds
 MF v[32:35],v[48:51],v[80:83]
 TR 42,43,89,512
 s_waitcnt lgkmcnt(0)
 s_sub_u32 s42, s49, 1
 s_cmp_eq_u32 s42, 0
 s_cbranch_scc1 g64_skip_3
g64_loop_2:
 MF v[4:7],v[36:39],v[52:55]
 RB 68,71,85,0
 MF v[8:11],v[36:39],v[56:59]
 RB 72,75,85,2048
 DM 40,52224,93,s[16:19],24,sc1 lds
 MF v[12:15],v[36:39],v[60:63]
 RB 76,79,85,4096
 MF v[16:19],v[36:39],v[64:67]
 RB 80,83,85,6144
 MF v[20:23],v[40:43],v[52:55]
 TR 44,45,88,4096
 DM 41,24576,94,s[20:23],25,lds
 MF v[24:27],v[40:43],v[56:59]
 TR 46,47,88,4608
 MF v[28:31],v[40:43],v[60:63]
 TR 48,49,89,4096
 DM 41,25600,95,s[20:23],25,lds
 s_add_u32 s24, s24, 128
 s_add_u32 s25, s25, 131072
 MF v[32:35],v[40:43],v[64:67]
 TR 50,51,89,4608
 s_waitcnt lgkmcnt(0)
 s_waitcnt vmcnt(12)
 s_barrier
 MF v[4:7],v[44:47],v[68:71]
 RB 52,55,84,16384
 MF v[8:11],v[44:47],v[72:75]
 RB 56,59,84,18432
 DM 40,0,90,s[16:19],24,sc1 lds
 MF v[12:15],v[44:47],v[76:79]
 RB 60,63,84,20480
 MF v[16:19],v[44:47],v[80:83]
 RB 64,67,84,22528
 MF v[20:23],v[48:51],v[68:71]
 TR 36,37,88,8192
 DM 40,1024,91,s[16:19],24,sc1 lds
 MF v[24:27],v[48:51],v[72:75]
 TR 38,39,88,8704
 MF v[28:31],v[48:51],v[76:79]
 TR 40,41,89,8192
 DM 40,2048,92,s[16:19],24,sc1 lds
 MF v[32:35],v[48:51],v[80:83]
 TR 42,43,89,8704
 s_waitcnt lgkmcnt(0)
 MF v[4:7],v[36:39],v[52:55]
 RB 68,71,85,16384
 MF v[8:11],v[36:39],v[56:59]
 RB 72,75,85,18432
 DM 40,3072,93,s[16:19],24,sc1 lds
 MF v[12:15],v[36:39],v[60:63]
 RB 76,79,85,20480
 MF v[16:19],v[36:39],v[64:67]
 RB 80,83,85,22528
 MF v[20:23],v[40:43],v[52:55]
 TR 44,45,88,12288
 DM 41,0,94,s[20:23],25,lds
 MF v[24:27],v[40:43],v[56:59]
 TR 46,47,88,12800
 MF v[28:31],v[40:43],v[60:63]
 TR 48,49,89,12288
 DM 41,1024,95,s[20:23],25,lds
 s_add_u32 s24, s24, 128
 s_add_u32 s25, s25, 131072
 MF v[32:35],v[40:43],v[64:67]
 TR 50,51,89,12800
 s_waitcnt lgkmcnt(0)
 s_waitcnt vmcnt(12)
 s_barrier
 MF v[4:7],v[44:47],v[68:71]
 RB 52,55,84,32768
 MF v[8:11],v[44:47],v[72:75]
 RB 56,59,84,34816
 DM 40,16384,90,s[16:19],24,sc1 lds
 MF v[12:15],v[44:47],v[76:79]
 RB 60,63,84,36864
 MF v[16:19],v[44:47],v[80:83]
 RB 64,67,84,38912
 MF v[20:23],v[48:51],v[68:71]
 TR 36,37,88,16384
 DM 40,17408,91,s[16:19],24,sc1 lds
 MF v[24:27],v[48:51],v[72:75]
 TR 38,39,88,16896
 MF v[28:31],v[48:51],v[76:79]
 TR 40,41,89,16384
 DM 40,18432,92,s[16:19],24,sc1 lds
 MF v[32:35],v[48:51],v[80:83]
 TR 42,43,89,16896
 s_waitcnt lgkmcnt(0)
 MF v[4:7],v[36:39],v[52:55]
 RB 68,71,85,32768
 MF v[8:11],v[36:39],v[56:59]
 RB 72,75,85,34816
 DM 40,19456,93,s[16:19],24,sc1 lds
 MF v[12:15],v[36:39],v[60:63]
 RB 76,79,85,36864
 MF v[16:19],v[36:39],v[64:67]
 RB 80,83,85,38912
 MF v[20:23],v[40:43],v[52:55]
 TR 44,45,88,20480
 DM 41,8192,94,s[20:23],25,lds
 MF v[24:27],v[40:43],v[56:59]
 TR 46,47,88,20992
 MF v[28:31],v[40:43],v[60:63]
 TR 48,49,89,20480
 DM 41,9216,95,s[20:23],25,lds
 s_add_u32 s24, s24, 128
 s_add_u32 s25, s25, 131072
 MF v[32:35],v[40:43],v[64:67]
 TR 50,51,89,20992
 s_waitcnt lgkmcnt(0)
 s_waitcnt vmcnt(12)
 s_barrier
 MF v[4:7],v[44:47],v[68:71]
 RB 52,55,84,49152
 MF v[8:11],v[44:47],v[72:75]
 RB 56,59,84,51200
 DM 40,32768,90,s[16:19],24,sc1 lds
 MF v[12:15],v[44:47],v[76:79]
 RB 60,63,84,53248
 MF v[16:19],v[44:47],v[80:83]
 RB 64,67,84,55296
 MF v[20:23],v[48:51],v[68:71]
 TR 36,37,88,24576
 DM 40,33792,91,s[16:19],24,sc1 lds
 MF v[24:27],v[48:51],v[72:75]
 TR 38,39,88,25088
 MF v[28:31],v[48:51],v[76:79]
 TR 40,41,89,24576
 DM 40,34816,92,s[16:19],24,sc1 lds
 MF v[32:35],v[48:51],v[80:83]
 TR 42,43,89,25088
 s_waitcnt lgkmcnt(0)
 MF v[4:7],v[36:39],v[52:55]
 RB 68,71,85,49152
 MF v[8:11],v[36:39],v[56:59]
 RB 72,75,85,51200
 DM 40,35840,93,s[16:19],24,sc1 lds
 MF v[12:15],v[36:39],v[60:63]
 RB 76,79,85,53248
 MF v[16:19],v[36:39],v[64:67]
 RB 80,83,85,55296
 MF v[20:23],v[40:43],v[52:55]
 TR 44,45,88,28672
 DM 41,16384,94,s[20:23],25,lds
 MF v[24:27],v[40:43],v[56:59]
 TR 46,47,88,29184
 MF v[28:31],v[40:43],v[60:63]
 TR 48,49,89,28672
 DM 41,17408,95,s[20:23],25,lds
 s_add_u32 s24, s24, 128
 s_add_u32 s25, s25, 131072
 MF v[32:35],v[40:43],v[64:67]
 TR 50,51,89,29184
 s_waitcnt lgkmcnt(0)
 s_waitcnt vmcnt(12)
 s_barrier
 MF v[4:7],v[44:47],v[68:71]
 RB 52,55,84,0
 MF v[8:11],v[44:47],v[72:75]
 RB 56,59,84,2048
 DM 40,49152,90,s[16:19],24,sc1 lds
 MF v[12:15],v[44:47],v[76:79]
 RB 60,63,84,4096
 MF v[16:19],v[44:47],v[80:83]
 RB 64,67,84,6144
 MF v[20:23],v[48:51],v[68:71]
 TR 36,37,88,0
 DM 40,50176,91,s[16:19],24,sc1 lds
 MF v[24:27],v[48:51],v[72:75]
 TR 38,39,88,512
 MF v[28:31],v[48:51],v[76:79]
 TR 40,41,89,0
 DM 40,51200,92,s[16:19],24,sc1 lds
 MF v[32:35],v[48:51],v[80:83]
 TR 42,43,89,512
 s_waitcnt lgkmcnt(0)
 s_sub_u32 s42, s42, 1
 s_cmp_lg_u32 s42, 0
 s_cbranch_scc1 g64_loop_2
g64_skip_3:
 MF v[4:7],v[36:39],v[52:55]
 RB 68,71,85,0
 MF v[8:11],v[36:39],v[56:59]
 RB 72,75,85,2048
 DM 40,52224,93,s[16:19],24,sc1 lds
 MF v[12:15],v[36:39],v[60:63]
 RB 76,79,85,4096
 MF v[16:19],v[36:39],v[64:67]
 RB 80,83,85,6144
 MF v[20:23],v[40:43],v[52:55]
 TR 44,45,88,4096
 DM 41,24576,94,s[20:23],25,lds
 MF v[24:27],v[40:43],v[56:59]
 TR 46,47,88,4608
 MF v[28:31],v[40:43],v[60:63]
 TR 48,49,89,4096
 DM 41,25600,95,s[20:23],25,lds
 s_add_u32 s24, s24, 128
 s_add_u32 s25, s25, 131072
 MF v[32:35],v[40:43],v[64:67]
 TR 50,51,89,4608
 s_waitcnt lgkmcnt(0)
 s_waitcnt vmcnt(12)
 s_barrier
 MF v[4:7],v[44:47],v[68:71]
 RB 52,55,84,16384
 MF v[8:11],v[44:47],v[72:75]
 RB 56,59,84,18432
 MF v[12:15],v[44:47],v[76:79]
 RB 60,63,84,20480
 MF v[16:19],v[44:47],v[80:83]
 RB 64,67,84,22528
 MF v[20:23],v[48:51],v[68:71]
 TR 36,37,88,8192
 MF v[24:27],v[48:51],v[72:75]
 TR 38,39,88,8704
 MF v[28:31],v[48:51],v[76:79]
 TR 40,41,89,8192
 MF v[32:35],v[48:51],v[80:83]
 TR 42,43,89,8704
 s_waitcnt lgkmcnt(0)
 MF v[4:7],v[36:39],v[52:55]
 RB 68,71,85,16384
 MF v[8:11],v[36:39],v[56:59]
 RB 72,75,85,18432
 MF v[12:15],v[36:39],v[60:63]
 RB 76,79,85,20480
 MF v[16:19],v[36:39],v[64:67]
 RB 80,83,85,22528
 MF v[20:23],v[40:43],v[52:55]
 TR 44,45,88,12288
 MF v[24:27],v[40:43],v[56:59]
 TR 46,47,88,12800
 MF v[28:31],v[40:43],v[60:63]
 TR 48,49,89,12288
 MF v[32:35],v[40:43],v[64:67]
 TR 50,51,89,12800
 s_waitcnt lgkmcnt(0)
 s_waitcnt vmcnt(6)
 s_barrier
 MF v[4:7],v[44:47],v[68:71]
 RB 52,55,84,32768
 MF v[8:11],v[44:47],v[72:75]
 RB 56,59,84,34816
 MF v[12:15],v[44:47],v[76:79]
 RB 60,63,84,36864
 MF v[16:19],v[44:47],v[80:83]
 RB 64,67,84,38912
 MF v[20:23],v[48:51],v[68:71]
 TR 36,37,88,16384
 MF v[24:27],v[48:51],v[72:75]
 TR 38,39,88,16896
 MF v[28:31],v[48:51],v[76:79]
 TR 40,41,89,16384
 MF v[32:35],v[48:51],v[80:83]
 TR 42,43,89,16896
 s_waitcnt lgkmcnt(0)
 MF v[4:7],v[36:39],v[52:55]
 RB 68,71,85,32768
 MF v[8:11],v[36:39],v[56:59]
 RB 72,75,85,34816
 MF v[12:15],v[36:39],v[60:63]
 RB 76,79,85,36864
 MF v[16:19],v[36:39],v[64:67]
 RB 80,83,85,38912
 MF v[20:23],v[40:43],v[52:55]
 TR 44,45,88,20480
 MF v[24:27],v[40:43],v[56:59]
 TR 46,47,88,20992
 MF v[28:31],v[40:43],v[60:63]
 TR 48,49,89,20480
 MF v[32:35],v[40:43],v[64:67]
 TR 50,51,89,20992
 s_waitcnt lgkmcnt(0)
 s_waitcnt vmcnt(0)
 s_barrier
 MF v[4:7],v[44:47],v[68:71]
 RB 52,55,84,49152
 MF v[8:11],v[44:47],v[72:75]
 RB 56,59,84,51200
 MF v[12:15],v[44:47],v[76:79]
 RB 60,63,84,53248
 MF v[16:19],v[44:47],v[80:83]
 RB 64,67,84,55296
 MF v[20:23],v[48:51],v[68:71]
 TR 36,37,88,24576
 MF v[24:27],v[48:51],v[72:75]
 TR 38,39,88,25088
 MF v[28:31],v[48:51],v[76:79]
 TR 40,41,89,24576
 MF v[32:35],v[48:51],v[80:83]
 TR 42,43,89,25088
 s_waitcnt lgkmcnt(0)
 MF v[4:7],v[36:39],v[52:55]
 RB 68,71,85,49152
 MF v[8:11],v[36:39],v[56:59]
 RB 72,75,85,51200
 MF v[12:15],v[36:39],v[60:63]
 RB 76,79,85,53248
 MF v[16:19],v[36:39],v[64:67]
 RB 80,83,85,55296
 MF v[20:23],v[40:43],v[52:55]
 TR 44,45,88,28672
 MF v[24:27],v[40:43],v[56:59]
 TR 46,47,88,29184
 MF v[28:31],v[40:43],v[60:63]
 TR 48,49,89,28672
 MF v[32:35],v[40:43],v[64:67]
 TR 50,51,89,29184
 s_waitcnt lgkmcnt(0)
 MF v[4:7],v[44:47],v[68:71]
 MF v[8:11],v[44:47],v[72:75]
 MF v[12:15],v[44:47],v[76:79]
 MF v[16:19],v[44:47],v[80:83]
 MF v[20:23],v[48:51],v[68:71]
 MF v[24:27],v[48:51],v[72:75]
 MF v[28:31],v[48:51],v[76:79]
 MF v[32:35],v[48:51],v[80:83]
 v_and_b32 v3, 15, v2
 v_lshlrev_b32 v3, 12, v3
 v_lshrrev_b32 v1, 4, v2
 v_lshl_add_u32 v3, v1, 4, v3
 s_lshl_b32 s26, s10, 2
 s_add_u32 s26, s26, s29
 s_lshl_b32 s26, s26, 7
 s_lshl_b32 s27, s43, 6
 s_add_u32 s26, s26, s27
 s_lshl_b32 s26, s26, 12
 s_mul_i32 s27, s12, 256
 s_add_u32 s26, s26, s27
 s_mul_i32 s27, s44, 128
 s_add_u32 s26, s26, s27
 s_add_u32 s26, s26, s50
 s_nop 4
 buffer_store_dwordx4 v[4:7], v3, s[16:19], s26 offen offset:0 sc1
 buffer_store_dwordx4 v[20:23], v3, s[16:19], s26 offen offset:64 sc1
 s_add_u32 s26, s26, 65536
 buffer_store_dwordx4 v[8:11], v3, s[16:19], s26 offen offset:0 sc1
 buffer_store_dwordx4 v[24:27], v3, s[16:19], s26 offen offset:64 sc1
 s_add_u32 s26, s26, 65536
 buffer_store_dwordx4 v[12:15], v3, s[16:19], s26 offen offset:0 sc1
 buffer_store_dwordx4 v[28:31], v3, s[16:19], s26 offen offset:64 sc1
 s_add_u32 s26, s26, 65536
 buffer_store_dwordx4 v[16:19], v3, s[16:19], s26 offen offset:0 sc1
 buffer_store_dwordx4 v[32:35], v3, s[16:19], s26 offen offset:64 sc1
 s_add_u32 s26, s26, 65536
 s_branch mk_done
mk_b_g128:
 s_waitcnt lgkmcnt(0)
 s_mov_b32 s20, s4
 s_and_b32 s21, s5, 0xffff
 s_mov_b32 s22, s51
 s_mov_b32 s23, 0x00020000
 s_lshr_b32 s43, s13, 1
 s_and_b32 s44, s13, 1
 v_and_b32 v148, 15, v2
 v_lshrrev_b32 v149, 4, v2
 v_lshrrev_b32 v150, 1, v148
 v_xor_b32 v150, v150, v149
 v_mov_b32 v151, v148
 s_mul_i32 s45, s43, 8192
 s_add_u32 s45, s45, 0
 v_lshlrev_b32 v151, 7, v151
 v_add_u32 v151, s45, v151
 v_lshlrev_b32 v152, 4, v150
 v_add_u32 v132, v151, v152
 v_xor_b32 v152, 64, v152
 v_add_u32 v133, v151, v152
 v_lshrrev_b32 v150, 2, v148
 v_and_b32 v151, 3, v2
 v_and_b32 v152, 1, v149
 v_lshlrev_b32 v152, 2, v152
 v_or_b32 v152, v152, v150
 v_lshlrev_b32 v149, 3, v149
 v_add_u32 v149, v149, v150
 v_mul_u32_u24 v149, 256, v149
 v_lshlrev_b32 v151, 3, v151
 v_add_u32 v149, v149, v151
 v_add_u32 v149, 65536, v149
 s_mul_i32 s45, s44, 4
 s_add_u32 s46, s45, 0
 v_xor_b32 v150, s46, v152
 v_lshlrev_b32 v150, 5, v150
 v_add_u32 v136, v149, v150
 s_add_u32 s46, s45, 1
 v_xor_b32 v150, s46, v152
 v_lshlrev_b32 v150, 5, v150
 v_add_u32 v137, v149, v150
 s_add_u32 s46, s45, 2
 v_xor_b32 v150, s46, v152
 v_lshlrev_b32 v150, 5, v150
 v_add_u32 v138, v149, v150
 s_add_u32 s46, s45, 3
 v_xor_b32 v150, s46, v152
 v_lshlrev_b32 v150, 5, v150
 v_add_u32 v139, v149, v150
 v_lshrrev_b32 v148, 3, v2
 v_and_b32 v149, 7, v2
 s_mul_i32 s45, s13, 4
 s_add_u32 s46, s45, 0
 s_lshl_b32 s47, s46, 3
 v_add_u32 v150, s47, v148
 v_bfe_u32 v151, v150, 1, 3
 v_xor_b32 v151, v151, v149
 v_lshlrev_b32 v151, 4, v151
 v_mul_u32_u24 v150, s48, v150
 v_add_u32 v140, v150, v151
 s_add_u32 s46, s45, 1
 s_lshl_b32 s47, s46, 3
 v_add_u32 v150, s47, v148
 v_bfe_u32 v151, v150, 1, 3
 v_xor_b32 v151, v151, v149
 v_lshlrev_b32 v151, 4, v151
 v_mul_u32_u24 v150, s48, v150
 v_add_u32 v141, v150, v151
 s_add_u32 s46, s45, 2
 s_lshl_b32 s47, s46, 3
 v_add_u32 v150, s47, v148
 v_bfe_u32 v151, v150, 1, 3
 v_xor_b32 v151, v151, v149
 v_lshlrev_b32 v151, 4, v151
 v_mul_u32_u24 v150, s48, v150
 v_add_u32 v142, v150, v151
 s_add_u32 s46, s45, 3
 s_lshl_b32 s47, s46, 3
 v_add_u32 v150, s47, v148
 v_bfe_u32 v151, v150, 1, 3
 v_xor_b32 v151, v151, v149
 v_lshlrev_b32 v151, 4, v151
 v_mul_u32_u24 v150, s48, v150
 v_add_u32 v143, v150, v151
 s_mul_i32 s40, s13, 4096
 s_add_u32 s40, s40, 0
 v_lshlrev_b32 v148, 4, v2
 s_mul_i32 s45, s13, 4096
 s_add_u32 s46, s45, 0
 v_add_u32 v149, s46, v148
 v_lshrrev_b32 v150, 8, v149
 v_and_b32 v149, 255, v149
 v_bfe_u32 v152, v150, 3, 1
 v_and_b32 v151, 3, v150
 v_lshlrev_b32 v152, 2, v152
 v_or_b32 v151, v151, v152
 v_lshlrev_b32 v151, 5, v151
 v_xor_b32 v149, v149, v151
 v_bfe_u32 v151, v150, 3, 2
 v_bfe_u32 v152, v150, 2, 1
 v_and_b32 v150, 0x23, v150
 v_lshlrev_b32 v151, 2, v151
 v_lshlrev_b32 v152, 4, v152
 v_or_b32 v150, v150, v151
 v_or_b32 v150, v150, v152
 v_mul_u32_u24 v150, 2048, v150
 v_add_u32 v144, v150, v149
 s_add_u32 s46, s45, 1024
 v_add_u32 v149, s46, v148
 v_lshrrev_b32 v150, 8, v149
 v_and_b32 v149, 255, v149
 v_bfe_u32 v152, v150, 3, 1
 v_and_b32 v151, 3, v150
 v_lshlrev_b32 v152, 2, v152
 v_or_b32 v151, v151, v152
 v_lshlrev_b32 v151, 5, v151
 v_xor_b32 v149, v149, v151
 v_bfe_u32 v151, v150, 3, 2
 v_bfe_u32 v152, v150, 2, 1
 v_and_b32 v150, 0x23, v150
 v_lshlrev_b32 v151, 2, v151
 v_lshlrev_b32 v152, 4, v152
 v_or_b32 v150, v150, v151
 v_or_b32 v150, v150, v152
 v_mul_u32_u24 v150, 2048, v150
 v_add_u32 v145, v150, v149
 s_add_u32 s46, s45, 2048
 v_add_u32 v149, s46, v148
 v_lshrrev_b32 v150, 8, v149
 v_and_b32 v149, 255, v149
 v_bfe_u32 v152, v150, 3, 1
 v_and_b32 v151, 3, v150
 v_lshlrev_b32 v152, 2, v152
 v_or_b32 v151, v151, v152
 v_lshlrev_b32 v151, 5, v151
 v_xor_b32 v149, v149, v151
 v_bfe_u32 v151, v150, 3, 2
 v_bfe_u32 v152, v150, 2, 1
 v_and_b32 v150, 0x23, v150
 v_lshlrev_b32 v151, 2, v151
 v_lshlrev_b32 v152, 4, v152
 v_or_b32 v150, v150, v151
 v_or_b32 v150, v150, v152
 v_mul_u32_u24 v150, 2048, v150
 v_add_u32 v146, v150, v149
 s_add_u32 s46, s45, 3072
 v_add_u32 v149, s46, v148
 v_lshrrev_b32 v150, 8, v149
 v_and_b32 v149, 255, v149
 v_bfe_u32 v152, v150, 3, 1
 v_and_b32 v151, 3, v150
 v_lshlrev_b32 v152, 2, v152
 v_or_b32 v151, v151, v152
 v_lshlrev_b32 v151, 5, v151
 v_xor_b32 v149, v149, v151
 v_bfe_u32 v151, v150, 3, 2
 v_bfe_u32 v152, v150, 2, 1
 v_and_b32 v150, 0x23, v150
 v_lshlrev_b32 v151, 2, v151
 v_lshlrev_b32 v152, 4, v152
 v_or_b32 v150, v150, v151
 v_or_b32 v150, v150, v152
 v_mul_u32_u24 v150, 2048, v150
 v_add_u32 v147, v150, v149
 s_mul_i32 s41, s13, 4096
 s_add_u32 s41, s41, 65536
 v_mov_b32 v4, 0
 v_mov_b32 v5, 0
 v_mov_b32 v6, 0
 v_mov_b32 v7, 0
 v_mov_b32 v8, 0
 v_mov_b32 v9, 0
 v_mov_b32 v10, 0
 v_mov_b32 v11, 0
 v_mov_b32 v12, 0
 v_mov_b32 v13, 0
 v_mov_b32 v14, 0
 v_mov_b32 v15, 0
 v_mov_b32 v16, 0
 v_mov_b32 v17, 0
 v_mov_b32 v18, 0
 v_mov_b32 v19, 0
 v_mov_b32 v20, 0
 v_mov_b32 v21, 0
 v_mov_b32 v22, 0
 v_mov_b32 v23, 0
 v_mov_b32 v24, 0
 v_mov_b32 v25, 0
 v_mov_b32 v26, 0
 v_mov_b32 v27, 0
 v_mov_b32 v28, 0
 v_mov_b32 v29, 0
 v_mov_b32 v30, 0
 v_mov_b32 v31, 0
 v_mov_b32 v32, 0
 v_mov_b32 v33, 0
 v_mov_b32 v34, 0
 v_mov_b32 v35, 0
 v_mov_b32 v36, 0
 v_mov_b32 v37, 0
 v_mov_b32 v38, 0
 v_mov_b32 v39, 0
 v_mov_b32 v40, 0
 v_mov_b32 v41, 0
 v_mov_b32 v42, 0
 v_mov_b32 v43, 0
 v_mov_b32 v44, 0
 v_mov_b32 v45, 0
 v_mov_b32 v46, 0
 v_mov_b32 v47, 0
 v_mov_b32 v48, 0
 v_mov_b32 v49, 0
 v_mov_b32 v50, 0
 v_mov_b32 v51, 0
 v_mov_b32 v52, 0
 v_mov_b32 v53, 0
 v_mov_b32 v54, 0
 v_mov_b32 v55, 0
 v_mov_b32 v56, 0
 v_mov_b32 v57, 0
 v_mov_b32 v58, 0
 v_mov_b32 v59, 0
 v_mov_b32 v60, 0
 v_mov_b32 v61, 0
 v_mov_b32 v62, 0
 v_mov_b32 v63, 0
 v_mov_b32 v64, 0
 v_mov_b32 v65, 0
 v_mov_b32 v66, 0
 v_mov_b32 v67, 0
 DM 40,0,140,s[16:19],24,sc1 lds
 DM 40,1024,141,s[16:19],24,sc1 lds
 DM 40,2048,142,s[16:19],24,sc1 lds
 DM 40,3072,143,s[16:19],24,sc1 lds
 DM 41,0,144,s[20:23],25,lds
 DM 41,1024,145,s[20:23],25,lds
 DM 41,2048,146,s[20:23],25,lds
 DM 41,3072,147,s[20:23],25,lds
 s_add_u32 s24, s24, 128
 s_add_u32 s25, s25, 131072
 DM 40,16384,140,s[16:19],24,sc1 lds
 DM 40,17408,141,s[16:19],24,sc1 lds
 DM 40,18432,142,s[16:19],24,sc1 lds
 DM 40,19456,143,s[16:19],24,sc1 lds
 DM 41,16384,144,s[20:23],25,lds
 DM 41,17408,145,s[20:23],25,lds
 DM 41,18432,146,s[20:23],25,lds
 DM 41,19456,147,s[20:23],25,lds
 s_add_u32 s24, s24, 128
 s_add_u32 s25, s25, 131072
 DM 40,32768,140,s[16:19],24,sc1 lds
 DM 40,33792,141,s[16:19],24,sc1 lds
 DM 40,34816,142,s[16:19],24,sc1 lds
 DM 40,35840,143,s[16:19],24,sc1 lds
 DM 41,32768,144,s[20:23],25,lds
 DM 41,33792,145,s[20:23],25,lds
 DM 41,34816,146,s[20:23],25,lds
 DM 41,35840,147,s[20:23],25,lds
 s_add_u32 s24, s24, 128
 s_add_u32 s25, s25, 131072
 DM 40,49152,140,s[16:19],24,sc1 lds
 DM 40,50176,141,s[16:19],24,sc1 lds
 DM 40,51200,142,s[16:19],24,sc1 lds
 DM 40,52224,143,s[16:19],24,sc1 lds
 DM 41,49152,144,s[20:23],25,lds
 DM 41,50176,145,s[20:23],25,lds
 DM 41,51200,146,s[20:23],25,lds
 DM 41,52224,147,s[20:23],25,lds
 s_add_u32 s24, s24, 128
 s_add_u32 s25, s25, 131072
 s_waitcnt vmcnt(24)
 s_barrier
 RB 100,103,132,0
 RB 104,107,132,2048
 RB 108,111,132,4096
 RB 112,115,132,6144
 TR 68,69,136,0
 TR 70,71,136,1024
 TR 72,73,137,0
 TR 74,75,137,1024
 TR 76,77,138,0
 TR 78,79,138,1024
 TR 80,81,139,0
 TR 82,83,139,1024
 s_waitcnt lgkmcnt(0)
 MF v[4:7],v[68:71],v[100:103]
 RB 116,119,133,0
 MF v[8:11],v[68:71],v[104:107]
 RB 120,123,133,2048
 MF v[12:15],v[68:71],v[108:111]
 RB 124,127,133,4096
 MF v[16:19],v[68:71],v[112:115]
 RB 128,131,133,6144
 MF v[20:23],v[72:75],v[100:103]
 TR 84,85,136,8192
 MF v[24:27],v[72:75],v[104:107]
 TR 86,87,136,9216
 MF v[28:31],v[72:75],v[108:111]
 TR 88,89,137,8192
 MF v[32:35],v[72:75],v[112:115]
 TR 90,91,137,9216
 MF v[36:39],v[76:79],v[100:103]
 TR 92,93,138,8192
 MF v[40:43],v[76:79],v[104:107]
 TR 94,95,138,9216
 MF v[44:47],v[76:79],v[108:111]
 TR 96,97,139,8192
 MF v[48:51],v[76:79],v[112:115]
 TR 98,99,139,9216
 MF v[52:55],v[80:83],v[100:103]
 MF v[56:59],v[80:83],v[104:107]
 MF v[60:63],v[80:83],v[108:111]
 MF v[64:67],v[80:83],v[112:115]
 s_waitcnt lgkmcnt(0)
 s_waitcnt vmcnt(16)
 s_barrier
 MF v[4:7],v[84:87],v[116:119]
 RB 100,103,132,16384
 MF v[8:11],v[84:87],v[120:123]
 RB 104,107,132,18432
 MF v[12:15],v[84:87],v[124:127]
 RB 108,111,132,20480
 DM 40,0,140,s[16:19],24,sc1 lds
 MF v[16:19],v[84:87],v[128:131]
 RB 112,115,132,22528
 MF v[20:23],v[88:91],v[116:119]
 TR 68,69,136,16384
 MF v[24:27],v[88:91],v[120:123]
 TR 70,71,136,17408
 MF v[28:31],v[88:91],v[124:127]
 TR 72,73,137,16384
 DM 40,1024,141,s[16:19],24,sc1 lds
 MF v[32:35],v[88:91],v[128:131]
 TR 74,75,137,17408
 MF v[36:39],v[92:95],v[116:119]
 TR 76,77,138,16384
 MF v[40:43],v[92:95],v[120:123]
 TR 78,79,138,17408
 MF v[44:47],v[92:95],v[124:127]
 TR 80,81,139,16384
 DM 40,2048,142,s[16:19],24,sc1 lds
 MF v[48:51],v[92:95],v[128:131]
 TR 82,83,139,17408
 MF v[52:55],v[96:99],v[116:119]
 MF v[56:59],v[96:99],v[120:123]
 MF v[60:63],v[96:99],v[124:127]
 DM 40,3072,143,s[16:19],24,sc1 lds
 MF v[64:67],v[96:99],v[128:131]
 s_waitcnt lgkmcnt(0)
 MF v[4:7],v[68:71],v[100:103]
 RB 116,119,133,16384
 MF v[8:11],v[68:71],v[104:107]
 RB 120,123,133,18432
 MF v[12:15],v[68:71],v[108:111]
 RB 124,127,133,20480
 DM 41,0,144,s[20:23],25,lds
 MF v[16:19],v[68:71],v[112:115]
 RB 128,131,133,22528
 MF v[20:23],v[72:75],v[100:103]
 TR 84,85,136,24576
 MF v[24:27],v[72:75],v[104:107]
 TR 86,87,136,25600
 MF v[28:31],v[72:75],v[108:111]
 TR 88,89,137,24576
 DM 41,1024,145,s[20:23],25,lds
 MF v[32:35],v[72:75],v[112:115]
 TR 90,91,137,25600
 MF v[36:39],v[76:79],v[100:103]
 TR 92,93,138,24576
 MF v[40:43],v[76:79],v[104:107]
 TR 94,95,138,25600
 MF v[44:47],v[76:79],v[108:111]
 TR 96,97,139,24576
 DM 41,2048,146,s[20:23],25,lds
 MF v[48:51],v[76:79],v[112:115]
 TR 98,99,139,25600
 MF v[52:55],v[80:83],v[100:103]
 MF v[56:59],v[80:83],v[104:107]
 MF v[60:63],v[80:83],v[108:111]
 DM 41,3072,147,s[20:23],25,lds
 s_add_u32 s24, s24, 128
 s_add_u32 s25, s25, 131072
 MF v[64:67],v[80:83],v[112:115]
 s_waitcnt lgkmcnt(0)
 s_waitcnt vmcnt(16)
 s_barrier
 MF v[4:7],v[84:87],v[116:119]
 RB 100,103,132,32768
 MF v[8:11],v[84:87],v[120:123]
 RB 104,107,132,34816
 MF v[12:15],v[84:87],v[124:127]
 RB 108,111,132,36864
 DM 40,16384,140,s[16:19],24,sc1 lds
 MF v[16:19],v[84:87],v[128:131]
 RB 112,115,132,38912
 MF v[20:23],v[88:91],v[116:119]
 TR 68,69,136,32768
 MF v[24:27],v[88:91],v[120:123]
 TR 70,71,136,33792
 MF v[28:31],v[88:91],v[124:127]
 TR 72,73,137,32768
 DM 40,17408,141,s[16:19],24,sc1 lds
 MF v[32:35],v[88:91],v[128:131]
 TR 74,75,137,33792
 MF v[36:39],v[92:95],v[116:119]
 TR 76,77,138,32768
 MF v[40:43],v[92:95],v[120:123]
 TR 78,79,138,33792
 MF v[44:47],v[92:95],v[124:127]
 TR 80,81,139,32768
 DM 40,18432,142,s[16:19],24,sc1 lds
 MF v[48:51],v[92:95],v[128:131]
 TR 82,83,139,33792
 MF v[52:55],v[96:99],v[116:119]
 MF v[56:59],v[96:99],v[120:123]
 MF v[60:63],v[96:99],v[124:127]
 DM 40,19456,143,s[16:19],24,sc1 lds
 MF v[64:67],v[96:99],v[128:131]
 s_waitcnt lgkmcnt(0)
 MF v[4:7],v[68:71],v[100:103]
 RB 116,119,133,32768
 MF v[8:11],v[68:71],v[104:107]
 RB 120,123,133,34816
 MF v[12:15],v[68:71],v[108:111]
 RB 124,127,133,36864
 DM 41,16384,144,s[20:23],25,lds
 MF v[16:19],v[68:71],v[112:115]
 RB 128,131,133,38912
 MF v[20:23],v[72:75],v[100:103]
 TR 84,85,136,40960
 MF v[24:27],v[72:75],v[104:107]
 TR 86,87,136,41984
 MF v[28:31],v[72:75],v[108:111]
 TR 88,89,137,40960
 DM 41,17408,145,s[20:23],25,lds
 MF v[32:35],v[72:75],v[112:115]
 TR 90,91,137,41984
 MF v[36:39],v[76:79],v[100:103]
 TR 92,93,138,40960
 MF v[40:43],v[76:79],v[104:107]
 TR 94,95,138,41984
 MF v[44:47],v[76:79],v[108:111]
 TR 96,97,139,40960
 DM 41,18432,146,s[20:23],25,lds
 MF v[48:51],v[76:79],v[112:115]
 TR 98,99,139,41984
 MF v[52:55],v[80:83],v[100:103]
 MF v[56:59],v[80:83],v[104:107]
 MF v[60:63],v[80:83],v[108:111]
 DM 41,19456,147,s[20:23],25,lds
 s_add_u32 s24, s24, 128
 s_add_u32 s25, s25, 131072
 MF v[64:67],v[80:83],v[112:115]
 s_waitcnt lgkmcnt(0)
 s_waitcnt vmcnt(16)
 s_barrier
 MF v[4:7],v[84:87],v[116:119]
 RB 100,103,132,49152
 MF v[8:11],v[84:87],v[120:123]
 RB 104,107,132,51200
 MF v[12:15],v[84:87],v[124:127]
 RB 108,111,132,53248
 DM 40,32768,140,s[16:19],24,sc1 lds
 MF v[16:19],v[84:87],v[128:131]
 RB 112,115,132,55296
 MF v[20:23],v[88:91],v[116:119]
 TR 68,69,136,49152
 MF v[24:27],v[88:91],v[120:123]
 TR 70,71,136,50176
 MF v[28:31],v[88:91],v[124:127]
 TR 72,73,137,49152
 DM 40,33792,141,s[16:19],24,sc1 lds
 MF v[32:35],v[88:91],v[128:131]
 TR 74,75,137,50176
 MF v[36:39],v[92:95],v[116:119]
 TR 76,77,138,49152
 MF v[40:43],v[92:95],v[120:123]
 TR 78,79,138,50176
 MF v[44:47],v[92:95],v[124:127]
 TR 80,81,139,49152
 DM 40,34816,142,s[16:19],24,sc1 lds
 MF v[48:51],v[92:95],v[128:131]
 TR 82,83,139,50176
 MF v[52:55],v[96:99],v[116:119]
 MF v[56:59],v[96:99],v[120:123]
 MF v[60:63],v[96:99],v[124:127]
 DM 40,35840,143,s[16:19],24,sc1 lds
 MF v[64:67],v[96:99],v[128:131]
 s_waitcnt lgkmcnt(0)
 MF v[4:7],v[68:71],v[100:103]
 RB 116,119,133,49152
 MF v[8:11],v[68:71],v[104:107]
 RB 120,123,133,51200
 MF v[12:15],v[68:71],v[108:111]
 RB 124,127,133,53248
 DM 41,32768,144,s[20:23],25,lds
 MF v[16:19],v[68:71],v[112:115]
 RB 128,131,133,55296
 MF v[20:23],v[72:75],v[100:103]
 TR 84,85,136,57344
 MF v[24:27],v[72:75],v[104:107]
 TR 86,87,136,58368
 MF v[28:31],v[72:75],v[108:111]
 TR 88,89,137,57344
 DM 41,33792,145,s[20:23],25,lds
 MF v[32:35],v[72:75],v[112:115]
 TR 90,91,137,58368
 MF v[36:39],v[76:79],v[100:103]
 TR 92,93,138,57344
 MF v[40:43],v[76:79],v[104:107]
 TR 94,95,138,58368
 MF v[44:47],v[76:79],v[108:111]
 TR 96,97,139,57344
 DM 41,34816,146,s[20:23],25,lds
 MF v[48:51],v[76:79],v[112:115]
 TR 98,99,139,58368
 MF v[52:55],v[80:83],v[100:103]
 MF v[56:59],v[80:83],v[104:107]
 MF v[60:63],v[80:83],v[108:111]
 DM 41,35840,147,s[20:23],25,lds
 s_add_u32 s24, s24, 128
 s_add_u32 s25, s25, 131072
 MF v[64:67],v[80:83],v[112:115]
 s_waitcnt lgkmcnt(0)
 s_waitcnt vmcnt(16)
 s_barrier
 MF v[4:7],v[84:87],v[116:119]
 RB 100,103,132,0
 MF v[8:11],v[84:87],v[120:123]
 RB 104,107,132,2048
 MF v[12:15],v[84:87],v[124:127]
 RB 108,111,132,4096
 DM 40,49152,140,s[16:19],24,sc1 lds
 MF v[16:19],v[84:87],v[128:131]
 RB 112,115,132,6144
 MF v[20:23],v[88:91],v[116:119]
 TR 68,69,136,0
 MF v[24:27],v[88:91],v[120:123]
 TR 70,71,136,1024
 MF v[28:31],v[88:91],v[124:127]
 TR 72,73,137,0
 DM 40,50176,141,s[16:19],24,sc1 lds
 MF v[32:35],v[88:91],v[128:131]
 TR 74,75,137,1024
 MF v[36:39],v[92:95],v[116:119]
 TR 76,77,138,0
 MF v[40:43],v[92:95],v[120:123]
 TR 78,79,138,1024
 MF v[44:47],v[92:95],v[124:127]
 TR 80,81,139,0
 DM 40,51200,142,s[16:19],24,sc1 lds
 MF v[48:51],v[92:95],v[128:131]
 TR 82,83,139,1024
 MF v[52:55],v[96:99],v[116:119]
 MF v[56:59],v[96:99],v[120:123]
 MF v[60:63],v[96:99],v[124:127]
 DM 40,52224,143,s[16:19],24,sc1 lds
 MF v[64:67],v[96:99],v[128:131]
 s_waitcnt lgkmcnt(0)
 s_sub_u32 s42, s49, 1
 s_cmp_eq_u32 s42, 0
 s_cbranch_scc1 g128_skip_5
g128_loop_4:
 MF v[4:7],v[68:71],v[100:103]
 RB 116,119,133,0
 MF v[8:11],v[68:71],v[104:107]
 RB 120,123,133,2048
 MF v[12:15],v[68:71],v[108:111]
 RB 124,127,133,4096
 DM 41,49152,144,s[20:23],25,lds
 MF v[16:19],v[68:71],v[112:115]
 RB 128,131,133,6144
 MF v[20:23],v[72:75],v[100:103]
 TR 84,85,136,8192
 MF v[24:27],v[72:75],v[104:107]
 TR 86,87,136,9216
 MF v[28:31],v[72:75],v[108:111]
 TR 88,89,137,8192
 DM 41,50176,145,s[20:23],25,lds
 MF v[32:35],v[72:75],v[112:115]
 TR 90,91,137,9216
 MF v[36:39],v[76:79],v[100:103]
 TR 92,93,138,8192
 MF v[40:43],v[76:79],v[104:107]
 TR 94,95,138,9216
 MF v[44:47],v[76:79],v[108:111]
 TR 96,97,139,8192
 DM 41,51200,146,s[20:23],25,lds
 MF v[48:51],v[76:79],v[112:115]
 TR 98,99,139,9216
 MF v[52:55],v[80:83],v[100:103]
 MF v[56:59],v[80:83],v[104:107]
 MF v[60:63],v[80:83],v[108:111]
 DM 41,52224,147,s[20:23],25,lds
 s_add_u32 s24, s24, 128
 s_add_u32 s25, s25, 131072
 MF v[64:67],v[80:83],v[112:115]
 s_waitcnt lgkmcnt(0)
 s_waitcnt vmcnt(16)
 s_barrier
 MF v[4:7],v[84:87],v[116:119]
 RB 100,103,132,16384
 MF v[8:11],v[84:87],v[120:123]
 RB 104,107,132,18432
 MF v[12:15],v[84:87],v[124:127]
 RB 108,111,132,20480
 DM 40,0,140,s[16:19],24,sc1 lds
 MF v[16:19],v[84:87],v[128:131]
 RB 112,115,132,22528
 MF v[20:23],v[88:91],v[116:119]
 TR 68,69,136,16384
 MF v[24:27],v[88:91],v[120:123]
 TR 70,71,136,17408
 MF v[28:31],v[88:91],v[124:127]
 TR 72,73,137,16384
 DM 40,1024,141,s[16:19],24,sc1 lds
 MF v[32:35],v[88:91],v[128:131]
 TR 74,75,137,17408
 MF v[36:39],v[92:95],v[116:119]
 TR 76,77,138,16384
 MF v[40:43],v[92:95],v[120:123]
 TR 78,79,138,17408
 MF v[44:47],v[92:95],v[124:127]
 TR 80,81,139,16384
 DM 40,2048,142,s[16:19],24,sc1 lds
 MF v[48:51],v[92:95],v[128:131]
 TR 82,83,139,17408
 MF v[52:55],v[96:99],v[116:119]
 MF v[56:59],v[96:99],v[120:123]
 MF v[60:63],v[96:99],v[124:127]
 DM 40,3072,143,s[16:19],24,sc1 lds
 MF v[64:67],v[96:99],v[128:131]
 s_waitcnt lgkmcnt(0)
 MF v[4:7],v[68:71],v[100:103]
 RB 116,119,133,16384
 MF v[8:11],v[68:71],v[104:107]
 RB 120,123,133,18432
 MF v[12:15],v[68:71],v[108:111]
 RB 124,127,133,20480
 DM 41,0,144,s[20:23],25,lds
 MF v[16:19],v[68:71],v[112:115]
 RB 128,131,133,22528
 MF v[20:23],v[72:75],v[100:103]
 TR 84,85,136,24576
 MF v[24:27],v[72:75],v[104:107]
 TR 86,87,136,25600
 MF v[28:31],v[72:75],v[108:111]
 TR 88,89,137,24576
 DM 41,1024,145,s[20:23],25,lds
 MF v[32:35],v[72:75],v[112:115]
 TR 90,91,137,25600
 MF v[36:39],v[76:79],v[100:103]
 TR 92,93,138,24576
 MF v[40:43],v[76:79],v[104:107]
 TR 94,95,138,25600
 MF v[44:47],v[76:79],v[108:111]
 TR 96,97,139,24576
 DM 41,2048,146,s[20:23],25,lds
 MF v[48:51],v[76:79],v[112:115]
 TR 98,99,139,25600
 MF v[52:55],v[80:83],v[100:103]
 MF v[56:59],v[80:83],v[104:107]
 MF v[60:63],v[80:83],v[108:111]
 DM 41,3072,147,s[20:23],25,lds
 s_add_u32 s24, s24, 128
 s_add_u32 s25, s25, 131072
 MF v[64:67],v[80:83],v[112:115]
 s_waitcnt lgkmcnt(0)
 s_waitcnt vmcnt(16)
 s_barrier
 MF v[4:7],v[84:87],v[116:119]
 RB 100,103,132,32768
 MF v[8:11],v[84:87],v[120:123]
 RB 104,107,132,34816
 MF v[12:15],v[84:87],v[124:127]
 RB 108,111,132,36864
 DM 40,16384,140,s[16:19],24,sc1 lds
 MF v[16:19],v[84:87],v[128:131]
 RB 112,115,132,38912
 MF v[20:23],v[88:91],v[116:119]
 TR 68,69,136,32768
 MF v[24:27],v[88:91],v[120:123]
 TR 70,71,136,33792
 MF v[28:31],v[88:91],v[124:127]
 TR 72,73,137,32768
 DM 40,17408,141,s[16:19],24,sc1 lds
 MF v[32:35],v[88:91],v[128:131]
 TR 74,75,137,33792
 MF v[36:39],v[92:95],v[116:119]
 TR 76,77,138,32768
 MF v[40:43],v[92:95],v[120:123]
 TR 78,79,138,33792
 MF v[44:47],v[92:95],v[124:127]
 TR 80,81,139,32768
 DM 40,18432,142,s[16:19],24,sc1 lds
 MF v[48:51],v[92:95],v[128:131]
 TR 82,83,139,33792
 MF v[52:55],v[96:99],v[116:119]
 MF v[56:59],v[96:99],v[120:123]
 MF v[60:63],v[96:99],v[124:127]
 DM 40,19456,143,s[16:19],24,sc1 lds
 MF v[64:67],v[96:99],v[128:131]
 s_waitcnt lgkmcnt(0)
 MF v[4:7],v[68:71],v[100:103]
 RB 116,119,133,32768
 MF v[8:11],v[68:71],v[104:107]
 RB 120,123,133,34816
 MF v[12:15],v[68:71],v[108:111]
 RB 124,127,133,36864
 DM 41,16384,144,s[20:23],25,lds
 MF v[16:19],v[68:71],v[112:115]
 RB 128,131,133,38912
 MF v[20:23],v[72:75],v[100:103]
 TR 84,85,136,40960
 MF v[24:27],v[72:75],v[104:107]
 TR 86,87,136,41984
 MF v[28:31],v[72:75],v[108:111]
 TR 88,89,137,40960
 DM 41,17408,145,s[20:23],25,lds
 MF v[32:35],v[72:75],v[112:115]
 TR 90,91,137,41984
 MF v[36:39],v[76:79],v[100:103]
 TR 92,93,138,40960
 MF v[40:43],v[76:79],v[104:107]
 TR 94,95,138,41984
 MF v[44:47],v[76:79],v[108:111]
 TR 96,97,139,40960
 DM 41,18432,146,s[20:23],25,lds
 MF v[48:51],v[76:79],v[112:115]
 TR 98,99,139,41984
 MF v[52:55],v[80:83],v[100:103]
 MF v[56:59],v[80:83],v[104:107]
 MF v[60:63],v[80:83],v[108:111]
 DM 41,19456,147,s[20:23],25,lds
 s_add_u32 s24, s24, 128
 s_add_u32 s25, s25, 131072
 MF v[64:67],v[80:83],v[112:115]
 s_waitcnt lgkmcnt(0)
 s_waitcnt vmcnt(16)
 s_barrier
 MF v[4:7],v[84:87],v[116:119]
 RB 100,103,132,49152
 MF v[8:11],v[84:87],v[120:123]
 RB 104,107,132,51200
 MF v[12:15],v[84:87],v[124:127]
 RB 108,111,132,53248
 DM 40,32768,140,s[16:19],24,sc1 lds
 MF v[16:19],v[84:87],v[128:131]
 RB 112,115,132,55296
 MF v[20:23],v[88:91],v[116:119]
 TR 68,69,136,49152
 MF v[24:27],v[88:91],v[120:123]
 TR 70,71,136,50176
 MF v[28:31],v[88:91],v[124:127]
 TR 72,73,137,49152
 DM 40,33792,141,s[16:19],24,sc1 lds
 MF v[32:35],v[88:91],v[128:131]
 TR 74,75,137,50176
 MF v[36:39],v[92:95],v[116:119]
 TR 76,77,138,49152
 MF v[40:43],v[92:95],v[120:123]
 TR 78,79,138,50176
 MF v[44:47],v[92:95],v[124:127]
 TR 80,81,139,49152
 DM 40,34816,142,s[16:19],24,sc1 lds
 MF v[48:51],v[92:95],v[128:131]
 TR 82,83,139,50176
 MF v[52:55],v[96:99],v[116:119]
 MF v[56:59],v[96:99],v[120:123]
 MF v[60:63],v[96:99],v[124:127]
 DM 40,35840,143,s[16:19],24,sc1 lds
 MF v[64:67],v[96:99],v[128:131]
 s_waitcnt lgkmcnt(0)
 MF v[4:7],v[68:71],v[100:103]
 RB 116,119,133,49152
 MF v[8:11],v[68:71],v[104:107]
 RB 120,123,133,51200
 MF v[12:15],v[68:71],v[108:111]
 RB 124,127,133,53248
 DM 41,32768,144,s[20:23],25,lds
 MF v[16:19],v[68:71],v[112:115]
 RB 128,131,133,55296
 MF v[20:23],v[72:75],v[100:103]
 TR 84,85,136,57344
 MF v[24:27],v[72:75],v[104:107]
 TR 86,87,136,58368
 MF v[28:31],v[72:75],v[108:111]
 TR 88,89,137,57344
 DM 41,33792,145,s[20:23],25,lds
 MF v[32:35],v[72:75],v[112:115]
 TR 90,91,137,58368
 MF v[36:39],v[76:79],v[100:103]
 TR 92,93,138,57344
 MF v[40:43],v[76:79],v[104:107]
 TR 94,95,138,58368
 MF v[44:47],v[76:79],v[108:111]
 TR 96,97,139,57344
 DM 41,34816,146,s[20:23],25,lds
 MF v[48:51],v[76:79],v[112:115]
 TR 98,99,139,58368
 MF v[52:55],v[80:83],v[100:103]
 MF v[56:59],v[80:83],v[104:107]
 MF v[60:63],v[80:83],v[108:111]
 DM 41,35840,147,s[20:23],25,lds
 s_add_u32 s24, s24, 128
 s_add_u32 s25, s25, 131072
 MF v[64:67],v[80:83],v[112:115]
 s_waitcnt lgkmcnt(0)
 s_waitcnt vmcnt(16)
 s_barrier
 MF v[4:7],v[84:87],v[116:119]
 RB 100,103,132,0
 MF v[8:11],v[84:87],v[120:123]
 RB 104,107,132,2048
 MF v[12:15],v[84:87],v[124:127]
 RB 108,111,132,4096
 DM 40,49152,140,s[16:19],24,sc1 lds
 MF v[16:19],v[84:87],v[128:131]
 RB 112,115,132,6144
 MF v[20:23],v[88:91],v[116:119]
 TR 68,69,136,0
 MF v[24:27],v[88:91],v[120:123]
 TR 70,71,136,1024
 MF v[28:31],v[88:91],v[124:127]
 TR 72,73,137,0
 DM 40,50176,141,s[16:19],24,sc1 lds
 MF v[32:35],v[88:91],v[128:131]
 TR 74,75,137,1024
 MF v[36:39],v[92:95],v[116:119]
 TR 76,77,138,0
 MF v[40:43],v[92:95],v[120:123]
 TR 78,79,138,1024
 MF v[44:47],v[92:95],v[124:127]
 TR 80,81,139,0
 DM 40,51200,142,s[16:19],24,sc1 lds
 MF v[48:51],v[92:95],v[128:131]
 TR 82,83,139,1024
 MF v[52:55],v[96:99],v[116:119]
 MF v[56:59],v[96:99],v[120:123]
 MF v[60:63],v[96:99],v[124:127]
 DM 40,52224,143,s[16:19],24,sc1 lds
 MF v[64:67],v[96:99],v[128:131]
 s_waitcnt lgkmcnt(0)
 s_sub_u32 s42, s42, 1
 s_cmp_lg_u32 s42, 0
 s_cbranch_scc1 g128_loop_4
g128_skip_5:
 MF v[4:7],v[68:71],v[100:103]
 RB 116,119,133,0
 MF v[8:11],v[68:71],v[104:107]
 RB 120,123,133,2048
 MF v[12:15],v[68:71],v[108:111]
 RB 124,127,133,4096
 DM 41,49152,144,s[20:23],25,lds
 MF v[16:19],v[68:71],v[112:115]
 RB 128,131,133,6144
 MF v[20:23],v[72:75],v[100:103]
 TR 84,85,136,8192
 MF v[24:27],v[72:75],v[104:107]
 TR 86,87,136,9216
 MF v[28:31],v[72:75],v[108:111]
 TR 88,89,137,8192
 DM 41,50176,145,s[20:23],25,lds
 MF v[32:35],v[72:75],v[112:115]
 TR 90,91,137,9216
 MF v[36:39],v[76:79],v[100:103]
 TR 92,93,138,8192
 MF v[40:43],v[76:79],v[104:107]
 TR 94,95,138,9216
 MF v[44:47],v[76:79],v[108:111]
 TR 96,97,139,8192
 DM 41,51200,146,s[20:23],25,lds
 MF v[48:51],v[76:79],v[112:115]
 TR 98,99,139,9216
 MF v[52:55],v[80:83],v[100:103]
 MF v[56:59],v[80:83],v[104:107]
 MF v[60:63],v[80:83],v[108:111]
 DM 41,52224,147,s[20:23],25,lds
 s_add_u32 s24, s24, 128
 s_add_u32 s25, s25, 131072
 MF v[64:67],v[80:83],v[112:115]
 s_waitcnt lgkmcnt(0)
 s_waitcnt vmcnt(16)
 s_barrier
 MF v[4:7],v[84:87],v[116:119]
 RB 100,103,132,16384
 MF v[8:11],v[84:87],v[120:123]
 RB 104,107,132,18432
 MF v[12:15],v[84:87],v[124:127]
 RB 108,111,132,20480
 MF v[16:19],v[84:87],v[128:131]
 RB 112,115,132,22528
 MF v[20:23],v[88:91],v[116:119]
 TR 68,69,136,16384
 MF v[24:27],v[88:91],v[120:123]
 TR 70,71,136,17408
 MF v[28:31],v[88:91],v[124:127]
 TR 72,73,137,16384
 MF v[32:35],v[88:91],v[128:131]
 TR 74,75,137,17408
 MF v[36:39],v[92:95],v[116:119]
 TR 76,77,138,16384
 MF v[40:43],v[92:95],v[120:123]
 TR 78,79,138,17408
 MF v[44:47],v[92:95],v[124:127]
 TR 80,81,139,16384
 MF v[48:51],v[92:95],v[128:131]
 TR 82,83,139,17408
 MF v[52:55],v[96:99],v[116:119]
 MF v[56:59],v[96:99],v[120:123]
 MF v[60:63],v[96:99],v[124:127]
 MF v[64:67],v[96:99],v[128:131]
 s_waitcnt lgkmcnt(0)
 MF v[4:7],v[68:71],v[100:103]
 RB 116,119,133,16384
 MF v[8:11],v[68:71],v[104:107]
 RB 120,123,133,18432
 MF v[12:15],v[68:71],v[108:111]
 RB 124,127,133,20480
 MF v[16:19],v[68:71],v[112:115]
 RB 128,131,133,22528
 MF v[20:23],v[72:75],v[100:103]
 TR 84,85,136,24576
 MF v[24:27],v[72:75],v[104:107]
 TR 86,87,136,25600
 MF v[28:31],v[72:75],v[108:111]
 TR 88,89,137,24576
 MF v[32:35],v[72:75],v[112:115]
 TR 90,91,137,25600
 MF v[36:39],v[76:79],v[100:103]
 TR 92,93,138,24576
 MF v[40:43],v[76:79],v[104:107]
 TR 94,95,138,25600
 MF v[44:47],v[76:79],v[108:111]
 TR 96,97,139,24576
 MF v[48:51],v[76:79],v[112:115]
 TR 98,99,139,25600
 MF v[52:55],v[80:83],v[100:103]
 MF v[56:59],v[80:83],v[104:107]
 MF v[60:63],v[80:83],v[108:111]
 MF v[64:67],v[80:83],v[112:115]
 s_waitcnt lgkmcnt(0)
 s_waitcnt vmcnt(8)
 s_barrier
 MF v[4:7],v[84:87],v[116:119]
 RB 100,103,132,32768
 MF v[8:11],v[84:87],v[120:123]
 RB 104,107,132,34816
 MF v[12:15],v[84:87],v[124:127]
 RB 108,111,132,36864
 MF v[16:19],v[84:87],v[128:131]
 RB 112,115,132,38912
 MF v[20:23],v[88:91],v[116:119]
 TR 68,69,136,32768
 MF v[24:27],v[88:91],v[120:123]
 TR 70,71,136,33792
 MF v[28:31],v[88:91],v[124:127]
 TR 72,73,137,32768
 MF v[32:35],v[88:91],v[128:131]
 TR 74,75,137,33792
 MF v[36:39],v[92:95],v[116:119]
 TR 76,77,138,32768
 MF v[40:43],v[92:95],v[120:123]
 TR 78,79,138,33792
 MF v[44:47],v[92:95],v[124:127]
 TR 80,81,139,32768
 MF v[48:51],v[92:95],v[128:131]
 TR 82,83,139,33792
 MF v[52:55],v[96:99],v[116:119]
 MF v[56:59],v[96:99],v[120:123]
 MF v[60:63],v[96:99],v[124:127]
 MF v[64:67],v[96:99],v[128:131]
 s_waitcnt lgkmcnt(0)
 MF v[4:7],v[68:71],v[100:103]
 RB 116,119,133,32768
 MF v[8:11],v[68:71],v[104:107]
 RB 120,123,133,34816
 MF v[12:15],v[68:71],v[108:111]
 RB 124,127,133,36864
 MF v[16:19],v[68:71],v[112:115]
 RB 128,131,133,38912
 MF v[20:23],v[72:75],v[100:103]
 TR 84,85,136,40960
 MF v[24:27],v[72:75],v[104:107]
 TR 86,87,136,41984
 MF v[28:31],v[72:75],v[108:111]
 TR 88,89,137,40960
 MF v[32:35],v[72:75],v[112:115]
 TR 90,91,137,41984
 MF v[36:39],v[76:79],v[100:103]
 TR 92,93,138,40960
 MF v[40:43],v[76:79],v[104:107]
 TR 94,95,138,41984
 MF v[44:47],v[76:79],v[108:111]
 TR 96,97,139,40960
 MF v[48:51],v[76:79],v[112:115]
 TR 98,99,139,41984
 MF v[52:55],v[80:83],v[100:103]
 MF v[56:59],v[80:83],v[104:107]
 MF v[60:63],v[80:83],v[108:111]
 MF v[64:67],v[80:83],v[112:115]
 s_waitcnt lgkmcnt(0)
 s_waitcnt vmcnt(0)
 s_barrier
 MF v[4:7],v[84:87],v[116:119]
 RB 100,103,132,49152
 MF v[8:11],v[84:87],v[120:123]
 RB 104,107,132,51200
 MF v[12:15],v[84:87],v[124:127]
 RB 108,111,132,53248
 MF v[16:19],v[84:87],v[128:131]
 RB 112,115,132,55296
 MF v[20:23],v[88:91],v[116:119]
 TR 68,69,136,49152
 MF v[24:27],v[88:91],v[120:123]
 TR 70,71,136,50176
 MF v[28:31],v[88:91],v[124:127]
 TR 72,73,137,49152
 MF v[32:35],v[88:91],v[128:131]
 TR 74,75,137,50176
 MF v[36:39],v[92:95],v[116:119]
 TR 76,77,138,49152
 MF v[40:43],v[92:95],v[120:123]
 TR 78,79,138,50176
 MF v[44:47],v[92:95],v[124:127]
 TR 80,81,139,49152
 MF v[48:51],v[92:95],v[128:131]
 TR 82,83,139,50176
 MF v[52:55],v[96:99],v[116:119]
 MF v[56:59],v[96:99],v[120:123]
 MF v[60:63],v[96:99],v[124:127]
 MF v[64:67],v[96:99],v[128:131]
 s_waitcnt lgkmcnt(0)
 MF v[4:7],v[68:71],v[100:103]
 RB 116,119,133,49152
 MF v[8:11],v[68:71],v[104:107]
 RB 120,123,133,51200
 MF v[12:15],v[68:71],v[108:111]
 RB 124,127,133,53248
 MF v[16:19],v[68:71],v[112:115]
 RB 128,131,133,55296
 MF v[20:23],v[72:75],v[100:103]
 TR 84,85,136,57344
 MF v[24:27],v[72:75],v[104:107]
 TR 86,87,136,58368
 MF v[28:31],v[72:75],v[108:111]
 TR 88,89,137,57344
 MF v[32:35],v[72:75],v[112:115]
 TR 90,91,137,58368
 MF v[36:39],v[76:79],v[100:103]
 TR 92,93,138,57344
 MF v[40:43],v[76:79],v[104:107]
 TR 94,95,138,58368
 MF v[44:47],v[76:79],v[108:111]
 TR 96,97,139,57344
 MF v[48:51],v[76:79],v[112:115]
 TR 98,99,139,58368
 MF v[52:55],v[80:83],v[100:103]
 MF v[56:59],v[80:83],v[104:107]
 MF v[60:63],v[80:83],v[108:111]
 MF v[64:67],v[80:83],v[112:115]
 s_waitcnt lgkmcnt(0)
 MF v[4:7],v[84:87],v[116:119]
 MF v[8:11],v[84:87],v[120:123]
 MF v[12:15],v[84:87],v[124:127]
 MF v[16:19],v[84:87],v[128:131]
 MF v[20:23],v[88:91],v[116:119]
 MF v[24:27],v[88:91],v[120:123]
 MF v[28:31],v[88:91],v[124:127]
 MF v[32:35],v[88:91],v[128:131]
 MF v[36:39],v[92:95],v[116:119]
 MF v[40:43],v[92:95],v[120:123]
 MF v[44:47],v[92:95],v[124:127]
 MF v[48:51],v[92:95],v[128:131]
 MF v[52:55],v[96:99],v[116:119]
 MF v[56:59],v[96:99],v[120:123]
 MF v[60:63],v[96:99],v[124:127]
 MF v[64:67],v[96:99],v[128:131]
 v_and_b32 v3, 15, v2
 v_lshlrev_b32 v3, 12, v3
 v_lshrrev_b32 v1, 4, v2
 v_lshl_add_u32 v3, v1, 4, v3
 s_lshl_b32 s26, s10, 2
 s_add_u32 s26, s26, s29
 s_lshl_b32 s26, s26, 7
 s_lshl_b32 s27, s43, 6
 s_add_u32 s26, s26, s27
 s_lshl_b32 s26, s26, 12
 s_mul_i32 s27, s12, 512
 s_add_u32 s26, s26, s27
 s_mul_i32 s27, s44, 256
 s_add_u32 s26, s26, s27
 s_add_u32 s26, s26, s50
 s_nop 4
 buffer_store_dwordx4 v[4:7], v3, s[16:19], s26 offen offset:0 sc1
 buffer_store_dwordx4 v[20:23], v3, s[16:19], s26 offen offset:64 sc1
 buffer_store_dwordx4 v[36:39], v3, s[16:19], s26 offen offset:128 sc1
 buffer_store_dwordx4 v[52:55], v3, s[16:19], s26 offen offset:192 sc1
 s_add_u32 s26, s26, 65536
 buffer_store_dwordx4 v[8:11], v3, s[16:19], s26 offen offset:0 sc1
 buffer_store_dwordx4 v[24:27], v3, s[16:19], s26 offen offset:64 sc1
 buffer_store_dwordx4 v[40:43], v3, s[16:19], s26 offen offset:128 sc1
 buffer_store_dwordx4 v[56:59], v3, s[16:19], s26 offen offset:192 sc1
 s_add_u32 s26, s26, 65536
 buffer_store_dwordx4 v[12:15], v3, s[16:19], s26 offen offset:0 sc1
 buffer_store_dwordx4 v[28:31], v3, s[16:19], s26 offen offset:64 sc1
 buffer_store_dwordx4 v[44:47], v3, s[16:19], s26 offen offset:128 sc1
 buffer_store_dwordx4 v[60:63], v3, s[16:19], s26 offen offset:192 sc1
 s_add_u32 s26, s26, 65536
 buffer_store_dwordx4 v[16:19], v3, s[16:19], s26 offen offset:0 sc1
 buffer_store_dwordx4 v[32:35], v3, s[16:19], s26 offen offset:64 sc1
 buffer_store_dwordx4 v[48:51], v3, s[16:19], s26 offen offset:128 sc1
 buffer_store_dwordx4 v[64:67], v3, s[16:19], s26 offen offset:192 sc1
 s_add_u32 s26, s26, 65536
 s_branch mk_done
mk_b_f1s:
 s_cmp_ge_u32 s11, 56
 s_cbranch_scc1 mk_skip
 s_load_dwordx2 s[4:5], s[0:1], 64
 s_waitcnt lgkmcnt(0)
 s_mov_b32 s20, s4
 s_and_b32 s21, s5, 0xffff
 s_mov_b32 s22, 0x700000
 s_mov_b32 s23, 0x00020000
 s_mul_i32 s24, s10, 262144
 s_add_u32 s24, s24, 58720256
 s_mul_i32 s25, s11, 128
 s_lshr_b32 s43, s13, 1
 s_and_b32 s44, s13, 1
 v_and_b32 v96, 15, v2
 v_lshrrev_b32 v97, 4, v2
 v_lshrrev_b32 v98, 1, v96
 v_xor_b32 v98, v98, v97
 v_mov_b32 v99, v96
 s_mul_i32 s45, s43, 8192
 s_add_u32 s45, s45, 0
 v_lshlrev_b32 v99, 7, v99
 v_add_u32 v99, s45, v99
 v_lshlrev_b32 v100, 4, v98
 v_add_u32 v84, v99, v100
 v_xor_b32 v100, 64, v100
 v_add_u32 v85, v99, v100
 v_add_u32 v86, 0x10000, v84
 v_add_u32 v87, 0x10000, v85
 v_lshrrev_b32 v98, 2, v96
 v_and_b32 v99, 3, v2
 v_and_b32 v100, 1, v97
 v_lshlrev_b32 v100, 1, v100
 v_lshrrev_b32 v101, 1, v98
 v_or_b32 v100, v100, v101
 v_lshlrev_b32 v97, 3, v97
 v_add_u32 v97, v97, v98
 v_mul_u32_u24 v97, 128, v97
 v_lshlrev_b32 v99, 3, v99
 v_add_u32 v97, v97, v99
 v_add_u32 v97, 98304, v97
 s_mul_i32 s45, s44, 2
 s_add_u32 s46, s45, 0
 v_xor_b32 v98, s46, v100
 v_lshlrev_b32 v98, 5, v98
 v_add_u32 v88, v97, v98
 s_add_u32 s46, s45, 1
 v_xor_b32 v98, s46, v100
 v_lshlrev_b32 v98, 5, v98
 v_add_u32 v89, v97, v98
 v_lshrrev_b32 v96, 3, v2
 v_and_b32 v97, 7, v2
 s_mul_i32 s45, s13, 4
 s_add_u32 s46, s45, 0
 s_lshl_b32 s47, s46, 3
 v_add_u32 v98, s47, v96
 v_bfe_u32 v99, v98, 1, 3
 v_xor_b32 v99, v99, v97
 v_lshlrev_b32 v99, 4, v99
 v_mul_u32_u24 v98, 2048, v98
 v_add_u32 v90, v98, v99
 s_add_u32 s46, s45, 1
 s_lshl_b32 s47, s46, 3
 v_add_u32 v98, s47, v96
 v_bfe_u32 v99, v98, 1, 3
 v_xor_b32 v99, v99, v97
 v_lshlrev_b32 v99, 4, v99
 v_mul_u32_u24 v98, 2048, v98
 v_add_u32 v91, v98, v99
 s_add_u32 s46, s45, 2
 s_lshl_b32 s47, s46, 3
 v_add_u32 v98, s47, v96
 v_bfe_u32 v99, v98, 1, 3
 v_xor_b32 v99, v99, v97
 v_lshlrev_b32 v99, 4, v99
 v_mul_u32_u24 v98, 2048, v98
 v_add_u32 v92, v98, v99
 s_add_u32 s46, s45, 3
 s_lshl_b32 s47, s46, 3
 v_add_u32 v98, s47, v96
 v_bfe_u32 v99, v98, 1, 3
 v_xor_b32 v99, v99, v97
 v_lshlrev_b32 v99, 4, v99
 v_mul_u32_u24 v98, 2048, v98
 v_add_u32 v93, v98, v99
 s_mul_i32 s40, s13, 4096
 s_add_u32 s40, s40, 0
 v_lshlrev_b32 v96, 4, v2
 s_mul_i32 s45, s13, 2048
 s_add_u32 s46, s45, 0
 v_add_u32 v97, s46, v96
 v_lshrrev_b32 v98, 7, v97
 v_and_b32 v97, 127, v97
 v_bfe_u32 v100, v98, 3, 1
 v_bfe_u32 v99, v98, 1, 1
 v_lshlrev_b32 v100, 1, v100
 v_or_b32 v99, v99, v100
 v_lshlrev_b32 v99, 5, v99
 v_xor_b32 v97, v97, v99
 v_mul_u32_u24 v98, 7168, v98
 v_add_u32 v94, v98, v97
 s_add_u32 s46, s45, 1024
 v_add_u32 v97, s46, v96
 v_lshrrev_b32 v98, 7, v97
 v_and_b32 v97, 127, v97
 v_bfe_u32 v100, v98, 3, 1
 v_bfe_u32 v99, v98, 1, 1
 v_lshlrev_b32 v100, 1, v100
 v_or_b32 v99, v99, v100
 v_lshlrev_b32 v99, 5, v99
 v_xor_b32 v97, v97, v99
 v_mul_u32_u24 v98, 7168, v98
 v_add_u32 v95, v98, v97
 s_mul_i32 s41, s13, 2048
 s_add_u32 s41, s41, 98304
 v_mov_b32 v4, 0
 v_mov_b32 v5, 0
 v_mov_b32 v6, 0
 v_mov_b32 v7, 0
 v_mov_b32 v8, 0
 v_mov_b32 v9, 0
 v_mov_b32 v10, 0
 v_mov_b32 v11, 0
 v_mov_b32 v12, 0
 v_mov_b32 v13, 0
 v_mov_b32 v14, 0
 v_mov_b32 v15, 0
 v_mov_b32 v16, 0
 v_mov_b32 v17, 0
 v_mov_b32 v18, 0
 v_mov_b32 v19, 0
 v_mov_b32 v20, 0
 v_mov_b32 v21, 0
 v_mov_b32 v22, 0
 v_mov_b32 v23, 0
 v_mov_b32 v24, 0
 v_mov_b32 v25, 0
 v_mov_b32 v26, 0
 v_mov_b32 v27, 0
 v_mov_b32 v28, 0
 v_mov_b32 v29, 0
 v_mov_b32 v30, 0
 v_mov_b32 v31, 0
 v_mov_b32 v32, 0
 v_mov_b32 v33, 0
 v_mov_b32 v34, 0
 v_mov_b32 v35, 0
 DM 41,0,94,s[20:23],25,lds
 DM 41,1024,95,s[20:23],25,lds
 s_add_u32 s25, s25, 458752
 DM 41,8192,94,s[20:23],25,lds
 DM 41,9216,95,s[20:23],25,lds
 s_add_u32 s25, s25, 458752
 DM 41,16384,94,s[20:23],25,lds
 DM 41,17408,95,s[20:23],25,lds
 s_add_u32 s25, s25, 458752
 DM 41,24576,94,s[20:23],25,lds
 DM 41,25600,95,s[20:23],25,lds
 s_add_u32 s25, s25, 458752
 DM 41,32768,94,s[20:23],25,lds
 DM 41,33792,95,s[20:23],25,lds
 s_add_u32 s25, s25, 458752
 DM 41,40960,94,s[20:23],25,lds
 DM 41,41984,95,s[20:23],25,lds
 s_add_u32 s25, s25, 458752
 s_bitcmp1_b32 s8, 31
 s_cbranch_scc0 mk_f1s_dw2
 s_cmp_lg_u32 s13, 0
 s_cbranch_scc1 mk_f1s_dw1
 s_mov_b32 s52, 81829888
 s_bfe_u32 s53, s8, 0x50018
 s_mov_b32 s54, 1048576
 v_mov_b32 v1, 0
mk_f1s_dw0:
 buffer_load_dword v3, v1, s[16:19], s52 offen sc1
 s_sub_u32 s54, s54, 1
 s_cbranch_scc1 mk_end
 s_waitcnt vmcnt(0)
 v_readfirstlane_b32 s55, v3
 s_bitcmp1_b32 s55, s53
 s_cbranch_scc1 mk_f1s_dw1
 s_sleep 2
 s_branch mk_f1s_dw0
mk_f1s_dw1:
 s_barrier
mk_f1s_dw2:
 DM 40,0,90,s[16:19],24,sc1 lds
 DM 40,1024,91,s[16:19],24,sc1 lds
 DM 40,2048,92,s[16:19],24,sc1 lds
 DM 40,3072,93,s[16:19],24,sc1 lds
 s_add_u32 s24, s24, 128
 DM 40,16384,90,s[16:19],24,sc1 lds
 DM 40,17408,91,s[16:19],24,sc1 lds
 DM 40,18432,92,s[16:19],24,sc1 lds
 DM 40,19456,93,s[16:19],24,sc1 lds
 s_add_u32 s24, s24, 128
 DM 40,32768,90,s[16:19],24,sc1 lds
 DM 40,33792,91,s[16:19],24,sc1 lds
 DM 40,34816,92,s[16:19],24,sc1 lds
 DM 40,35840,93,s[16:19],24,sc1 lds
 s_add_u32 s24, s24, 128
 DM 40,49152,90,s[16:19],24,sc1 lds
 DM 40,50176,91,s[16:19],24,sc1 lds
 DM 40,51200,92,s[16:19],24,sc1 lds
 DM 40,52224,93,s[16:19],24,sc1 lds
 s_add_u32 s24, s24, 128
 DM 40,65536,90,s[16:19],24,sc1 lds
 DM 40,66560,91,s[16:19],24,sc1 lds
 DM 40,67584,92,s[16:19],24,sc1 lds
 DM 40,68608,93,s[16:19],24,sc1 lds
 s_add_u32 s24, s24, 128
 DM 40,81920,90,s[16:19],24,sc1 lds
 DM 40,82944,91,s[16:19],24,sc1 lds
 DM 40,83968,92,s[16:19],24,sc1 lds
 DM 40,84992,93,s[16:19],24,sc1 lds
 s_add_u32 s24, s24, 128
 s_waitcnt vmcnt(20)
 s_barrier
 RB 52,55,84,0
 RB 56,59,84,2048
 RB 60,63,84,4096
 RB 64,67,84,6144
 TR 36,37,88,0
 TR 38,39,88,512
 TR 40,41,89,0
 TR 42,43,89,512
 s_waitcnt lgkmcnt(0)
 MF v[4:7],v[36:39],v[52:55]
 RB 68,71,85,0
 MF v[8:11],v[36:39],v[56:59]
 RB 72,75,85,2048
 MF v[12:15],v[36:39],v[60:63]
 RB 76,79,85,4096
 MF v[16:19],v[36:39],v[64:67]
 RB 80,83,85,6144
 MF v[20:23],v[40:43],v[52:55]
 TR 44,45,88,4096
 MF v[24:27],v[40:43],v[56:59]
 TR 46,47,88,4608
 MF v[28:31],v[40:43],v[60:63]
 TR 48,49,89,4096
 MF v[32:35],v[40:43],v[64:67]
 TR 50,51,89,4608
 s_waitcnt lgkmcnt(0)
 s_waitcnt vmcnt(16)
 s_barrier
 MF v[4:7],v[44:47],v[68:71]
 RB 52,55,84,16384
 MF v[8:11],v[44:47],v[72:75]
 RB 56,59,84,18432
 DM 40,0,90,s[16:19],24,sc1 lds
 MF v[12:15],v[44:47],v[76:79]
 RB 60,63,84,20480
 MF v[16:19],v[44:47],v[80:83]
 RB 64,67,84,22528
 MF v[20:23],v[48:51],v[68:71]
 TR 36,37,88,8192
 DM 40,1024,91,s[16:19],24,sc1 lds
 MF v[24:27],v[48:51],v[72:75]
 TR 38,39,88,8704
 MF v[28:31],v[48:51],v[76:79]
 TR 40,41,89,8192
 DM 40,2048,92,s[16:19],24,sc1 lds
 MF v[32:35],v[48:51],v[80:83]
 TR 42,43,89,8704
 s_waitcnt lgkmcnt(0)
 MF v[4:7],v[36:39],v[52:55]
 RB 68,71,85,16384
 MF v[8:11],v[36:39],v[56:59]
 RB 72,75,85,18432
 DM 40,3072,93,s[16:19],24,sc1 lds
 MF v[12:15],v[36:39],v[60:63]
 RB 76,79,85,20480
 MF v[16:19],v[36:39],v[64:67]
 RB 80,83,85,22528
 MF v[20:23],v[40:43],v[52:55]
 TR 44,45,88,12288
 DM 41,0,94,s[20:23],25,lds
 MF v[24:27],v[40:43],v[56:59]
 TR 46,47,88,12800
 MF v[28:31],v[40:43],v[60:63]
 TR 48,49,89,12288
 DM 41,1024,95,s[20:23],25,lds
 s_add_u32 s24, s24, 128
 s_add_u32 s25, s25, 458752
 MF v[32:35],v[40:43],v[64:67]
 TR 50,51,89,12800
 s_waitcnt lgkmcnt(0)
 s_waitcnt vmcnt(18)
 s_barrier
 MF v[4:7],v[44:47],v[68:71]
 RB 52,55,84,32768
 MF v[8:11],v[44:47],v[72:75]
 RB 56,59,84,34816
 DM 40,16384,90,s[16:19],24,sc1 lds
 MF v[12:15],v[44:47],v[76:79]
 RB 60,63,84,36864
 MF v[16:19],v[44:47],v[80:83]
 RB 64,67,84,38912
 MF v[20:23],v[48:51],v[68:71]
 TR 36,37,88,16384
 DM 40,17408,91,s[16:19],24,sc1 lds
 MF v[24:27],v[48:51],v[72:75]
 TR 38,39,88,16896
 MF v[28:31],v[48:51],v[76:79]
 TR 40,41,89,16384
 DM 40,18432,92,s[16:19],24,sc1 lds
 MF v[32:35],v[48:51],v[80:83]
 TR 42,43,89,16896
 s_waitcnt lgkmcnt(0)
 MF v[4:7],v[36:39],v[52:55]
 RB 68,71,85,32768
 MF v[8:11],v[36:39],v[56:59]
 RB 72,75,85,34816
 DM 40,19456,93,s[16:19],24,sc1 lds
 MF v[12:15],v[36:39],v[60:63]
 RB 76,79,85,36864
 MF v[16:19],v[36:39],v[64:67]
 RB 80,83,85,38912
 MF v[20:23],v[40:43],v[52:55]
 TR 44,45,88,20480
 DM 41,8192,94,s[20:23],25,lds
 MF v[24:27],v[40:43],v[56:59]
 TR 46,47,88,20992
 MF v[28:31],v[40:43],v[60:63]
 TR 48,49,89,20480
 DM 41,9216,95,s[20:23],25,lds
 s_add_u32 s24, s24, 128
 s_add_u32 s25, s25, 458752
 MF v[32:35],v[40:43],v[64:67]
 TR 50,51,89,20992
 s_waitcnt lgkmcnt(0)
 s_waitcnt vmcnt(20)
 s_barrier
 MF v[4:7],v[44:47],v[68:71]
 RB 52,55,84,49152
 MF v[8:11],v[44:47],v[72:75]
 RB 56,59,84,51200
 DM 40,32768,90,s[16:19],24,sc1 lds
 MF v[12:15],v[44:47],v[76:79]
 RB 60,63,84,53248
 MF v[16:19],v[44:47],v[80:83]
 RB 64,67,84,55296
 MF v[20:23],v[48:51],v[68:71]
 TR 36,37,88,24576
 DM 40,33792,91,s[16:19],24,sc1 lds
 MF v[24:27],v[48:51],v[72:75]
 TR 38,39,88,25088
 MF v[28:31],v[48:51],v[76:79]
 TR 40,41,89,24576
 DM 40,34816,92,s[16:19],24,sc1 lds
 MF v[32:35],v[48:51],v[80:83]
 TR 42,43,89,25088
 s_waitcnt lgkmcnt(0)
 MF v[4:7],v[36:39],v[52:55]
 RB 68,71,85,49152
 MF v[8:11],v[36:39],v[56:59]
 RB 72,75,85,51200
 DM 40,35840,93,s[16:19],24,sc1 lds
 MF v[12:15],v[36:39],v[60:63]
 RB 76,79,85,53248
 MF v[16:19],v[36:39],v[64:67]
 RB 80,83,85,55296
 MF v[20:23],v[40:43],v[52:55]
 TR 44,45,88,28672
 DM 41,16384,94,s[20:23],25,lds
 MF v[24:27],v[40:43],v[56:59]
 TR 46,47,88,29184
 MF v[28:31],v[40:43],v[60:63]
 TR 48,49,89,28672
 DM 41,17408,95,s[20:23],25,lds
 s_add_u32 s24, s24, 128
 s_add_u32 s25, s25, 458752
 MF v[32:35],v[40:43],v[64:67]
 TR 50,51,89,29184
 s_waitcnt lgkmcnt(0)
 s_waitcnt vmcnt(22)
 s_barrier
 MF v[4:7],v[44:47],v[68:71]
 RB 52,55,86,0
 MF v[8:11],v[44:47],v[72:75]
 RB 56,59,86,2048
 DM 40,49152,90,s[16:19],24,sc1 lds
 MF v[12:15],v[44:47],v[76:79]
 RB 60,63,86,4096
 MF v[16:19],v[44:47],v[80:83]
 RB 64,67,86,6144
 MF v[20:23],v[48:51],v[68:71]
 TR 36,37,88,32768
 DM 40,50176,91,s[16:19],24,sc1 lds
 MF v[24:27],v[48:51],v[72:75]
 TR 38,39,88,33280
 MF v[28:31],v[48:51],v[76:79]
 TR 40,41,89,32768
 DM 40,51200,92,s[16:19],24,sc1 lds
 MF v[32:35],v[48:51],v[80:83]
 TR 42,43,89,33280
 s_waitcnt lgkmcnt(0)
 MF v[4:7],v[36:39],v[52:55]
 RB 68,71,87,0
 MF v[8:11],v[36:39],v[56:59]
 RB 72,75,87,2048
 DM 40,52224,93,s[16:19],24,sc1 lds
 MF v[12:15],v[36:39],v[60:63]
 RB 76,79,87,4096
 MF v[16:19],v[36:39],v[64:67]
 RB 80,83,87,6144
 MF v[20:23],v[40:43],v[52:55]
 TR 44,45,88,36864
 DM 41,24576,94,s[20:23],25,lds
 MF v[24:27],v[40:43],v[56:59]
 TR 46,47,88,37376
 MF v[28:31],v[40:43],v[60:63]
 TR 48,49,89,36864
 DM 41,25600,95,s[20:23],25,lds
 s_add_u32 s24, s24, 128
 s_add_u32 s25, s25, 458752
 MF v[32:35],v[40:43],v[64:67]
 TR 50,51,89,37376
 s_waitcnt lgkmcnt(0)
 s_waitcnt vmcnt(24)
 s_barrier
 MF v[4:7],v[44:47],v[68:71]
 RB 52,55,86,16384
 MF v[8:11],v[44:47],v[72:75]
 RB 56,59,86,18432
 DM 40,65536,90,s[16:19],24,sc1 lds
 MF v[12:15],v[44:47],v[76:79]
 RB 60,63,86,20480
 MF v[16:19],v[44:47],v[80:83]
 RB 64,67,86,22528
 MF v[20:23],v[48:51],v[68:71]
 TR 36,37,88,40960
 DM 40,66560,91,s[16:19],24,sc1 lds
 MF v[24:27],v[48:51],v[72:75]
 TR 38,39,88,41472
 MF v[28:31],v[48:51],v[76:79]
 TR 40,41,89,40960
 DM 40,67584,92,s[16:19],24,sc1 lds
 MF v[32:35],v[48:51],v[80:83]
 TR 42,43,89,41472
 s_waitcnt lgkmcnt(0)
 MF v[4:7],v[36:39],v[52:55]
 RB 68,71,87,16384
 MF v[8:11],v[36:39],v[56:59]
 RB 72,75,87,18432
 DM 40,68608,93,s[16:19],24,sc1 lds
 MF v[12:15],v[36:39],v[60:63]
 RB 76,79,87,20480
 MF v[16:19],v[36:39],v[64:67]
 RB 80,83,87,22528
 MF v[20:23],v[40:43],v[52:55]
 TR 44,45,88,45056
 DM 41,32768,94,s[20:23],25,lds
 MF v[24:27],v[40:43],v[56:59]
 TR 46,47,88,45568
 MF v[28:31],v[40:43],v[60:63]
 TR 48,49,89,45056
 DM 41,33792,95,s[20:23],25,lds
 s_add_u32 s24, s24, 128
 s_add_u32 s25, s25, 458752
 MF v[32:35],v[40:43],v[64:67]
 TR 50,51,89,45568
 s_waitcnt lgkmcnt(0)
 s_waitcnt vmcnt(24)
 s_barrier
 MF v[4:7],v[44:47],v[68:71]
 RB 52,55,84,0
 MF v[8:11],v[44:47],v[72:75]
 RB 56,59,84,2048
 DM 40,81920,90,s[16:19],24,sc1 lds
 MF v[12:15],v[44:47],v[76:79]
 RB 60,63,84,4096
 MF v[16:19],v[44:47],v[80:83]
 RB 64,67,84,6144
 MF v[20:23],v[48:51],v[68:71]
 TR 36,37,88,0
 DM 40,82944,91,s[16:19],24,sc1 lds
 MF v[24:27],v[48:51],v[72:75]
 TR 38,39,88,512
 MF v[28:31],v[48:51],v[76:79]
 TR 40,41,89,0
 DM 40,83968,92,s[16:19],24,sc1 lds
 MF v[32:35],v[48:51],v[80:83]
 TR 42,43,89,512
 s_waitcnt lgkmcnt(0)
 MF v[4:7],v[36:39],v[52:55]
 RB 68,71,85,0
 MF v[8:11],v[36:39],v[56:59]
 RB 72,75,85,2048
 DM 40,84992,93,s[16:19],24,sc1 lds
 MF v[12:15],v[36:39],v[60:63]
 RB 76,79,85,4096
 MF v[16:19],v[36:39],v[64:67]
 RB 80,83,85,6144
 MF v[20:23],v[40:43],v[52:55]
 TR 44,45,88,4096
 DM 41,40960,94,s[20:23],25,lds
 MF v[24:27],v[40:43],v[56:59]
 TR 46,47,88,4608
 MF v[28:31],v[40:43],v[60:63]
 TR 48,49,89,4096
 DM 41,41984,95,s[20:23],25,lds
 s_add_u32 s24, s24, 128
 s_add_u32 s25, s25, 458752
 MF v[32:35],v[40:43],v[64:67]
 TR 50,51,89,4608
 s_waitcnt lgkmcnt(0)
 s_waitcnt vmcnt(24)
 s_barrier
 MF v[4:7],v[44:47],v[68:71]
 RB 52,55,84,16384
 MF v[8:11],v[44:47],v[72:75]
 RB 56,59,84,18432
 DM 40,0,90,s[16:19],24,sc1 lds
 MF v[12:15],v[44:47],v[76:79]
 RB 60,63,84,20480
 MF v[16:19],v[44:47],v[80:83]
 RB 64,67,84,22528
 MF v[20:23],v[48:51],v[68:71]
 TR 36,37,88,8192
 DM 40,1024,91,s[16:19],24,sc1 lds
 MF v[24:27],v[48:51],v[72:75]
 TR 38,39,88,8704
 MF v[28:31],v[48:51],v[76:79]
 TR 40,41,89,8192
 DM 40,2048,92,s[16:19],24,sc1 lds
 MF v[32:35],v[48:51],v[80:83]
 TR 42,43,89,8704
 s_waitcnt lgkmcnt(0)
 MF v[4:7],v[36:39],v[52:55]
 RB 68,71,85,16384
 MF v[8:11],v[36:39],v[56:59]
 RB 72,75,85,18432
 DM 40,3072,93,s[16:19],24,sc1 lds
 MF v[12:15],v[36:39],v[60:63]
 RB 76,79,85,20480
 MF v[16:19],v[36:39],v[64:67]
 RB 80,83,85,22528
 MF v[20:23],v[40:43],v[52:55]
 TR 44,45,88,12288
 DM 41,0,94,s[20:23],25,lds
 MF v[24:27],v[40:43],v[56:59]
 TR 46,47,88,12800
 MF v[28:31],v[40:43],v[60:63]
 TR 48,49,89,12288
 DM 41,1024,95,s[20:23],25,lds
 s_add_u32 s24, s24, 128
 s_add_u32 s25, s25, 458752
 MF v[32:35],v[40:43],v[64:67]
 TR 50,51,89,12800
 s_waitcnt lgkmcnt(0)
 s_waitcnt vmcnt(24)
 s_barrier
 MF v[4:7],v[44:47],v[68:71]
 RB 52,55,84,32768
 MF v[8:11],v[44:47],v[72:75]
 RB 56,59,84,34816
 DM 40,16384,90,s[16:19],24,sc1 lds
 MF v[12:15],v[44:47],v[76:79]
 RB 60,63,84,36864
 MF v[16:19],v[44:47],v[80:83]
 RB 64,67,84,38912
 MF v[20:23],v[48:51],v[68:71]
 TR 36,37,88,16384
 DM 40,17408,91,s[16:19],24,sc1 lds
 MF v[24:27],v[48:51],v[72:75]
 TR 38,39,88,16896
 MF v[28:31],v[48:51],v[76:79]
 TR 40,41,89,16384
 DM 40,18432,92,s[16:19],24,sc1 lds
 MF v[32:35],v[48:51],v[80:83]
 TR 42,43,89,16896
 s_waitcnt lgkmcnt(0)
 MF v[4:7],v[36:39],v[52:55]
 RB 68,71,85,32768
 MF v[8:11],v[36:39],v[56:59]
 RB 72,75,85,34816
 DM 40,19456,93,s[16:19],24,sc1 lds
 MF v[12:15],v[36:39],v[60:63]
 RB 76,79,85,36864
 MF v[16:19],v[36:39],v[64:67]
 RB 80,83,85,38912
 MF v[20:23],v[40:43],v[52:55]
 TR 44,45,88,20480
 DM 41,8192,94,s[20:23],25,lds
 MF v[24:27],v[40:43],v[56:59]
 TR 46,47,88,20992
 MF v[28:31],v[40:43],v[60:63]
 TR 48,49,89,20480
 DM 41,9216,95,s[20:23],25,lds
 s_add_u32 s24, s24, 128
 s_add_u32 s25, s25, 458752
 MF v[32:35],v[40:43],v[64:67]
 TR 50,51,89,20992
 s_waitcnt lgkmcnt(0)
 s_waitcnt vmcnt(24)
 s_barrier
 MF v[4:7],v[44:47],v[68:71]
 RB 52,55,84,49152
 MF v[8:11],v[44:47],v[72:75]
 RB 56,59,84,51200
 DM 40,32768,90,s[16:19],24,sc1 lds
 MF v[12:15],v[44:47],v[76:79]
 RB 60,63,84,53248
 MF v[16:19],v[44:47],v[80:83]
 RB 64,67,84,55296
 MF v[20:23],v[48:51],v[68:71]
 TR 36,37,88,24576
 DM 40,33792,91,s[16:19],24,sc1 lds
 MF v[24:27],v[48:51],v[72:75]
 TR 38,39,88,25088
 MF v[28:31],v[48:51],v[76:79]
 TR 40,41,89,24576
 DM 40,34816,92,s[16:19],24,sc1 lds
 MF v[32:35],v[48:51],v[80:83]
 TR 42,43,89,25088
 s_waitcnt lgkmcnt(0)
 MF v[4:7],v[36:39],v[52:55]
 RB 68,71,85,49152
 MF v[8:11],v[36:39],v[56:59]
 RB 72,75,85,51200
 DM 40,35840,93,s[16:19],24,sc1 lds
 MF v[12:15],v[36:39],v[60:63]
 RB 76,79,85,53248
 MF v[16:19],v[36:39],v[64:67]
 RB 80,83,85,55296
 MF v[20:23],v[40:43],v[52:55]
 TR 44,45,88,28672
 DM 41,16384,94,s[20:23],25,lds
 MF v[24:27],v[40:43],v[56:59]
 TR 46,47,88,29184
 MF v[28:31],v[40:43],v[60:63]
 TR 48,49,89,28672
 DM 41,17408,95,s[20:23],25,lds
 s_add_u32 s24, s24, 128
 s_add_u32 s25, s25, 458752
 MF v[32:35],v[40:43],v[64:67]
 TR 50,51,89,29184
 s_waitcnt lgkmcnt(0)
 s_waitcnt vmcnt(24)
 s_barrier
 MF v[4:7],v[44:47],v[68:71]
 RB 52,55,86,0
 MF v[8:11],v[44:47],v[72:75]
 RB 56,59,86,2048
 DM 40,49152,90,s[16:19],24,sc1 lds
 MF v[12:15],v[44:47],v[76:79]
 RB 60,63,86,4096
 MF v[16:19],v[44:47],v[80:83]
 RB 64,67,86,6144
 MF v[20:23],v[48:51],v[68:71]
 TR 36,37,88,32768
 DM 40,50176,91,s[16:19],24,sc1 lds
 MF v[24:27],v[48:51],v[72:75]
 TR 38,39,88,33280
 MF v[28:31],v[48:51],v[76:79]
 TR 40,41,89,32768
 DM 40,51200,92,s[16:19],24,sc1 lds
 MF v[32:35],v[48:51],v[80:83]
 TR 42,43,89,33280
 s_waitcnt lgkmcnt(0)
 MF v[4:7],v[36:39],v[52:55]
 RB 68,71,87,0
 MF v[8:11],v[36:39],v[56:59]
 RB 72,75,87,2048
 DM 40,52224,93,s[16:19],24,sc1 lds
 MF v[12:15],v[36:39],v[60:63]
 RB 76,79,87,4096
 MF v[16:19],v[36:39],v[64:67]
 RB 80,83,87,6144
 MF v[20:23],v[40:43],v[52:55]
 TR 44,45,88,36864
 DM 41,24576,94,s[20:23],25,lds
 MF v[24:27],v[40:43],v[56:59]
 TR 46,47,88,37376
 MF v[28:31],v[40:43],v[60:63]
 TR 48,49,89,36864
 DM 41,25600,95,s[20:23],25,lds
 s_add_u32 s24, s24, 128
 s_add_u32 s25, s25, 458752
 MF v[32:35],v[40:43],v[64:67]
 TR 50,51,89,37376
 s_waitcnt lgkmcnt(0)
 s_waitcnt vmcnt(24)
 s_barrier
 MF v[4:7],v[44:47],v[68:71]
 RB 52,55,86,16384
 MF v[8:11],v[44:47],v[72:75]
 RB 56,59,86,18432
 MF v[12:15],v[44:47],v[76:79]
 RB 60,63,86,20480
 MF v[16:19],v[44:47],v[80:83]
 RB 64,67,86,22528
 MF v[20:23],v[48:51],v[68:71]
 TR 36,37,88,40960
 MF v[24:27],v[48:51],v[72:75]
 TR 38,39,88,41472
 MF v[28:31],v[48:51],v[76:79]
 TR 40,41,89,40960
 MF v[32:35],v[48:51],v[80:83]
 TR 42,43,89,41472
 s_waitcnt lgkmcnt(0)
 MF v[4:7],v[36:39],v[52:55]
 RB 68,71,87,16384
 MF v[8:11],v[36:39],v[56:59]
 RB 72,75,87,18432
 MF v[12:15],v[36:39],v[60:63]
 RB 76,79,87,20480
 MF v[16:19],v[36:39],v[64:67]
 RB 80,83,87,22528
 MF v[20:23],v[40:43],v[52:55]
 TR 44,45,88,45056
 MF v[24:27],v[40:43],v[56:59]
 TR 46,47,88,45568
 MF v[28:31],v[40:43],v[60:63]
 TR 48,49,89,45056
 MF v[32:35],v[40:43],v[64:67]
 TR 50,51,89,45568
 s_waitcnt lgkmcnt(0)
 s_waitcnt vmcnt(18)
 s_barrier
 MF v[4:7],v[44:47],v[68:71]
 RB 52,55,84,0
 MF v[8:11],v[44:47],v[72:75]
 RB 56,59,84,2048
 MF v[12:15],v[44:47],v[76:79]
 RB 60,63,84,4096
 MF v[16:19],v[44:47],v[80:83]
 RB 64,67,84,6144
 MF v[20:23],v[48:51],v[68:71]
 TR 36,37,88,0
 MF v[24:27],v[48:51],v[72:75]
 TR 38,39,88,512
 MF v[28:31],v[48:51],v[76:79]
 TR 40,41,89,0
 MF v[32:35],v[48:51],v[80:83]
 TR 42,43,89,512
 s_waitcnt lgkmcnt(0)
 MF v[4:7],v[36:39],v[52:55]
 RB 68,71,85,0
 MF v[8:11],v[36:39],v[56:59]
 RB 72,75,85,2048
 MF v[12:15],v[36:39],v[60:63]
 RB 76,79,85,4096
 MF v[16:19],v[36:39],v[64:67]
 RB 80,83,85,6144
 MF v[20:23],v[40:43],v[52:55]
 TR 44,45,88,4096
 MF v[24:27],v[40:43],v[56:59]
 TR 46,47,88,4608
 MF v[28:31],v[40:43],v[60:63]
 TR 48,49,89,4096
 MF v[32:35],v[40:43],v[64:67]
 TR 50,51,89,4608
 s_waitcnt lgkmcnt(0)
 s_waitcnt vmcnt(12)
 s_barrier
 MF v[4:7],v[44:47],v[68:71]
 RB 52,55,84,16384
 MF v[8:11],v[44:47],v[72:75]
 RB 56,59,84,18432
 MF v[12:15],v[44:47],v[76:79]
 RB 60,63,84,20480
 MF v[16:19],v[44:47],v[80:83]
 RB 64,67,84,22528
 MF v[20:23],v[48:51],v[68:71]
 TR 36,37,88,8192
 MF v[24:27],v[48:51],v[72:75]
 TR 38,39,88,8704
 MF v[28:31],v[48:51],v[76:79]
 TR 40,41,89,8192
 MF v[32:35],v[48:51],v[80:83]
 TR 42,43,89,8704
 s_waitcnt lgkmcnt(0)
 MF v[4:7],v[36:39],v[52:55]
 RB 68,71,85,16384
 MF v[8:11],v[36:39],v[56:59]
 RB 72,75,85,18432
 MF v[12:15],v[36:39],v[60:63]
 RB 76,79,85,20480
 MF v[16:19],v[36:39],v[64:67]
 RB 80,83,85,22528
 MF v[20:23],v[40:43],v[52:55]
 TR 44,45,88,12288
 MF v[24:27],v[40:43],v[56:59]
 TR 46,47,88,12800
 MF v[28:31],v[40:43],v[60:63]
 TR 48,49,89,12288
 MF v[32:35],v[40:43],v[64:67]
 TR 50,51,89,12800
 s_waitcnt lgkmcnt(0)
 s_waitcnt vmcnt(6)
 s_barrier
 MF v[4:7],v[44:47],v[68:71]
 RB 52,55,84,32768
 MF v[8:11],v[44:47],v[72:75]
 RB 56,59,84,34816
 MF v[12:15],v[44:47],v[76:79]
 RB 60,63,84,36864
 MF v[16:19],v[44:47],v[80:83]
 RB 64,67,84,38912
 MF v[20:23],v[48:51],v[68:71]
 TR 36,37,88,16384
 MF v[24:27],v[48:51],v[72:75]
 TR 38,39,88,16896
 MF v[28:31],v[48:51],v[76:79]
 TR 40,41,89,16384
 MF v[32:35],v[48:51],v[80:83]
 TR 42,43,89,16896
 s_waitcnt lgkmcnt(0)
 MF v[4:7],v[36:39],v[52:55]
 RB 68,71,85,32768
 MF v[8:11],v[36:39],v[56:59]
 RB 72,75,85,34816
 MF v[12:15],v[36:39],v[60:63]
 RB 76,79,85,36864
 MF v[16:19],v[36:39],v[64:67]
 RB 80,83,85,38912
 MF v[20:23],v[40:43],v[52:55]
 TR 44,45,88,20480
 MF v[24:27],v[40:43],v[56:59]
 TR 46,47,88,20992
 MF v[28:31],v[40:43],v[60:63]
 TR 48,49,89,20480
 MF v[32:35],v[40:43],v[64:67]
 TR 50,51,89,20992
 s_waitcnt lgkmcnt(0)
 s_waitcnt vmcnt(0)
 s_barrier
 MF v[4:7],v[44:47],v[68:71]
 RB 52,55,84,49152
 MF v[8:11],v[44:47],v[72:75]
 RB 56,59,84,51200
 MF v[12:15],v[44:47],v[76:79]
 RB 60,63,84,53248
 MF v[16:19],v[44:47],v[80:83]
 RB 64,67,84,55296
 MF v[20:23],v[48:51],v[68:71]
 TR 36,37,88,24576
 MF v[24:27],v[48:51],v[72:75]
 TR 38,39,88,25088
 MF v[28:31],v[48:51],v[76:79]
 TR 40,41,89,24576
 MF v[32:35],v[48:51],v[80:83]
 TR 42,43,89,25088
 s_waitcnt lgkmcnt(0)
 MF v[4:7],v[36:39],v[52:55]
 RB 68,71,85,49152
 MF v[8:11],v[36:39],v[56:59]
 RB 72,75,85,51200
 MF v[12:15],v[36:39],v[60:63]
 RB 76,79,85,53248
 MF v[16:19],v[36:39],v[64:67]
 RB 80,83,85,55296
 MF v[20:23],v[40:43],v[52:55]
 TR 44,45,88,28672
 MF v[24:27],v[40:43],v[56:59]
 TR 46,47,88,29184
 MF v[28:31],v[40:43],v[60:63]
 TR 48,49,89,28672
 MF v[32:35],v[40:43],v[64:67]
 TR 50,51,89,29184
 s_waitcnt lgkmcnt(0)
 MF v[4:7],v[44:47],v[68:71]
 MF v[8:11],v[44:47],v[72:75]
 MF v[12:15],v[44:47],v[76:79]
 MF v[16:19],v[44:47],v[80:83]
 MF v[20:23],v[48:51],v[68:71]
 MF v[24:27],v[48:51],v[72:75]
 MF v[28:31],v[48:51],v[76:79]
 MF v[32:35],v[48:51],v[80:83]
 v_and_b32 v3, 15, v2
 v_mul_u32_u24 v3, 7168, v3
 v_lshrrev_b32 v1, 4, v2
 v_lshl_add_u32 v3, v1, 4, v3
 s_mul_i32 s26, s10, 128
 s_mul_i32 s27, s43, 64
 s_add_u32 s26, s26, s27
 s_mul_i32 s26, s26, 7168
 s_mul_i32 s27, s11, 128
 s_add_u32 s26, s26, s27
 s_mul_i32 s27, s44, 64
 s_add_u32 s26, s26, s27
 s_add_u32 s26, s26, 62914560
 s_mov_b32 s28, 0xbfb8aa3b
 s_nop 4
 CV 52,4,5
 v_lshlrev_b32 v4, 16, v52
 v_and_b32 v5, 0xffff0000, v52
 CV 52,6,7
 v_lshlrev_b32 v6, 16, v52
 v_and_b32 v7, 0xffff0000, v52
 v_mul_f32 v52, s28, v4
 v_mul_f32 v53, s28, v5
 v_mul_f32 v54, s28, v6
 v_mul_f32 v55, s28, v7
 v_exp_f32 v52, v52
 v_exp_f32 v53, v53
 v_exp_f32 v54, v54
 v_exp_f32 v55, v55
 s_nop 0
 v_add_f32 v52, 1.0, v52
 v_add_f32 v53, 1.0, v53
 v_add_f32 v54, 1.0, v54
 v_add_f32 v55, 1.0, v55
 v_rcp_f32 v52, v52
 v_rcp_f32 v53, v53
 v_rcp_f32 v54, v54
 v_rcp_f32 v55, v55
 s_nop 0
 v_mul_f32 v4, v4, v52
 v_mul_f32 v5, v5, v53
 v_mul_f32 v6, v6, v54
 v_mul_f32 v7, v7, v55
 CV 36,4,5
 CV 37,6,7
 CV 52,20,21
 v_lshlrev_b32 v20, 16, v52
 v_and_b32 v21, 0xffff0000, v52
 CV 52,22,23
 v_lshlrev_b32 v22, 16, v52
 v_and_b32 v23, 0xffff0000, v52
 v_mul_f32 v52, s28, v20
 v_mul_f32 v53, s28, v21
 v_mul_f32 v54, s28, v22
 v_mul_f32 v55, s28, v23
 v_exp_f32 v52, v52
 v_exp_f32 v53, v53
 v_exp_f32 v54, v54
 v_exp_f32 v55, v55
 s_nop 0
 v_add_f32 v52, 1.0, v52
 v_add_f32 v53, 1.0, v53
 v_add_f32 v54, 1.0, v54
 v_add_f32 v55, 1.0, v55
 v_rcp_f32 v52, v52
 v_rcp_f32 v53, v53
 v_rcp_f32 v54, v54
 v_rcp_f32 v55, v55
 s_nop 0
 v_mul_f32 v20, v20, v52
 v_mul_f32 v21, v21, v53
 v_mul_f32 v22, v22, v54
 v_mul_f32 v23, v23, v55
 CV 38,20,21
 CV 39,22,23
 buffer_store_dwordx4 v[36:39], v3, s[16:19], s26 offen offset:0 sc1
 s_add_u32 s26, s26, 114688
 CV 52,8,9
 v_lshlrev_b32 v8, 16, v52
 v_and_b32 v9, 0xffff0000, v52
 CV 52,10,11
 v_lshlrev_b32 v10, 16, v52
 v_and_b32 v11, 0xffff0000, v52
 v_mul_f32 v52, s28, v8
 v_mul_f32 v53, s28, v9
 v_mul_f32 v54, s28, v10
 v_mul_f32 v55, s28, v11
 v_exp_f32 v52, v52
 v_exp_f32 v53, v53
 v_exp_f32 v54, v54
 v_exp_f32 v55, v55
 s_nop 0
 v_add_f32 v52, 1.0, v52
 v_add_f32 v53, 1.0, v53
 v_add_f32 v54, 1.0, v54
 v_add_f32 v55, 1.0, v55
 v_rcp_f32 v52, v52
 v_rcp_f32 v53, v53
 v_rcp_f32 v54, v54
 v_rcp_f32 v55, v55
 s_nop 0
 v_mul_f32 v8, v8, v52
 v_mul_f32 v9, v9, v53
 v_mul_f32 v10, v10, v54
 v_mul_f32 v11, v11, v55
 CV 40,8,9
 CV 41,10,11
 CV 52,24,25
 v_lshlrev_b32 v24, 16, v52
 v_and_b32 v25, 0xffff0000, v52
 CV 52,26,27
 v_lshlrev_b32 v26, 16, v52
 v_and_b32 v27, 0xffff0000, v52
 v_mul_f32 v52, s28, v24
 v_mul_f32 v53, s28, v25
 v_mul_f32 v54, s28, v26
 v_mul_f32 v55, s28, v27
 v_exp_f32 v52, v52
 v_exp_f32 v53, v53
 v_exp_f32 v54, v54
 v_exp_f32 v55, v55
 s_nop 0
 v_add_f32 v52, 1.0, v52
 v_add_f32 v53, 1.0, v53
 v_add_f32 v54, 1.0, v54
 v_add_f32 v55, 1.0, v55
 v_rcp_f32 v52, v52
 v_rcp_f32 v53, v53
 v_rcp_f32 v54, v54
 v_rcp_f32 v55, v55
 s_nop 0
 v_mul_f32 v24, v24, v52
 v_mul_f32 v25, v25, v53
 v_mul_f32 v26, v26, v54
 v_mul_f32 v27, v27, v55
 CV 42,24,25
 CV 43,26,27
 buffer_store_dwordx4 v[40:43], v3, s[16:19], s26 offen offset:0 sc1
 s_add_u32 s26, s26, 114688
 CV 52,12,13
 v_lshlrev_b32 v12, 16, v52
 v_and_b32 v13, 0xffff0000, v52
 CV 52,14,15
 v_lshlrev_b32 v14, 16, v52
 v_and_b32 v15, 0xffff0000, v52
 v_mul_f32 v52, s28, v12
 v_mul_f32 v53, s28, v13
 v_mul_f32 v54, s28, v14
 v_mul_f32 v55, s28, v15
 v_exp_f32 v52, v52
 v_exp_f32 v53, v53
 v_exp_f32 v54, v54
 v_exp_f32 v55, v55
 s_nop 0
 v_add_f32 v52, 1.0, v52
 v_add_f32 v53, 1.0, v53
 v_add_f32 v54, 1.0, v54
 v_add_f32 v55, 1.0, v55
 v_rcp_f32 v52, v52
 v_rcp_f32 v53, v53
 v_rcp_f32 v54, v54
 v_rcp_f32 v55, v55
 s_nop 0
 v_mul_f32 v12, v12, v52
 v_mul_f32 v13, v13, v53
 v_mul_f32 v14, v14, v54
 v_mul_f32 v15, v15, v55
 CV 44,12,13
 CV 45,14,15
 CV 52,28,29
 v_lshlrev_b32 v28, 16, v52
 v_and_b32 v29, 0xffff0000, v52
 CV 52,30,31
 v_lshlrev_b32 v30, 16, v52
 v_and_b32 v31, 0xffff0000, v52
 v_mul_f32 v52, s28, v28
 v_mul_f32 v53, s28, v29
 v_mul_f32 v54, s28, v30
 v_mul_f32 v55, s28, v31
 v_exp_f32 v52, v52
 v_exp_f32 v53, v53
 v_exp_f32 v54, v54
 v_exp_f32 v55, v55
 s_nop 0
 v_add_f32 v52, 1.0, v52
 v_add_f32 v53, 1.0, v53
 v_add_f32 v54, 1.0, v54
 v_add_f32 v55, 1.0, v55
 v_rcp_f32 v52, v52
 v_rcp_f32 v53, v53
 v_rcp_f32 v54, v54
 v_rcp_f32 v55, v55
 s_nop 0
 v_mul_f32 v28, v28, v52
 v_mul_f32 v29, v29, v53
 v_mul_f32 v30, v30, v54
 v_mul_f32 v31, v31, v55
 CV 46,28,29
 CV 47,30,31
 buffer_store_dwordx4 v[44:47], v3, s[16:19], s26 offen offset:0 sc1
 s_add_u32 s26, s26, 114688
 CV 52,16,17
 v_lshlrev_b32 v16, 16, v52
 v_and_b32 v17, 0xffff0000, v52
 CV 52,18,19
 v_lshlrev_b32 v18, 16, v52
 v_and_b32 v19, 0xffff0000, v52
 v_mul_f32 v52, s28, v16
 v_mul_f32 v53, s28, v17
 v_mul_f32 v54, s28, v18
 v_mul_f32 v55, s28, v19
 v_exp_f32 v52, v52
 v_exp_f32 v53, v53
 v_exp_f32 v54, v54
 v_exp_f32 v55, v55
 s_nop 0
 v_add_f32 v52, 1.0, v52
 v_add_f32 v53, 1.0, v53
 v_add_f32 v54, 1.0, v54
 v_add_f32 v55, 1.0, v55
 v_rcp_f32 v52, v52
 v_rcp_f32 v53, v53
 v_rcp_f32 v54, v54
 v_rcp_f32 v55, v55
 s_nop 0
 v_mul_f32 v16, v16, v52
 v_mul_f32 v17, v17, v53
 v_mul_f32 v18, v18, v54
 v_mul_f32 v19, v19, v55
 CV 48,16,17
 CV 49,18,19
 CV 52,32,33
 v_lshlrev_b32 v32, 16, v52
 v_and_b32 v33, 0xffff0000, v52
 CV 52,34,35
 v_lshlrev_b32 v34, 16, v52
 v_and_b32 v35, 0xffff0000, v52
 v_mul_f32 v52, s28, v32
 v_mul_f32 v53, s28, v33
 v_mul_f32 v54, s28, v34
 v_mul_f32 v55, s28, v35
 v_exp_f32 v52, v52
 v_exp_f32 v53, v53
 v_exp_f32 v54, v54
 v_exp_f32 v55, v55
 s_nop 0
 v_add_f32 v52, 1.0, v52
 v_add_f32 v53, 1.0, v53
 v_add_f32 v54, 1.0, v54
 v_add_f32 v55, 1.0, v55
 v_rcp_f32 v52, v52
 v_rcp_f32 v53, v53
 v_rcp_f32 v54, v54
 v_rcp_f32 v55, v55
 s_nop 0
 v_mul_f32 v32, v32, v52
 v_mul_f32 v33, v33, v53
 v_mul_f32 v34, v34, v54
 v_mul_f32 v35, v35, v55
 CV 50,32,33
 CV 51,34,35
 buffer_store_dwordx4 v[48:51], v3, s[16:19], s26 offen offset:0 sc1
 s_add_u32 s26, s26, 114688
 s_branch mk_done
mk_b_f1:
 s_bitcmp1_b32 s82, 24
 s_cbranch_scc1 mk_b_f1l
 s_cmp_ge_u32 s11, 28
 s_cbranch_scc1 mk_skip
 s_load_dwordx2 s[4:5], s[0:1], 64
 s_waitcnt lgkmcnt(0)
 s_mov_b32 s20, s4
 s_and_b32 s21, s5, 0xffff
 s_mov_b32 s22, 0x700000
 s_mov_b32 s23, 0x00020000
 s_mul_i32 s24, s10, 262144
 s_add_u32 s24, s24, 58720256
 s_mul_i32 s25, s11, 256
 s_lshr_b32 s43, s13, 1
 s_and_b32 s44, s13, 1
 v_and_b32 v148, 15, v2
 v_lshrrev_b32 v149, 4, v2
 v_lshrrev_b32 v150, 1, v148
 v_xor_b32 v150, v150, v149
 v_mov_b32 v151, v148
 s_mul_i32 s45, s43, 8192
 s_add_u32 s45, s45, 0
 v_lshlrev_b32 v151, 7, v151
 v_add_u32 v151, s45, v151
 v_lshlrev_b32 v152, 4, v150
 v_add_u32 v132, v151, v152
 v_xor_b32 v152, 64, v152
 v_add_u32 v133, v151, v152
 v_lshrrev_b32 v150, 2, v148
 v_and_b32 v151, 3, v2
 v_and_b32 v152, 1, v149
 v_lshlrev_b32 v152, 2, v152
 v_or_b32 v152, v152, v150
 v_lshlrev_b32 v149, 3, v149
 v_add_u32 v149, v149, v150
 v_mul_u32_u24 v149, 256, v149
 v_lshlrev_b32 v151, 3, v151
 v_add_u32 v149, v149, v151
 v_add_u32 v149, 65536, v149
 s_mul_i32 s45, s44, 4
 s_add_u32 s46, s45, 0
 v_xor_b32 v150, s46, v152
 v_lshlrev_b32 v150, 5, v150
 v_add_u32 v136, v149, v150
 s_add_u32 s46, s45, 1
 v_xor_b32 v150, s46, v152
 v_lshlrev_b32 v150, 5, v150
 v_add_u32 v137, v149, v150
 s_add_u32 s46, s45, 2
 v_xor_b32 v150, s46, v152
 v_lshlrev_b32 v150, 5, v150
 v_add_u32 v138, v149, v150
 s_add_u32 s46, s45, 3
 v_xor_b32 v150, s46, v152
 v_lshlrev_b32 v150, 5, v150
 v_add_u32 v139, v149, v150
 v_lshrrev_b32 v148, 3, v2
 v_and_b32 v149, 7, v2
 s_mul_i32 s45, s13, 4
 s_add_u32 s46, s45, 0
 s_lshl_b32 s47, s46, 3
 v_add_u32 v150, s47, v148
 v_bfe_u32 v151, v150, 1, 3
 v_xor_b32 v151, v151, v149
 v_lshlrev_b32 v151, 4, v151
 v_mul_u32_u24 v150, 2048, v150
 v_add_u32 v140, v150, v151
 s_add_u32 s46, s45, 1
 s_lshl_b32 s47, s46, 3
 v_add_u32 v150, s47, v148
 v_bfe_u32 v151, v150, 1, 3
 v_xor_b32 v151, v151, v149
 v_lshlrev_b32 v151, 4, v151
 v_mul_u32_u24 v150, 2048, v150
 v_add_u32 v141, v150, v151
 s_add_u32 s46, s45, 2
 s_lshl_b32 s47, s46, 3
 v_add_u32 v150, s47, v148
 v_bfe_u32 v151, v150, 1, 3
 v_xor_b32 v151, v151, v149
 v_lshlrev_b32 v151, 4, v151
 v_mul_u32_u24 v150, 2048, v150
 v_add_u32 v142, v150, v151
 s_add_u32 s46, s45, 3
 s_lshl_b32 s47, s46, 3
 v_add_u32 v150, s47, v148
 v_bfe_u32 v151, v150, 1, 3
 v_xor_b32 v151, v151, v149
 v_lshlrev_b32 v151, 4, v151
 v_mul_u32_u24 v150, 2048, v150
 v_add_u32 v143, v150, v151
 s_mul_i32 s40, s13, 4096
 s_add_u32 s40, s40, 0
 v_lshlrev_b32 v148, 4, v2
 s_mul_i32 s45, s13, 4096
 s_add_u32 s46, s45, 0
 v_add_u32 v149, s46, v148
 v_lshrrev_b32 v150, 8, v149
 v_and_b32 v149, 255, v149
 v_bfe_u32 v152, v150, 3, 1
 v_and_b32 v151, 3, v150
 v_lshlrev_b32 v152, 2, v152
 v_or_b32 v151, v151, v152
 v_lshlrev_b32 v151, 5, v151
 v_xor_b32 v149, v149, v151
 v_mul_u32_u24 v150, 7168, v150
 v_add_u32 v144, v150, v149
 s_add_u32 s46, s45, 1024
 v_add_u32 v149, s46, v148
 v_lshrrev_b32 v150, 8, v149
 v_and_b32 v149, 255, v149
 v_bfe_u32 v152, v150, 3, 1
 v_and_b32 v151, 3, v150
 v_lshlrev_b32 v152, 2, v152
 v_or_b32 v151, v151, v152
 v_lshlrev_b32 v151, 5, v151
 v_xor_b32 v149, v149, v151
 v_mul_u32_u24 v150, 7168, v150
 v_add_u32 v145, v150, v149
 s_add_u32 s46, s45, 2048
 v_add_u32 v149, s46, v148
 v_lshrrev_b32 v150, 8, v149
 v_and_b32 v149, 255, v149
 v_bfe_u32 v152, v150, 3, 1
 v_and_b32 v151, 3, v150
 v_lshlrev_b32 v152, 2, v152
 v_or_b32 v151, v151, v152
 v_lshlrev_b32 v151, 5, v151
 v_xor_b32 v149, v149, v151
 v_mul_u32_u24 v150, 7168, v150
 v_add_u32 v146, v150, v149
 s_add_u32 s46, s45, 3072
 v_add_u32 v149, s46, v148
 v_lshrrev_b32 v150, 8, v149
 v_and_b32 v149, 255, v149
 v_bfe_u32 v152, v150, 3, 1
 v_and_b32 v151, 3, v150
 v_lshlrev_b32 v152, 2, v152
 v_or_b32 v151, v151, v152
 v_lshlrev_b32 v151, 5, v151
 v_xor_b32 v149, v149, v151
 v_mul_u32_u24 v150, 7168, v150
 v_add_u32 v147, v150, v149
 s_mul_i32 s41, s13, 4096
 s_add_u32 s41, s41, 65536
 v_mov_b32 v4, 0
 v_mov_b32 v5, 0
 v_mov_b32 v6, 0
 v_mov_b32 v7, 0
 v_mov_b32 v8, 0
 v_mov_b32 v9, 0
 v_mov_b32 v10, 0
 v_mov_b32 v11, 0
 v_mov_b32 v12, 0
 v_mov_b32 v13, 0
 v_mov_b32 v14, 0
 v_mov_b32 v15, 0
 v_mov_b32 v16, 0
 v_mov_b32 v17, 0
 v_mov_b32 v18, 0
 v_mov_b32 v19, 0
 v_mov_b32 v20, 0
 v_mov_b32 v21, 0
 v_mov_b32 v22, 0
 v_mov_b32 v23, 0
 v_mov_b32 v24, 0
 v_mov_b32 v25, 0
 v_mov_b32 v26, 0
 v_mov_b32 v27, 0
 v_mov_b32 v28, 0
 v_mov_b32 v29, 0
 v_mov_b32 v30, 0
 v_mov_b32 v31, 0
 v_mov_b32 v32, 0
 v_mov_b32 v33, 0
 v_mov_b32 v34, 0
 v_mov_b32 v35, 0
 v_mov_b32 v36, 0
 v_mov_b32 v37, 0
 v_mov_b32 v38, 0
 v_mov_b32 v39, 0
 v_mov_b32 v40, 0
 v_mov_b32 v41, 0
 v_mov_b32 v42, 0
 v_mov_b32 v43, 0
 v_mov_b32 v44, 0
 v_mov_b32 v45, 0
 v_mov_b32 v46, 0
 v_mov_b32 v47, 0
 v_mov_b32 v48, 0
 v_mov_b32 v49, 0
 v_mov_b32 v50, 0
 v_mov_b32 v51, 0
 v_mov_b32 v52, 0
 v_mov_b32 v53, 0
 v_mov_b32 v54, 0
 v_mov_b32 v55, 0
 v_mov_b32 v56, 0
 v_mov_b32 v57, 0
 v_mov_b32 v58, 0
 v_mov_b32 v59, 0
 v_mov_b32 v60, 0
 v_mov_b32 v61, 0
 v_mov_b32 v62, 0
 v_mov_b32 v63, 0
 v_mov_b32 v64, 0
 v_mov_b32 v65, 0
 v_mov_b32 v66, 0
 v_mov_b32 v67, 0
 DM 40,0,140,s[16:19],24,sc1 lds
 DM 40,1024,141,s[16:19],24,sc1 lds
 DM 40,2048,142,s[16:19],24,sc1 lds
 DM 40,3072,143,s[16:19],24,sc1 lds
 DM 41,0,144,s[20:23],25,lds
 DM 41,1024,145,s[20:23],25,lds
 DM 41,2048,146,s[20:23],25,lds
 DM 41,3072,147,s[20:23],25,lds
 s_add_u32 s24, s24, 128
 s_add_u32 s25, s25, 458752
 DM 40,16384,140,s[16:19],24,sc1 lds
 DM 40,17408,141,s[16:19],24,sc1 lds
 DM 40,18432,142,s[16:19],24,sc1 lds
 DM 40,19456,143,s[16:19],24,sc1 lds
 DM 41,16384,144,s[20:23],25,lds
 DM 41,17408,145,s[20:23],25,lds
 DM 41,18432,146,s[20:23],25,lds
 DM 41,19456,147,s[20:23],25,lds
 s_add_u32 s24, s24, 128
 s_add_u32 s25, s25, 458752
 DM 40,32768,140,s[16:19],24,sc1 lds
 DM 40,33792,141,s[16:19],24,sc1 lds
 DM 40,34816,142,s[16:19],24,sc1 lds
 DM 40,35840,143,s[16:19],24,sc1 lds
 DM 41,32768,144,s[20:23],25,lds
 DM 41,33792,145,s[20:23],25,lds
 DM 41,34816,146,s[20:23],25,lds
 DM 41,35840,147,s[20:23],25,lds
 s_add_u32 s24, s24, 128
 s_add_u32 s25, s25, 458752
 DM 40,49152,140,s[16:19],24,sc1 lds
 DM 40,50176,141,s[16:19],24,sc1 lds
 DM 40,51200,142,s[16:19],24,sc1 lds
 DM 40,52224,143,s[16:19],24,sc1 lds
 DM 41,49152,144,s[20:23],25,lds
 DM 41,50176,145,s[20:23],25,lds
 DM 41,51200,146,s[20:23],25,lds
 DM 41,52224,147,s[20:23],25,lds
 s_add_u32 s24, s24, 128
 s_add_u32 s25, s25, 458752
 s_waitcnt vmcnt(24)
 s_barrier
 RB 100,103,132,0
 RB 104,107,132,2048
 RB 108,111,132,4096
 RB 112,115,132,6144
 TR 68,69,136,0
 TR 70,71,136,1024
 TR 72,73,137,0
 TR 74,75,137,1024
 TR 76,77,138,0
 TR 78,79,138,1024
 TR 80,81,139,0
 TR 82,83,139,1024
 s_waitcnt lgkmcnt(0)
 MF v[4:7],v[68:71],v[100:103]
 RB 116,119,133,0
 MF v[8:11],v[68:71],v[104:107]
 RB 120,123,133,2048
 MF v[12:15],v[68:71],v[108:111]
 RB 124,127,133,4096
 MF v[16:19],v[68:71],v[112:115]
 RB 128,131,133,6144
 MF v[20:23],v[72:75],v[100:103]
 TR 84,85,136,8192
 MF v[24:27],v[72:75],v[104:107]
 TR 86,87,136,9216
 MF v[28:31],v[72:75],v[108:111]
 TR 88,89,137,8192
 MF v[32:35],v[72:75],v[112:115]
 TR 90,91,137,9216
 MF v[36:39],v[76:79],v[100:103]
 TR 92,93,138,8192
 MF v[40:43],v[76:79],v[104:107]
 TR 94,95,138,9216
 MF v[44:47],v[76:79],v[108:111]
 TR 96,97,139,8192
 MF v[48:51],v[76:79],v[112:115]
 TR 98,99,139,9216
 MF v[52:55],v[80:83],v[100:103]
 MF v[56:59],v[80:83],v[104:107]
 MF v[60:63],v[80:83],v[108:111]
 MF v[64:67],v[80:83],v[112:115]
 s_waitcnt lgkmcnt(0)
 s_waitcnt vmcnt(16)
 s_barrier
 MF v[4:7],v[84:87],v[116:119]
 RB 100,103,132,16384
 MF v[8:11],v[84:87],v[120:123]
 RB 104,107,132,18432
 MF v[12:15],v[84:87],v[124:127]
 RB 108,111,132,20480
 DM 40,0,140,s[16:19],24,sc1 lds
 MF v[16:19],v[84:87],v[128:131]
 RB 112,115,132,22528
 MF v[20:23],v[88:91],v[116:119]
 TR 68,69,136,16384
 MF v[24:27],v[88:91],v[120:123]
 TR 70,71,136,17408
 MF v[28:31],v[88:91],v[124:127]
 TR 72,73,137,16384
 DM 40,1024,141,s[16:19],24,sc1 lds
 MF v[32:35],v[88:91],v[128:131]
 TR 74,75,137,17408
 MF v[36:39],v[92:95],v[116:119]
 TR 76,77,138,16384
 MF v[40:43],v[92:95],v[120:123]
 TR 78,79,138,17408
 MF v[44:47],v[92:95],v[124:127]
 TR 80,81,139,16384
 DM 40,2048,142,s[16:19],24,sc1 lds
 MF v[48:51],v[92:95],v[128:131]
 TR 82,83,139,17408
 MF v[52:55],v[96:99],v[116:119]
 MF v[56:59],v[96:99],v[120:123]
 MF v[60:63],v[96:99],v[124:127]
 DM 40,3072,143,s[16:19],24,sc1 lds
 MF v[64:67],v[96:99],v[128:131]
 s_waitcnt lgkmcnt(0)
 MF v[4:7],v[68:71],v[100:103]
 RB 116,119,133,16384
 MF v[8:11],v[68:71],v[104:107]
 RB 120,123,133,18432
 MF v[12:15],v[68:71],v[108:111]
 RB 124,127,133,20480
 DM 41,0,144,s[20:23],25,lds
 MF v[16:19],v[68:71],v[112:115]
 RB 128,131,133,22528
 MF v[20:23],v[72:75],v[100:103]
 TR 84,85,136,24576
 MF v[24:27],v[72:75],v[104:107]
 TR 86,87,136,25600
 MF v[28:31],v[72:75],v[108:111]
 TR 88,89,137,24576
 DM 41,1024,145,s[20:23],25,lds
 MF v[32:35],v[72:75],v[112:115]
 TR 90,91,137,25600
 MF v[36:39],v[76:79],v[100:103]
 TR 92,93,138,24576
 MF v[40:43],v[76:79],v[104:107]
 TR 94,95,138,25600
 MF v[44:47],v[76:79],v[108:111]
 TR 96,97,139,24576
 DM 41,2048,146,s[20:23],25,lds
 MF v[48:51],v[76:79],v[112:115]
 TR 98,99,139,25600
 MF v[52:55],v[80:83],v[100:103]
 MF v[56:59],v[80:83],v[104:107]
 MF v[60:63],v[80:83],v[108:111]
 DM 41,3072,147,s[20:23],25,lds
 s_add_u32 s24, s24, 128
 s_add_u32 s25, s25, 458752
 MF v[64:67],v[80:83],v[112:115]
 s_waitcnt lgkmcnt(0)
 s_waitcnt vmcnt(16)
 s_barrier
 MF v[4:7],v[84:87],v[116:119]
 RB 100,103,132,32768
 MF v[8:11],v[84:87],v[120:123]
 RB 104,107,132,34816
 MF v[12:15],v[84:87],v[124:127]
 RB 108,111,132,36864
 DM 40,16384,140,s[16:19],24,sc1 lds
 MF v[16:19],v[84:87],v[128:131]
 RB 112,115,132,38912
 MF v[20:23],v[88:91],v[116:119]
 TR 68,69,136,32768
 MF v[24:27],v[88:91],v[120:123]
 TR 70,71,136,33792
 MF v[28:31],v[88:91],v[124:127]
 TR 72,73,137,32768
 DM 40,17408,141,s[16:19],24,sc1 lds
 MF v[32:35],v[88:91],v[128:131]
 TR 74,75,137,33792
 MF v[36:39],v[92:95],v[116:119]
 TR 76,77,138,32768
 MF v[40:43],v[92:95],v[120:123]
 TR 78,79,138,33792
 MF v[44:47],v[92:95],v[124:127]
 TR 80,81,139,32768
 DM 40,18432,142,s[16:19],24,sc1 lds
 MF v[48:51],v[92:95],v[128:131]
 TR 82,83,139,33792
 MF v[52:55],v[96:99],v[116:119]
 MF v[56:59],v[96:99],v[120:123]
 MF v[60:63],v[96:99],v[124:127]
 DM 40,19456,143,s[16:19],24,sc1 lds
 MF v[64:67],v[96:99],v[128:131]
 s_waitcnt lgkmcnt(0)
 MF v[4:7],v[68:71],v[100:103]
 RB 116,119,133,32768
 MF v[8:11],v[68:71],v[104:107]
 RB 120,123,133,34816
 MF v[12:15],v[68:71],v[108:111]
 RB 124,127,133,36864
 DM 41,16384,144,s[20:23],25,lds
 MF v[16:19],v[68:71],v[112:115]
 RB 128,131,133,38912
 MF v[20:23],v[72:75],v[100:103]
 TR 84,85,136,40960
 MF v[24:27],v[72:75],v[104:107]
 TR 86,87,136,41984
 MF v[28:31],v[72:75],v[108:111]
 TR 88,89,137,40960
 DM 41,17408,145,s[20:23],25,lds
 MF v[32:35],v[72:75],v[112:115]
 TR 90,91,137,41984
 MF v[36:39],v[76:79],v[100:103]
 TR 92,93,138,40960
 MF v[40:43],v[76:79],v[104:107]
 TR 94,95,138,41984
 MF v[44:47],v[76:79],v[108:111]
 TR 96,97,139,40960
 DM 41,18432,146,s[20:23],25,lds
 MF v[48:51],v[76:79],v[112:115]
 TR 98,99,139,41984
 MF v[52:55],v[80:83],v[100:103]
 MF v[56:59],v[80:83],v[104:107]
 MF v[60:63],v[80:83],v[108:111]
 DM 41,19456,147,s[20:23],25,lds
 s_add_u32 s24, s24, 128
 s_add_u32 s25, s25, 458752
 MF v[64:67],v[80:83],v[112:115]
 s_waitcnt lgkmcnt(0)
 s_waitcnt vmcnt(16)
 s_barrier
 MF v[4:7],v[84:87],v[116:119]
 RB 100,103,132,49152
 MF v[8:11],v[84:87],v[120:123]
 RB 104,107,132,51200
 MF v[12:15],v[84:87],v[124:127]
 RB 108,111,132,53248
 DM 40,32768,140,s[16:19],24,sc1 lds
 MF v[16:19],v[84:87],v[128:131]
 RB 112,115,132,55296
 MF v[20:23],v[88:91],v[116:119]
 TR 68,69,136,49152
 MF v[24:27],v[88:91],v[120:123]
 TR 70,71,136,50176
 MF v[28:31],v[88:91],v[124:127]
 TR 72,73,137,49152
 DM 40,33792,141,s[16:19],24,sc1 lds
 MF v[32:35],v[88:91],v[128:131]
 TR 74,75,137,50176
 MF v[36:39],v[92:95],v[116:119]
 TR 76,77,138,49152
 MF v[40:43],v[92:95],v[120:123]
 TR 78,79,138,50176
 MF v[44:47],v[92:95],v[124:127]
 TR 80,81,139,49152
 DM 40,34816,142,s[16:19],24,sc1 lds
 MF v[48:51],v[92:95],v[128:131]
 TR 82,83,139,50176
 MF v[52:55],v[96:99],v[116:119]
 MF v[56:59],v[96:99],v[120:123]
 MF v[60:63],v[96:99],v[124:127]
 DM 40,35840,143,s[16:19],24,sc1 lds
 MF v[64:67],v[96:99],v[128:131]
 s_waitcnt lgkmcnt(0)
 MF v[4:7],v[68:71],v[100:103]
 RB 116,119,133,49152
 MF v[8:11],v[68:71],v[104:107]
 RB 120,123,133,51200
 MF v[12:15],v[68:71],v[108:111]
 RB 124,127,133,53248
 DM 41,32768,144,s[20:23],25,lds
 MF v[16:19],v[68:71],v[112:115]
 RB 128,131,133,55296
 MF v[20:23],v[72:75],v[100:103]
 TR 84,85,136,57344
 MF v[24:27],v[72:75],v[104:107]
 TR 86,87,136,58368
 MF v[28:31],v[72:75],v[108:111]
 TR 88,89,137,57344
 DM 41,33792,145,s[20:23],25,lds
 MF v[32:35],v[72:75],v[112:115]
 TR 90,91,137,58368
 MF v[36:39],v[76:79],v[100:103]
 TR 92,93,138,57344
 MF v[40:43],v[76:79],v[104:107]
 TR 94,95,138,58368
 MF v[44:47],v[76:79],v[108:111]
 TR 96,97,139,57344
 DM 41,34816,146,s[20:23],25,lds
 MF v[48:51],v[76:79],v[112:115]
 TR 98,99,139,58368
 MF v[52:55],v[80:83],v[100:103]
 MF v[56:59],v[80:83],v[104:107]
 MF v[60:63],v[80:83],v[108:111]
 DM 41,35840,147,s[20:23],25,lds
 s_add_u32 s24, s24, 128
 s_add_u32 s25, s25, 458752
 MF v[64:67],v[80:83],v[112:115]
 s_waitcnt lgkmcnt(0)
 s_waitcnt vmcnt(16)
 s_barrier
 MF v[4:7],v[84:87],v[116:119]
 RB 100,103,132,0
 MF v[8:11],v[84:87],v[120:123]
 RB 104,107,132,2048
 MF v[12:15],v[84:87],v[124:127]
 RB 108,111,132,4096
 DM 40,49152,140,s[16:19],24,sc1 lds
 MF v[16:19],v[84:87],v[128:131]
 RB 112,115,132,6144
 MF v[20:23],v[88:91],v[116:119]
 TR 68,69,136,0
 MF v[24:27],v[88:91],v[120:123]
 TR 70,71,136,1024
 MF v[28:31],v[88:91],v[124:127]
 TR 72,73,137,0
 DM 40,50176,141,s[16:19],24,sc1 lds
 MF v[32:35],v[88:91],v[128:131]
 TR 74,75,137,1024
 MF v[36:39],v[92:95],v[116:119]
 TR 76,77,138,0
 MF v[40:43],v[92:95],v[120:123]
 TR 78,79,138,1024
 MF v[44:47],v[92:95],v[124:127]
 TR 80,81,139,0
 DM 40,51200,142,s[16:19],24,sc1 lds
 MF v[48:51],v[92:95],v[128:131]
 TR 82,83,139,1024
 MF v[52:55],v[96:99],v[116:119]
 MF v[56:59],v[96:99],v[120:123]
 MF v[60:63],v[96:99],v[124:127]
 DM 40,52224,143,s[16:19],24,sc1 lds
 MF v[64:67],v[96:99],v[128:131]
 s_waitcnt lgkmcnt(0)
 s_mov_b32 s42, 2
f1_loop_7:
 MF v[4:7],v[68:71],v[100:103]
 RB 116,119,133,0
 MF v[8:11],v[68:71],v[104:107]
 RB 120,123,133,2048
 MF v[12:15],v[68:71],v[108:111]
 RB 124,127,133,4096
 DM 41,49152,144,s[20:23],25,lds
 MF v[16:19],v[68:71],v[112:115]
 RB 128,131,133,6144
 MF v[20:23],v[72:75],v[100:103]
 TR 84,85,136,8192
 MF v[24:27],v[72:75],v[104:107]
 TR 86,87,136,9216
 MF v[28:31],v[72:75],v[108:111]
 TR 88,89,137,8192
 DM 41,50176,145,s[20:23],25,lds
 MF v[32:35],v[72:75],v[112:115]
 TR 90,91,137,9216
 MF v[36:39],v[76:79],v[100:103]
 TR 92,93,138,8192
 MF v[40:43],v[76:79],v[104:107]
 TR 94,95,138,9216
 MF v[44:47],v[76:79],v[108:111]
 TR 96,97,139,8192
 DM 41,51200,146,s[20:23],25,lds
 MF v[48:51],v[76:79],v[112:115]
 TR 98,99,139,9216
 MF v[52:55],v[80:83],v[100:103]
 MF v[56:59],v[80:83],v[104:107]
 MF v[60:63],v[80:83],v[108:111]
 DM 41,52224,147,s[20:23],25,lds
 s_add_u32 s24, s24, 128
 s_add_u32 s25, s25, 458752
 MF v[64:67],v[80:83],v[112:115]
 s_waitcnt lgkmcnt(0)
 s_waitcnt vmcnt(16)
 s_barrier
 MF v[4:7],v[84:87],v[116:119]
 RB 100,103,132,16384
 MF v[8:11],v[84:87],v[120:123]
 RB 104,107,132,18432
 MF v[12:15],v[84:87],v[124:127]
 RB 108,111,132,20480
 DM 40,0,140,s[16:19],24,sc1 lds
 MF v[16:19],v[84:87],v[128:131]
 RB 112,115,132,22528
 MF v[20:23],v[88:91],v[116:119]
 TR 68,69,136,16384
 MF v[24:27],v[88:91],v[120:123]
 TR 70,71,136,17408
 MF v[28:31],v[88:91],v[124:127]
 TR 72,73,137,16384
 DM 40,1024,141,s[16:19],24,sc1 lds
 MF v[32:35],v[88:91],v[128:131]
 TR 74,75,137,17408
 MF v[36:39],v[92:95],v[116:119]
 TR 76,77,138,16384
 MF v[40:43],v[92:95],v[120:123]
 TR 78,79,138,17408
 MF v[44:47],v[92:95],v[124:127]
 TR 80,81,139,16384
 DM 40,2048,142,s[16:19],24,sc1 lds
 MF v[48:51],v[92:95],v[128:131]
 TR 82,83,139,17408
 MF v[52:55],v[96:99],v[116:119]
 MF v[56:59],v[96:99],v[120:123]
 MF v[60:63],v[96:99],v[124:127]
 DM 40,3072,143,s[16:19],24,sc1 lds
 MF v[64:67],v[96:99],v[128:131]
 s_waitcnt lgkmcnt(0)
 MF v[4:7],v[68:71],v[100:103]
 RB 116,119,133,16384
 MF v[8:11],v[68:71],v[104:107]
 RB 120,123,133,18432
 MF v[12:15],v[68:71],v[108:111]
 RB 124,127,133,20480
 DM 41,0,144,s[20:23],25,lds
 MF v[16:19],v[68:71],v[112:115]
 RB 128,131,133,22528
 MF v[20:23],v[72:75],v[100:103]
 TR 84,85,136,24576
 MF v[24:27],v[72:75],v[104:107]
 TR 86,87,136,25600
 MF v[28:31],v[72:75],v[108:111]
 TR 88,89,137,24576
 DM 41,1024,145,s[20:23],25,lds
 MF v[32:35],v[72:75],v[112:115]
 TR 90,91,137,25600
 MF v[36:39],v[76:79],v[100:103]
 TR 92,93,138,24576
 MF v[40:43],v[76:79],v[104:107]
 TR 94,95,138,25600
 MF v[44:47],v[76:79],v[108:111]
 TR 96,97,139,24576
 DM 41,2048,146,s[20:23],25,lds
 MF v[48:51],v[76:79],v[112:115]
 TR 98,99,139,25600
 MF v[52:55],v[80:83],v[100:103]
 MF v[56:59],v[80:83],v[104:107]
 MF v[60:63],v[80:83],v[108:111]
 DM 41,3072,147,s[20:23],25,lds
 s_add_u32 s24, s24, 128
 s_add_u32 s25, s25, 458752
 MF v[64:67],v[80:83],v[112:115]
 s_waitcnt lgkmcnt(0)
 s_waitcnt vmcnt(16)
 s_barrier
 MF v[4:7],v[84:87],v[116:119]
 RB 100,103,132,32768
 MF v[8:11],v[84:87],v[120:123]
 RB 104,107,132,34816
 MF v[12:15],v[84:87],v[124:127]
 RB 108,111,132,36864
 DM 40,16384,140,s[16:19],24,sc1 lds
 MF v[16:19],v[84:87],v[128:131]
 RB 112,115,132,38912
 MF v[20:23],v[88:91],v[116:119]
 TR 68,69,136,32768
 MF v[24:27],v[88:91],v[120:123]
 TR 70,71,136,33792
 MF v[28:31],v[88:91],v[124:127]
 TR 72,73,137,32768
 DM 40,17408,141,s[16:19],24,sc1 lds
 MF v[32:35],v[88:91],v[128:131]
 TR 74,75,137,33792
 MF v[36:39],v[92:95],v[116:119]
 TR 76,77,138,32768
 MF v[40:43],v[92:95],v[120:123]
 TR 78,79,138,33792
 MF v[44:47],v[92:95],v[124:127]
 TR 80,81,139,32768
 DM 40,18432,142,s[16:19],24,sc1 lds
 MF v[48:51],v[92:95],v[128:131]
 TR 82,83,139,33792
 MF v[52:55],v[96:99],v[116:119]
 MF v[56:59],v[96:99],v[120:123]
 MF v[60:63],v[96:99],v[124:127]
 DM 40,19456,143,s[16:19],24,sc1 lds
 MF v[64:67],v[96:99],v[128:131]
 s_waitcnt lgkmcnt(0)
 MF v[4:7],v[68:71],v[100:103]
 RB 116,119,133,32768
 MF v[8:11],v[68:71],v[104:107]
 RB 120,123,133,34816
 MF v[12:15],v[68:71],v[108:111]
 RB 124,127,133,36864
 DM 41,16384,144,s[20:23],25,lds
 MF v[16:19],v[68:71],v[112:115]
 RB 128,131,133,38912
 MF v[20:23],v[72:75],v[100:103]
 TR 84,85,136,40960
 MF v[24:27],v[72:75],v[104:107]
 TR 86,87,136,41984
 MF v[28:31],v[72:75],v[108:111]
 TR 88,89,137,40960
 DM 41,17408,145,s[20:23],25,lds
 MF v[32:35],v[72:75],v[112:115]
 TR 90,91,137,41984
 MF v[36:39],v[76:79],v[100:103]
 TR 92,93,138,40960
 MF v[40:43],v[76:79],v[104:107]
 TR 94,95,138,41984
 MF v[44:47],v[76:79],v[108:111]
 TR 96,97,139,40960
 DM 41,18432,146,s[20:23],25,lds
 MF v[48:51],v[76:79],v[112:115]
 TR 98,99,139,41984
 MF v[52:55],v[80:83],v[100:103]
 MF v[56:59],v[80:83],v[104:107]
 MF v[60:63],v[80:83],v[108:111]
 DM 41,19456,147,s[20:23],25,lds
 s_add_u32 s24, s24, 128
 s_add_u32 s25, s25, 458752
 MF v[64:67],v[80:83],v[112:115]
 s_waitcnt lgkmcnt(0)
 s_waitcnt vmcnt(16)
 s_barrier
 MF v[4:7],v[84:87],v[116:119]
 RB 100,103,132,49152
 MF v[8:11],v[84:87],v[120:123]
 RB 104,107,132,51200
 MF v[12:15],v[84:87],v[124:127]
 RB 108,111,132,53248
 DM 40,32768,140,s[16:19],24,sc1 lds
 MF v[16:19],v[84:87],v[128:131]
 RB 112,115,132,55296
 MF v[20:23],v[88:91],v[116:119]
 TR 68,69,136,49152
 MF v[24:27],v[88:91],v[120:123]
 TR 70,71,136,50176
 MF v[28:31],v[88:91],v[124:127]
 TR 72,73,137,49152
 DM 40,33792,141,s[16:19],24,sc1 lds
 MF v[32:35],v[88:91],v[128:131]
 TR 74,75,137,50176
 MF v[36:39],v[92:95],v[116:119]
 TR 76,77,138,49152
 MF v[40:43],v[92:95],v[120:123]
 TR 78,79,138,50176
 MF v[44:47],v[92:95],v[124:127]
 TR 80,81,139,49152
 DM 40,34816,142,s[16:19],24,sc1 lds
 MF v[48:51],v[92:95],v[128:131]
 TR 82,83,139,50176
 MF v[52:55],v[96:99],v[116:119]
 MF v[56:59],v[96:99],v[120:123]
 MF v[60:63],v[96:99],v[124:127]
 DM 40,35840,143,s[16:19],24,sc1 lds
 MF v[64:67],v[96:99],v[128:131]
 s_waitcnt lgkmcnt(0)
 MF v[4:7],v[68:71],v[100:103]
 RB 116,119,133,49152
 MF v[8:11],v[68:71],v[104:107]
 RB 120,123,133,51200
 MF v[12:15],v[68:71],v[108:111]
 RB 124,127,133,53248
 DM 41,32768,144,s[20:23],25,lds
 MF v[16:19],v[68:71],v[112:115]
 RB 128,131,133,55296
 MF v[20:23],v[72:75],v[100:103]
 TR 84,85,136,57344
 MF v[24:27],v[72:75],v[104:107]
 TR 86,87,136,58368
 MF v[28:31],v[72:75],v[108:111]
 TR 88,89,137,57344
 DM 41,33792,145,s[20:23],25,lds
 MF v[32:35],v[72:75],v[112:115]
 TR 90,91,137,58368
 MF v[36:39],v[76:79],v[100:103]
 TR 92,93,138,57344
 MF v[40:43],v[76:79],v[104:107]
 TR 94,95,138,58368
 MF v[44:47],v[76:79],v[108:111]
 TR 96,97,139,57344
 DM 41,34816,146,s[20:23],25,lds
 MF v[48:51],v[76:79],v[112:115]
 TR 98,99,139,58368
 MF v[52:55],v[80:83],v[100:103]
 MF v[56:59],v[80:83],v[104:107]
 MF v[60:63],v[80:83],v[108:111]
 DM 41,35840,147,s[20:23],25,lds
 s_add_u32 s24, s24, 128
 s_add_u32 s25, s25, 458752
 MF v[64:67],v[80:83],v[112:115]
 s_waitcnt lgkmcnt(0)
 s_waitcnt vmcnt(16)
 s_barrier
 MF v[4:7],v[84:87],v[116:119]
 RB 100,103,132,0
 MF v[8:11],v[84:87],v[120:123]
 RB 104,107,132,2048
 MF v[12:15],v[84:87],v[124:127]
 RB 108,111,132,4096
 DM 40,49152,140,s[16:19],24,sc1 lds
 MF v[16:19],v[84:87],v[128:131]
 RB 112,115,132,6144
 MF v[20:23],v[88:91],v[116:119]
 TR 68,69,136,0
 MF v[24:27],v[88:91],v[120:123]
 TR 70,71,136,1024
 MF v[28:31],v[88:91],v[124:127]
 TR 72,73,137,0
 DM 40,50176,141,s[16:19],24,sc1 lds
 MF v[32:35],v[88:91],v[128:131]
 TR 74,75,137,1024
 MF v[36:39],v[92:95],v[116:119]
 TR 76,77,138,0
 MF v[40:43],v[92:95],v[120:123]
 TR 78,79,138,1024
 MF v[44:47],v[92:95],v[124:127]
 TR 80,81,139,0
 DM 40,51200,142,s[16:19],24,sc1 lds
 MF v[48:51],v[92:95],v[128:131]
 TR 82,83,139,1024
 MF v[52:55],v[96:99],v[116:119]
 MF v[56:59],v[96:99],v[120:123]
 MF v[60:63],v[96:99],v[124:127]
 DM 40,52224,143,s[16:19],24,sc1 lds
 MF v[64:67],v[96:99],v[128:131]
 s_waitcnt lgkmcnt(0)
 s_sub_u32 s42, s42, 1
 s_cmp_lg_u32 s42, 0
 s_cbranch_scc1 f1_loop_7
 MF v[4:7],v[68:71],v[100:103]
 RB 116,119,133,0
 MF v[8:11],v[68:71],v[104:107]
 RB 120,123,133,2048
 MF v[12:15],v[68:71],v[108:111]
 RB 124,127,133,4096
 DM 41,49152,144,s[20:23],25,lds
 MF v[16:19],v[68:71],v[112:115]
 RB 128,131,133,6144
 MF v[20:23],v[72:75],v[100:103]
 TR 84,85,136,8192
 MF v[24:27],v[72:75],v[104:107]
 TR 86,87,136,9216
 MF v[28:31],v[72:75],v[108:111]
 TR 88,89,137,8192
 DM 41,50176,145,s[20:23],25,lds
 MF v[32:35],v[72:75],v[112:115]
 TR 90,91,137,9216
 MF v[36:39],v[76:79],v[100:103]
 TR 92,93,138,8192
 MF v[40:43],v[76:79],v[104:107]
 TR 94,95,138,9216
 MF v[44:47],v[76:79],v[108:111]
 TR 96,97,139,8192
 DM 41,51200,146,s[20:23],25,lds
 MF v[48:51],v[76:79],v[112:115]
 TR 98,99,139,9216
 MF v[52:55],v[80:83],v[100:103]
 MF v[56:59],v[80:83],v[104:107]
 MF v[60:63],v[80:83],v[108:111]
 DM 41,52224,147,s[20:23],25,lds
 s_add_u32 s24, s24, 128
 s_add_u32 s25, s25, 458752
 MF v[64:67],v[80:83],v[112:115]
 s_waitcnt lgkmcnt(0)
 s_waitcnt vmcnt(16)
 s_barrier
 MF v[4:7],v[84:87],v[116:119]
 RB 100,103,132,16384
 MF v[8:11],v[84:87],v[120:123]
 RB 104,107,132,18432
 MF v[12:15],v[84:87],v[124:127]
 RB 108,111,132,20480
 MF v[16:19],v[84:87],v[128:131]
 RB 112,115,132,22528
 MF v[20:23],v[88:91],v[116:119]
 TR 68,69,136,16384
 MF v[24:27],v[88:91],v[120:123]
 TR 70,71,136,17408
 MF v[28:31],v[88:91],v[124:127]
 TR 72,73,137,16384
 MF v[32:35],v[88:91],v[128:131]
 TR 74,75,137,17408
 MF v[36:39],v[92:95],v[116:119]
 TR 76,77,138,16384
 MF v[40:43],v[92:95],v[120:123]
 TR 78,79,138,17408
 MF v[44:47],v[92:95],v[124:127]
 TR 80,81,139,16384
 MF v[48:51],v[92:95],v[128:131]
 TR 82,83,139,17408
 MF v[52:55],v[96:99],v[116:119]
 MF v[56:59],v[96:99],v[120:123]
 MF v[60:63],v[96:99],v[124:127]
 MF v[64:67],v[96:99],v[128:131]
 s_waitcnt lgkmcnt(0)
 MF v[4:7],v[68:71],v[100:103]
 RB 116,119,133,16384
 MF v[8:11],v[68:71],v[104:107]
 RB 120,123,133,18432
 MF v[12:15],v[68:71],v[108:111]
 RB 124,127,133,20480
 MF v[16:19],v[68:71],v[112:115]
 RB 128,131,133,22528
 MF v[20:23],v[72:75],v[100:103]
 TR 84,85,136,24576
 MF v[24:27],v[72:75],v[104:107]
 TR 86,87,136,25600
 MF v[28:31],v[72:75],v[108:111]
 TR 88,89,137,24576
 MF v[32:35],v[72:75],v[112:115]
 TR 90,91,137,25600
 MF v[36:39],v[76:79],v[100:103]
 TR 92,93,138,24576
 MF v[40:43],v[76:79],v[104:107]
 TR 94,95,138,25600
 MF v[44:47],v[76:79],v[108:111]
 TR 96,97,139,24576
 MF v[48:51],v[76:79],v[112:115]
 TR 98,99,139,25600
 MF v[52:55],v[80:83],v[100:103]
 MF v[56:59],v[80:83],v[104:107]
 MF v[60:63],v[80:83],v[108:111]
 MF v[64:67],v[80:83],v[112:115]
 s_waitcnt lgkmcnt(0)
 s_waitcnt vmcnt(8)
 s_barrier
 MF v[4:7],v[84:87],v[116:119]
 RB 100,103,132,32768
 MF v[8:11],v[84:87],v[120:123]
 RB 104,107,132,34816
 MF v[12:15],v[84:87],v[124:127]
 RB 108,111,132,36864
 MF v[16:19],v[84:87],v[128:131]
 RB 112,115,132,38912
 MF v[20:23],v[88:91],v[116:119]
 TR 68,69,136,32768
 MF v[24:27],v[88:91],v[120:123]
 TR 70,71,136,33792
 MF v[28:31],v[88:91],v[124:127]
 TR 72,73,137,32768
 MF v[32:35],v[88:91],v[128:131]
 TR 74,75,137,33792
 MF v[36:39],v[92:95],v[116:119]
 TR 76,77,138,32768
 MF v[40:43],v[92:95],v[120:123]
 TR 78,79,138,33792
 MF v[44:47],v[92:95],v[124:127]
 TR 80,81,139,32768
 MF v[48:51],v[92:95],v[128:131]
 TR 82,83,139,33792
 MF v[52:55],v[96:99],v[116:119]
 MF v[56:59],v[96:99],v[120:123]
 MF v[60:63],v[96:99],v[124:127]
 MF v[64:67],v[96:99],v[128:131]
 s_waitcnt lgkmcnt(0)
 MF v[4:7],v[68:71],v[100:103]
 RB 116,119,133,32768
 MF v[8:11],v[68:71],v[104:107]
 RB 120,123,133,34816
 MF v[12:15],v[68:71],v[108:111]
 RB 124,127,133,36864
 MF v[16:19],v[68:71],v[112:115]
 RB 128,131,133,38912
 MF v[20:23],v[72:75],v[100:103]
 TR 84,85,136,40960
 MF v[24:27],v[72:75],v[104:107]
 TR 86,87,136,41984
 MF v[28:31],v[72:75],v[108:111]
 TR 88,89,137,40960
 MF v[32:35],v[72:75],v[112:115]
 TR 90,91,137,41984
 MF v[36:39],v[76:79],v[100:103]
 TR 92,93,138,40960
 MF v[40:43],v[76:79],v[104:107]
 TR 94,95,138,41984
 MF v[44:47],v[76:79],v[108:111]
 TR 96,97,139,40960
 MF v[48:51],v[76:79],v[112:115]
 TR 98,99,139,41984
 MF v[52:55],v[80:83],v[100:103]
 MF v[56:59],v[80:83],v[104:107]
 MF v[60:63],v[80:83],v[108:111]
 MF v[64:67],v[80:83],v[112:115]
 s_waitcnt lgkmcnt(0)
 s_waitcnt vmcnt(0)
 s_barrier
 MF v[4:7],v[84:87],v[116:119]
 RB 100,103,132,49152
 MF v[8:11],v[84:87],v[120:123]
 RB 104,107,132,51200
 MF v[12:15],v[84:87],v[124:127]
 RB 108,111,132,53248
 MF v[16:19],v[84:87],v[128:131]
 RB 112,115,132,55296
 MF v[20:23],v[88:91],v[116:119]
 TR 68,69,136,49152
 MF v[24:27],v[88:91],v[120:123]
 TR 70,71,136,50176
 MF v[28:31],v[88:91],v[124:127]
 TR 72,73,137,49152
 MF v[32:35],v[88:91],v[128:131]
 TR 74,75,137,50176
 MF v[36:39],v[92:95],v[116:119]
 TR 76,77,138,49152
 MF v[40:43],v[92:95],v[120:123]
 TR 78,79,138,50176
 MF v[44:47],v[92:95],v[124:127]
 TR 80,81,139,49152
 MF v[48:51],v[92:95],v[128:131]
 TR 82,83,139,50176
 MF v[52:55],v[96:99],v[116:119]
 MF v[56:59],v[96:99],v[120:123]
 MF v[60:63],v[96:99],v[124:127]
 MF v[64:67],v[96:99],v[128:131]
 s_waitcnt lgkmcnt(0)
 MF v[4:7],v[68:71],v[100:103]
 RB 116,119,133,49152
 MF v[8:11],v[68:71],v[104:107]
 RB 120,123,133,51200
 MF v[12:15],v[68:71],v[108:111]
 RB 124,127,133,53248
 MF v[16:19],v[68:71],v[112:115]
 RB 128,131,133,55296
 MF v[20:23],v[72:75],v[100:103]
 TR 84,85,136,57344
 MF v[24:27],v[72:75],v[104:107]
 TR 86,87,136,58368
 MF v[28:31],v[72:75],v[108:111]
 TR 88,89,137,57344
 MF v[32:35],v[72:75],v[112:115]
 TR 90,91,137,58368
 MF v[36:39],v[76:79],v[100:103]
 TR 92,93,138,57344
 MF v[40:43],v[76:79],v[104:107]
 TR 94,95,138,58368
 MF v[44:47],v[76:79],v[108:111]
 TR 96,97,139,57344
 MF v[48:51],v[76:79],v[112:115]
 TR 98,99,139,58368
 MF v[52:55],v[80:83],v[100:103]
 MF v[56:59],v[80:83],v[104:107]
 MF v[60:63],v[80:83],v[108:111]
 MF v[64:67],v[80:83],v[112:115]
 s_waitcnt lgkmcnt(0)
 MF v[4:7],v[84:87],v[116:119]
 MF v[8:11],v[84:87],v[120:123]
 MF v[12:15],v[84:87],v[124:127]
 MF v[16:19],v[84:87],v[128:131]
 MF v[20:23],v[88:91],v[116:119]
 MF v[24:27],v[88:91],v[120:123]
 MF v[28:31],v[88:91],v[124:127]
 MF v[32:35],v[88:91],v[128:131]
 MF v[36:39],v[92:95],v[116:119]
 MF v[40:43],v[92:95],v[120:123]
 MF v[44:47],v[92:95],v[124:127]
 MF v[48:51],v[92:95],v[128:131]
 MF v[52:55],v[96:99],v[116:119]
 MF v[56:59],v[96:99],v[120:123]
 MF v[60:63],v[96:99],v[124:127]
 MF v[64:67],v[96:99],v[128:131]
 v_and_b32 v3, 15, v2
 v_mul_u32_u24 v3, 7168, v3
 v_lshrrev_b32 v1, 4, v2
 v_lshl_add_u32 v3, v1, 4, v3
 s_mul_i32 s26, s10, 128
 s_mul_i32 s27, s43, 64
 s_add_u32 s26, s26, s27
 s_mul_i32 s26, s26, 7168
 s_mul_i32 s27, s11, 256
 s_add_u32 s26, s26, s27
 s_mul_i32 s27, s44, 128
 s_add_u32 s26, s26, s27
 s_add_u32 s26, s26, 62914560
 s_mov_b32 s28, 0xbfb8aa3b
 s_nop 4
 CV 100,4,5
 v_lshlrev_b32 v4, 16, v100
 v_and_b32 v5, 0xffff0000, v100
 CV 100,6,7
 v_lshlrev_b32 v6, 16, v100
 v_and_b32 v7, 0xffff0000, v100
 v_mul_f32 v100, s28, v4
 v_mul_f32 v101, s28, v5
 v_mul_f32 v102, s28, v6
 v_mul_f32 v103, s28, v7
 v_exp_f32 v100, v100
 v_exp_f32 v101, v101
 v_exp_f32 v102, v102
 v_exp_f32 v103, v103
 s_nop 0
 v_add_f32 v100, 1.0, v100
 v_add_f32 v101, 1.0, v101
 v_add_f32 v102, 1.0, v102
 v_add_f32 v103, 1.0, v103
 v_rcp_f32 v100, v100
 v_rcp_f32 v101, v101
 v_rcp_f32 v102, v102
 v_rcp_f32 v103, v103
 s_nop 0
 v_mul_f32 v4, v4, v100
 v_mul_f32 v5, v5, v101
 v_mul_f32 v6, v6, v102
 v_mul_f32 v7, v7, v103
 CV 68,4,5
 CV 69,6,7
 CV 100,20,21
 v_lshlrev_b32 v20, 16, v100
 v_and_b32 v21, 0xffff0000, v100
 CV 100,22,23
 v_lshlrev_b32 v22, 16, v100
 v_and_b32 v23, 0xffff0000, v100
 v_mul_f32 v100, s28, v20
 v_mul_f32 v101, s28, v21
 v_mul_f32 v102, s28, v22
 v_mul_f32 v103, s28, v23
 v_exp_f32 v100, v100
 v_exp_f32 v101, v101
 v_exp_f32 v102, v102
 v_exp_f32 v103, v103
 s_nop 0
 v_add_f32 v100, 1.0, v100
 v_add_f32 v101, 1.0, v101
 v_add_f32 v102, 1.0, v102
 v_add_f32 v103, 1.0, v103
 v_rcp_f32 v100, v100
 v_rcp_f32 v101, v101
 v_rcp_f32 v102, v102
 v_rcp_f32 v103, v103
 s_nop 0
 v_mul_f32 v20, v20, v100
 v_mul_f32 v21, v21, v101
 v_mul_f32 v22, v22, v102
 v_mul_f32 v23, v23, v103
 CV 70,20,21
 CV 71,22,23
 buffer_store_dwordx4 v[68:71], v3, s[16:19], s26 offen offset:0 sc1
 CV 100,36,37
 v_lshlrev_b32 v36, 16, v100
 v_and_b32 v37, 0xffff0000, v100
 CV 100,38,39
 v_lshlrev_b32 v38, 16, v100
 v_and_b32 v39, 0xffff0000, v100
 v_mul_f32 v100, s28, v36
 v_mul_f32 v101, s28, v37
 v_mul_f32 v102, s28, v38
 v_mul_f32 v103, s28, v39
 v_exp_f32 v100, v100
 v_exp_f32 v101, v101
 v_exp_f32 v102, v102
 v_exp_f32 v103, v103
 s_nop 0
 v_add_f32 v100, 1.0, v100
 v_add_f32 v101, 1.0, v101
 v_add_f32 v102, 1.0, v102
 v_add_f32 v103, 1.0, v103
 v_rcp_f32 v100, v100
 v_rcp_f32 v101, v101
 v_rcp_f32 v102, v102
 v_rcp_f32 v103, v103
 s_nop 0
 v_mul_f32 v36, v36, v100
 v_mul_f32 v37, v37, v101
 v_mul_f32 v38, v38, v102
 v_mul_f32 v39, v39, v103
 CV 72,36,37
 CV 73,38,39
 CV 100,52,53
 v_lshlrev_b32 v52, 16, v100
 v_and_b32 v53, 0xffff0000, v100
 CV 100,54,55
 v_lshlrev_b32 v54, 16, v100
 v_and_b32 v55, 0xffff0000, v100
 v_mul_f32 v100, s28, v52
 v_mul_f32 v101, s28, v53
 v_mul_f32 v102, s28, v54
 v_mul_f32 v103, s28, v55
 v_exp_f32 v100, v100
 v_exp_f32 v101, v101
 v_exp_f32 v102, v102
 v_exp_f32 v103, v103
 s_nop 0
 v_add_f32 v100, 1.0, v100
 v_add_f32 v101, 1.0, v101
 v_add_f32 v102, 1.0, v102
 v_add_f32 v103, 1.0, v103
 v_rcp_f32 v100, v100
 v_rcp_f32 v101, v101
 v_rcp_f32 v102, v102
 v_rcp_f32 v103, v103
 s_nop 0
 v_mul_f32 v52, v52, v100
 v_mul_f32 v53, v53, v101
 v_mul_f32 v54, v54, v102
 v_mul_f32 v55, v55, v103
 CV 74,52,53
 CV 75,54,55
 buffer_store_dwordx4 v[72:75], v3, s[16:19], s26 offen offset:64 sc1
 s_add_u32 s26, s26, 114688
 CV 100,8,9
 v_lshlrev_b32 v8, 16, v100
 v_and_b32 v9, 0xffff0000, v100
 CV 100,10,11
 v_lshlrev_b32 v10, 16, v100
 v_and_b32 v11, 0xffff0000, v100
 v_mul_f32 v100, s28, v8
 v_mul_f32 v101, s28, v9
 v_mul_f32 v102, s28, v10
 v_mul_f32 v103, s28, v11
 v_exp_f32 v100, v100
 v_exp_f32 v101, v101
 v_exp_f32 v102, v102
 v_exp_f32 v103, v103
 s_nop 0
 v_add_f32 v100, 1.0, v100
 v_add_f32 v101, 1.0, v101
 v_add_f32 v102, 1.0, v102
 v_add_f32 v103, 1.0, v103
 v_rcp_f32 v100, v100
 v_rcp_f32 v101, v101
 v_rcp_f32 v102, v102
 v_rcp_f32 v103, v103
 s_nop 0
 v_mul_f32 v8, v8, v100
 v_mul_f32 v9, v9, v101
 v_mul_f32 v10, v10, v102
 v_mul_f32 v11, v11, v103
 CV 76,8,9
 CV 77,10,11
 CV 100,24,25
 v_lshlrev_b32 v24, 16, v100
 v_and_b32 v25, 0xffff0000, v100
 CV 100,26,27
 v_lshlrev_b32 v26, 16, v100
 v_and_b32 v27, 0xffff0000, v100
 v_mul_f32 v100, s28, v24
 v_mul_f32 v101, s28, v25
 v_mul_f32 v102, s28, v26
 v_mul_f32 v103, s28, v27
 v_exp_f32 v100, v100
 v_exp_f32 v101, v101
 v_exp_f32 v102, v102
 v_exp_f32 v103, v103
 s_nop 0
 v_add_f32 v100, 1.0, v100
 v_add_f32 v101, 1.0, v101
 v_add_f32 v102, 1.0, v102
 v_add_f32 v103, 1.0, v103
 v_rcp_f32 v100, v100
 v_rcp_f32 v101, v101
 v_rcp_f32 v102, v102
 v_rcp_f32 v103, v103
 s_nop 0
 v_mul_f32 v24, v24, v100
 v_mul_f32 v25, v25, v101
 v_mul_f32 v26, v26, v102
 v_mul_f32 v27, v27, v103
 CV 78,24,25
 CV 79,26,27
 buffer_store_dwordx4 v[76:79], v3, s[16:19], s26 offen offset:0 sc1
 CV 100,40,41
 v_lshlrev_b32 v40, 16, v100
 v_and_b32 v41, 0xffff0000, v100
 CV 100,42,43
 v_lshlrev_b32 v42, 16, v100
 v_and_b32 v43, 0xffff0000, v100
 v_mul_f32 v100, s28, v40
 v_mul_f32 v101, s28, v41
 v_mul_f32 v102, s28, v42
 v_mul_f32 v103, s28, v43
 v_exp_f32 v100, v100
 v_exp_f32 v101, v101
 v_exp_f32 v102, v102
 v_exp_f32 v103, v103
 s_nop 0
 v_add_f32 v100, 1.0, v100
 v_add_f32 v101, 1.0, v101
 v_add_f32 v102, 1.0, v102
 v_add_f32 v103, 1.0, v103
 v_rcp_f32 v100, v100
 v_rcp_f32 v101, v101
 v_rcp_f32 v102, v102
 v_rcp_f32 v103, v103
 s_nop 0
 v_mul_f32 v40, v40, v100
 v_mul_f32 v41, v41, v101
 v_mul_f32 v42, v42, v102
 v_mul_f32 v43, v43, v103
 CV 80,40,41
 CV 81,42,43
 CV 100,56,57
 v_lshlrev_b32 v56, 16, v100
 v_and_b32 v57, 0xffff0000, v100
 CV 100,58,59
 v_lshlrev_b32 v58, 16, v100
 v_and_b32 v59, 0xffff0000, v100
 v_mul_f32 v100, s28, v56
 v_mul_f32 v101, s28, v57
 v_mul_f32 v102, s28, v58
 v_mul_f32 v103, s28, v59
 v_exp_f32 v100, v100
 v_exp_f32 v101, v101
 v_exp_f32 v102, v102
 v_exp_f32 v103, v103
 s_nop 0
 v_add_f32 v100, 1.0, v100
 v_add_f32 v101, 1.0, v101
 v_add_f32 v102, 1.0, v102
 v_add_f32 v103, 1.0, v103
 v_rcp_f32 v100, v100
 v_rcp_f32 v101, v101
 v_rcp_f32 v102, v102
 v_rcp_f32 v103, v103
 s_nop 0
 v_mul_f32 v56, v56, v100
 v_mul_f32 v57, v57, v101
 v_mul_f32 v58, v58, v102
 v_mul_f32 v59, v59, v103
 CV 82,56,57
 CV 83,58,59
 buffer_store_dwordx4 v[80:83], v3, s[16:19], s26 offen offset:64 sc1
 s_add_u32 s26, s26, 114688
 CV 100,12,13
 v_lshlrev_b32 v12, 16, v100
 v_and_b32 v13, 0xffff0000, v100
 CV 100,14,15
 v_lshlrev_b32 v14, 16, v100
 v_and_b32 v15, 0xffff0000, v100
 v_mul_f32 v100, s28, v12
 v_mul_f32 v101, s28, v13
 v_mul_f32 v102, s28, v14
 v_mul_f32 v103, s28, v15
 v_exp_f32 v100, v100
 v_exp_f32 v101, v101
 v_exp_f32 v102, v102
 v_exp_f32 v103, v103
 s_nop 0
 v_add_f32 v100, 1.0, v100
 v_add_f32 v101, 1.0, v101
 v_add_f32 v102, 1.0, v102
 v_add_f32 v103, 1.0, v103
 v_rcp_f32 v100, v100
 v_rcp_f32 v101, v101
 v_rcp_f32 v102, v102
 v_rcp_f32 v103, v103
 s_nop 0
 v_mul_f32 v12, v12, v100
 v_mul_f32 v13, v13, v101
 v_mul_f32 v14, v14, v102
 v_mul_f32 v15, v15, v103
 CV 68,12,13
 CV 69,14,15
 CV 100,28,29
 v_lshlrev_b32 v28, 16, v100
 v_and_b32 v29, 0xffff0000, v100
 CV 100,30,31
 v_lshlrev_b32 v30, 16, v100
 v_and_b32 v31, 0xffff0000, v100
 v_mul_f32 v100, s28, v28
 v_mul_f32 v101, s28, v29
 v_mul_f32 v102, s28, v30
 v_mul_f32 v103, s28, v31
 v_exp_f32 v100, v100
 v_exp_f32 v101, v101
 v_exp_f32 v102, v102
 v_exp_f32 v103, v103
 s_nop 0
 v_add_f32 v100, 1.0, v100
 v_add_f32 v101, 1.0, v101
 v_add_f32 v102, 1.0, v102
 v_add_f32 v103, 1.0, v103
 v_rcp_f32 v100, v100
 v_rcp_f32 v101, v101
 v_rcp_f32 v102, v102
 v_rcp_f32 v103, v103
 s_nop 0
 v_mul_f32 v28, v28, v100
 v_mul_f32 v29, v29, v101
 v_mul_f32 v30, v30, v102
 v_mul_f32 v31, v31, v103
 CV 70,28,29
 CV 71,30,31
 buffer_store_dwordx4 v[68:71], v3, s[16:19], s26 offen offset:0 sc1
 CV 100,44,45
 v_lshlrev_b32 v44, 16, v100
 v_and_b32 v45, 0xffff0000, v100
 CV 100,46,47
 v_lshlrev_b32 v46, 16, v100
 v_and_b32 v47, 0xffff0000, v100
 v_mul_f32 v100, s28, v44
 v_mul_f32 v101, s28, v45
 v_mul_f32 v102, s28, v46
 v_mul_f32 v103, s28, v47
 v_exp_f32 v100, v100
 v_exp_f32 v101, v101
 v_exp_f32 v102, v102
 v_exp_f32 v103, v103
 s_nop 0
 v_add_f32 v100, 1.0, v100
 v_add_f32 v101, 1.0, v101
 v_add_f32 v102, 1.0, v102
 v_add_f32 v103, 1.0, v103
 v_rcp_f32 v100, v100
 v_rcp_f32 v101, v101
 v_rcp_f32 v102, v102
 v_rcp_f32 v103, v103
 s_nop 0
 v_mul_f32 v44, v44, v100
 v_mul_f32 v45, v45, v101
 v_mul_f32 v46, v46, v102
 v_mul_f32 v47, v47, v103
 CV 72,44,45
 CV 73,46,47
 CV 100,60,61
 v_lshlrev_b32 v60, 16, v100
 v_and_b32 v61, 0xffff0000, v100
 CV 100,62,63
 v_lshlrev_b32 v62, 16, v100
 v_and_b32 v63, 0xffff0000, v100
 v_mul_f32 v100, s28, v60
 v_mul_f32 v101, s28, v61
 v_mul_f32 v102, s28, v62
 v_mul_f32 v103, s28, v63
 v_exp_f32 v100, v100
 v_exp_f32 v101, v101
 v_exp_f32 v102, v102
 v_exp_f32 v103, v103
 s_nop 0
 v_add_f32 v100, 1.0, v100
 v_add_f32 v101, 1.0, v101
 v_add_f32 v102, 1.0, v102
 v_add_f32 v103, 1.0, v103
 v_rcp_f32 v100, v100
 v_rcp_f32 v101, v101
 v_rcp_f32 v102, v102
 v_rcp_f32 v103, v103
 s_nop 0
 v_mul_f32 v60, v60, v100
 v_mul_f32 v61, v61, v101
 v_mul_f32 v62, v62, v102
 v_mul_f32 v63, v63, v103
 CV 74,60,61
 CV 75,62,63
 buffer_store_dwordx4 v[72:75], v3, s[16:19], s26 offen offset:64 sc1
 s_add_u32 s26, s26, 114688
 CV 100,16,17
 v_lshlrev_b32 v16, 16, v100
 v_and_b32 v17, 0xffff0000, v100
 CV 100,18,19
 v_lshlrev_b32 v18, 16, v100
 v_and_b32 v19, 0xffff0000, v100
 v_mul_f32 v100, s28, v16
 v_mul_f32 v101, s28, v17
 v_mul_f32 v102, s28, v18
 v_mul_f32 v103, s28, v19
 v_exp_f32 v100, v100
 v_exp_f32 v101, v101
 v_exp_f32 v102, v102
 v_exp_f32 v103, v103
 s_nop 0
 v_add_f32 v100, 1.0, v100
 v_add_f32 v101, 1.0, v101
 v_add_f32 v102, 1.0, v102
 v_add_f32 v103, 1.0, v103
 v_rcp_f32 v100, v100
 v_rcp_f32 v101, v101
 v_rcp_f32 v102, v102
 v_rcp_f32 v103, v103
 s_nop 0
 v_mul_f32 v16, v16, v100
 v_mul_f32 v17, v17, v101
 v_mul_f32 v18, v18, v102
 v_mul_f32 v19, v19, v103
 CV 76,16,17
 CV 77,18,19
 CV 100,32,33
 v_lshlrev_b32 v32, 16, v100
 v_and_b32 v33, 0xffff0000, v100
 CV 100,34,35
 v_lshlrev_b32 v34, 16, v100
 v_and_b32 v35, 0xffff0000, v100
 v_mul_f32 v100, s28, v32
 v_mul_f32 v101, s28, v33
 v_mul_f32 v102, s28, v34
 v_mul_f32 v103, s28, v35
 v_exp_f32 v100, v100
 v_exp_f32 v101, v101
 v_exp_f32 v102, v102
 v_exp_f32 v103, v103
 s_nop 0
 v_add_f32 v100, 1.0, v100
 v_add_f32 v101, 1.0, v101
 v_add_f32 v102, 1.0, v102
 v_add_f32 v103, 1.0, v103
 v_rcp_f32 v100, v100
 v_rcp_f32 v101, v101
 v_rcp_f32 v102, v102
 v_rcp_f32 v103, v103
 s_nop 0
 v_mul_f32 v32, v32, v100
 v_mul_f32 v33, v33, v101
 v_mul_f32 v34, v34, v102
 v_mul_f32 v35, v35, v103
 CV 78,32,33
 CV 79,34,35
 buffer_store_dwordx4 v[76:79], v3, s[16:19], s26 offen offset:0 sc1
 CV 100,48,49
 v_lshlrev_b32 v48, 16, v100
 v_and_b32 v49, 0xffff0000, v100
 CV 100,50,51
 v_lshlrev_b32 v50, 16, v100
 v_and_b32 v51, 0xffff0000, v100
 v_mul_f32 v100, s28, v48
 v_mul_f32 v101, s28, v49
 v_mul_f32 v102, s28, v50
 v_mul_f32 v103, s28, v51
 v_exp_f32 v100, v100
 v_exp_f32 v101, v101
 v_exp_f32 v102, v102
 v_exp_f32 v103, v103
 s_nop 0
 v_add_f32 v100, 1.0, v100
 v_add_f32 v101, 1.0, v101
 v_add_f32 v102, 1.0, v102
 v_add_f32 v103, 1.0, v103
 v_rcp_f32 v100, v100
 v_rcp_f32 v101, v101
 v_rcp_f32 v102, v102
 v_rcp_f32 v103, v103
 s_nop 0
 v_mul_f32 v48, v48, v100
 v_mul_f32 v49, v49, v101
 v_mul_f32 v50, v50, v102
 v_mul_f32 v51, v51, v103
 CV 80,48,49
 CV 81,50,51
 CV 100,64,65
 v_lshlrev_b32 v64, 16, v100
 v_and_b32 v65, 0xffff0000, v100
 CV 100,66,67
 v_lshlrev_b32 v66, 16, v100
 v_and_b32 v67, 0xffff0000, v100
 v_mul_f32 v100, s28, v64
 v_mul_f32 v101, s28, v65
 v_mul_f32 v102, s28, v66
 v_mul_f32 v103, s28, v67
 v_exp_f32 v100, v100
 v_exp_f32 v101, v101
 v_exp_f32 v102, v102
 v_exp_f32 v103, v103
 s_nop 0
 v_add_f32 v100, 1.0, v100
 v_add_f32 v101, 1.0, v101
 v_add_f32 v102, 1.0, v102
 v_add_f32 v103, 1.0, v103
 v_rcp_f32 v100, v100
 v_rcp_f32 v101, v101
 v_rcp_f32 v102, v102
 v_rcp_f32 v103, v103
 s_nop 0
 v_mul_f32 v64, v64, v100
 v_mul_f32 v65, v65, v101
 v_mul_f32 v66, v66, v102
 v_mul_f32 v67, v67, v103
 CV 82,64,65
 CV 83,66,67
 buffer_store_dwordx4 v[80:83], v3, s[16:19], s26 offen offset:64 sc1
 s_add_u32 s26, s26, 114688
 s_branch mk_done
mk_b_kvs:
 s_cmp_ge_u32 s11, 32
 s_cselect_b32 s4, s64, s62
 s_cselect_b32 s5, s65, s63
 s_cmp_ge_u32 s11, 64
 s_cselect_b32 s4, s60, s4
 s_cselect_b32 s5, s61, s5
 s_mov_b32 s29, 20971520
 s_cselect_b32 s29, 121634816, s29
 s_mov_b32 s20, s4
 s_and_b32 s21, s5, 0xffff
 s_mov_b32 s22, 0x800000
 s_mov_b32 s23, 0x00020000
 s_cmp_ge_u32 s11, 64
 s_cbranch_scc1 mk_kvs_na
 s_branch mk_kvs_na
 s_mul_i32 s24, s10, 2097152
 s_mul_i32 s25, s11, 32768
 s_add_u32 s24, s24, s25
 s_add_u32 s24, s24, 83886080
 v_lshlrev_b32 v3, 4, v0
 v_mov_b32 v4, -1
 v_mov_b32 v5, -1
 v_mov_b32 v6, -1
 v_mov_b32 v7, -1
 s_mov_b32 s25, 8
mk_kvs_al:
 buffer_store_dwordx4 v[4:7], v3, s[16:19], s24 offen sc1
 s_add_u32 s24, s24, 4096
 s_sub_u32 s25, s25, 1
 s_cmp_lg_u32 s25, 0
 s_cbranch_scc1 mk_kvs_al
mk_kvs_na:
 s_mul_i32 s24, s10, 262144
 s_add_u32 s24, s24, 0
 s_and_b32 s12, s11, 31
 s_mul_i32 s25, s12, 256
 s_cmp_ge_u32 s11, 32
 s_cbranch_scc1 mk_kvs_v
 s_mov_b32 s29, 4194304
 s_lshr_b32 s33, s13, 1
 s_and_b32 s34, s13, 1
 v_and_b32 v84, 15, v2
 v_lshrrev_b32 v85, 4, v2
 v_lshrrev_b32 v86, 1, v84
 v_xor_b32 v86, v86, v85
 v_lshrrev_b32 v87, 2, v84
 v_lshlrev_b32 v87, 3, v87
 v_and_b32 v88, 3, v84
 v_add_u32 v87, v87, v88
 s_mul_i32 s35, s33, 8192
 s_add_u32 s35, s35, 0
 v_lshlrev_b32 v87, 7, v87
 v_add_u32 v87, s35, v87
 v_lshlrev_b32 v88, 4, v86
 v_add_u32 v68, v87, v88
 v_xor_b32 v88, 64, v88
 v_add_u32 v69, v87, v88
 v_lshrrev_b32 v86, 2, v84
 v_and_b32 v87, 3, v2
 v_and_b32 v88, 1, v85
 v_lshlrev_b32 v88, 2, v88
 v_or_b32 v88, v88, v86
 v_lshlrev_b32 v85, 3, v85
 v_add_u32 v85, v85, v86
 v_mul_u32_u24 v85, 256, v85
 v_lshlrev_b32 v87, 3, v87
 v_add_u32 v85, v85, v87
 v_add_u32 v85, 65536, v85
 s_mul_i32 s35, s34, 4
 s_add_u32 s36, s35, 0
 v_xor_b32 v86, s36, v88
 v_lshlrev_b32 v86, 5, v86
 v_add_u32 v72, v85, v86
 s_add_u32 s36, s35, 1
 v_xor_b32 v86, s36, v88
 v_lshlrev_b32 v86, 5, v86
 v_add_u32 v73, v85, v86
 s_add_u32 s36, s35, 2
 v_xor_b32 v86, s36, v88
 v_lshlrev_b32 v86, 5, v86
 v_add_u32 v74, v85, v86
 s_add_u32 s36, s35, 3
 v_xor_b32 v86, s36, v88
 v_lshlrev_b32 v86, 5, v86
 v_add_u32 v75, v85, v86
 v_lshrrev_b32 v84, 3, v2
 v_and_b32 v85, 7, v2
 s_mul_i32 s35, s13, 4
 s_add_u32 s36, s35, 0
 s_lshl_b32 s37, s36, 3
 v_add_u32 v86, s37, v84
 v_bfe_u32 v87, v86, 1, 1
 v_bfe_u32 v88, v86, 3, 2
 v_lshlrev_b32 v88, 1, v88
 v_or_b32 v87, v87, v88
 v_xor_b32 v87, v87, v85
 v_lshlrev_b32 v87, 4, v87
 v_mul_u32_u24 v86, 2048, v86
 v_add_u32 v76, v86, v87
 s_add_u32 s36, s35, 1
 s_lshl_b32 s37, s36, 3
 v_add_u32 v86, s37, v84
 v_bfe_u32 v87, v86, 1, 1
 v_bfe_u32 v88, v86, 3, 2
 v_lshlrev_b32 v88, 1, v88
 v_or_b32 v87, v87, v88
 v_xor_b32 v87, v87, v85
 v_lshlrev_b32 v87, 4, v87
 v_mul_u32_u24 v86, 2048, v86
 v_add_u32 v77, v86, v87
 s_add_u32 s36, s35, 2
 s_lshl_b32 s37, s36, 3
 v_add_u32 v86, s37, v84
 v_bfe_u32 v87, v86, 1, 1
 v_bfe_u32 v88, v86, 3, 2
 v_lshlrev_b32 v88, 1, v88
 v_or_b32 v87, v87, v88
 v_xor_b32 v87, v87, v85
 v_lshlrev_b32 v87, 4, v87
 v_mul_u32_u24 v86, 2048, v86
 v_add_u32 v78, v86, v87
 s_add_u32 s36, s35, 3
 s_lshl_b32 s37, s36, 3
 v_add_u32 v86, s37, v84
 v_bfe_u32 v87, v86, 1, 1
 v_bfe_u32 v88, v86, 3, 2
 v_lshlrev_b32 v88, 1, v88
 v_or_b32 v87, v87, v88
 v_xor_b32 v87, v87, v85
 v_lshlrev_b32 v87, 4, v87
 v_mul_u32_u24 v86, 2048, v86
 v_add_u32 v79, v86, v87
 s_mul_i32 s30, s13, 4096
 s_add_u32 s30, s30, 0
 v_lshlrev_b32 v84, 4, v2
 s_mul_i32 s35, s13, 4096
 s_add_u32 s36, s35, 0
 v_add_u32 v85, s36, v84
 v_lshrrev_b32 v86, 8, v85
 v_and_b32 v85, 255, v85
 v_bfe_u32 v88, v86, 3, 1
 v_and_b32 v87, 3, v86
 v_lshlrev_b32 v88, 2, v88
 v_or_b32 v87, v87, v88
 v_lshlrev_b32 v87, 5, v87
 v_xor_b32 v85, v85, v87
 v_mul_u32_u24 v86, 8192, v86
 v_add_u32 v80, v86, v85
 s_add_u32 s36, s35, 1024
 v_add_u32 v85, s36, v84
 v_lshrrev_b32 v86, 8, v85
 v_and_b32 v85, 255, v85
 v_bfe_u32 v88, v86, 3, 1
 v_and_b32 v87, 3, v86
 v_lshlrev_b32 v88, 2, v88
 v_or_b32 v87, v87, v88
 v_lshlrev_b32 v87, 5, v87
 v_xor_b32 v85, v85, v87
 v_mul_u32_u24 v86, 8192, v86
 v_add_u32 v81, v86, v85
 s_add_u32 s36, s35, 2048
 v_add_u32 v85, s36, v84
 v_lshrrev_b32 v86, 8, v85
 v_and_b32 v85, 255, v85
 v_bfe_u32 v88, v86, 3, 1
 v_and_b32 v87, 3, v86
 v_lshlrev_b32 v88, 2, v88
 v_or_b32 v87, v87, v88
 v_lshlrev_b32 v87, 5, v87
 v_xor_b32 v85, v85, v87
 v_mul_u32_u24 v86, 8192, v86
 v_add_u32 v82, v86, v85
 s_add_u32 s36, s35, 3072
 v_add_u32 v85, s36, v84
 v_lshrrev_b32 v86, 8, v85
 v_and_b32 v85, 255, v85
 v_bfe_u32 v88, v86, 3, 1
 v_and_b32 v87, 3, v86
 v_lshlrev_b32 v88, 2, v88
 v_or_b32 v87, v87, v88
 v_lshlrev_b32 v87, 5, v87
 v_xor_b32 v85, v85, v87
 v_mul_u32_u24 v86, 8192, v86
 v_add_u32 v83, v86, v85
 s_mul_i32 s31, s13, 4096
 s_add_u32 s31, s31, 65536
 AW 0
 AW 1
 AW 2
 AW 3
 AW 4
 AW 5
 AW 6
 AW 7
 AW 8
 AW 9
 AW 10
 AW 11
 AW 12
 AW 13
 AW 14
 AW 15
 AW 16
 AW 17
 AW 18
 AW 19
 AW 20
 AW 21
 AW 22
 AW 23
 AW 24
 AW 25
 AW 26
 AW 27
 AW 28
 AW 29
 AW 30
 AW 31
 AW 32
 AW 33
 AW 34
 AW 35
 AW 36
 AW 37
 AW 38
 AW 39
 AW 40
 AW 41
 AW 42
 AW 43
 AW 44
 AW 45
 AW 46
 AW 47
 AW 48
 AW 49
 AW 50
 AW 51
 AW 52
 AW 53
 AW 54
 AW 55
 AW 56
 AW 57
 AW 58
 AW 59
 AW 60
 AW 61
 AW 62
 AW 63
 s_branch mk_kvs_m
mk_kvs_v:
 s_lshr_b32 s33, s13, 1
 s_and_b32 s34, s13, 1
 v_and_b32 v84, 15, v2
 v_lshrrev_b32 v85, 4, v2
 v_lshrrev_b32 v86, 1, v84
 v_xor_b32 v86, v86, v85
 v_lshrrev_b32 v87, 2, v84
 v_lshlrev_b32 v87, 3, v87
 v_and_b32 v88, 3, v84
 v_add_u32 v87, v87, v88
 s_mul_i32 s35, s33, 8192
 s_add_u32 s35, s35, 0
 v_lshlrev_b32 v87, 7, v87
 v_add_u32 v87, s35, v87
 v_lshlrev_b32 v88, 4, v86
 v_add_u32 v68, v87, v88
 v_xor_b32 v88, 64, v88
 v_add_u32 v69, v87, v88
 v_lshrrev_b32 v86, 2, v84
 v_and_b32 v87, 3, v2
 v_and_b32 v88, 1, v85
 v_lshlrev_b32 v88, 2, v88
 v_or_b32 v88, v88, v86
 v_lshlrev_b32 v85, 3, v85
 v_add_u32 v85, v85, v86
 v_mul_u32_u24 v85, 256, v85
 v_lshlrev_b32 v87, 3, v87
 v_add_u32 v85, v85, v87
 v_add_u32 v85, 65536, v85
 s_mul_i32 s35, s34, 4
 s_add_u32 s36, s35, 0
 v_xor_b32 v86, s36, v88
 v_lshlrev_b32 v86, 5, v86
 v_add_u32 v72, v85, v86
 s_add_u32 s36, s35, 1
 v_xor_b32 v86, s36, v88
 v_lshlrev_b32 v86, 5, v86
 v_add_u32 v73, v85, v86
 s_add_u32 s36, s35, 2
 v_xor_b32 v86, s36, v88
 v_lshlrev_b32 v86, 5, v86
 v_add_u32 v74, v85, v86
 s_add_u32 s36, s35, 3
 v_xor_b32 v86, s36, v88
 v_lshlrev_b32 v86, 5, v86
 v_add_u32 v75, v85, v86
 v_lshrrev_b32 v84, 3, v2
 v_and_b32 v85, 7, v2
 s_mul_i32 s35, s13, 4
 s_add_u32 s36, s35, 0
 s_lshl_b32 s37, s36, 3
 v_add_u32 v86, s37, v84
 v_bfe_u32 v87, v86, 1, 1
 v_bfe_u32 v88, v86, 3, 2
 v_lshlrev_b32 v88, 1, v88
 v_or_b32 v87, v87, v88
 v_xor_b32 v87, v87, v85
 v_lshlrev_b32 v87, 4, v87
 v_bfe_u32 v88, v86, 2, 1
 v_bfe_u32 v89, v86, 3, 2
 v_and_b32 v86, 0xffe3, v86
 v_lshl_or_b32 v86, v88, 4, v86
 v_lshl_or_b32 v86, v89, 2, v86
 v_mul_u32_u24 v86, 2048, v86
 v_add_u32 v76, v86, v87
 s_add_u32 s36, s35, 1
 s_lshl_b32 s37, s36, 3
 v_add_u32 v86, s37, v84
 v_bfe_u32 v87, v86, 1, 1
 v_bfe_u32 v88, v86, 3, 2
 v_lshlrev_b32 v88, 1, v88
 v_or_b32 v87, v87, v88
 v_xor_b32 v87, v87, v85
 v_lshlrev_b32 v87, 4, v87
 v_bfe_u32 v88, v86, 2, 1
 v_bfe_u32 v89, v86, 3, 2
 v_and_b32 v86, 0xffe3, v86
 v_lshl_or_b32 v86, v88, 4, v86
 v_lshl_or_b32 v86, v89, 2, v86
 v_mul_u32_u24 v86, 2048, v86
 v_add_u32 v77, v86, v87
 s_add_u32 s36, s35, 2
 s_lshl_b32 s37, s36, 3
 v_add_u32 v86, s37, v84
 v_bfe_u32 v87, v86, 1, 1
 v_bfe_u32 v88, v86, 3, 2
 v_lshlrev_b32 v88, 1, v88
 v_or_b32 v87, v87, v88
 v_xor_b32 v87, v87, v85
 v_lshlrev_b32 v87, 4, v87
 v_bfe_u32 v88, v86, 2, 1
 v_bfe_u32 v89, v86, 3, 2
 v_and_b32 v86, 0xffe3, v86
 v_lshl_or_b32 v86, v88, 4, v86
 v_lshl_or_b32 v86, v89, 2, v86
 v_mul_u32_u24 v86, 2048, v86
 v_add_u32 v78, v86, v87
 s_add_u32 s36, s35, 3
 s_lshl_b32 s37, s36, 3
 v_add_u32 v86, s37, v84
 v_bfe_u32 v87, v86, 1, 1
 v_bfe_u32 v88, v86, 3, 2
 v_lshlrev_b32 v88, 1, v88
 v_or_b32 v87, v87, v88
 v_xor_b32 v87, v87, v85
 v_lshlrev_b32 v87, 4, v87
 v_bfe_u32 v88, v86, 2, 1
 v_bfe_u32 v89, v86, 3, 2
 v_and_b32 v86, 0xffe3, v86
 v_lshl_or_b32 v86, v88, 4, v86
 v_lshl_or_b32 v86, v89, 2, v86
 v_mul_u32_u24 v86, 2048, v86
 v_add_u32 v79, v86, v87
 s_mul_i32 s30, s13, 4096
 s_add_u32 s30, s30, 0
 v_lshlrev_b32 v84, 4, v2
 s_mul_i32 s35, s13, 4096
 s_add_u32 s36, s35, 0
 v_add_u32 v85, s36, v84
 v_lshrrev_b32 v86, 8, v85
 v_and_b32 v85, 255, v85
 v_bfe_u32 v88, v86, 3, 1
 v_and_b32 v87, 3, v86
 v_lshlrev_b32 v88, 2, v88
 v_or_b32 v87, v87, v88
 v_lshlrev_b32 v87, 5, v87
 v_xor_b32 v85, v85, v87
 v_mul_u32_u24 v86, 8192, v86
 v_add_u32 v80, v86, v85
 s_add_u32 s36, s35, 1024
 v_add_u32 v85, s36, v84
 v_lshrrev_b32 v86, 8, v85
 v_and_b32 v85, 255, v85
 v_bfe_u32 v88, v86, 3, 1
 v_and_b32 v87, 3, v86
 v_lshlrev_b32 v88, 2, v88
 v_or_b32 v87, v87, v88
 v_lshlrev_b32 v87, 5, v87
 v_xor_b32 v85, v85, v87
 v_mul_u32_u24 v86, 8192, v86
 v_add_u32 v81, v86, v85
 s_add_u32 s36, s35, 2048
 v_add_u32 v85, s36, v84
 v_lshrrev_b32 v86, 8, v85
 v_and_b32 v85, 255, v85
 v_bfe_u32 v88, v86, 3, 1
 v_and_b32 v87, 3, v86
 v_lshlrev_b32 v88, 2, v88
 v_or_b32 v87, v87, v88
 v_lshlrev_b32 v87, 5, v87
 v_xor_b32 v85, v85, v87
 v_mul_u32_u24 v86, 8192, v86
 v_add_u32 v82, v86, v85
 s_add_u32 s36, s35, 3072
 v_add_u32 v85, s36, v84
 v_lshrrev_b32 v86, 8, v85
 v_and_b32 v85, 255, v85
 v_bfe_u32 v88, v86, 3, 1
 v_and_b32 v87, 3, v86
 v_lshlrev_b32 v88, 2, v88
 v_or_b32 v87, v87, v88
 v_lshlrev_b32 v87, 5, v87
 v_xor_b32 v85, v85, v87
 v_mul_u32_u24 v86, 8192, v86
 v_add_u32 v83, v86, v85
 s_mul_i32 s31, s13, 4096
 s_add_u32 s31, s31, 65536
 AW 0
 AW 1
 AW 2
 AW 3
 AW 4
 AW 5
 AW 6
 AW 7
 AW 8
 AW 9
 AW 10
 AW 11
 AW 12
 AW 13
 AW 14
 AW 15
 AW 16
 AW 17
 AW 18
 AW 19
 AW 20
 AW 21
 AW 22
 AW 23
 AW 24
 AW 25
 AW 26
 AW 27
 AW 28
 AW 29
 AW 30
 AW 31
 AW 32
 AW 33
 AW 34
 AW 35
 AW 36
 AW 37
 AW 38
 AW 39
 AW 40
 AW 41
 AW 42
 AW 43
 AW 44
 AW 45
 AW 46
 AW 47
 AW 48
 AW 49
 AW 50
 AW 51
 AW 52
 AW 53
 AW 54
 AW 55
 AW 56
 AW 57
 AW 58
 AW 59
 AW 60
 AW 61
 AW 62
 AW 63
mk_kvs_m:
 DM 30,0,76,s[16:19],24,sc1 lds
 DM 30,1024,77,s[16:19],24,sc1 lds
 DM 30,2048,78,s[16:19],24,sc1 lds
 DM 30,3072,79,s[16:19],24,sc1 lds
 DM 31,0,80,s[20:23],25,lds
 DM 31,1024,81,s[20:23],25,lds
 DM 31,2048,82,s[20:23],25,lds
 DM 31,3072,83,s[20:23],25,lds
 s_add_u32 s24, s24, 128
 s_add_u32 s25, s25, 524288
 DM 30,16384,76,s[16:19],24,sc1 lds
 DM 30,17408,77,s[16:19],24,sc1 lds
 DM 30,18432,78,s[16:19],24,sc1 lds
 DM 30,19456,79,s[16:19],24,sc1 lds
 DM 31,16384,80,s[20:23],25,lds
 DM 31,17408,81,s[20:23],25,lds
 DM 31,18432,82,s[20:23],25,lds
 DM 31,19456,83,s[20:23],25,lds
 s_add_u32 s24, s24, 128
 s_add_u32 s25, s25, 524288
 DM 30,32768,76,s[16:19],24,sc1 lds
 DM 30,33792,77,s[16:19],24,sc1 lds
 DM 30,34816,78,s[16:19],24,sc1 lds
 DM 30,35840,79,s[16:19],24,sc1 lds
 DM 31,32768,80,s[20:23],25,lds
 DM 31,33792,81,s[20:23],25,lds
 DM 31,34816,82,s[20:23],25,lds
 DM 31,35840,83,s[20:23],25,lds
 s_add_u32 s24, s24, 128
 s_add_u32 s25, s25, 524288
 DM 30,49152,76,s[16:19],24,sc1 lds
 DM 30,50176,77,s[16:19],24,sc1 lds
 DM 30,51200,78,s[16:19],24,sc1 lds
 DM 30,52224,79,s[16:19],24,sc1 lds
 DM 31,49152,80,s[20:23],25,lds
 DM 31,50176,81,s[20:23],25,lds
 DM 31,51200,82,s[20:23],25,lds
 DM 31,52224,83,s[20:23],25,lds
 s_add_u32 s24, s24, 128
 s_add_u32 s25, s25, 524288
 s_waitcnt vmcnt(24)
 s_barrier
 RB 36,39,68,0
 RB 40,43,68,512
 RB 44,47,68,4096
 RB 48,51,68,4608
 TR 4,5,72,0
 TR 6,7,72,1024
 TR 8,9,73,0
 TR 10,11,73,1024
 TR 12,13,74,0
 TR 14,15,74,1024
 TR 16,17,75,0
 TR 18,19,75,1024
 s_waitcnt lgkmcnt(0)
 MF a[0:3],v[4:7],v[36:39]
 RB 52,55,69,0
 MF a[4:7],v[4:7],v[40:43]
 RB 56,59,69,512
 MF a[8:11],v[4:7],v[44:47]
 RB 60,63,69,4096
 MF a[12:15],v[4:7],v[48:51]
 RB 64,67,69,4608
 MF a[16:19],v[8:11],v[36:39]
 TR 20,21,72,8192
 MF a[20:23],v[8:11],v[40:43]
 TR 22,23,72,9216
 MF a[24:27],v[8:11],v[44:47]
 TR 24,25,73,8192
 MF a[28:31],v[8:11],v[48:51]
 TR 26,27,73,9216
 MF a[32:35],v[12:15],v[36:39]
 TR 28,29,74,8192
 MF a[36:39],v[12:15],v[40:43]
 TR 30,31,74,9216
 MF a[40:43],v[12:15],v[44:47]
 TR 32,33,75,8192
 MF a[44:47],v[12:15],v[48:51]
 TR 34,35,75,9216
 MF a[48:51],v[16:19],v[36:39]
 MF a[52:55],v[16:19],v[40:43]
 MF a[56:59],v[16:19],v[44:47]
 MF a[60:63],v[16:19],v[48:51]
 s_waitcnt lgkmcnt(0)
 s_waitcnt vmcnt(16)
 s_barrier
 MF a[0:3],v[20:23],v[52:55]
 RB 36,39,68,16384
 MF a[4:7],v[20:23],v[56:59]
 RB 40,43,68,16896
 MF a[8:11],v[20:23],v[60:63]
 RB 44,47,68,20480
 DM 30,0,76,s[16:19],24,sc1 lds
 MF a[12:15],v[20:23],v[64:67]
 RB 48,51,68,20992
 MF a[16:19],v[24:27],v[52:55]
 TR 4,5,72,16384
 MF a[20:23],v[24:27],v[56:59]
 TR 6,7,72,17408
 MF a[24:27],v[24:27],v[60:63]
 TR 8,9,73,16384
 DM 30,1024,77,s[16:19],24,sc1 lds
 MF a[28:31],v[24:27],v[64:67]
 TR 10,11,73,17408
 MF a[32:35],v[28:31],v[52:55]
 TR 12,13,74,16384
 MF a[36:39],v[28:31],v[56:59]
 TR 14,15,74,17408
 MF a[40:43],v[28:31],v[60:63]
 TR 16,17,75,16384
 DM 30,2048,78,s[16:19],24,sc1 lds
 MF a[44:47],v[28:31],v[64:67]
 TR 18,19,75,17408
 MF a[48:51],v[32:35],v[52:55]
 MF a[52:55],v[32:35],v[56:59]
 MF a[56:59],v[32:35],v[60:63]
 DM 30,3072,79,s[16:19],24,sc1 lds
 MF a[60:63],v[32:35],v[64:67]
 s_waitcnt lgkmcnt(0)
 MF a[0:3],v[4:7],v[36:39]
 RB 52,55,69,16384
 MF a[4:7],v[4:7],v[40:43]
 RB 56,59,69,16896
 MF a[8:11],v[4:7],v[44:47]
 RB 60,63,69,20480
 DM 31,0,80,s[20:23],25,lds
 MF a[12:15],v[4:7],v[48:51]
 RB 64,67,69,20992
 MF a[16:19],v[8:11],v[36:39]
 TR 20,21,72,24576
 MF a[20:23],v[8:11],v[40:43]
 TR 22,23,72,25600
 MF a[24:27],v[8:11],v[44:47]
 TR 24,25,73,24576
 DM 31,1024,81,s[20:23],25,lds
 MF a[28:31],v[8:11],v[48:51]
 TR 26,27,73,25600
 MF a[32:35],v[12:15],v[36:39]
 TR 28,29,74,24576
 MF a[36:39],v[12:15],v[40:43]
 TR 30,31,74,25600
 MF a[40:43],v[12:15],v[44:47]
 TR 32,33,75,24576
 DM 31,2048,82,s[20:23],25,lds
 MF a[44:47],v[12:15],v[48:51]
 TR 34,35,75,25600
 MF a[48:51],v[16:19],v[36:39]
 MF a[52:55],v[16:19],v[40:43]
 MF a[56:59],v[16:19],v[44:47]
 DM 31,3072,83,s[20:23],25,lds
 s_add_u32 s24, s24, 128
 s_add_u32 s25, s25, 524288
 MF a[60:63],v[16:19],v[48:51]
 s_waitcnt lgkmcnt(0)
 s_waitcnt vmcnt(16)
 s_barrier
 MF a[0:3],v[20:23],v[52:55]
 RB 36,39,68,32768
 MF a[4:7],v[20:23],v[56:59]
 RB 40,43,68,33280
 MF a[8:11],v[20:23],v[60:63]
 RB 44,47,68,36864
 DM 30,16384,76,s[16:19],24,sc1 lds
 MF a[12:15],v[20:23],v[64:67]
 RB 48,51,68,37376
 MF a[16:19],v[24:27],v[52:55]
 TR 4,5,72,32768
 MF a[20:23],v[24:27],v[56:59]
 TR 6,7,72,33792
 MF a[24:27],v[24:27],v[60:63]
 TR 8,9,73,32768
 DM 30,17408,77,s[16:19],24,sc1 lds
 MF a[28:31],v[24:27],v[64:67]
 TR 10,11,73,33792
 MF a[32:35],v[28:31],v[52:55]
 TR 12,13,74,32768
 MF a[36:39],v[28:31],v[56:59]
 TR 14,15,74,33792
 MF a[40:43],v[28:31],v[60:63]
 TR 16,17,75,32768
 DM 30,18432,78,s[16:19],24,sc1 lds
 MF a[44:47],v[28:31],v[64:67]
 TR 18,19,75,33792
 MF a[48:51],v[32:35],v[52:55]
 MF a[52:55],v[32:35],v[56:59]
 MF a[56:59],v[32:35],v[60:63]
 DM 30,19456,79,s[16:19],24,sc1 lds
 MF a[60:63],v[32:35],v[64:67]
 s_waitcnt lgkmcnt(0)
 MF a[0:3],v[4:7],v[36:39]
 RB 52,55,69,32768
 MF a[4:7],v[4:7],v[40:43]
 RB 56,59,69,33280
 MF a[8:11],v[4:7],v[44:47]
 RB 60,63,69,36864
 DM 31,16384,80,s[20:23],25,lds
 MF a[12:15],v[4:7],v[48:51]
 RB 64,67,69,37376
 MF a[16:19],v[8:11],v[36:39]
 TR 20,21,72,40960
 MF a[20:23],v[8:11],v[40:43]
 TR 22,23,72,41984
 MF a[24:27],v[8:11],v[44:47]
 TR 24,25,73,40960
 DM 31,17408,81,s[20:23],25,lds
 MF a[28:31],v[8:11],v[48:51]
 TR 26,27,73,41984
 MF a[32:35],v[12:15],v[36:39]
 TR 28,29,74,40960
 MF a[36:39],v[12:15],v[40:43]
 TR 30,31,74,41984
 MF a[40:43],v[12:15],v[44:47]
 TR 32,33,75,40960
 DM 31,18432,82,s[20:23],25,lds
 MF a[44:47],v[12:15],v[48:51]
 TR 34,35,75,41984
 MF a[48:51],v[16:19],v[36:39]
 MF a[52:55],v[16:19],v[40:43]
 MF a[56:59],v[16:19],v[44:47]
 DM 31,19456,83,s[20:23],25,lds
 s_add_u32 s24, s24, 128
 s_add_u32 s25, s25, 524288
 MF a[60:63],v[16:19],v[48:51]
 s_waitcnt lgkmcnt(0)
 s_waitcnt vmcnt(16)
 s_barrier
 MF a[0:3],v[20:23],v[52:55]
 RB 36,39,68,49152
 MF a[4:7],v[20:23],v[56:59]
 RB 40,43,68,49664
 MF a[8:11],v[20:23],v[60:63]
 RB 44,47,68,53248
 DM 30,32768,76,s[16:19],24,sc1 lds
 MF a[12:15],v[20:23],v[64:67]
 RB 48,51,68,53760
 MF a[16:19],v[24:27],v[52:55]
 TR 4,5,72,49152
 MF a[20:23],v[24:27],v[56:59]
 TR 6,7,72,50176
 MF a[24:27],v[24:27],v[60:63]
 TR 8,9,73,49152
 DM 30,33792,77,s[16:19],24,sc1 lds
 MF a[28:31],v[24:27],v[64:67]
 TR 10,11,73,50176
 MF a[32:35],v[28:31],v[52:55]
 TR 12,13,74,49152
 MF a[36:39],v[28:31],v[56:59]
 TR 14,15,74,50176
 MF a[40:43],v[28:31],v[60:63]
 TR 16,17,75,49152
 DM 30,34816,78,s[16:19],24,sc1 lds
 MF a[44:47],v[28:31],v[64:67]
 TR 18,19,75,50176
 MF a[48:51],v[32:35],v[52:55]
 MF a[52:55],v[32:35],v[56:59]
 MF a[56:59],v[32:35],v[60:63]
 DM 30,35840,79,s[16:19],24,sc1 lds
 MF a[60:63],v[32:35],v[64:67]
 s_waitcnt lgkmcnt(0)
 MF a[0:3],v[4:7],v[36:39]
 RB 52,55,69,49152
 MF a[4:7],v[4:7],v[40:43]
 RB 56,59,69,49664
 MF a[8:11],v[4:7],v[44:47]
 RB 60,63,69,53248
 DM 31,32768,80,s[20:23],25,lds
 MF a[12:15],v[4:7],v[48:51]
 RB 64,67,69,53760
 MF a[16:19],v[8:11],v[36:39]
 TR 20,21,72,57344
 MF a[20:23],v[8:11],v[40:43]
 TR 22,23,72,58368
 MF a[24:27],v[8:11],v[44:47]
 TR 24,25,73,57344
 DM 31,33792,81,s[20:23],25,lds
 MF a[28:31],v[8:11],v[48:51]
 TR 26,27,73,58368
 MF a[32:35],v[12:15],v[36:39]
 TR 28,29,74,57344
 MF a[36:39],v[12:15],v[40:43]
 TR 30,31,74,58368
 MF a[40:43],v[12:15],v[44:47]
 TR 32,33,75,57344
 DM 31,34816,82,s[20:23],25,lds
 MF a[44:47],v[12:15],v[48:51]
 TR 34,35,75,58368
 MF a[48:51],v[16:19],v[36:39]
 MF a[52:55],v[16:19],v[40:43]
 MF a[56:59],v[16:19],v[44:47]
 DM 31,35840,83,s[20:23],25,lds
 s_add_u32 s24, s24, 128
 s_add_u32 s25, s25, 524288
 MF a[60:63],v[16:19],v[48:51]
 s_waitcnt lgkmcnt(0)
 s_waitcnt vmcnt(16)
 s_barrier
 MF a[0:3],v[20:23],v[52:55]
 RB 36,39,68,0
 MF a[4:7],v[20:23],v[56:59]
 RB 40,43,68,512
 MF a[8:11],v[20:23],v[60:63]
 RB 44,47,68,4096
 DM 30,49152,76,s[16:19],24,sc1 lds
 MF a[12:15],v[20:23],v[64:67]
 RB 48,51,68,4608
 MF a[16:19],v[24:27],v[52:55]
 TR 4,5,72,0
 MF a[20:23],v[24:27],v[56:59]
 TR 6,7,72,1024
 MF a[24:27],v[24:27],v[60:63]
 TR 8,9,73,0
 DM 30,50176,77,s[16:19],24,sc1 lds
 MF a[28:31],v[24:27],v[64:67]
 TR 10,11,73,1024
 MF a[32:35],v[28:31],v[52:55]
 TR 12,13,74,0
 MF a[36:39],v[28:31],v[56:59]
 TR 14,15,74,1024
 MF a[40:43],v[28:31],v[60:63]
 TR 16,17,75,0
 DM 30,51200,78,s[16:19],24,sc1 lds
 MF a[44:47],v[28:31],v[64:67]
 TR 18,19,75,1024
 MF a[48:51],v[32:35],v[52:55]
 MF a[52:55],v[32:35],v[56:59]
 MF a[56:59],v[32:35],v[60:63]
 DM 30,52224,79,s[16:19],24,sc1 lds
 MF a[60:63],v[32:35],v[64:67]
 s_waitcnt lgkmcnt(0)
 s_mov_b32 s32, 2
kvs_loop_8:
 MF a[0:3],v[4:7],v[36:39]
 RB 52,55,69,0
 MF a[4:7],v[4:7],v[40:43]
 RB 56,59,69,512
 MF a[8:11],v[4:7],v[44:47]
 RB 60,63,69,4096
 DM 31,49152,80,s[20:23],25,lds
 MF a[12:15],v[4:7],v[48:51]
 RB 64,67,69,4608
 MF a[16:19],v[8:11],v[36:39]
 TR 20,21,72,8192
 MF a[20:23],v[8:11],v[40:43]
 TR 22,23,72,9216
 MF a[24:27],v[8:11],v[44:47]
 TR 24,25,73,8192
 DM 31,50176,81,s[20:23],25,lds
 MF a[28:31],v[8:11],v[48:51]
 TR 26,27,73,9216
 MF a[32:35],v[12:15],v[36:39]
 TR 28,29,74,8192
 MF a[36:39],v[12:15],v[40:43]
 TR 30,31,74,9216
 MF a[40:43],v[12:15],v[44:47]
 TR 32,33,75,8192
 DM 31,51200,82,s[20:23],25,lds
 MF a[44:47],v[12:15],v[48:51]
 TR 34,35,75,9216
 MF a[48:51],v[16:19],v[36:39]
 MF a[52:55],v[16:19],v[40:43]
 MF a[56:59],v[16:19],v[44:47]
 DM 31,52224,83,s[20:23],25,lds
 s_add_u32 s24, s24, 128
 s_add_u32 s25, s25, 524288
 MF a[60:63],v[16:19],v[48:51]
 s_waitcnt lgkmcnt(0)
 s_waitcnt vmcnt(16)
 s_barrier
 MF a[0:3],v[20:23],v[52:55]
 RB 36,39,68,16384
 MF a[4:7],v[20:23],v[56:59]
 RB 40,43,68,16896
 MF a[8:11],v[20:23],v[60:63]
 RB 44,47,68,20480
 DM 30,0,76,s[16:19],24,sc1 lds
 MF a[12:15],v[20:23],v[64:67]
 RB 48,51,68,20992
 MF a[16:19],v[24:27],v[52:55]
 TR 4,5,72,16384
 MF a[20:23],v[24:27],v[56:59]
 TR 6,7,72,17408
 MF a[24:27],v[24:27],v[60:63]
 TR 8,9,73,16384
 DM 30,1024,77,s[16:19],24,sc1 lds
 MF a[28:31],v[24:27],v[64:67]
 TR 10,11,73,17408
 MF a[32:35],v[28:31],v[52:55]
 TR 12,13,74,16384
 MF a[36:39],v[28:31],v[56:59]
 TR 14,15,74,17408
 MF a[40:43],v[28:31],v[60:63]
 TR 16,17,75,16384
 DM 30,2048,78,s[16:19],24,sc1 lds
 MF a[44:47],v[28:31],v[64:67]
 TR 18,19,75,17408
 MF a[48:51],v[32:35],v[52:55]
 MF a[52:55],v[32:35],v[56:59]
 MF a[56:59],v[32:35],v[60:63]
 DM 30,3072,79,s[16:19],24,sc1 lds
 MF a[60:63],v[32:35],v[64:67]
 s_waitcnt lgkmcnt(0)
 MF a[0:3],v[4:7],v[36:39]
 RB 52,55,69,16384
 MF a[4:7],v[4:7],v[40:43]
 RB 56,59,69,16896
 MF a[8:11],v[4:7],v[44:47]
 RB 60,63,69,20480
 DM 31,0,80,s[20:23],25,lds
 MF a[12:15],v[4:7],v[48:51]
 RB 64,67,69,20992
 MF a[16:19],v[8:11],v[36:39]
 TR 20,21,72,24576
 MF a[20:23],v[8:11],v[40:43]
 TR 22,23,72,25600
 MF a[24:27],v[8:11],v[44:47]
 TR 24,25,73,24576
 DM 31,1024,81,s[20:23],25,lds
 MF a[28:31],v[8:11],v[48:51]
 TR 26,27,73,25600
 MF a[32:35],v[12:15],v[36:39]
 TR 28,29,74,24576
 MF a[36:39],v[12:15],v[40:43]
 TR 30,31,74,25600
 MF a[40:43],v[12:15],v[44:47]
 TR 32,33,75,24576
 DM 31,2048,82,s[20:23],25,lds
 MF a[44:47],v[12:15],v[48:51]
 TR 34,35,75,25600
 MF a[48:51],v[16:19],v[36:39]
 MF a[52:55],v[16:19],v[40:43]
 MF a[56:59],v[16:19],v[44:47]
 DM 31,3072,83,s[20:23],25,lds
 s_add_u32 s24, s24, 128
 s_add_u32 s25, s25, 524288
 MF a[60:63],v[16:19],v[48:51]
 s_waitcnt lgkmcnt(0)
 s_waitcnt vmcnt(16)
 s_barrier
 MF a[0:3],v[20:23],v[52:55]
 RB 36,39,68,32768
 MF a[4:7],v[20:23],v[56:59]
 RB 40,43,68,33280
 MF a[8:11],v[20:23],v[60:63]
 RB 44,47,68,36864
 DM 30,16384,76,s[16:19],24,sc1 lds
 MF a[12:15],v[20:23],v[64:67]
 RB 48,51,68,37376
 MF a[16:19],v[24:27],v[52:55]
 TR 4,5,72,32768
 MF a[20:23],v[24:27],v[56:59]
 TR 6,7,72,33792
 MF a[24:27],v[24:27],v[60:63]
 TR 8,9,73,32768
 DM 30,17408,77,s[16:19],24,sc1 lds
 MF a[28:31],v[24:27],v[64:67]
 TR 10,11,73,33792
 MF a[32:35],v[28:31],v[52:55]
 TR 12,13,74,32768
 MF a[36:39],v[28:31],v[56:59]
 TR 14,15,74,33792
 MF a[40:43],v[28:31],v[60:63]
 TR 16,17,75,32768
 DM 30,18432,78,s[16:19],24,sc1 lds
 MF a[44:47],v[28:31],v[64:67]
 TR 18,19,75,33792
 MF a[48:51],v[32:35],v[52:55]
 MF a[52:55],v[32:35],v[56:59]
 MF a[56:59],v[32:35],v[60:63]
 DM 30,19456,79,s[16:19],24,sc1 lds
 MF a[60:63],v[32:35],v[64:67]
 s_waitcnt lgkmcnt(0)
 MF a[0:3],v[4:7],v[36:39]
 RB 52,55,69,32768
 MF a[4:7],v[4:7],v[40:43]
 RB 56,59,69,33280
 MF a[8:11],v[4:7],v[44:47]
 RB 60,63,69,36864
 DM 31,16384,80,s[20:23],25,lds
 MF a[12:15],v[4:7],v[48:51]
 RB 64,67,69,37376
 MF a[16:19],v[8:11],v[36:39]
 TR 20,21,72,40960
 MF a[20:23],v[8:11],v[40:43]
 TR 22,23,72,41984
 MF a[24:27],v[8:11],v[44:47]
 TR 24,25,73,40960
 DM 31,17408,81,s[20:23],25,lds
 MF a[28:31],v[8:11],v[48:51]
 TR 26,27,73,41984
 MF a[32:35],v[12:15],v[36:39]
 TR 28,29,74,40960
 MF a[36:39],v[12:15],v[40:43]
 TR 30,31,74,41984
 MF a[40:43],v[12:15],v[44:47]
 TR 32,33,75,40960
 DM 31,18432,82,s[20:23],25,lds
 MF a[44:47],v[12:15],v[48:51]
 TR 34,35,75,41984
 MF a[48:51],v[16:19],v[36:39]
 MF a[52:55],v[16:19],v[40:43]
 MF a[56:59],v[16:19],v[44:47]
 DM 31,19456,83,s[20:23],25,lds
 s_add_u32 s24, s24, 128
 s_add_u32 s25, s25, 524288
 MF a[60:63],v[16:19],v[48:51]
 s_waitcnt lgkmcnt(0)
 s_waitcnt vmcnt(16)
 s_barrier
 MF a[0:3],v[20:23],v[52:55]
 RB 36,39,68,49152
 MF a[4:7],v[20:23],v[56:59]
 RB 40,43,68,49664
 MF a[8:11],v[20:23],v[60:63]
 RB 44,47,68,53248
 DM 30,32768,76,s[16:19],24,sc1 lds
 MF a[12:15],v[20:23],v[64:67]
 RB 48,51,68,53760
 MF a[16:19],v[24:27],v[52:55]
 TR 4,5,72,49152
 MF a[20:23],v[24:27],v[56:59]
 TR 6,7,72,50176
 MF a[24:27],v[24:27],v[60:63]
 TR 8,9,73,49152
 DM 30,33792,77,s[16:19],24,sc1 lds
 MF a[28:31],v[24:27],v[64:67]
 TR 10,11,73,50176
 MF a[32:35],v[28:31],v[52:55]
 TR 12,13,74,49152
 MF a[36:39],v[28:31],v[56:59]
 TR 14,15,74,50176
 MF a[40:43],v[28:31],v[60:63]
 TR 16,17,75,49152
 DM 30,34816,78,s[16:19],24,sc1 lds
 MF a[44:47],v[28:31],v[64:67]
 TR 18,19,75,50176
 MF a[48:51],v[32:35],v[52:55]
 MF a[52:55],v[32:35],v[56:59]
 MF a[56:59],v[32:35],v[60:63]
 DM 30,35840,79,s[16:19],24,sc1 lds
 MF a[60:63],v[32:35],v[64:67]
 s_waitcnt lgkmcnt(0)
 MF a[0:3],v[4:7],v[36:39]
 RB 52,55,69,49152
 MF a[4:7],v[4:7],v[40:43]
 RB 56,59,69,49664
 MF a[8:11],v[4:7],v[44:47]
 RB 60,63,69,53248
 DM 31,32768,80,s[20:23],25,lds
 MF a[12:15],v[4:7],v[48:51]
 RB 64,67,69,53760
 MF a[16:19],v[8:11],v[36:39]
 TR 20,21,72,57344
 MF a[20:23],v[8:11],v[40:43]
 TR 22,23,72,58368
 MF a[24:27],v[8:11],v[44:47]
 TR 24,25,73,57344
 DM 31,33792,81,s[20:23],25,lds
 MF a[28:31],v[8:11],v[48:51]
 TR 26,27,73,58368
 MF a[32:35],v[12:15],v[36:39]
 TR 28,29,74,57344
 MF a[36:39],v[12:15],v[40:43]
 TR 30,31,74,58368
 MF a[40:43],v[12:15],v[44:47]
 TR 32,33,75,57344
 DM 31,34816,82,s[20:23],25,lds
 MF a[44:47],v[12:15],v[48:51]
 TR 34,35,75,58368
 MF a[48:51],v[16:19],v[36:39]
 MF a[52:55],v[16:19],v[40:43]
 MF a[56:59],v[16:19],v[44:47]
 DM 31,35840,83,s[20:23],25,lds
 s_add_u32 s24, s24, 128
 s_add_u32 s25, s25, 524288
 MF a[60:63],v[16:19],v[48:51]
 s_waitcnt lgkmcnt(0)
 s_waitcnt vmcnt(16)
 s_barrier
 MF a[0:3],v[20:23],v[52:55]
 RB 36,39,68,0
 MF a[4:7],v[20:23],v[56:59]
 RB 40,43,68,512
 MF a[8:11],v[20:23],v[60:63]
 RB 44,47,68,4096
 DM 30,49152,76,s[16:19],24,sc1 lds
 MF a[12:15],v[20:23],v[64:67]
 RB 48,51,68,4608
 MF a[16:19],v[24:27],v[52:55]
 TR 4,5,72,0
 MF a[20:23],v[24:27],v[56:59]
 TR 6,7,72,1024
 MF a[24:27],v[24:27],v[60:63]
 TR 8,9,73,0
 DM 30,50176,77,s[16:19],24,sc1 lds
 MF a[28:31],v[24:27],v[64:67]
 TR 10,11,73,1024
 MF a[32:35],v[28:31],v[52:55]
 TR 12,13,74,0
 MF a[36:39],v[28:31],v[56:59]
 TR 14,15,74,1024
 MF a[40:43],v[28:31],v[60:63]
 TR 16,17,75,0
 DM 30,51200,78,s[16:19],24,sc1 lds
 MF a[44:47],v[28:31],v[64:67]
 TR 18,19,75,1024
 MF a[48:51],v[32:35],v[52:55]
 MF a[52:55],v[32:35],v[56:59]
 MF a[56:59],v[32:35],v[60:63]
 DM 30,52224,79,s[16:19],24,sc1 lds
 MF a[60:63],v[32:35],v[64:67]
 s_waitcnt lgkmcnt(0)
 s_sub_u32 s32, s32, 1
 s_cmp_lg_u32 s32, 0
 s_cbranch_scc1 kvs_loop_8
 MF a[0:3],v[4:7],v[36:39]
 RB 52,55,69,0
 MF a[4:7],v[4:7],v[40:43]
 RB 56,59,69,512
 MF a[8:11],v[4:7],v[44:47]
 RB 60,63,69,4096
 DM 31,49152,80,s[20:23],25,lds
 MF a[12:15],v[4:7],v[48:51]
 RB 64,67,69,4608
 MF a[16:19],v[8:11],v[36:39]
 TR 20,21,72,8192
 MF a[20:23],v[8:11],v[40:43]
 TR 22,23,72,9216
 MF a[24:27],v[8:11],v[44:47]
 TR 24,25,73,8192
 DM 31,50176,81,s[20:23],25,lds
 MF a[28:31],v[8:11],v[48:51]
 TR 26,27,73,9216
 MF a[32:35],v[12:15],v[36:39]
 TR 28,29,74,8192
 MF a[36:39],v[12:15],v[40:43]
 TR 30,31,74,9216
 MF a[40:43],v[12:15],v[44:47]
 TR 32,33,75,8192
 DM 31,51200,82,s[20:23],25,lds
 MF a[44:47],v[12:15],v[48:51]
 TR 34,35,75,9216
 MF a[48:51],v[16:19],v[36:39]
 MF a[52:55],v[16:19],v[40:43]
 MF a[56:59],v[16:19],v[44:47]
 DM 31,52224,83,s[20:23],25,lds
 s_add_u32 s24, s24, 128
 s_add_u32 s25, s25, 524288
 MF a[60:63],v[16:19],v[48:51]
 s_waitcnt lgkmcnt(0)
 s_waitcnt vmcnt(16)
 s_barrier
 MF a[0:3],v[20:23],v[52:55]
 RB 36,39,68,16384
 MF a[4:7],v[20:23],v[56:59]
 RB 40,43,68,16896
 MF a[8:11],v[20:23],v[60:63]
 RB 44,47,68,20480
 MF a[12:15],v[20:23],v[64:67]
 RB 48,51,68,20992
 MF a[16:19],v[24:27],v[52:55]
 TR 4,5,72,16384
 MF a[20:23],v[24:27],v[56:59]
 TR 6,7,72,17408
 MF a[24:27],v[24:27],v[60:63]
 TR 8,9,73,16384
 MF a[28:31],v[24:27],v[64:67]
 TR 10,11,73,17408
 MF a[32:35],v[28:31],v[52:55]
 TR 12,13,74,16384
 MF a[36:39],v[28:31],v[56:59]
 TR 14,15,74,17408
 MF a[40:43],v[28:31],v[60:63]
 TR 16,17,75,16384
 MF a[44:47],v[28:31],v[64:67]
 TR 18,19,75,17408
 MF a[48:51],v[32:35],v[52:55]
 MF a[52:55],v[32:35],v[56:59]
 MF a[56:59],v[32:35],v[60:63]
 MF a[60:63],v[32:35],v[64:67]
 s_waitcnt lgkmcnt(0)
 MF a[0:3],v[4:7],v[36:39]
 RB 52,55,69,16384
 MF a[4:7],v[4:7],v[40:43]
 RB 56,59,69,16896
 MF a[8:11],v[4:7],v[44:47]
 RB 60,63,69,20480
 MF a[12:15],v[4:7],v[48:51]
 RB 64,67,69,20992
 MF a[16:19],v[8:11],v[36:39]
 TR 20,21,72,24576
 MF a[20:23],v[8:11],v[40:43]
 TR 22,23,72,25600
 MF a[24:27],v[8:11],v[44:47]
 TR 24,25,73,24576
 MF a[28:31],v[8:11],v[48:51]
 TR 26,27,73,25600
 MF a[32:35],v[12:15],v[36:39]
 TR 28,29,74,24576
 MF a[36:39],v[12:15],v[40:43]
 TR 30,31,74,25600
 MF a[40:43],v[12:15],v[44:47]
 TR 32,33,75,24576
 MF a[44:47],v[12:15],v[48:51]
 TR 34,35,75,25600
 MF a[48:51],v[16:19],v[36:39]
 MF a[52:55],v[16:19],v[40:43]
 MF a[56:59],v[16:19],v[44:47]
 MF a[60:63],v[16:19],v[48:51]
 s_waitcnt lgkmcnt(0)
 s_waitcnt vmcnt(8)
 s_barrier
 MF a[0:3],v[20:23],v[52:55]
 RB 36,39,68,32768
 MF a[4:7],v[20:23],v[56:59]
 RB 40,43,68,33280
 MF a[8:11],v[20:23],v[60:63]
 RB 44,47,68,36864
 MF a[12:15],v[20:23],v[64:67]
 RB 48,51,68,37376
 MF a[16:19],v[24:27],v[52:55]
 TR 4,5,72,32768
 MF a[20:23],v[24:27],v[56:59]
 TR 6,7,72,33792
 MF a[24:27],v[24:27],v[60:63]
 TR 8,9,73,32768
 MF a[28:31],v[24:27],v[64:67]
 TR 10,11,73,33792
 MF a[32:35],v[28:31],v[52:55]
 TR 12,13,74,32768
 MF a[36:39],v[28:31],v[56:59]
 TR 14,15,74,33792
 MF a[40:43],v[28:31],v[60:63]
 TR 16,17,75,32768
 MF a[44:47],v[28:31],v[64:67]
 TR 18,19,75,33792
 MF a[48:51],v[32:35],v[52:55]
 MF a[52:55],v[32:35],v[56:59]
 MF a[56:59],v[32:35],v[60:63]
 MF a[60:63],v[32:35],v[64:67]
 s_waitcnt lgkmcnt(0)
 MF a[0:3],v[4:7],v[36:39]
 RB 52,55,69,32768
 MF a[4:7],v[4:7],v[40:43]
 RB 56,59,69,33280
 MF a[8:11],v[4:7],v[44:47]
 RB 60,63,69,36864
 MF a[12:15],v[4:7],v[48:51]
 RB 64,67,69,37376
 MF a[16:19],v[8:11],v[36:39]
 TR 20,21,72,40960
 MF a[20:23],v[8:11],v[40:43]
 TR 22,23,72,41984
 MF a[24:27],v[8:11],v[44:47]
 TR 24,25,73,40960
 MF a[28:31],v[8:11],v[48:51]
 TR 26,27,73,41984
 MF a[32:35],v[12:15],v[36:39]
 TR 28,29,74,40960
 MF a[36:39],v[12:15],v[40:43]
 TR 30,31,74,41984
 MF a[40:43],v[12:15],v[44:47]
 TR 32,33,75,40960
 MF a[44:47],v[12:15],v[48:51]
 TR 34,35,75,41984
 MF a[48:51],v[16:19],v[36:39]
 MF a[52:55],v[16:19],v[40:43]
 MF a[56:59],v[16:19],v[44:47]
 MF a[60:63],v[16:19],v[48:51]
 s_waitcnt lgkmcnt(0)
 s_waitcnt vmcnt(0)
 s_barrier
 MF a[0:3],v[20:23],v[52:55]
 RB 36,39,68,49152
 MF a[4:7],v[20:23],v[56:59]
 RB 40,43,68,49664
 MF a[8:11],v[20:23],v[60:63]
 RB 44,47,68,53248
 MF a[12:15],v[20:23],v[64:67]
 RB 48,51,68,53760
 MF a[16:19],v[24:27],v[52:55]
 TR 4,5,72,49152
 MF a[20:23],v[24:27],v[56:59]
 TR 6,7,72,50176
 MF a[24:27],v[24:27],v[60:63]
 TR 8,9,73,49152
 MF a[28:31],v[24:27],v[64:67]
 TR 10,11,73,50176
 MF a[32:35],v[28:31],v[52:55]
 TR 12,13,74,49152
 MF a[36:39],v[28:31],v[56:59]
 TR 14,15,74,50176
 MF a[40:43],v[28:31],v[60:63]
 TR 16,17,75,49152
 MF a[44:47],v[28:31],v[64:67]
 TR 18,19,75,50176
 MF a[48:51],v[32:35],v[52:55]
 MF a[52:55],v[32:35],v[56:59]
 MF a[56:59],v[32:35],v[60:63]
 MF a[60:63],v[32:35],v[64:67]
 s_waitcnt lgkmcnt(0)
 MF a[0:3],v[4:7],v[36:39]
 RB 52,55,69,49152
 MF a[4:7],v[4:7],v[40:43]
 RB 56,59,69,49664
 MF a[8:11],v[4:7],v[44:47]
 RB 60,63,69,53248
 MF a[12:15],v[4:7],v[48:51]
 RB 64,67,69,53760
 MF a[16:19],v[8:11],v[36:39]
 TR 20,21,72,57344
 MF a[20:23],v[8:11],v[40:43]
 TR 22,23,72,58368
 MF a[24:27],v[8:11],v[44:47]
 TR 24,25,73,57344
 MF a[28:31],v[8:11],v[48:51]
 TR 26,27,73,58368
 MF a[32:35],v[12:15],v[36:39]
 TR 28,29,74,57344
 MF a[36:39],v[12:15],v[40:43]
 TR 30,31,74,58368
 MF a[40:43],v[12:15],v[44:47]
 TR 32,33,75,57344
 MF a[44:47],v[12:15],v[48:51]
 TR 34,35,75,58368
 MF a[48:51],v[16:19],v[36:39]
 MF a[52:55],v[16:19],v[40:43]
 MF a[56:59],v[16:19],v[44:47]
 MF a[60:63],v[16:19],v[48:51]
 s_waitcnt lgkmcnt(0)
 MF a[0:3],v[20:23],v[52:55]
 MF a[4:7],v[20:23],v[56:59]
 MF a[8:11],v[20:23],v[60:63]
 MF a[12:15],v[20:23],v[64:67]
 MF a[16:19],v[24:27],v[52:55]
 MF a[20:23],v[24:27],v[56:59]
 MF a[24:27],v[24:27],v[60:63]
 MF a[28:31],v[24:27],v[64:67]
 MF a[32:35],v[28:31],v[52:55]
 MF a[36:39],v[28:31],v[56:59]
 MF a[40:43],v[28:31],v[60:63]
 MF a[44:47],v[28:31],v[64:67]
 MF a[48:51],v[32:35],v[52:55]
 MF a[52:55],v[32:35],v[56:59]
 MF a[56:59],v[32:35],v[60:63]
 MF a[60:63],v[32:35],v[64:67]
 v_lshlrev_b32 v3, 4, v2
 s_mul_i32 s26, s10, 4
 s_mul_i32 s27, s33, 2
 s_add_u32 s26, s26, s27
 s_lshl_b32 s26, s26, 18
 s_mul_i32 s27, s12, 128
 s_mul_i32 s28, s34, 64
 s_add_u32 s27, s27, s28
 s_lshr_b32 s28, s27, 7
 s_lshl_b32 s28, s28, 13
 s_add_u32 s26, s26, s28
 s_and_b32 s27, s27, 127
 s_lshl_b32 s27, s27, 5
 s_add_u32 s26, s26, s27
 s_add_u32 s26, s26, s29
 s_nop 3
 AR 36,0
 AR 37,1
 AR 38,2
 AR 39,3
 AR 40,16
 AR 41,17
 AR 42,18
 AR 43,19
 CV 4,36,37
 CV 5,38,39
 CV 6,40,41
 CV 7,42,43
 buffer_store_dwordx4 v[4:7], v3, s[16:19], s26 offen offset:0 sc1
 AR 44,32
 AR 45,33
 AR 46,34
 AR 47,35
 AR 48,48
 AR 49,49
 AR 50,50
 AR 51,51
 CV 8,44,45
 CV 9,46,47
 CV 10,48,49
 CV 11,50,51
 buffer_store_dwordx4 v[8:11], v3, s[16:19], s26 offen offset:1024 sc1
 s_add_u32 s26, s26, 4096
 AR 36,4
 AR 37,5
 AR 38,6
 AR 39,7
 AR 40,20
 AR 41,21
 AR 42,22
 AR 43,23
 CV 12,36,37
 CV 13,38,39
 CV 14,40,41
 CV 15,42,43
 buffer_store_dwordx4 v[12:15], v3, s[16:19], s26 offen offset:0 sc1
 AR 44,36
 AR 45,37
 AR 46,38
 AR 47,39
 AR 48,52
 AR 49,53
 AR 50,54
 AR 51,55
 CV 16,44,45
 CV 17,46,47
 CV 18,48,49
 CV 19,50,51
 buffer_store_dwordx4 v[16:19], v3, s[16:19], s26 offen offset:1024 sc1
 s_add_u32 s26, s26, 258048
 AR 36,8
 AR 37,9
 AR 38,10
 AR 39,11
 AR 40,24
 AR 41,25
 AR 42,26
 AR 43,27
 CV 20,36,37
 CV 21,38,39
 CV 22,40,41
 CV 23,42,43
 buffer_store_dwordx4 v[20:23], v3, s[16:19], s26 offen offset:0 sc1
 AR 44,40
 AR 45,41
 AR 46,42
 AR 47,43
 AR 48,56
 AR 49,57
 AR 50,58
 AR 51,59
 CV 24,44,45
 CV 25,46,47
 CV 26,48,49
 CV 27,50,51
 buffer_store_dwordx4 v[24:27], v3, s[16:19], s26 offen offset:1024 sc1
 s_add_u32 s26, s26, 4096
 AR 36,12
 AR 37,13
 AR 38,14
 AR 39,15
 AR 40,28
 AR 41,29
 AR 42,30
 AR 43,31
 CV 28,36,37
 CV 29,38,39
 CV 30,40,41
 CV 31,42,43
 buffer_store_dwordx4 v[28:31], v3, s[16:19], s26 offen offset:0 sc1
 AR 44,44
 AR 45,45
 AR 46,46
 AR 47,47
 AR 48,60
 AR 49,61
 AR 50,62
 AR 51,63
 CV 32,44,45
 CV 33,46,47
 CV 34,48,49
 CV 35,50,51
 buffer_store_dwordx4 v[32:35], v3, s[16:19], s26 offen offset:1024 sc1
 s_add_u32 s26, s26, 258048
 s_branch mk_done
mk_b_kvl:
 s_cmp_ge_u32 s11, 16
 s_cselect_b32 s4, s64, s62
 s_cselect_b32 s5, s65, s63
 s_cmp_ge_u32 s11, 32
 s_cselect_b32 s4, s60, s4
 s_cselect_b32 s5, s61, s5
 s_mov_b32 s29, 20971520
 s_cselect_b32 s29, 121634816, s29
 s_mov_b32 s20, s4
 s_and_b32 s21, s5, 0xffff
 s_mov_b32 s22, 0x800000
 s_mov_b32 s23, 0x00020000
 s_cmp_ge_u32 s11, 32
 s_cbranch_scc1 mk_kvl_na
 s_mul_i32 s24, s10, 4194304
 s_mul_i32 s25, s11, 131072
 s_add_u32 s24, s24, s25
 s_add_u32 s24, s24, 83886080
 v_lshlrev_b32 v3, 4, v0
 v_mov_b32 v4, -1
 v_mov_b32 v5, -1
 v_mov_b32 v6, -1
 v_mov_b32 v7, -1
 s_mov_b32 s25, 32
mk_kvl_al:
 buffer_store_dwordx4 v[4:7], v3, s[16:19], s24 offen sc1
 s_add_u32 s24, s24, 4096
 s_sub_u32 s25, s25, 1
 s_cmp_lg_u32 s25, 0
 s_cbranch_scc1 mk_kvl_al
mk_kvl_na:
 s_mul_i32 s24, s10, 524288
 s_add_u32 s24, s24, 0
 s_and_b32 s12, s11, 15
 s_mul_i32 s25, s12, 512
 s_cmp_ge_u32 s11, 16
 s_cbranch_scc1 mk_kvl_v
 s_mov_b32 s29, 4194304
 s_lshr_b32 s33, s13, 1
 s_and_b32 s34, s13, 1
 v_and_b32 v128, 15, v2
 v_lshrrev_b32 v129, 4, v2
 v_lshrrev_b32 v130, 1, v128
 v_xor_b32 v130, v130, v129
 v_lshrrev_b32 v131, 2, v128
 v_lshlrev_b32 v131, 3, v131
 v_and_b32 v132, 3, v128
 v_add_u32 v131, v131, v132
 s_mul_i32 s35, s33, 16384
 s_add_u32 s35, s35, 0
 v_lshlrev_b32 v131, 7, v131
 v_add_u32 v131, s35, v131
 v_lshlrev_b32 v132, 4, v130
 v_add_u32 v100, v131, v132
 v_xor_b32 v132, 64, v132
 v_add_u32 v101, v131, v132
 v_lshrrev_b32 v130, 2, v128
 v_and_b32 v131, 3, v2
 v_and_b32 v132, 1, v129
 v_lshlrev_b32 v132, 2, v132
 v_or_b32 v132, v132, v130
 v_lshlrev_b32 v129, 3, v129
 v_add_u32 v129, v129, v130
 v_mul_u32_u24 v129, 512, v129
 v_lshlrev_b32 v131, 3, v131
 v_add_u32 v129, v129, v131
 v_add_u32 v129, 65536, v129
 s_mul_i32 s35, s34, 8
 s_add_u32 s36, s35, 0
 v_xor_b32 v130, s36, v132
 v_lshlrev_b32 v130, 5, v130
 v_add_u32 v104, v129, v130
 s_add_u32 s36, s35, 1
 v_xor_b32 v130, s36, v132
 v_lshlrev_b32 v130, 5, v130
 v_add_u32 v105, v129, v130
 s_add_u32 s36, s35, 2
 v_xor_b32 v130, s36, v132
 v_lshlrev_b32 v130, 5, v130
 v_add_u32 v106, v129, v130
 s_add_u32 s36, s35, 3
 v_xor_b32 v130, s36, v132
 v_lshlrev_b32 v130, 5, v130
 v_add_u32 v107, v129, v130
 s_add_u32 s36, s35, 4
 v_xor_b32 v130, s36, v132
 v_lshlrev_b32 v130, 5, v130
 v_add_u32 v108, v129, v130
 s_add_u32 s36, s35, 5
 v_xor_b32 v130, s36, v132
 v_lshlrev_b32 v130, 5, v130
 v_add_u32 v109, v129, v130
 s_add_u32 s36, s35, 6
 v_xor_b32 v130, s36, v132
 v_lshlrev_b32 v130, 5, v130
 v_add_u32 v110, v129, v130
 s_add_u32 s36, s35, 7
 v_xor_b32 v130, s36, v132
 v_lshlrev_b32 v130, 5, v130
 v_add_u32 v111, v129, v130
 v_lshrrev_b32 v128, 3, v2
 v_and_b32 v129, 7, v2
 s_mul_i32 s35, s13, 8
 s_add_u32 s36, s35, 0
 s_lshl_b32 s37, s36, 3
 v_add_u32 v130, s37, v128
 v_bfe_u32 v131, v130, 1, 1
 v_bfe_u32 v132, v130, 3, 2
 v_lshlrev_b32 v132, 1, v132
 v_or_b32 v131, v131, v132
 v_xor_b32 v131, v131, v129
 v_lshlrev_b32 v131, 4, v131
 v_mul_u32_u24 v130, 2048, v130
 v_add_u32 v112, v130, v131
 s_add_u32 s36, s35, 1
 s_lshl_b32 s37, s36, 3
 v_add_u32 v130, s37, v128
 v_bfe_u32 v131, v130, 1, 1
 v_bfe_u32 v132, v130, 3, 2
 v_lshlrev_b32 v132, 1, v132
 v_or_b32 v131, v131, v132
 v_xor_b32 v131, v131, v129
 v_lshlrev_b32 v131, 4, v131
 v_mul_u32_u24 v130, 2048, v130
 v_add_u32 v113, v130, v131
 s_add_u32 s36, s35, 2
 s_lshl_b32 s37, s36, 3
 v_add_u32 v130, s37, v128
 v_bfe_u32 v131, v130, 1, 1
 v_bfe_u32 v132, v130, 3, 2
 v_lshlrev_b32 v132, 1, v132
 v_or_b32 v131, v131, v132
 v_xor_b32 v131, v131, v129
 v_lshlrev_b32 v131, 4, v131
 v_mul_u32_u24 v130, 2048, v130
 v_add_u32 v114, v130, v131
 s_add_u32 s36, s35, 3
 s_lshl_b32 s37, s36, 3
 v_add_u32 v130, s37, v128
 v_bfe_u32 v131, v130, 1, 1
 v_bfe_u32 v132, v130, 3, 2
 v_lshlrev_b32 v132, 1, v132
 v_or_b32 v131, v131, v132
 v_xor_b32 v131, v131, v129
 v_lshlrev_b32 v131, 4, v131
 v_mul_u32_u24 v130, 2048, v130
 v_add_u32 v115, v130, v131
 s_add_u32 s36, s35, 4
 s_lshl_b32 s37, s36, 3
 v_add_u32 v130, s37, v128
 v_bfe_u32 v131, v130, 1, 1
 v_bfe_u32 v132, v130, 3, 2
 v_lshlrev_b32 v132, 1, v132
 v_or_b32 v131, v131, v132
 v_xor_b32 v131, v131, v129
 v_lshlrev_b32 v131, 4, v131
 v_mul_u32_u24 v130, 2048, v130
 v_add_u32 v116, v130, v131
 s_add_u32 s36, s35, 5
 s_lshl_b32 s37, s36, 3
 v_add_u32 v130, s37, v128
 v_bfe_u32 v131, v130, 1, 1
 v_bfe_u32 v132, v130, 3, 2
 v_lshlrev_b32 v132, 1, v132
 v_or_b32 v131, v131, v132
 v_xor_b32 v131, v131, v129
 v_lshlrev_b32 v131, 4, v131
 v_mul_u32_u24 v130, 2048, v130
 v_add_u32 v117, v130, v131
 s_add_u32 s36, s35, 6
 s_lshl_b32 s37, s36, 3
 v_add_u32 v130, s37, v128
 v_bfe_u32 v131, v130, 1, 1
 v_bfe_u32 v132, v130, 3, 2
 v_lshlrev_b32 v132, 1, v132
 v_or_b32 v131, v131, v132
 v_xor_b32 v131, v131, v129
 v_lshlrev_b32 v131, 4, v131
 v_mul_u32_u24 v130, 2048, v130
 v_add_u32 v118, v130, v131
 s_add_u32 s36, s35, 7
 s_lshl_b32 s37, s36, 3
 v_add_u32 v130, s37, v128
 v_bfe_u32 v131, v130, 1, 1
 v_bfe_u32 v132, v130, 3, 2
 v_lshlrev_b32 v132, 1, v132
 v_or_b32 v131, v131, v132
 v_xor_b32 v131, v131, v129
 v_lshlrev_b32 v131, 4, v131
 v_mul_u32_u24 v130, 2048, v130
 v_add_u32 v119, v130, v131
 s_mul_i32 s30, s13, 8192
 s_add_u32 s30, s30, 0
 v_lshlrev_b32 v128, 4, v2
 s_mul_i32 s35, s13, 8192
 s_add_u32 s36, s35, 0
 v_add_u32 v129, s36, v128
 v_lshrrev_b32 v130, 9, v129
 v_and_b32 v129, 511, v129
 v_bfe_u32 v132, v130, 3, 1
 v_and_b32 v131, 3, v130
 v_lshlrev_b32 v132, 2, v132
 v_or_b32 v131, v131, v132
 v_lshlrev_b32 v131, 5, v131
 v_xor_b32 v129, v129, v131
 v_mul_u32_u24 v130, 8192, v130
 v_add_u32 v120, v130, v129
 s_add_u32 s36, s35, 1024
 v_add_u32 v129, s36, v128
 v_lshrrev_b32 v130, 9, v129
 v_and_b32 v129, 511, v129
 v_bfe_u32 v132, v130, 3, 1
 v_and_b32 v131, 3, v130
 v_lshlrev_b32 v132, 2, v132
 v_or_b32 v131, v131, v132
 v_lshlrev_b32 v131, 5, v131
 v_xor_b32 v129, v129, v131
 v_mul_u32_u24 v130, 8192, v130
 v_add_u32 v121, v130, v129
 s_add_u32 s36, s35, 2048
 v_add_u32 v129, s36, v128
 v_lshrrev_b32 v130, 9, v129
 v_and_b32 v129, 511, v129
 v_bfe_u32 v132, v130, 3, 1
 v_and_b32 v131, 3, v130
 v_lshlrev_b32 v132, 2, v132
 v_or_b32 v131, v131, v132
 v_lshlrev_b32 v131, 5, v131
 v_xor_b32 v129, v129, v131
 v_mul_u32_u24 v130, 8192, v130
 v_add_u32 v122, v130, v129
 s_add_u32 s36, s35, 3072
 v_add_u32 v129, s36, v128
 v_lshrrev_b32 v130, 9, v129
 v_and_b32 v129, 511, v129
 v_bfe_u32 v132, v130, 3, 1
 v_and_b32 v131, 3, v130
 v_lshlrev_b32 v132, 2, v132
 v_or_b32 v131, v131, v132
 v_lshlrev_b32 v131, 5, v131
 v_xor_b32 v129, v129, v131
 v_mul_u32_u24 v130, 8192, v130
 v_add_u32 v123, v130, v129
 s_add_u32 s36, s35, 4096
 v_add_u32 v129, s36, v128
 v_lshrrev_b32 v130, 9, v129
 v_and_b32 v129, 511, v129
 v_bfe_u32 v132, v130, 3, 1
 v_and_b32 v131, 3, v130
 v_lshlrev_b32 v132, 2, v132
 v_or_b32 v131, v131, v132
 v_lshlrev_b32 v131, 5, v131
 v_xor_b32 v129, v129, v131
 v_mul_u32_u24 v130, 8192, v130
 v_add_u32 v124, v130, v129
 s_add_u32 s36, s35, 5120
 v_add_u32 v129, s36, v128
 v_lshrrev_b32 v130, 9, v129
 v_and_b32 v129, 511, v129
 v_bfe_u32 v132, v130, 3, 1
 v_and_b32 v131, 3, v130
 v_lshlrev_b32 v132, 2, v132
 v_or_b32 v131, v131, v132
 v_lshlrev_b32 v131, 5, v131
 v_xor_b32 v129, v129, v131
 v_mul_u32_u24 v130, 8192, v130
 v_add_u32 v125, v130, v129
 s_add_u32 s36, s35, 6144
 v_add_u32 v129, s36, v128
 v_lshrrev_b32 v130, 9, v129
 v_and_b32 v129, 511, v129
 v_bfe_u32 v132, v130, 3, 1
 v_and_b32 v131, 3, v130
 v_lshlrev_b32 v132, 2, v132
 v_or_b32 v131, v131, v132
 v_lshlrev_b32 v131, 5, v131
 v_xor_b32 v129, v129, v131
 v_mul_u32_u24 v130, 8192, v130
 v_add_u32 v126, v130, v129
 s_add_u32 s36, s35, 7168
 v_add_u32 v129, s36, v128
 v_lshrrev_b32 v130, 9, v129
 v_and_b32 v129, 511, v129
 v_bfe_u32 v132, v130, 3, 1
 v_and_b32 v131, 3, v130
 v_lshlrev_b32 v132, 2, v132
 v_or_b32 v131, v131, v132
 v_lshlrev_b32 v131, 5, v131
 v_xor_b32 v129, v129, v131
 v_mul_u32_u24 v130, 8192, v130
 v_add_u32 v127, v130, v129
 s_mul_i32 s31, s13, 8192
 s_add_u32 s31, s31, 65536
 AW 0
 AW 1
 AW 2
 AW 3
 AW 4
 AW 5
 AW 6
 AW 7
 AW 8
 AW 9
 AW 10
 AW 11
 AW 12
 AW 13
 AW 14
 AW 15
 AW 16
 AW 17
 AW 18
 AW 19
 AW 20
 AW 21
 AW 22
 AW 23
 AW 24
 AW 25
 AW 26
 AW 27
 AW 28
 AW 29
 AW 30
 AW 31
 AW 32
 AW 33
 AW 34
 AW 35
 AW 36
 AW 37
 AW 38
 AW 39
 AW 40
 AW 41
 AW 42
 AW 43
 AW 44
 AW 45
 AW 46
 AW 47
 AW 48
 AW 49
 AW 50
 AW 51
 AW 52
 AW 53
 AW 54
 AW 55
 AW 56
 AW 57
 AW 58
 AW 59
 AW 60
 AW 61
 AW 62
 AW 63
 AW 64
 AW 65
 AW 66
 AW 67
 AW 68
 AW 69
 AW 70
 AW 71
 AW 72
 AW 73
 AW 74
 AW 75
 AW 76
 AW 77
 AW 78
 AW 79
 AW 80
 AW 81
 AW 82
 AW 83
 AW 84
 AW 85
 AW 86
 AW 87
 AW 88
 AW 89
 AW 90
 AW 91
 AW 92
 AW 93
 AW 94
 AW 95
 AW 96
 AW 97
 AW 98
 AW 99
 AW 100
 AW 101
 AW 102
 AW 103
 AW 104
 AW 105
 AW 106
 AW 107
 AW 108
 AW 109
 AW 110
 AW 111
 AW 112
 AW 113
 AW 114
 AW 115
 AW 116
 AW 117
 AW 118
 AW 119
 AW 120
 AW 121
 AW 122
 AW 123
 AW 124
 AW 125
 AW 126
 AW 127
 AW 128
 AW 129
 AW 130
 AW 131
 AW 132
 AW 133
 AW 134
 AW 135
 AW 136
 AW 137
 AW 138
 AW 139
 AW 140
 AW 141
 AW 142
 AW 143
 AW 144
 AW 145
 AW 146
 AW 147
 AW 148
 AW 149
 AW 150
 AW 151
 AW 152
 AW 153
 AW 154
 AW 155
 AW 156
 AW 157
 AW 158
 AW 159
 AW 160
 AW 161
 AW 162
 AW 163
 AW 164
 AW 165
 AW 166
 AW 167
 AW 168
 AW 169
 AW 170
 AW 171
 AW 172
 AW 173
 AW 174
 AW 175
 AW 176
 AW 177
 AW 178
 AW 179
 AW 180
 AW 181
 AW 182
 AW 183
 AW 184
 AW 185
 AW 186
 AW 187
 AW 188
 AW 189
 AW 190
 AW 191
 AW 192
 AW 193
 AW 194
 AW 195
 AW 196
 AW 197
 AW 198
 AW 199
 AW 200
 AW 201
 AW 202
 AW 203
 AW 204
 AW 205
 AW 206
 AW 207
 AW 208
 AW 209
 AW 210
 AW 211
 AW 212
 AW 213
 AW 214
 AW 215
 AW 216
 AW 217
 AW 218
 AW 219
 AW 220
 AW 221
 AW 222
 AW 223
 AW 224
 AW 225
 AW 226
 AW 227
 AW 228
 AW 229
 AW 230
 AW 231
 AW 232
 AW 233
 AW 234
 AW 235
 AW 236
 AW 237
 AW 238
 AW 239
 AW 240
 AW 241
 AW 242
 AW 243
 AW 244
 AW 245
 AW 246
 AW 247
 AW 248
 AW 249
 AW 250
 AW 251
 AW 252
 AW 253
 AW 254
 AW 255
 s_branch mk_kvl_m
mk_kvl_v:
 s_lshr_b32 s33, s13, 1
 s_and_b32 s34, s13, 1
 v_and_b32 v128, 15, v2
 v_lshrrev_b32 v129, 4, v2
 v_lshrrev_b32 v130, 1, v128
 v_xor_b32 v130, v130, v129
 v_lshrrev_b32 v131, 2, v128
 v_lshlrev_b32 v131, 3, v131
 v_and_b32 v132, 3, v128
 v_add_u32 v131, v131, v132
 s_mul_i32 s35, s33, 16384
 s_add_u32 s35, s35, 0
 v_lshlrev_b32 v131, 7, v131
 v_add_u32 v131, s35, v131
 v_lshlrev_b32 v132, 4, v130
 v_add_u32 v100, v131, v132
 v_xor_b32 v132, 64, v132
 v_add_u32 v101, v131, v132
 v_lshrrev_b32 v130, 2, v128
 v_and_b32 v131, 3, v2
 v_and_b32 v132, 1, v129
 v_lshlrev_b32 v132, 2, v132
 v_or_b32 v132, v132, v130
 v_lshlrev_b32 v129, 3, v129
 v_add_u32 v129, v129, v130
 v_mul_u32_u24 v129, 512, v129
 v_lshlrev_b32 v131, 3, v131
 v_add_u32 v129, v129, v131
 v_add_u32 v129, 65536, v129
 s_mul_i32 s35, s34, 8
 s_add_u32 s36, s35, 0
 v_xor_b32 v130, s36, v132
 v_lshlrev_b32 v130, 5, v130
 v_add_u32 v104, v129, v130
 s_add_u32 s36, s35, 1
 v_xor_b32 v130, s36, v132
 v_lshlrev_b32 v130, 5, v130
 v_add_u32 v105, v129, v130
 s_add_u32 s36, s35, 2
 v_xor_b32 v130, s36, v132
 v_lshlrev_b32 v130, 5, v130
 v_add_u32 v106, v129, v130
 s_add_u32 s36, s35, 3
 v_xor_b32 v130, s36, v132
 v_lshlrev_b32 v130, 5, v130
 v_add_u32 v107, v129, v130
 s_add_u32 s36, s35, 4
 v_xor_b32 v130, s36, v132
 v_lshlrev_b32 v130, 5, v130
 v_add_u32 v108, v129, v130
 s_add_u32 s36, s35, 5
 v_xor_b32 v130, s36, v132
 v_lshlrev_b32 v130, 5, v130
 v_add_u32 v109, v129, v130
 s_add_u32 s36, s35, 6
 v_xor_b32 v130, s36, v132
 v_lshlrev_b32 v130, 5, v130
 v_add_u32 v110, v129, v130
 s_add_u32 s36, s35, 7
 v_xor_b32 v130, s36, v132
 v_lshlrev_b32 v130, 5, v130
 v_add_u32 v111, v129, v130
 v_lshrrev_b32 v128, 3, v2
 v_and_b32 v129, 7, v2
 s_mul_i32 s35, s13, 8
 s_add_u32 s36, s35, 0
 s_lshl_b32 s37, s36, 3
 v_add_u32 v130, s37, v128
 v_bfe_u32 v131, v130, 1, 1
 v_bfe_u32 v132, v130, 3, 2
 v_lshlrev_b32 v132, 1, v132
 v_or_b32 v131, v131, v132
 v_xor_b32 v131, v131, v129
 v_lshlrev_b32 v131, 4, v131
 v_bfe_u32 v132, v130, 2, 1
 v_bfe_u32 v133, v130, 3, 2
 v_and_b32 v130, 0xffe3, v130
 v_lshl_or_b32 v130, v132, 4, v130
 v_lshl_or_b32 v130, v133, 2, v130
 v_mul_u32_u24 v130, 2048, v130
 v_add_u32 v112, v130, v131
 s_add_u32 s36, s35, 1
 s_lshl_b32 s37, s36, 3
 v_add_u32 v130, s37, v128
 v_bfe_u32 v131, v130, 1, 1
 v_bfe_u32 v132, v130, 3, 2
 v_lshlrev_b32 v132, 1, v132
 v_or_b32 v131, v131, v132
 v_xor_b32 v131, v131, v129
 v_lshlrev_b32 v131, 4, v131
 v_bfe_u32 v132, v130, 2, 1
 v_bfe_u32 v133, v130, 3, 2
 v_and_b32 v130, 0xffe3, v130
 v_lshl_or_b32 v130, v132, 4, v130
 v_lshl_or_b32 v130, v133, 2, v130
 v_mul_u32_u24 v130, 2048, v130
 v_add_u32 v113, v130, v131
 s_add_u32 s36, s35, 2
 s_lshl_b32 s37, s36, 3
 v_add_u32 v130, s37, v128
 v_bfe_u32 v131, v130, 1, 1
 v_bfe_u32 v132, v130, 3, 2
 v_lshlrev_b32 v132, 1, v132
 v_or_b32 v131, v131, v132
 v_xor_b32 v131, v131, v129
 v_lshlrev_b32 v131, 4, v131
 v_bfe_u32 v132, v130, 2, 1
 v_bfe_u32 v133, v130, 3, 2
 v_and_b32 v130, 0xffe3, v130
 v_lshl_or_b32 v130, v132, 4, v130
 v_lshl_or_b32 v130, v133, 2, v130
 v_mul_u32_u24 v130, 2048, v130
 v_add_u32 v114, v130, v131
 s_add_u32 s36, s35, 3
 s_lshl_b32 s37, s36, 3
 v_add_u32 v130, s37, v128
 v_bfe_u32 v131, v130, 1, 1
 v_bfe_u32 v132, v130, 3, 2
 v_lshlrev_b32 v132, 1, v132
 v_or_b32 v131, v131, v132
 v_xor_b32 v131, v131, v129
 v_lshlrev_b32 v131, 4, v131
 v_bfe_u32 v132, v130, 2, 1
 v_bfe_u32 v133, v130, 3, 2
 v_and_b32 v130, 0xffe3, v130
 v_lshl_or_b32 v130, v132, 4, v130
 v_lshl_or_b32 v130, v133, 2, v130
 v_mul_u32_u24 v130, 2048, v130
 v_add_u32 v115, v130, v131
 s_add_u32 s36, s35, 4
 s_lshl_b32 s37, s36, 3
 v_add_u32 v130, s37, v128
 v_bfe_u32 v131, v130, 1, 1
 v_bfe_u32 v132, v130, 3, 2
 v_lshlrev_b32 v132, 1, v132
 v_or_b32 v131, v131, v132
 v_xor_b32 v131, v131, v129
 v_lshlrev_b32 v131, 4, v131
 v_bfe_u32 v132, v130, 2, 1
 v_bfe_u32 v133, v130, 3, 2
 v_and_b32 v130, 0xffe3, v130
 v_lshl_or_b32 v130, v132, 4, v130
 v_lshl_or_b32 v130, v133, 2, v130
 v_mul_u32_u24 v130, 2048, v130
 v_add_u32 v116, v130, v131
 s_add_u32 s36, s35, 5
 s_lshl_b32 s37, s36, 3
 v_add_u32 v130, s37, v128
 v_bfe_u32 v131, v130, 1, 1
 v_bfe_u32 v132, v130, 3, 2
 v_lshlrev_b32 v132, 1, v132
 v_or_b32 v131, v131, v132
 v_xor_b32 v131, v131, v129
 v_lshlrev_b32 v131, 4, v131
 v_bfe_u32 v132, v130, 2, 1
 v_bfe_u32 v133, v130, 3, 2
 v_and_b32 v130, 0xffe3, v130
 v_lshl_or_b32 v130, v132, 4, v130
 v_lshl_or_b32 v130, v133, 2, v130
 v_mul_u32_u24 v130, 2048, v130
 v_add_u32 v117, v130, v131
 s_add_u32 s36, s35, 6
 s_lshl_b32 s37, s36, 3
 v_add_u32 v130, s37, v128
 v_bfe_u32 v131, v130, 1, 1
 v_bfe_u32 v132, v130, 3, 2
 v_lshlrev_b32 v132, 1, v132
 v_or_b32 v131, v131, v132
 v_xor_b32 v131, v131, v129
 v_lshlrev_b32 v131, 4, v131
 v_bfe_u32 v132, v130, 2, 1
 v_bfe_u32 v133, v130, 3, 2
 v_and_b32 v130, 0xffe3, v130
 v_lshl_or_b32 v130, v132, 4, v130
 v_lshl_or_b32 v130, v133, 2, v130
 v_mul_u32_u24 v130, 2048, v130
 v_add_u32 v118, v130, v131
 s_add_u32 s36, s35, 7
 s_lshl_b32 s37, s36, 3
 v_add_u32 v130, s37, v128
 v_bfe_u32 v131, v130, 1, 1
 v_bfe_u32 v132, v130, 3, 2
 v_lshlrev_b32 v132, 1, v132
 v_or_b32 v131, v131, v132
 v_xor_b32 v131, v131, v129
 v_lshlrev_b32 v131, 4, v131
 v_bfe_u32 v132, v130, 2, 1
 v_bfe_u32 v133, v130, 3, 2
 v_and_b32 v130, 0xffe3, v130
 v_lshl_or_b32 v130, v132, 4, v130
 v_lshl_or_b32 v130, v133, 2, v130
 v_mul_u32_u24 v130, 2048, v130
 v_add_u32 v119, v130, v131
 s_mul_i32 s30, s13, 8192
 s_add_u32 s30, s30, 0
 v_lshlrev_b32 v128, 4, v2
 s_mul_i32 s35, s13, 8192
 s_add_u32 s36, s35, 0
 v_add_u32 v129, s36, v128
 v_lshrrev_b32 v130, 9, v129
 v_and_b32 v129, 511, v129
 v_bfe_u32 v132, v130, 3, 1
 v_and_b32 v131, 3, v130
 v_lshlrev_b32 v132, 2, v132
 v_or_b32 v131, v131, v132
 v_lshlrev_b32 v131, 5, v131
 v_xor_b32 v129, v129, v131
 v_mul_u32_u24 v130, 8192, v130
 v_add_u32 v120, v130, v129
 s_add_u32 s36, s35, 1024
 v_add_u32 v129, s36, v128
 v_lshrrev_b32 v130, 9, v129
 v_and_b32 v129, 511, v129
 v_bfe_u32 v132, v130, 3, 1
 v_and_b32 v131, 3, v130
 v_lshlrev_b32 v132, 2, v132
 v_or_b32 v131, v131, v132
 v_lshlrev_b32 v131, 5, v131
 v_xor_b32 v129, v129, v131
 v_mul_u32_u24 v130, 8192, v130
 v_add_u32 v121, v130, v129
 s_add_u32 s36, s35, 2048
 v_add_u32 v129, s36, v128
 v_lshrrev_b32 v130, 9, v129
 v_and_b32 v129, 511, v129
 v_bfe_u32 v132, v130, 3, 1
 v_and_b32 v131, 3, v130
 v_lshlrev_b32 v132, 2, v132
 v_or_b32 v131, v131, v132
 v_lshlrev_b32 v131, 5, v131
 v_xor_b32 v129, v129, v131
 v_mul_u32_u24 v130, 8192, v130
 v_add_u32 v122, v130, v129
 s_add_u32 s36, s35, 3072
 v_add_u32 v129, s36, v128
 v_lshrrev_b32 v130, 9, v129
 v_and_b32 v129, 511, v129
 v_bfe_u32 v132, v130, 3, 1
 v_and_b32 v131, 3, v130
 v_lshlrev_b32 v132, 2, v132
 v_or_b32 v131, v131, v132
 v_lshlrev_b32 v131, 5, v131
 v_xor_b32 v129, v129, v131
 v_mul_u32_u24 v130, 8192, v130
 v_add_u32 v123, v130, v129
 s_add_u32 s36, s35, 4096
 v_add_u32 v129, s36, v128
 v_lshrrev_b32 v130, 9, v129
 v_and_b32 v129, 511, v129
 v_bfe_u32 v132, v130, 3, 1
 v_and_b32 v131, 3, v130
 v_lshlrev_b32 v132, 2, v132
 v_or_b32 v131, v131, v132
 v_lshlrev_b32 v131, 5, v131
 v_xor_b32 v129, v129, v131
 v_mul_u32_u24 v130, 8192, v130
 v_add_u32 v124, v130, v129
 s_add_u32 s36, s35, 5120
 v_add_u32 v129, s36, v128
 v_lshrrev_b32 v130, 9, v129
 v_and_b32 v129, 511, v129
 v_bfe_u32 v132, v130, 3, 1
 v_and_b32 v131, 3, v130
 v_lshlrev_b32 v132, 2, v132
 v_or_b32 v131, v131, v132
 v_lshlrev_b32 v131, 5, v131
 v_xor_b32 v129, v129, v131
 v_mul_u32_u24 v130, 8192, v130
 v_add_u32 v125, v130, v129
 s_add_u32 s36, s35, 6144
 v_add_u32 v129, s36, v128
 v_lshrrev_b32 v130, 9, v129
 v_and_b32 v129, 511, v129
 v_bfe_u32 v132, v130, 3, 1
 v_and_b32 v131, 3, v130
 v_lshlrev_b32 v132, 2, v132
 v_or_b32 v131, v131, v132
 v_lshlrev_b32 v131, 5, v131
 v_xor_b32 v129, v129, v131
 v_mul_u32_u24 v130, 8192, v130
 v_add_u32 v126, v130, v129
 s_add_u32 s36, s35, 7168
 v_add_u32 v129, s36, v128
 v_lshrrev_b32 v130, 9, v129
 v_and_b32 v129, 511, v129
 v_bfe_u32 v132, v130, 3, 1
 v_and_b32 v131, 3, v130
 v_lshlrev_b32 v132, 2, v132
 v_or_b32 v131, v131, v132
 v_lshlrev_b32 v131, 5, v131
 v_xor_b32 v129, v129, v131
 v_mul_u32_u24 v130, 8192, v130
 v_add_u32 v127, v130, v129
 s_mul_i32 s31, s13, 8192
 s_add_u32 s31, s31, 65536
 AW 0
 AW 1
 AW 2
 AW 3
 AW 4
 AW 5
 AW 6
 AW 7
 AW 8
 AW 9
 AW 10
 AW 11
 AW 12
 AW 13
 AW 14
 AW 15
 AW 16
 AW 17
 AW 18
 AW 19
 AW 20
 AW 21
 AW 22
 AW 23
 AW 24
 AW 25
 AW 26
 AW 27
 AW 28
 AW 29
 AW 30
 AW 31
 AW 32
 AW 33
 AW 34
 AW 35
 AW 36
 AW 37
 AW 38
 AW 39
 AW 40
 AW 41
 AW 42
 AW 43
 AW 44
 AW 45
 AW 46
 AW 47
 AW 48
 AW 49
 AW 50
 AW 51
 AW 52
 AW 53
 AW 54
 AW 55
 AW 56
 AW 57
 AW 58
 AW 59
 AW 60
 AW 61
 AW 62
 AW 63
 AW 64
 AW 65
 AW 66
 AW 67
 AW 68
 AW 69
 AW 70
 AW 71
 AW 72
 AW 73
 AW 74
 AW 75
 AW 76
 AW 77
 AW 78
 AW 79
 AW 80
 AW 81
 AW 82
 AW 83
 AW 84
 AW 85
 AW 86
 AW 87
 AW 88
 AW 89
 AW 90
 AW 91
 AW 92
 AW 93
 AW 94
 AW 95
 AW 96
 AW 97
 AW 98
 AW 99
 AW 100
 AW 101
 AW 102
 AW 103
 AW 104
 AW 105
 AW 106
 AW 107
 AW 108
 AW 109
 AW 110
 AW 111
 AW 112
 AW 113
 AW 114
 AW 115
 AW 116
 AW 117
 AW 118
 AW 119
 AW 120
 AW 121
 AW 122
 AW 123
 AW 124
 AW 125
 AW 126
 AW 127
 AW 128
 AW 129
 AW 130
 AW 131
 AW 132
 AW 133
 AW 134
 AW 135
 AW 136
 AW 137
 AW 138
 AW 139
 AW 140
 AW 141
 AW 142
 AW 143
 AW 144
 AW 145
 AW 146
 AW 147
 AW 148
 AW 149
 AW 150
 AW 151
 AW 152
 AW 153
 AW 154
 AW 155
 AW 156
 AW 157
 AW 158
 AW 159
 AW 160
 AW 161
 AW 162
 AW 163
 AW 164
 AW 165
 AW 166
 AW 167
 AW 168
 AW 169
 AW 170
 AW 171
 AW 172
 AW 173
 AW 174
 AW 175
 AW 176
 AW 177
 AW 178
 AW 179
 AW 180
 AW 181
 AW 182
 AW 183
 AW 184
 AW 185
 AW 186
 AW 187
 AW 188
 AW 189
 AW 190
 AW 191
 AW 192
 AW 193
 AW 194
 AW 195
 AW 196
 AW 197
 AW 198
 AW 199
 AW 200
 AW 201
 AW 202
 AW 203
 AW 204
 AW 205
 AW 206
 AW 207
 AW 208
 AW 209
 AW 210
 AW 211
 AW 212
 AW 213
 AW 214
 AW 215
 AW 216
 AW 217
 AW 218
 AW 219
 AW 220
 AW 221
 AW 222
 AW 223
 AW 224
 AW 225
 AW 226
 AW 227
 AW 228
 AW 229
 AW 230
 AW 231
 AW 232
 AW 233
 AW 234
 AW 235
 AW 236
 AW 237
 AW 238
 AW 239
 AW 240
 AW 241
 AW 242
 AW 243
 AW 244
 AW 245
 AW 246
 AW 247
 AW 248
 AW 249
 AW 250
 AW 251
 AW 252
 AW 253
 AW 254
 AW 255
mk_kvl_m:
 DM 30,0,112,s[16:19],24,sc1 lds
 DM 30,1024,113,s[16:19],24,sc1 lds
 DM 30,2048,114,s[16:19],24,sc1 lds
 DM 30,3072,115,s[16:19],24,sc1 lds
 DM 30,4096,116,s[16:19],24,sc1 lds
 DM 30,5120,117,s[16:19],24,sc1 lds
 DM 30,6144,118,s[16:19],24,sc1 lds
 DM 30,7168,119,s[16:19],24,sc1 lds
 DM 31,0,120,s[20:23],25,lds
 DM 31,1024,121,s[20:23],25,lds
 DM 31,2048,122,s[20:23],25,lds
 DM 31,3072,123,s[20:23],25,lds
 DM 31,4096,124,s[20:23],25,lds
 DM 31,5120,125,s[20:23],25,lds
 DM 31,6144,126,s[20:23],25,lds
 DM 31,7168,127,s[20:23],25,lds
 s_add_u32 s24, s24, 128
 s_add_u32 s25, s25, 524288
 DM 30,32768,112,s[16:19],24,sc1 lds
 DM 30,33792,113,s[16:19],24,sc1 lds
 DM 30,34816,114,s[16:19],24,sc1 lds
 DM 30,35840,115,s[16:19],24,sc1 lds
 DM 30,36864,116,s[16:19],24,sc1 lds
 DM 30,37888,117,s[16:19],24,sc1 lds
 DM 30,38912,118,s[16:19],24,sc1 lds
 DM 30,39936,119,s[16:19],24,sc1 lds
 DM 31,32768,120,s[20:23],25,lds
 DM 31,33792,121,s[20:23],25,lds
 DM 31,34816,122,s[20:23],25,lds
 DM 31,35840,123,s[20:23],25,lds
 DM 31,36864,124,s[20:23],25,lds
 DM 31,37888,125,s[20:23],25,lds
 DM 31,38912,126,s[20:23],25,lds
 DM 31,39936,127,s[20:23],25,lds
 s_add_u32 s24, s24, 128
 s_add_u32 s25, s25, 524288
 s_waitcnt vmcnt(16)
 s_barrier
 RB 36,39,100,0
 RB 40,43,100,512
 RB 44,47,100,4096
 RB 48,51,100,4608
 RB 52,55,100,8192
 RB 56,59,100,8704
 RB 60,63,100,12288
 RB 64,67,100,12800
 TR 4,5,104,0
 TR 6,7,104,2048
 TR 8,9,105,0
 TR 10,11,105,2048
 TR 12,13,106,0
 TR 14,15,106,2048
 TR 16,17,107,0
 TR 18,19,107,2048
 s_waitcnt lgkmcnt(0)
 MF a[0:3],v[4:7],v[36:39]
 TR 20,21,108,0
 MF a[4:7],v[4:7],v[40:43]
 TR 22,23,108,2048
 MF a[8:11],v[4:7],v[44:47]
 TR 24,25,109,0
 MF a[12:15],v[4:7],v[48:51]
 TR 26,27,109,2048
 MF a[16:19],v[4:7],v[52:55]
 TR 28,29,110,0
 MF a[20:23],v[4:7],v[56:59]
 TR 30,31,110,2048
 MF a[24:27],v[4:7],v[60:63]
 TR 32,33,111,0
 MF a[28:31],v[4:7],v[64:67]
 TR 34,35,111,2048
 MF a[32:35],v[8:11],v[36:39]
 MF a[36:39],v[8:11],v[40:43]
 MF a[40:43],v[8:11],v[44:47]
 MF a[44:47],v[8:11],v[48:51]
 MF a[48:51],v[8:11],v[52:55]
 MF a[52:55],v[8:11],v[56:59]
 MF a[56:59],v[8:11],v[60:63]
 MF a[60:63],v[8:11],v[64:67]
 MF a[64:67],v[12:15],v[36:39]
 MF a[68:71],v[12:15],v[40:43]
 MF a[72:75],v[12:15],v[44:47]
 MF a[76:79],v[12:15],v[48:51]
 MF a[80:83],v[12:15],v[52:55]
 MF a[84:87],v[12:15],v[56:59]
 MF a[88:91],v[12:15],v[60:63]
 MF a[92:95],v[12:15],v[64:67]
 MF a[96:99],v[16:19],v[36:39]
 MF a[100:103],v[16:19],v[40:43]
 MF a[104:107],v[16:19],v[44:47]
 MF a[108:111],v[16:19],v[48:51]
 MF a[112:115],v[16:19],v[52:55]
 MF a[116:119],v[16:19],v[56:59]
 MF a[120:123],v[16:19],v[60:63]
 MF a[124:127],v[16:19],v[64:67]
 s_waitcnt lgkmcnt(0)
 MF a[128:131],v[20:23],v[36:39]
 RB 68,71,101,0
 MF a[132:135],v[20:23],v[40:43]
 RB 72,75,101,512
 MF a[136:139],v[20:23],v[44:47]
 RB 76,79,101,4096
 MF a[140:143],v[20:23],v[48:51]
 RB 80,83,101,4608
 MF a[144:147],v[20:23],v[52:55]
 RB 84,87,101,8192
 MF a[148:151],v[20:23],v[56:59]
 RB 88,91,101,8704
 MF a[152:155],v[20:23],v[60:63]
 RB 92,95,101,12288
 MF a[156:159],v[20:23],v[64:67]
 RB 96,99,101,12800
 MF a[160:163],v[24:27],v[36:39]
 TR 4,5,104,16384
 MF a[164:167],v[24:27],v[40:43]
 TR 6,7,104,18432
 MF a[168:171],v[24:27],v[44:47]
 TR 8,9,105,16384
 MF a[172:175],v[24:27],v[48:51]
 TR 10,11,105,18432
 MF a[176:179],v[24:27],v[52:55]
 TR 12,13,106,16384
 MF a[180:183],v[24:27],v[56:59]
 TR 14,15,106,18432
 MF a[184:187],v[24:27],v[60:63]
 TR 16,17,107,16384
 MF a[188:191],v[24:27],v[64:67]
 TR 18,19,107,18432
 MF a[192:195],v[28:31],v[36:39]
 MF a[196:199],v[28:31],v[40:43]
 MF a[200:203],v[28:31],v[44:47]
 MF a[204:207],v[28:31],v[48:51]
 MF a[208:211],v[28:31],v[52:55]
 MF a[212:215],v[28:31],v[56:59]
 MF a[216:219],v[28:31],v[60:63]
 MF a[220:223],v[28:31],v[64:67]
 MF a[224:227],v[32:35],v[36:39]
 MF a[228:231],v[32:35],v[40:43]
 MF a[232:235],v[32:35],v[44:47]
 MF a[236:239],v[32:35],v[48:51]
 MF a[240:243],v[32:35],v[52:55]
 MF a[244:247],v[32:35],v[56:59]
 MF a[248:251],v[32:35],v[60:63]
 MF a[252:255],v[32:35],v[64:67]
 s_waitcnt lgkmcnt(0)
 MF a[0:3],v[4:7],v[68:71]
 TR 20,21,108,16384
 MF a[4:7],v[4:7],v[72:75]
 TR 22,23,108,18432
 MF a[8:11],v[4:7],v[76:79]
 TR 24,25,109,16384
 MF a[12:15],v[4:7],v[80:83]
 TR 26,27,109,18432
 MF a[16:19],v[4:7],v[84:87]
 TR 28,29,110,16384
 MF a[20:23],v[4:7],v[88:91]
 TR 30,31,110,18432
 MF a[24:27],v[4:7],v[92:95]
 TR 32,33,111,16384
 MF a[28:31],v[4:7],v[96:99]
 TR 34,35,111,18432
 MF a[32:35],v[8:11],v[68:71]
 MF a[36:39],v[8:11],v[72:75]
 MF a[40:43],v[8:11],v[76:79]
 MF a[44:47],v[8:11],v[80:83]
 MF a[48:51],v[8:11],v[84:87]
 MF a[52:55],v[8:11],v[88:91]
 MF a[56:59],v[8:11],v[92:95]
 MF a[60:63],v[8:11],v[96:99]
 MF a[64:67],v[12:15],v[68:71]
 MF a[68:71],v[12:15],v[72:75]
 MF a[72:75],v[12:15],v[76:79]
 MF a[76:79],v[12:15],v[80:83]
 MF a[80:83],v[12:15],v[84:87]
 MF a[84:87],v[12:15],v[88:91]
 MF a[88:91],v[12:15],v[92:95]
 MF a[92:95],v[12:15],v[96:99]
 MF a[96:99],v[16:19],v[68:71]
 MF a[100:103],v[16:19],v[72:75]
 MF a[104:107],v[16:19],v[76:79]
 MF a[108:111],v[16:19],v[80:83]
 MF a[112:115],v[16:19],v[84:87]
 MF a[116:119],v[16:19],v[88:91]
 MF a[120:123],v[16:19],v[92:95]
 MF a[124:127],v[16:19],v[96:99]
 s_waitcnt lgkmcnt(0)
 s_waitcnt vmcnt(0)
 s_barrier
 MF a[128:131],v[20:23],v[68:71]
 RB 36,39,100,32768
 MF a[132:135],v[20:23],v[72:75]
 RB 40,43,100,33280
 MF a[136:139],v[20:23],v[76:79]
 RB 44,47,100,36864
 DM 30,0,112,s[16:19],24,sc1 lds
 MF a[140:143],v[20:23],v[80:83]
 RB 48,51,100,37376
 MF a[144:147],v[20:23],v[84:87]
 RB 52,55,100,40960
 MF a[148:151],v[20:23],v[88:91]
 RB 56,59,100,41472
 MF a[152:155],v[20:23],v[92:95]
 RB 60,63,100,45056
 DM 30,1024,113,s[16:19],24,sc1 lds
 MF a[156:159],v[20:23],v[96:99]
 RB 64,67,100,45568
 MF a[160:163],v[24:27],v[68:71]
 TR 4,5,104,32768
 MF a[164:167],v[24:27],v[72:75]
 TR 6,7,104,34816
 MF a[168:171],v[24:27],v[76:79]
 TR 8,9,105,32768
 DM 30,2048,114,s[16:19],24,sc1 lds
 MF a[172:175],v[24:27],v[80:83]
 TR 10,11,105,34816
 MF a[176:179],v[24:27],v[84:87]
 TR 12,13,106,32768
 MF a[180:183],v[24:27],v[88:91]
 TR 14,15,106,34816
 MF a[184:187],v[24:27],v[92:95]
 TR 16,17,107,32768
 DM 30,3072,115,s[16:19],24,sc1 lds
 MF a[188:191],v[24:27],v[96:99]
 TR 18,19,107,34816
 MF a[192:195],v[28:31],v[68:71]
 MF a[196:199],v[28:31],v[72:75]
 MF a[200:203],v[28:31],v[76:79]
 DM 30,4096,116,s[16:19],24,sc1 lds
 MF a[204:207],v[28:31],v[80:83]
 MF a[208:211],v[28:31],v[84:87]
 MF a[212:215],v[28:31],v[88:91]
 MF a[216:219],v[28:31],v[92:95]
 DM 30,5120,117,s[16:19],24,sc1 lds
 MF a[220:223],v[28:31],v[96:99]
 MF a[224:227],v[32:35],v[68:71]
 MF a[228:231],v[32:35],v[72:75]
 MF a[232:235],v[32:35],v[76:79]
 DM 30,6144,118,s[16:19],24,sc1 lds
 MF a[236:239],v[32:35],v[80:83]
 MF a[240:243],v[32:35],v[84:87]
 MF a[244:247],v[32:35],v[88:91]
 MF a[248:251],v[32:35],v[92:95]
 DM 30,7168,119,s[16:19],24,sc1 lds
 MF a[252:255],v[32:35],v[96:99]
 s_waitcnt lgkmcnt(0)
 MF a[0:3],v[4:7],v[36:39]
 TR 20,21,108,32768
 MF a[4:7],v[4:7],v[40:43]
 TR 22,23,108,34816
 MF a[8:11],v[4:7],v[44:47]
 TR 24,25,109,32768
 DM 31,0,120,s[20:23],25,lds
 MF a[12:15],v[4:7],v[48:51]
 TR 26,27,109,34816
 MF a[16:19],v[4:7],v[52:55]
 TR 28,29,110,32768
 MF a[20:23],v[4:7],v[56:59]
 TR 30,31,110,34816
 MF a[24:27],v[4:7],v[60:63]
 TR 32,33,111,32768
 DM 31,1024,121,s[20:23],25,lds
 MF a[28:31],v[4:7],v[64:67]
 TR 34,35,111,34816
 MF a[32:35],v[8:11],v[36:39]
 MF a[36:39],v[8:11],v[40:43]
 MF a[40:43],v[8:11],v[44:47]
 DM 31,2048,122,s[20:23],25,lds
 MF a[44:47],v[8:11],v[48:51]
 MF a[48:51],v[8:11],v[52:55]
 MF a[52:55],v[8:11],v[56:59]
 MF a[56:59],v[8:11],v[60:63]
 DM 31,3072,123,s[20:23],25,lds
 MF a[60:63],v[8:11],v[64:67]
 MF a[64:67],v[12:15],v[36:39]
 MF a[68:71],v[12:15],v[40:43]
 MF a[72:75],v[12:15],v[44:47]
 DM 31,4096,124,s[20:23],25,lds
 MF a[76:79],v[12:15],v[48:51]
 MF a[80:83],v[12:15],v[52:55]
 MF a[84:87],v[12:15],v[56:59]
 MF a[88:91],v[12:15],v[60:63]
 DM 31,5120,125,s[20:23],25,lds
 MF a[92:95],v[12:15],v[64:67]
 MF a[96:99],v[16:19],v[36:39]
 MF a[100:103],v[16:19],v[40:43]
 MF a[104:107],v[16:19],v[44:47]
 DM 31,6144,126,s[20:23],25,lds
 MF a[108:111],v[16:19],v[48:51]
 MF a[112:115],v[16:19],v[52:55]
 MF a[116:119],v[16:19],v[56:59]
 MF a[120:123],v[16:19],v[60:63]
 DM 31,7168,127,s[20:23],25,lds
 s_add_u32 s24, s24, 128
 s_add_u32 s25, s25, 524288
 MF a[124:127],v[16:19],v[64:67]
 s_waitcnt lgkmcnt(0)
 MF a[128:131],v[20:23],v[36:39]
 RB 68,71,101,32768
 MF a[132:135],v[20:23],v[40:43]
 RB 72,75,101,33280
 MF a[136:139],v[20:23],v[44:47]
 RB 76,79,101,36864
 MF a[140:143],v[20:23],v[48:51]
 RB 80,83,101,37376
 MF a[144:147],v[20:23],v[52:55]
 RB 84,87,101,40960
 MF a[148:151],v[20:23],v[56:59]
 RB 88,91,101,41472
 MF a[152:155],v[20:23],v[60:63]
 RB 92,95,101,45056
 MF a[156:159],v[20:23],v[64:67]
 RB 96,99,101,45568
 MF a[160:163],v[24:27],v[36:39]
 TR 4,5,104,49152
 MF a[164:167],v[24:27],v[40:43]
 TR 6,7,104,51200
 MF a[168:171],v[24:27],v[44:47]
 TR 8,9,105,49152
 MF a[172:175],v[24:27],v[48:51]
 TR 10,11,105,51200
 MF a[176:179],v[24:27],v[52:55]
 TR 12,13,106,49152
 MF a[180:183],v[24:27],v[56:59]
 TR 14,15,106,51200
 MF a[184:187],v[24:27],v[60:63]
 TR 16,17,107,49152
 MF a[188:191],v[24:27],v[64:67]
 TR 18,19,107,51200
 MF a[192:195],v[28:31],v[36:39]
 MF a[196:199],v[28:31],v[40:43]
 MF a[200:203],v[28:31],v[44:47]
 MF a[204:207],v[28:31],v[48:51]
 MF a[208:211],v[28:31],v[52:55]
 MF a[212:215],v[28:31],v[56:59]
 MF a[216:219],v[28:31],v[60:63]
 MF a[220:223],v[28:31],v[64:67]
 MF a[224:227],v[32:35],v[36:39]
 MF a[228:231],v[32:35],v[40:43]
 MF a[232:235],v[32:35],v[44:47]
 MF a[236:239],v[32:35],v[48:51]
 MF a[240:243],v[32:35],v[52:55]
 MF a[244:247],v[32:35],v[56:59]
 MF a[248:251],v[32:35],v[60:63]
 MF a[252:255],v[32:35],v[64:67]
 s_waitcnt lgkmcnt(0)
 MF a[0:3],v[4:7],v[68:71]
 TR 20,21,108,49152
 MF a[4:7],v[4:7],v[72:75]
 TR 22,23,108,51200
 MF a[8:11],v[4:7],v[76:79]
 TR 24,25,109,49152
 MF a[12:15],v[4:7],v[80:83]
 TR 26,27,109,51200
 MF a[16:19],v[4:7],v[84:87]
 TR 28,29,110,49152
 MF a[20:23],v[4:7],v[88:91]
 TR 30,31,110,51200
 MF a[24:27],v[4:7],v[92:95]
 TR 32,33,111,49152
 MF a[28:31],v[4:7],v[96:99]
 TR 34,35,111,51200
 MF a[32:35],v[8:11],v[68:71]
 MF a[36:39],v[8:11],v[72:75]
 MF a[40:43],v[8:11],v[76:79]
 MF a[44:47],v[8:11],v[80:83]
 MF a[48:51],v[8:11],v[84:87]
 MF a[52:55],v[8:11],v[88:91]
 MF a[56:59],v[8:11],v[92:95]
 MF a[60:63],v[8:11],v[96:99]
 MF a[64:67],v[12:15],v[68:71]
 MF a[68:71],v[12:15],v[72:75]
 MF a[72:75],v[12:15],v[76:79]
 MF a[76:79],v[12:15],v[80:83]
 MF a[80:83],v[12:15],v[84:87]
 MF a[84:87],v[12:15],v[88:91]
 MF a[88:91],v[12:15],v[92:95]
 MF a[92:95],v[12:15],v[96:99]
 MF a[96:99],v[16:19],v[68:71]
 MF a[100:103],v[16:19],v[72:75]
 MF a[104:107],v[16:19],v[76:79]
 MF a[108:111],v[16:19],v[80:83]
 MF a[112:115],v[16:19],v[84:87]
 MF a[116:119],v[16:19],v[88:91]
 MF a[120:123],v[16:19],v[92:95]
 MF a[124:127],v[16:19],v[96:99]
 s_waitcnt lgkmcnt(0)
 s_waitcnt vmcnt(0)
 s_barrier
 MF a[128:131],v[20:23],v[68:71]
 RB 36,39,100,0
 MF a[132:135],v[20:23],v[72:75]
 RB 40,43,100,512
 MF a[136:139],v[20:23],v[76:79]
 RB 44,47,100,4096
 DM 30,32768,112,s[16:19],24,sc1 lds
 MF a[140:143],v[20:23],v[80:83]
 RB 48,51,100,4608
 MF a[144:147],v[20:23],v[84:87]
 RB 52,55,100,8192
 MF a[148:151],v[20:23],v[88:91]
 RB 56,59,100,8704
 MF a[152:155],v[20:23],v[92:95]
 RB 60,63,100,12288
 DM 30,33792,113,s[16:19],24,sc1 lds
 MF a[156:159],v[20:23],v[96:99]
 RB 64,67,100,12800
 MF a[160:163],v[24:27],v[68:71]
 TR 4,5,104,0
 MF a[164:167],v[24:27],v[72:75]
 TR 6,7,104,2048
 MF a[168:171],v[24:27],v[76:79]
 TR 8,9,105,0
 DM 30,34816,114,s[16:19],24,sc1 lds
 MF a[172:175],v[24:27],v[80:83]
 TR 10,11,105,2048
 MF a[176:179],v[24:27],v[84:87]
 TR 12,13,106,0
 MF a[180:183],v[24:27],v[88:91]
 TR 14,15,106,2048
 MF a[184:187],v[24:27],v[92:95]
 TR 16,17,107,0
 DM 30,35840,115,s[16:19],24,sc1 lds
 MF a[188:191],v[24:27],v[96:99]
 TR 18,19,107,2048
 MF a[192:195],v[28:31],v[68:71]
 MF a[196:199],v[28:31],v[72:75]
 MF a[200:203],v[28:31],v[76:79]
 DM 30,36864,116,s[16:19],24,sc1 lds
 MF a[204:207],v[28:31],v[80:83]
 MF a[208:211],v[28:31],v[84:87]
 MF a[212:215],v[28:31],v[88:91]
 MF a[216:219],v[28:31],v[92:95]
 DM 30,37888,117,s[16:19],24,sc1 lds
 MF a[220:223],v[28:31],v[96:99]
 MF a[224:227],v[32:35],v[68:71]
 MF a[228:231],v[32:35],v[72:75]
 MF a[232:235],v[32:35],v[76:79]
 DM 30,38912,118,s[16:19],24,sc1 lds
 MF a[236:239],v[32:35],v[80:83]
 MF a[240:243],v[32:35],v[84:87]
 MF a[244:247],v[32:35],v[88:91]
 MF a[248:251],v[32:35],v[92:95]
 DM 30,39936,119,s[16:19],24,sc1 lds
 MF a[252:255],v[32:35],v[96:99]
 s_waitcnt lgkmcnt(0)
 s_mov_b32 s32, 6
kvl_loop_9:
 MF a[0:3],v[4:7],v[36:39]
 TR 20,21,108,0
 MF a[4:7],v[4:7],v[40:43]
 TR 22,23,108,2048
 MF a[8:11],v[4:7],v[44:47]
 TR 24,25,109,0
 DM 31,32768,120,s[20:23],25,lds
 MF a[12:15],v[4:7],v[48:51]
 TR 26,27,109,2048
 MF a[16:19],v[4:7],v[52:55]
 TR 28,29,110,0
 MF a[20:23],v[4:7],v[56:59]
 TR 30,31,110,2048
 MF a[24:27],v[4:7],v[60:63]
 TR 32,33,111,0
 DM 31,33792,121,s[20:23],25,lds
 MF a[28:31],v[4:7],v[64:67]
 TR 34,35,111,2048
 MF a[32:35],v[8:11],v[36:39]
 MF a[36:39],v[8:11],v[40:43]
 MF a[40:43],v[8:11],v[44:47]
 DM 31,34816,122,s[20:23],25,lds
 MF a[44:47],v[8:11],v[48:51]
 MF a[48:51],v[8:11],v[52:55]
 MF a[52:55],v[8:11],v[56:59]
 MF a[56:59],v[8:11],v[60:63]
 DM 31,35840,123,s[20:23],25,lds
 MF a[60:63],v[8:11],v[64:67]
 MF a[64:67],v[12:15],v[36:39]
 MF a[68:71],v[12:15],v[40:43]
 MF a[72:75],v[12:15],v[44:47]
 DM 31,36864,124,s[20:23],25,lds
 MF a[76:79],v[12:15],v[48:51]
 MF a[80:83],v[12:15],v[52:55]
 MF a[84:87],v[12:15],v[56:59]
 MF a[88:91],v[12:15],v[60:63]
 DM 31,37888,125,s[20:23],25,lds
 MF a[92:95],v[12:15],v[64:67]
 MF a[96:99],v[16:19],v[36:39]
 MF a[100:103],v[16:19],v[40:43]
 MF a[104:107],v[16:19],v[44:47]
 DM 31,38912,126,s[20:23],25,lds
 MF a[108:111],v[16:19],v[48:51]
 MF a[112:115],v[16:19],v[52:55]
 MF a[116:119],v[16:19],v[56:59]
 MF a[120:123],v[16:19],v[60:63]
 DM 31,39936,127,s[20:23],25,lds
 s_add_u32 s24, s24, 128
 s_add_u32 s25, s25, 524288
 MF a[124:127],v[16:19],v[64:67]
 s_waitcnt lgkmcnt(0)
 MF a[128:131],v[20:23],v[36:39]
 RB 68,71,101,0
 MF a[132:135],v[20:23],v[40:43]
 RB 72,75,101,512
 MF a[136:139],v[20:23],v[44:47]
 RB 76,79,101,4096
 MF a[140:143],v[20:23],v[48:51]
 RB 80,83,101,4608
 MF a[144:147],v[20:23],v[52:55]
 RB 84,87,101,8192
 MF a[148:151],v[20:23],v[56:59]
 RB 88,91,101,8704
 MF a[152:155],v[20:23],v[60:63]
 RB 92,95,101,12288
 MF a[156:159],v[20:23],v[64:67]
 RB 96,99,101,12800
 MF a[160:163],v[24:27],v[36:39]
 TR 4,5,104,16384
 MF a[164:167],v[24:27],v[40:43]
 TR 6,7,104,18432
 MF a[168:171],v[24:27],v[44:47]
 TR 8,9,105,16384
 MF a[172:175],v[24:27],v[48:51]
 TR 10,11,105,18432
 MF a[176:179],v[24:27],v[52:55]
 TR 12,13,106,16384
 MF a[180:183],v[24:27],v[56:59]
 TR 14,15,106,18432
 MF a[184:187],v[24:27],v[60:63]
 TR 16,17,107,16384
 MF a[188:191],v[24:27],v[64:67]
 TR 18,19,107,18432
 MF a[192:195],v[28:31],v[36:39]
 MF a[196:199],v[28:31],v[40:43]
 MF a[200:203],v[28:31],v[44:47]
 MF a[204:207],v[28:31],v[48:51]
 MF a[208:211],v[28:31],v[52:55]
 MF a[212:215],v[28:31],v[56:59]
 MF a[216:219],v[28:31],v[60:63]
 MF a[220:223],v[28:31],v[64:67]
 MF a[224:227],v[32:35],v[36:39]
 MF a[228:231],v[32:35],v[40:43]
 MF a[232:235],v[32:35],v[44:47]
 MF a[236:239],v[32:35],v[48:51]
 MF a[240:243],v[32:35],v[52:55]
 MF a[244:247],v[32:35],v[56:59]
 MF a[248:251],v[32:35],v[60:63]
 MF a[252:255],v[32:35],v[64:67]
 s_waitcnt lgkmcnt(0)
 MF a[0:3],v[4:7],v[68:71]
 TR 20,21,108,16384
 MF a[4:7],v[4:7],v[72:75]
 TR 22,23,108,18432
 MF a[8:11],v[4:7],v[76:79]
 TR 24,25,109,16384
 MF a[12:15],v[4:7],v[80:83]
 TR 26,27,109,18432
 MF a[16:19],v[4:7],v[84:87]
 TR 28,29,110,16384
 MF a[20:23],v[4:7],v[88:91]
 TR 30,31,110,18432
 MF a[24:27],v[4:7],v[92:95]
 TR 32,33,111,16384
 MF a[28:31],v[4:7],v[96:99]
 TR 34,35,111,18432
 MF a[32:35],v[8:11],v[68:71]
 MF a[36:39],v[8:11],v[72:75]
 MF a[40:43],v[8:11],v[76:79]
 MF a[44:47],v[8:11],v[80:83]
 MF a[48:51],v[8:11],v[84:87]
 MF a[52:55],v[8:11],v[88:91]
 MF a[56:59],v[8:11],v[92:95]
 MF a[60:63],v[8:11],v[96:99]
 MF a[64:67],v[12:15],v[68:71]
 MF a[68:71],v[12:15],v[72:75]
 MF a[72:75],v[12:15],v[76:79]
 MF a[76:79],v[12:15],v[80:83]
 MF a[80:83],v[12:15],v[84:87]
 MF a[84:87],v[12:15],v[88:91]
 MF a[88:91],v[12:15],v[92:95]
 MF a[92:95],v[12:15],v[96:99]
 MF a[96:99],v[16:19],v[68:71]
 MF a[100:103],v[16:19],v[72:75]
 MF a[104:107],v[16:19],v[76:79]
 MF a[108:111],v[16:19],v[80:83]
 MF a[112:115],v[16:19],v[84:87]
 MF a[116:119],v[16:19],v[88:91]
 MF a[120:123],v[16:19],v[92:95]
 MF a[124:127],v[16:19],v[96:99]
 s_waitcnt lgkmcnt(0)
 s_waitcnt vmcnt(0)
 s_barrier
 MF a[128:131],v[20:23],v[68:71]
 RB 36,39,100,32768
 MF a[132:135],v[20:23],v[72:75]
 RB 40,43,100,33280
 MF a[136:139],v[20:23],v[76:79]
 RB 44,47,100,36864
 DM 30,0,112,s[16:19],24,sc1 lds
 MF a[140:143],v[20:23],v[80:83]
 RB 48,51,100,37376
 MF a[144:147],v[20:23],v[84:87]
 RB 52,55,100,40960
 MF a[148:151],v[20:23],v[88:91]
 RB 56,59,100,41472
 MF a[152:155],v[20:23],v[92:95]
 RB 60,63,100,45056
 DM 30,1024,113,s[16:19],24,sc1 lds
 MF a[156:159],v[20:23],v[96:99]
 RB 64,67,100,45568
 MF a[160:163],v[24:27],v[68:71]
 TR 4,5,104,32768
 MF a[164:167],v[24:27],v[72:75]
 TR 6,7,104,34816
 MF a[168:171],v[24:27],v[76:79]
 TR 8,9,105,32768
 DM 30,2048,114,s[16:19],24,sc1 lds
 MF a[172:175],v[24:27],v[80:83]
 TR 10,11,105,34816
 MF a[176:179],v[24:27],v[84:87]
 TR 12,13,106,32768
 MF a[180:183],v[24:27],v[88:91]
 TR 14,15,106,34816
 MF a[184:187],v[24:27],v[92:95]
 TR 16,17,107,32768
 DM 30,3072,115,s[16:19],24,sc1 lds
 MF a[188:191],v[24:27],v[96:99]
 TR 18,19,107,34816
 MF a[192:195],v[28:31],v[68:71]
 MF a[196:199],v[28:31],v[72:75]
 MF a[200:203],v[28:31],v[76:79]
 DM 30,4096,116,s[16:19],24,sc1 lds
 MF a[204:207],v[28:31],v[80:83]
 MF a[208:211],v[28:31],v[84:87]
 MF a[212:215],v[28:31],v[88:91]
 MF a[216:219],v[28:31],v[92:95]
 DM 30,5120,117,s[16:19],24,sc1 lds
 MF a[220:223],v[28:31],v[96:99]
 MF a[224:227],v[32:35],v[68:71]
 MF a[228:231],v[32:35],v[72:75]
 MF a[232:235],v[32:35],v[76:79]
 DM 30,6144,118,s[16:19],24,sc1 lds
 MF a[236:239],v[32:35],v[80:83]
 MF a[240:243],v[32:35],v[84:87]
 MF a[244:247],v[32:35],v[88:91]
 MF a[248:251],v[32:35],v[92:95]
 DM 30,7168,119,s[16:19],24,sc1 lds
 MF a[252:255],v[32:35],v[96:99]
 s_waitcnt lgkmcnt(0)
 MF a[0:3],v[4:7],v[36:39]
 TR 20,21,108,32768
 MF a[4:7],v[4:7],v[40:43]
 TR 22,23,108,34816
 MF a[8:11],v[4:7],v[44:47]
 TR 24,25,109,32768
 DM 31,0,120,s[20:23],25,lds
 MF a[12:15],v[4:7],v[48:51]
 TR 26,27,109,34816
 MF a[16:19],v[4:7],v[52:55]
 TR 28,29,110,32768
 MF a[20:23],v[4:7],v[56:59]
 TR 30,31,110,34816
 MF a[24:27],v[4:7],v[60:63]
 TR 32,33,111,32768
 DM 31,1024,121,s[20:23],25,lds
 MF a[28:31],v[4:7],v[64:67]
 TR 34,35,111,34816
 MF a[32:35],v[8:11],v[36:39]
 MF a[36:39],v[8:11],v[40:43]
 MF a[40:43],v[8:11],v[44:47]
 DM 31,2048,122,s[20:23],25,lds
 MF a[44:47],v[8:11],v[48:51]
 MF a[48:51],v[8:11],v[52:55]
 MF a[52:55],v[8:11],v[56:59]
 MF a[56:59],v[8:11],v[60:63]
 DM 31,3072,123,s[20:23],25,lds
 MF a[60:63],v[8:11],v[64:67]
 MF a[64:67],v[12:15],v[36:39]
 MF a[68:71],v[12:15],v[40:43]
 MF a[72:75],v[12:15],v[44:47]
 DM 31,4096,124,s[20:23],25,lds
 MF a[76:79],v[12:15],v[48:51]
 MF a[80:83],v[12:15],v[52:55]
 MF a[84:87],v[12:15],v[56:59]
 MF a[88:91],v[12:15],v[60:63]
 DM 31,5120,125,s[20:23],25,lds
 MF a[92:95],v[12:15],v[64:67]
 MF a[96:99],v[16:19],v[36:39]
 MF a[100:103],v[16:19],v[40:43]
 MF a[104:107],v[16:19],v[44:47]
 DM 31,6144,126,s[20:23],25,lds
 MF a[108:111],v[16:19],v[48:51]
 MF a[112:115],v[16:19],v[52:55]
 MF a[116:119],v[16:19],v[56:59]
 MF a[120:123],v[16:19],v[60:63]
 DM 31,7168,127,s[20:23],25,lds
 s_add_u32 s24, s24, 128
 s_add_u32 s25, s25, 524288
 MF a[124:127],v[16:19],v[64:67]
 s_waitcnt lgkmcnt(0)
 MF a[128:131],v[20:23],v[36:39]
 RB 68,71,101,32768
 MF a[132:135],v[20:23],v[40:43]
 RB 72,75,101,33280
 MF a[136:139],v[20:23],v[44:47]
 RB 76,79,101,36864
 MF a[140:143],v[20:23],v[48:51]
 RB 80,83,101,37376
 MF a[144:147],v[20:23],v[52:55]
 RB 84,87,101,40960
 MF a[148:151],v[20:23],v[56:59]
 RB 88,91,101,41472
 MF a[152:155],v[20:23],v[60:63]
 RB 92,95,101,45056
 MF a[156:159],v[20:23],v[64:67]
 RB 96,99,101,45568
 MF a[160:163],v[24:27],v[36:39]
 TR 4,5,104,49152
 MF a[164:167],v[24:27],v[40:43]
 TR 6,7,104,51200
 MF a[168:171],v[24:27],v[44:47]
 TR 8,9,105,49152
 MF a[172:175],v[24:27],v[48:51]
 TR 10,11,105,51200
 MF a[176:179],v[24:27],v[52:55]
 TR 12,13,106,49152
 MF a[180:183],v[24:27],v[56:59]
 TR 14,15,106,51200
 MF a[184:187],v[24:27],v[60:63]
 TR 16,17,107,49152
 MF a[188:191],v[24:27],v[64:67]
 TR 18,19,107,51200
 MF a[192:195],v[28:31],v[36:39]
 MF a[196:199],v[28:31],v[40:43]
 MF a[200:203],v[28:31],v[44:47]
 MF a[204:207],v[28:31],v[48:51]
 MF a[208:211],v[28:31],v[52:55]
 MF a[212:215],v[28:31],v[56:59]
 MF a[216:219],v[28:31],v[60:63]
 MF a[220:223],v[28:31],v[64:67]
 MF a[224:227],v[32:35],v[36:39]
 MF a[228:231],v[32:35],v[40:43]
 MF a[232:235],v[32:35],v[44:47]
 MF a[236:239],v[32:35],v[48:51]
 MF a[240:243],v[32:35],v[52:55]
 MF a[244:247],v[32:35],v[56:59]
 MF a[248:251],v[32:35],v[60:63]
 MF a[252:255],v[32:35],v[64:67]
 s_waitcnt lgkmcnt(0)
 MF a[0:3],v[4:7],v[68:71]
 TR 20,21,108,49152
 MF a[4:7],v[4:7],v[72:75]
 TR 22,23,108,51200
 MF a[8:11],v[4:7],v[76:79]
 TR 24,25,109,49152
 MF a[12:15],v[4:7],v[80:83]
 TR 26,27,109,51200
 MF a[16:19],v[4:7],v[84:87]
 TR 28,29,110,49152
 MF a[20:23],v[4:7],v[88:91]
 TR 30,31,110,51200
 MF a[24:27],v[4:7],v[92:95]
 TR 32,33,111,49152
 MF a[28:31],v[4:7],v[96:99]
 TR 34,35,111,51200
 MF a[32:35],v[8:11],v[68:71]
 MF a[36:39],v[8:11],v[72:75]
 MF a[40:43],v[8:11],v[76:79]
 MF a[44:47],v[8:11],v[80:83]
 MF a[48:51],v[8:11],v[84:87]
 MF a[52:55],v[8:11],v[88:91]
 MF a[56:59],v[8:11],v[92:95]
 MF a[60:63],v[8:11],v[96:99]
 MF a[64:67],v[12:15],v[68:71]
 MF a[68:71],v[12:15],v[72:75]
 MF a[72:75],v[12:15],v[76:79]
 MF a[76:79],v[12:15],v[80:83]
 MF a[80:83],v[12:15],v[84:87]
 MF a[84:87],v[12:15],v[88:91]
 MF a[88:91],v[12:15],v[92:95]
 MF a[92:95],v[12:15],v[96:99]
 MF a[96:99],v[16:19],v[68:71]
 MF a[100:103],v[16:19],v[72:75]
 MF a[104:107],v[16:19],v[76:79]
 MF a[108:111],v[16:19],v[80:83]
 MF a[112:115],v[16:19],v[84:87]
 MF a[116:119],v[16:19],v[88:91]
 MF a[120:123],v[16:19],v[92:95]
 MF a[124:127],v[16:19],v[96:99]
 s_waitcnt lgkmcnt(0)
 s_waitcnt vmcnt(0)
 s_barrier
 MF a[128:131],v[20:23],v[68:71]
 RB 36,39,100,0
 MF a[132:135],v[20:23],v[72:75]
 RB 40,43,100,512
 MF a[136:139],v[20:23],v[76:79]
 RB 44,47,100,4096
 DM 30,32768,112,s[16:19],24,sc1 lds
 MF a[140:143],v[20:23],v[80:83]
 RB 48,51,100,4608
 MF a[144:147],v[20:23],v[84:87]
 RB 52,55,100,8192
 MF a[148:151],v[20:23],v[88:91]
 RB 56,59,100,8704
 MF a[152:155],v[20:23],v[92:95]
 RB 60,63,100,12288
 DM 30,33792,113,s[16:19],24,sc1 lds
 MF a[156:159],v[20:23],v[96:99]
 RB 64,67,100,12800
 MF a[160:163],v[24:27],v[68:71]
 TR 4,5,104,0
 MF a[164:167],v[24:27],v[72:75]
 TR 6,7,104,2048
 MF a[168:171],v[24:27],v[76:79]
 TR 8,9,105,0
 DM 30,34816,114,s[16:19],24,sc1 lds
 MF a[172:175],v[24:27],v[80:83]
 TR 10,11,105,2048
 MF a[176:179],v[24:27],v[84:87]
 TR 12,13,106,0
 MF a[180:183],v[24:27],v[88:91]
 TR 14,15,106,2048
 MF a[184:187],v[24:27],v[92:95]
 TR 16,17,107,0
 DM 30,35840,115,s[16:19],24,sc1 lds
 MF a[188:191],v[24:27],v[96:99]
 TR 18,19,107,2048
 MF a[192:195],v[28:31],v[68:71]
 MF a[196:199],v[28:31],v[72:75]
 MF a[200:203],v[28:31],v[76:79]
 DM 30,36864,116,s[16:19],24,sc1 lds
 MF a[204:207],v[28:31],v[80:83]
 MF a[208:211],v[28:31],v[84:87]
 MF a[212:215],v[28:31],v[88:91]
 MF a[216:219],v[28:31],v[92:95]
 DM 30,37888,117,s[16:19],24,sc1 lds
 MF a[220:223],v[28:31],v[96:99]
 MF a[224:227],v[32:35],v[68:71]
 MF a[228:231],v[32:35],v[72:75]
 MF a[232:235],v[32:35],v[76:79]
 DM 30,38912,118,s[16:19],24,sc1 lds
 MF a[236:239],v[32:35],v[80:83]
 MF a[240:243],v[32:35],v[84:87]
 MF a[244:247],v[32:35],v[88:91]
 MF a[248:251],v[32:35],v[92:95]
 DM 30,39936,119,s[16:19],24,sc1 lds
 MF a[252:255],v[32:35],v[96:99]
 s_waitcnt lgkmcnt(0)
 s_sub_u32 s32, s32, 1
 s_cmp_lg_u32 s32, 0
 s_cbranch_scc1 kvl_loop_9
 MF a[0:3],v[4:7],v[36:39]
 TR 20,21,108,0
 MF a[4:7],v[4:7],v[40:43]
 TR 22,23,108,2048
 MF a[8:11],v[4:7],v[44:47]
 TR 24,25,109,0
 DM 31,32768,120,s[20:23],25,lds
 MF a[12:15],v[4:7],v[48:51]
 TR 26,27,109,2048
 MF a[16:19],v[4:7],v[52:55]
 TR 28,29,110,0
 MF a[20:23],v[4:7],v[56:59]
 TR 30,31,110,2048
 MF a[24:27],v[4:7],v[60:63]
 TR 32,33,111,0
 DM 31,33792,121,s[20:23],25,lds
 MF a[28:31],v[4:7],v[64:67]
 TR 34,35,111,2048
 MF a[32:35],v[8:11],v[36:39]
 MF a[36:39],v[8:11],v[40:43]
 MF a[40:43],v[8:11],v[44:47]
 DM 31,34816,122,s[20:23],25,lds
 MF a[44:47],v[8:11],v[48:51]
 MF a[48:51],v[8:11],v[52:55]
 MF a[52:55],v[8:11],v[56:59]
 MF a[56:59],v[8:11],v[60:63]
 DM 31,35840,123,s[20:23],25,lds
 MF a[60:63],v[8:11],v[64:67]
 MF a[64:67],v[12:15],v[36:39]
 MF a[68:71],v[12:15],v[40:43]
 MF a[72:75],v[12:15],v[44:47]
 DM 31,36864,124,s[20:23],25,lds
 MF a[76:79],v[12:15],v[48:51]
 MF a[80:83],v[12:15],v[52:55]
 MF a[84:87],v[12:15],v[56:59]
 MF a[88:91],v[12:15],v[60:63]
 DM 31,37888,125,s[20:23],25,lds
 MF a[92:95],v[12:15],v[64:67]
 MF a[96:99],v[16:19],v[36:39]
 MF a[100:103],v[16:19],v[40:43]
 MF a[104:107],v[16:19],v[44:47]
 DM 31,38912,126,s[20:23],25,lds
 MF a[108:111],v[16:19],v[48:51]
 MF a[112:115],v[16:19],v[52:55]
 MF a[116:119],v[16:19],v[56:59]
 MF a[120:123],v[16:19],v[60:63]
 DM 31,39936,127,s[20:23],25,lds
 s_add_u32 s24, s24, 128
 s_add_u32 s25, s25, 524288
 MF a[124:127],v[16:19],v[64:67]
 s_waitcnt lgkmcnt(0)
 MF a[128:131],v[20:23],v[36:39]
 RB 68,71,101,0
 MF a[132:135],v[20:23],v[40:43]
 RB 72,75,101,512
 MF a[136:139],v[20:23],v[44:47]
 RB 76,79,101,4096
 MF a[140:143],v[20:23],v[48:51]
 RB 80,83,101,4608
 MF a[144:147],v[20:23],v[52:55]
 RB 84,87,101,8192
 MF a[148:151],v[20:23],v[56:59]
 RB 88,91,101,8704
 MF a[152:155],v[20:23],v[60:63]
 RB 92,95,101,12288
 MF a[156:159],v[20:23],v[64:67]
 RB 96,99,101,12800
 MF a[160:163],v[24:27],v[36:39]
 TR 4,5,104,16384
 MF a[164:167],v[24:27],v[40:43]
 TR 6,7,104,18432
 MF a[168:171],v[24:27],v[44:47]
 TR 8,9,105,16384
 MF a[172:175],v[24:27],v[48:51]
 TR 10,11,105,18432
 MF a[176:179],v[24:27],v[52:55]
 TR 12,13,106,16384
 MF a[180:183],v[24:27],v[56:59]
 TR 14,15,106,18432
 MF a[184:187],v[24:27],v[60:63]
 TR 16,17,107,16384
 MF a[188:191],v[24:27],v[64:67]
 TR 18,19,107,18432
 MF a[192:195],v[28:31],v[36:39]
 MF a[196:199],v[28:31],v[40:43]
 MF a[200:203],v[28:31],v[44:47]
 MF a[204:207],v[28:31],v[48:51]
 MF a[208:211],v[28:31],v[52:55]
 MF a[212:215],v[28:31],v[56:59]
 MF a[216:219],v[28:31],v[60:63]
 MF a[220:223],v[28:31],v[64:67]
 MF a[224:227],v[32:35],v[36:39]
 MF a[228:231],v[32:35],v[40:43]
 MF a[232:235],v[32:35],v[44:47]
 MF a[236:239],v[32:35],v[48:51]
 MF a[240:243],v[32:35],v[52:55]
 MF a[244:247],v[32:35],v[56:59]
 MF a[248:251],v[32:35],v[60:63]
 MF a[252:255],v[32:35],v[64:67]
 s_waitcnt lgkmcnt(0)
 MF a[0:3],v[4:7],v[68:71]
 TR 20,21,108,16384
 MF a[4:7],v[4:7],v[72:75]
 TR 22,23,108,18432
 MF a[8:11],v[4:7],v[76:79]
 TR 24,25,109,16384
 MF a[12:15],v[4:7],v[80:83]
 TR 26,27,109,18432
 MF a[16:19],v[4:7],v[84:87]
 TR 28,29,110,16384
 MF a[20:23],v[4:7],v[88:91]
 TR 30,31,110,18432
 MF a[24:27],v[4:7],v[92:95]
 TR 32,33,111,16384
 MF a[28:31],v[4:7],v[96:99]
 TR 34,35,111,18432
 MF a[32:35],v[8:11],v[68:71]
 MF a[36:39],v[8:11],v[72:75]
 MF a[40:43],v[8:11],v[76:79]
 MF a[44:47],v[8:11],v[80:83]
 MF a[48:51],v[8:11],v[84:87]
 MF a[52:55],v[8:11],v[88:91]
 MF a[56:59],v[8:11],v[92:95]
 MF a[60:63],v[8:11],v[96:99]
 MF a[64:67],v[12:15],v[68:71]
 MF a[68:71],v[12:15],v[72:75]
 MF a[72:75],v[12:15],v[76:79]
 MF a[76:79],v[12:15],v[80:83]
 MF a[80:83],v[12:15],v[84:87]
 MF a[84:87],v[12:15],v[88:91]
 MF a[88:91],v[12:15],v[92:95]
 MF a[92:95],v[12:15],v[96:99]
 MF a[96:99],v[16:19],v[68:71]
 MF a[100:103],v[16:19],v[72:75]
 MF a[104:107],v[16:19],v[76:79]
 MF a[108:111],v[16:19],v[80:83]
 MF a[112:115],v[16:19],v[84:87]
 MF a[116:119],v[16:19],v[88:91]
 MF a[120:123],v[16:19],v[92:95]
 MF a[124:127],v[16:19],v[96:99]
 s_waitcnt lgkmcnt(0)
 s_waitcnt vmcnt(0)
 s_barrier
 MF a[128:131],v[20:23],v[68:71]
 RB 36,39,100,32768
 MF a[132:135],v[20:23],v[72:75]
 RB 40,43,100,33280
 MF a[136:139],v[20:23],v[76:79]
 RB 44,47,100,36864
 MF a[140:143],v[20:23],v[80:83]
 RB 48,51,100,37376
 MF a[144:147],v[20:23],v[84:87]
 RB 52,55,100,40960
 MF a[148:151],v[20:23],v[88:91]
 RB 56,59,100,41472
 MF a[152:155],v[20:23],v[92:95]
 RB 60,63,100,45056
 MF a[156:159],v[20:23],v[96:99]
 RB 64,67,100,45568
 MF a[160:163],v[24:27],v[68:71]
 TR 4,5,104,32768
 MF a[164:167],v[24:27],v[72:75]
 TR 6,7,104,34816
 MF a[168:171],v[24:27],v[76:79]
 TR 8,9,105,32768
 MF a[172:175],v[24:27],v[80:83]
 TR 10,11,105,34816
 MF a[176:179],v[24:27],v[84:87]
 TR 12,13,106,32768
 MF a[180:183],v[24:27],v[88:91]
 TR 14,15,106,34816
 MF a[184:187],v[24:27],v[92:95]
 TR 16,17,107,32768
 MF a[188:191],v[24:27],v[96:99]
 TR 18,19,107,34816
 MF a[192:195],v[28:31],v[68:71]
 MF a[196:199],v[28:31],v[72:75]
 MF a[200:203],v[28:31],v[76:79]
 MF a[204:207],v[28:31],v[80:83]
 MF a[208:211],v[28:31],v[84:87]
 MF a[212:215],v[28:31],v[88:91]
 MF a[216:219],v[28:31],v[92:95]
 MF a[220:223],v[28:31],v[96:99]
 MF a[224:227],v[32:35],v[68:71]
 MF a[228:231],v[32:35],v[72:75]
 MF a[232:235],v[32:35],v[76:79]
 MF a[236:239],v[32:35],v[80:83]
 MF a[240:243],v[32:35],v[84:87]
 MF a[244:247],v[32:35],v[88:91]
 MF a[248:251],v[32:35],v[92:95]
 MF a[252:255],v[32:35],v[96:99]
 s_waitcnt lgkmcnt(0)
 MF a[0:3],v[4:7],v[36:39]
 TR 20,21,108,32768
 MF a[4:7],v[4:7],v[40:43]
 TR 22,23,108,34816
 MF a[8:11],v[4:7],v[44:47]
 TR 24,25,109,32768
 MF a[12:15],v[4:7],v[48:51]
 TR 26,27,109,34816
 MF a[16:19],v[4:7],v[52:55]
 TR 28,29,110,32768
 MF a[20:23],v[4:7],v[56:59]
 TR 30,31,110,34816
 MF a[24:27],v[4:7],v[60:63]
 TR 32,33,111,32768
 MF a[28:31],v[4:7],v[64:67]
 TR 34,35,111,34816
 MF a[32:35],v[8:11],v[36:39]
 MF a[36:39],v[8:11],v[40:43]
 MF a[40:43],v[8:11],v[44:47]
 MF a[44:47],v[8:11],v[48:51]
 MF a[48:51],v[8:11],v[52:55]
 MF a[52:55],v[8:11],v[56:59]
 MF a[56:59],v[8:11],v[60:63]
 MF a[60:63],v[8:11],v[64:67]
 MF a[64:67],v[12:15],v[36:39]
 MF a[68:71],v[12:15],v[40:43]
 MF a[72:75],v[12:15],v[44:47]
 MF a[76:79],v[12:15],v[48:51]
 MF a[80:83],v[12:15],v[52:55]
 MF a[84:87],v[12:15],v[56:59]
 MF a[88:91],v[12:15],v[60:63]
 MF a[92:95],v[12:15],v[64:67]
 MF a[96:99],v[16:19],v[36:39]
 MF a[100:103],v[16:19],v[40:43]
 MF a[104:107],v[16:19],v[44:47]
 MF a[108:111],v[16:19],v[48:51]
 MF a[112:115],v[16:19],v[52:55]
 MF a[116:119],v[16:19],v[56:59]
 MF a[120:123],v[16:19],v[60:63]
 MF a[124:127],v[16:19],v[64:67]
 s_waitcnt lgkmcnt(0)
 MF a[128:131],v[20:23],v[36:39]
 RB 68,71,101,32768
 MF a[132:135],v[20:23],v[40:43]
 RB 72,75,101,33280
 MF a[136:139],v[20:23],v[44:47]
 RB 76,79,101,36864
 MF a[140:143],v[20:23],v[48:51]
 RB 80,83,101,37376
 MF a[144:147],v[20:23],v[52:55]
 RB 84,87,101,40960
 MF a[148:151],v[20:23],v[56:59]
 RB 88,91,101,41472
 MF a[152:155],v[20:23],v[60:63]
 RB 92,95,101,45056
 MF a[156:159],v[20:23],v[64:67]
 RB 96,99,101,45568
 MF a[160:163],v[24:27],v[36:39]
 TR 4,5,104,49152
 MF a[164:167],v[24:27],v[40:43]
 TR 6,7,104,51200
 MF a[168:171],v[24:27],v[44:47]
 TR 8,9,105,49152
 MF a[172:175],v[24:27],v[48:51]
 TR 10,11,105,51200
 MF a[176:179],v[24:27],v[52:55]
 TR 12,13,106,49152
 MF a[180:183],v[24:27],v[56:59]
 TR 14,15,106,51200
 MF a[184:187],v[24:27],v[60:63]
 TR 16,17,107,49152
 MF a[188:191],v[24:27],v[64:67]
 TR 18,19,107,51200
 MF a[192:195],v[28:31],v[36:39]
 MF a[196:199],v[28:31],v[40:43]
 MF a[200:203],v[28:31],v[44:47]
 MF a[204:207],v[28:31],v[48:51]
 MF a[208:211],v[28:31],v[52:55]
 MF a[212:215],v[28:31],v[56:59]
 MF a[216:219],v[28:31],v[60:63]
 MF a[220:223],v[28:31],v[64:67]
 MF a[224:227],v[32:35],v[36:39]
 MF a[228:231],v[32:35],v[40:43]
 MF a[232:235],v[32:35],v[44:47]
 MF a[236:239],v[32:35],v[48:51]
 MF a[240:243],v[32:35],v[52:55]
 MF a[244:247],v[32:35],v[56:59]
 MF a[248:251],v[32:35],v[60:63]
 MF a[252:255],v[32:35],v[64:67]
 s_waitcnt lgkmcnt(0)
 MF a[0:3],v[4:7],v[68:71]
 TR 20,21,108,49152
 MF a[4:7],v[4:7],v[72:75]
 TR 22,23,108,51200
 MF a[8:11],v[4:7],v[76:79]
 TR 24,25,109,49152
 MF a[12:15],v[4:7],v[80:83]
 TR 26,27,109,51200
 MF a[16:19],v[4:7],v[84:87]
 TR 28,29,110,49152
 MF a[20:23],v[4:7],v[88:91]
 TR 30,31,110,51200
 MF a[24:27],v[4:7],v[92:95]
 TR 32,33,111,49152
 MF a[28:31],v[4:7],v[96:99]
 TR 34,35,111,51200
 MF a[32:35],v[8:11],v[68:71]
 MF a[36:39],v[8:11],v[72:75]
 MF a[40:43],v[8:11],v[76:79]
 MF a[44:47],v[8:11],v[80:83]
 MF a[48:51],v[8:11],v[84:87]
 MF a[52:55],v[8:11],v[88:91]
 MF a[56:59],v[8:11],v[92:95]
 MF a[60:63],v[8:11],v[96:99]
 MF a[64:67],v[12:15],v[68:71]
 MF a[68:71],v[12:15],v[72:75]
 MF a[72:75],v[12:15],v[76:79]
 MF a[76:79],v[12:15],v[80:83]
 MF a[80:83],v[12:15],v[84:87]
 MF a[84:87],v[12:15],v[88:91]
 MF a[88:91],v[12:15],v[92:95]
 MF a[92:95],v[12:15],v[96:99]
 MF a[96:99],v[16:19],v[68:71]
 MF a[100:103],v[16:19],v[72:75]
 MF a[104:107],v[16:19],v[76:79]
 MF a[108:111],v[16:19],v[80:83]
 MF a[112:115],v[16:19],v[84:87]
 MF a[116:119],v[16:19],v[88:91]
 MF a[120:123],v[16:19],v[92:95]
 MF a[124:127],v[16:19],v[96:99]
 s_waitcnt lgkmcnt(0)
 MF a[128:131],v[20:23],v[68:71]
 MF a[132:135],v[20:23],v[72:75]
 MF a[136:139],v[20:23],v[76:79]
 MF a[140:143],v[20:23],v[80:83]
 MF a[144:147],v[20:23],v[84:87]
 MF a[148:151],v[20:23],v[88:91]
 MF a[152:155],v[20:23],v[92:95]
 MF a[156:159],v[20:23],v[96:99]
 MF a[160:163],v[24:27],v[68:71]
 MF a[164:167],v[24:27],v[72:75]
 MF a[168:171],v[24:27],v[76:79]
 MF a[172:175],v[24:27],v[80:83]
 MF a[176:179],v[24:27],v[84:87]
 MF a[180:183],v[24:27],v[88:91]
 MF a[184:187],v[24:27],v[92:95]
 MF a[188:191],v[24:27],v[96:99]
 MF a[192:195],v[28:31],v[68:71]
 MF a[196:199],v[28:31],v[72:75]
 MF a[200:203],v[28:31],v[76:79]
 MF a[204:207],v[28:31],v[80:83]
 MF a[208:211],v[28:31],v[84:87]
 MF a[212:215],v[28:31],v[88:91]
 MF a[216:219],v[28:31],v[92:95]
 MF a[220:223],v[28:31],v[96:99]
 MF a[224:227],v[32:35],v[68:71]
 MF a[228:231],v[32:35],v[72:75]
 MF a[232:235],v[32:35],v[76:79]
 MF a[236:239],v[32:35],v[80:83]
 MF a[240:243],v[32:35],v[84:87]
 MF a[244:247],v[32:35],v[88:91]
 MF a[248:251],v[32:35],v[92:95]
 MF a[252:255],v[32:35],v[96:99]
 v_lshlrev_b32 v3, 4, v2
 s_mul_i32 s26, s10, 8
 s_mul_i32 s27, s33, 4
 s_add_u32 s26, s26, s27
 s_lshl_b32 s26, s26, 18
 s_mul_i32 s27, s12, 256
 s_mul_i32 s28, s34, 128
 s_add_u32 s27, s27, s28
 s_lshr_b32 s28, s27, 7
 s_lshl_b32 s28, s28, 13
 s_add_u32 s26, s26, s28
 s_and_b32 s27, s27, 127
 s_lshl_b32 s27, s27, 5
 s_add_u32 s26, s26, s27
 s_add_u32 s26, s26, s29
 s_nop 3
 AR 36,0
 AR 37,1
 AR 38,2
 AR 39,3
 AR 40,32
 AR 41,33
 AR 42,34
 AR 43,35
 CV 4,36,37
 CV 5,38,39
 CV 6,40,41
 CV 7,42,43
 buffer_store_dwordx4 v[4:7], v3, s[16:19], s26 offen offset:0 sc1
 AR 44,64
 AR 45,65
 AR 46,66
 AR 47,67
 AR 48,96
 AR 49,97
 AR 50,98
 AR 51,99
 CV 8,44,45
 CV 9,46,47
 CV 10,48,49
 CV 11,50,51
 buffer_store_dwordx4 v[8:11], v3, s[16:19], s26 offen offset:1024 sc1
 AR 36,128
 AR 37,129
 AR 38,130
 AR 39,131
 AR 40,160
 AR 41,161
 AR 42,162
 AR 43,163
 CV 12,36,37
 CV 13,38,39
 CV 14,40,41
 CV 15,42,43
 buffer_store_dwordx4 v[12:15], v3, s[16:19], s26 offen offset:2048 sc1
 AR 44,192
 AR 45,193
 AR 46,194
 AR 47,195
 AR 48,224
 AR 49,225
 AR 50,226
 AR 51,227
 CV 16,44,45
 CV 17,46,47
 CV 18,48,49
 CV 19,50,51
 buffer_store_dwordx4 v[16:19], v3, s[16:19], s26 offen offset:3072 sc1
 s_add_u32 s26, s26, 4096
 AR 36,4
 AR 37,5
 AR 38,6
 AR 39,7
 AR 40,36
 AR 41,37
 AR 42,38
 AR 43,39
 CV 20,36,37
 CV 21,38,39
 CV 22,40,41
 CV 23,42,43
 buffer_store_dwordx4 v[20:23], v3, s[16:19], s26 offen offset:0 sc1
 AR 44,68
 AR 45,69
 AR 46,70
 AR 47,71
 AR 48,100
 AR 49,101
 AR 50,102
 AR 51,103
 CV 24,44,45
 CV 25,46,47
 CV 26,48,49
 CV 27,50,51
 buffer_store_dwordx4 v[24:27], v3, s[16:19], s26 offen offset:1024 sc1
 AR 36,132
 AR 37,133
 AR 38,134
 AR 39,135
 AR 40,164
 AR 41,165
 AR 42,166
 AR 43,167
 CV 28,36,37
 CV 29,38,39
 CV 30,40,41
 CV 31,42,43
 buffer_store_dwordx4 v[28:31], v3, s[16:19], s26 offen offset:2048 sc1
 AR 44,196
 AR 45,197
 AR 46,198
 AR 47,199
 AR 48,228
 AR 49,229
 AR 50,230
 AR 51,231
 CV 32,44,45
 CV 33,46,47
 CV 34,48,49
 CV 35,50,51
 buffer_store_dwordx4 v[32:35], v3, s[16:19], s26 offen offset:3072 sc1
 s_add_u32 s26, s26, 258048
 AR 36,8
 AR 37,9
 AR 38,10
 AR 39,11
 AR 40,40
 AR 41,41
 AR 42,42
 AR 43,43
 CV 4,36,37
 CV 5,38,39
 CV 6,40,41
 CV 7,42,43
 buffer_store_dwordx4 v[4:7], v3, s[16:19], s26 offen offset:0 sc1
 AR 44,72
 AR 45,73
 AR 46,74
 AR 47,75
 AR 48,104
 AR 49,105
 AR 50,106
 AR 51,107
 CV 8,44,45
 CV 9,46,47
 CV 10,48,49
 CV 11,50,51
 buffer_store_dwordx4 v[8:11], v3, s[16:19], s26 offen offset:1024 sc1
 AR 36,136
 AR 37,137
 AR 38,138
 AR 39,139
 AR 40,168
 AR 41,169
 AR 42,170
 AR 43,171
 CV 12,36,37
 CV 13,38,39
 CV 14,40,41
 CV 15,42,43
 buffer_store_dwordx4 v[12:15], v3, s[16:19], s26 offen offset:2048 sc1
 AR 44,200
 AR 45,201
 AR 46,202
 AR 47,203
 AR 48,232
 AR 49,233
 AR 50,234
 AR 51,235
 CV 16,44,45
 CV 17,46,47
 CV 18,48,49
 CV 19,50,51
 buffer_store_dwordx4 v[16:19], v3, s[16:19], s26 offen offset:3072 sc1
 s_add_u32 s26, s26, 4096
 AR 36,12
 AR 37,13
 AR 38,14
 AR 39,15
 AR 40,44
 AR 41,45
 AR 42,46
 AR 43,47
 CV 20,36,37
 CV 21,38,39
 CV 22,40,41
 CV 23,42,43
 buffer_store_dwordx4 v[20:23], v3, s[16:19], s26 offen offset:0 sc1
 AR 44,76
 AR 45,77
 AR 46,78
 AR 47,79
 AR 48,108
 AR 49,109
 AR 50,110
 AR 51,111
 CV 24,44,45
 CV 25,46,47
 CV 26,48,49
 CV 27,50,51
 buffer_store_dwordx4 v[24:27], v3, s[16:19], s26 offen offset:1024 sc1
 AR 36,140
 AR 37,141
 AR 38,142
 AR 39,143
 AR 40,172
 AR 41,173
 AR 42,174
 AR 43,175
 CV 28,36,37
 CV 29,38,39
 CV 30,40,41
 CV 31,42,43
 buffer_store_dwordx4 v[28:31], v3, s[16:19], s26 offen offset:2048 sc1
 AR 44,204
 AR 45,205
 AR 46,206
 AR 47,207
 AR 48,236
 AR 49,237
 AR 50,238
 AR 51,239
 CV 32,44,45
 CV 33,46,47
 CV 34,48,49
 CV 35,50,51
 buffer_store_dwordx4 v[32:35], v3, s[16:19], s26 offen offset:3072 sc1
 s_add_u32 s26, s26, 258048
 AR 36,16
 AR 37,17
 AR 38,18
 AR 39,19
 AR 40,48
 AR 41,49
 AR 42,50
 AR 43,51
 CV 4,36,37
 CV 5,38,39
 CV 6,40,41
 CV 7,42,43
 buffer_store_dwordx4 v[4:7], v3, s[16:19], s26 offen offset:0 sc1
 AR 44,80
 AR 45,81
 AR 46,82
 AR 47,83
 AR 48,112
 AR 49,113
 AR 50,114
 AR 51,115
 CV 8,44,45
 CV 9,46,47
 CV 10,48,49
 CV 11,50,51
 buffer_store_dwordx4 v[8:11], v3, s[16:19], s26 offen offset:1024 sc1
 AR 36,144
 AR 37,145
 AR 38,146
 AR 39,147
 AR 40,176
 AR 41,177
 AR 42,178
 AR 43,179
 CV 12,36,37
 CV 13,38,39
 CV 14,40,41
 CV 15,42,43
 buffer_store_dwordx4 v[12:15], v3, s[16:19], s26 offen offset:2048 sc1
 AR 44,208
 AR 45,209
 AR 46,210
 AR 47,211
 AR 48,240
 AR 49,241
 AR 50,242
 AR 51,243
 CV 16,44,45
 CV 17,46,47
 CV 18,48,49
 CV 19,50,51
 buffer_store_dwordx4 v[16:19], v3, s[16:19], s26 offen offset:3072 sc1
 s_add_u32 s26, s26, 4096
 AR 36,20
 AR 37,21
 AR 38,22
 AR 39,23
 AR 40,52
 AR 41,53
 AR 42,54
 AR 43,55
 CV 20,36,37
 CV 21,38,39
 CV 22,40,41
 CV 23,42,43
 buffer_store_dwordx4 v[20:23], v3, s[16:19], s26 offen offset:0 sc1
 AR 44,84
 AR 45,85
 AR 46,86
 AR 47,87
 AR 48,116
 AR 49,117
 AR 50,118
 AR 51,119
 CV 24,44,45
 CV 25,46,47
 CV 26,48,49
 CV 27,50,51
 buffer_store_dwordx4 v[24:27], v3, s[16:19], s26 offen offset:1024 sc1
 AR 36,148
 AR 37,149
 AR 38,150
 AR 39,151
 AR 40,180
 AR 41,181
 AR 42,182
 AR 43,183
 CV 28,36,37
 CV 29,38,39
 CV 30,40,41
 CV 31,42,43
 buffer_store_dwordx4 v[28:31], v3, s[16:19], s26 offen offset:2048 sc1
 AR 44,212
 AR 45,213
 AR 46,214
 AR 47,215
 AR 48,244
 AR 49,245
 AR 50,246
 AR 51,247
 CV 32,44,45
 CV 33,46,47
 CV 34,48,49
 CV 35,50,51
 buffer_store_dwordx4 v[32:35], v3, s[16:19], s26 offen offset:3072 sc1
 s_add_u32 s26, s26, 258048
 AR 36,24
 AR 37,25
 AR 38,26
 AR 39,27
 AR 40,56
 AR 41,57
 AR 42,58
 AR 43,59
 CV 4,36,37
 CV 5,38,39
 CV 6,40,41
 CV 7,42,43
 buffer_store_dwordx4 v[4:7], v3, s[16:19], s26 offen offset:0 sc1
 AR 44,88
 AR 45,89
 AR 46,90
 AR 47,91
 AR 48,120
 AR 49,121
 AR 50,122
 AR 51,123
 CV 8,44,45
 CV 9,46,47
 CV 10,48,49
 CV 11,50,51
 buffer_store_dwordx4 v[8:11], v3, s[16:19], s26 offen offset:1024 sc1
 AR 36,152
 AR 37,153
 AR 38,154
 AR 39,155
 AR 40,184
 AR 41,185
 AR 42,186
 AR 43,187
 CV 12,36,37
 CV 13,38,39
 CV 14,40,41
 CV 15,42,43
 buffer_store_dwordx4 v[12:15], v3, s[16:19], s26 offen offset:2048 sc1
 AR 44,216
 AR 45,217
 AR 46,218
 AR 47,219
 AR 48,248
 AR 49,249
 AR 50,250
 AR 51,251
 CV 16,44,45
 CV 17,46,47
 CV 18,48,49
 CV 19,50,51
 buffer_store_dwordx4 v[16:19], v3, s[16:19], s26 offen offset:3072 sc1
 s_add_u32 s26, s26, 4096
 AR 36,28
 AR 37,29
 AR 38,30
 AR 39,31
 AR 40,60
 AR 41,61
 AR 42,62
 AR 43,63
 CV 20,36,37
 CV 21,38,39
 CV 22,40,41
 CV 23,42,43
 buffer_store_dwordx4 v[20:23], v3, s[16:19], s26 offen offset:0 sc1
 AR 44,92
 AR 45,93
 AR 46,94
 AR 47,95
 AR 48,124
 AR 49,125
 AR 50,126
 AR 51,127
 CV 24,44,45
 CV 25,46,47
 CV 26,48,49
 CV 27,50,51
 buffer_store_dwordx4 v[24:27], v3, s[16:19], s26 offen offset:1024 sc1
 AR 36,156
 AR 37,157
 AR 38,158
 AR 39,159
 AR 40,188
 AR 41,189
 AR 42,190
 AR 43,191
 CV 28,36,37
 CV 29,38,39
 CV 30,40,41
 CV 31,42,43
 buffer_store_dwordx4 v[28:31], v3, s[16:19], s26 offen offset:2048 sc1
 AR 44,220
 AR 45,221
 AR 46,222
 AR 47,223
 AR 48,252
 AR 49,253
 AR 50,254
 AR 51,255
 CV 32,44,45
 CV 33,46,47
 CV 34,48,49
 CV 35,50,51
 buffer_store_dwordx4 v[32:35], v3, s[16:19], s26 offen offset:3072 sc1
 s_add_u32 s26, s26, 258048
 s_branch mk_done
 s_branch mk_end
mk_haverole:
 s_lshr_b32 s35, s34, 4
 s_and_b32 s36, s34, 15
 s_mov_b32 s50, 0
 s_mov_b32 s51, -1
 s_mov_b32 s52, -1
 s_mov_b32 s53, 0
 s_mov_b32 s54, 0x3e0293ee
 s_mov_b32 s55, 0x3e0293ee
 s_mov_b32 s59, 0xbe0293ee
 s_mov_b32 s95, 0xffff0000
 v_and_b32 v16, 15, v2
 v_lshrrev_b32 v17, 4, v2
 v_lshlrev_b32 v6, 4, v2
 v_add_u32 v15, 0x1000, v6
 v_lshlrev_b32 v13, 2, v2
 v_lshlrev_b32 v10, 3, v2
 v_mov_b32 v3, 0x44444444
 v_mov_b32 v18, 0xeeeeeeee
 v_cmp_lt_u32 vcc, 7, v16
 s_nop 1
 v_cndmask_b32 v3, v3, v18, vcc
 v_lshrrev_b32 v21, 5, v2
 v_and_b32 v20, 1, v17

 v_lshrrev_b32 v18, 2, v16
 v_lshl_add_u32 v19, v18, 1, v20
 v_mul_u32_u24 v18, 144, v19
 v_lshl_add_u32 v18, v21, 4, v18
 v_and_b32 v19, 3, v16
 v_lshl_add_u32 v18, v19, 2, v18
 s_mul_i32 s56, s13, 3584
 v_add_u32 v7, s56, v18

 v_lshrrev_b32 v18, 3, v16
 v_lshl_add_u32 v18, v18, 2, v20
 v_bfe_u32 v19, v16, 1, 1
 v_lshl_add_u32 v18, v19, 1, v18
 v_mul_u32_u24 v18, 144, v18
 v_bfe_u32 v19, v16, 2, 1
 v_lshl_add_u32 v18, v19, 4, v18
 v_lshl_add_u32 v18, v21, 3, v18
 v_and_b32 v19, 1, v16
 v_lshl_add_u32 v18, v19, 2, v18
 s_add_u32 s56, s56, 2304
 v_add_u32 v8, s56, v18

 v_lshrrev_b32 v18, 3, v2
 v_lshl_add_u32 v18, v18, 4, v6
 s_mul_i32 s56, s13, 1152
 v_add_u32 v9, s56, v18

 v_lshlrev_b32 v18, 8, v17
 v_lshl_add_u32 v18, v16, 3, v18
 s_cmp_eq_u32 s13, 2
 s_cbranch_scc1 mk_d1v
 v_mov_b32 v10, v18
 s_cmp_eq_u32 s13, 3
 s_cbranch_scc0 mk_d1v

 v_lshrrev_b32 v18, 3, v2
 v_and_b32 v19, 7, v2
 v_lshlrev_b32 v10, 8, v18
 v_lshl_add_u32 v10, v19, 3, v10
 v_lshrrev_b32 v9, 2, v19
 v_lshlrev_b32 v9, 2, v9
 v_lshrrev_b32 v4, 2, v18
 v_add_u32 v9, v9, v4
 v_mul_u32_u24 v9, 144, v9
 v_and_b32 v18, 3, v18
 v_lshl_add_u32 v9, v18, 5, v9
 v_and_b32 v19, 3, v19
 v_lshl_add_u32 v9, v19, 3, v9
 v_add_u32 v9, 2304, v9
mk_d1v:

 v_lshrrev_b32 v18, 3, v16
 v_lshl_add_u32 v18, v18, 1, v20
 v_mul_u32_u24 v18, 160, v18
 v_mul_u32_u24 v19, 640, v21
 v_add_u32 v18, v18, v19
 v_and_b32 v19, 7, v16
 v_lshl_add_u32 v18, v19, 2, v18
 s_mul_i32 s56, s13, 2560
 s_add_u32 s56, s56, 14336
 v_add_u32 v11, s56, v18

 v_lshlrev_b32 v18, 3, v2
 v_lshl_add_u32 v18, v17, 5, v18
 s_mul_i32 s56, s13, 640
 s_add_u32 s56, s56, 14336
 v_add_u32 v12, s56, v18
 v_mov_b32 v244, 0x3f803f80
 v_mov_b32 v245, 0
 v_mov_b32 v246, 0x3f803f80
 v_mov_b32 v247, 0
 v_mov_b32 v248, 0x3f803f80
 v_mov_b32 v249, 0
 v_mov_b32 v250, 0x3f803f80
 v_mov_b32 v251, 0
 s_mov_b64 exec, s[52:53]
 v_mov_b32 v249, 0x3f803f80
 v_mov_b32 v251, 0x3f803f80
 s_mov_b64 exec, -1
 v_mov_b32 v193, 0
 v_mov_b32 v195, 0
 v_mov_b32 v201, 0
 v_mov_b32 v203, 0
 v_mov_b32 v209, 0
 v_mov_b32 v211, 0
 v_mov_b32 v217, 0
 v_mov_b32 v219, 0
 s_lshl_b32 s40, s35, 14
 s_lshl_b32 s56, s13, 12
 s_add_u32 s40, s40, s56
 s_add_u32 s40, s40, 83886080
 s_mul_i32 s57, s35, 32768
 s_add_u32 s57, s57, 84017152
 s_mul_i32 s56, s13, 8192
 s_add_u32 s42, s57, s56
 s_lshr_b32 s56, s36, 2
 s_mul_i32 s56, s56, 8192
 s_add_u32 s57, s57, s56
 s_and_b32 s56, s36, 3
 s_lshl_b32 s58, s56, 10
 s_add_u32 s41, s57, s58
 s_lshl_b32 s58, s13, 7
 s_add_u32 s41, s41, s58
 s_lshl_b32 s58, s56, 9
 s_add_u32 s58, s58, s57
 s_add_u32 s58, s58, 4096
 s_cmp_eq_u32 s13, 2
 s_cselect_b32 s41, s58, s41
 s_lshl_b32 s58, s56, 6
 s_add_u32 s58, s58, s57
 s_add_u32 s58, s58, 6144
 s_cmp_eq_u32 s13, 3
 s_cselect_b32 s41, s58, s41
 s_lshl_b32 s56, s36, 13
 s_add_u32 s56, s56, 84279296
 s_lshl_b32 s57, s13, 8
 s_add_u32 s44, s56, s57
 s_add_u32 s93, s44, 4096
 s_lshl_b32 s58, s35, 10
 s_add_u32 s43, s44, s58
 s_lshl_b32 s45, s35, 14
 s_lshl_b32 s56, s13, 8
 s_add_u32 s45, s45, s56
 s_lshl_b32 s56, s36, 10
 s_add_u32 s45, s45, s56
 s_add_u32 s45, s45, 84410368
 s_lshl_b32 s56, s35, 2
 s_add_u32 s56, s56, s13
 s_lshl_b32 s56, s56, 13
 s_add_u32 s46, s56, 4194304
 s_add_u32 s49, s56, 20971520

 s_lshl_b32 s92, s35, 15
 s_lshl_b32 s56, s36, 11
 s_add_u32 s92, s92, s56
 s_and_b32 s56, s13, 1
 s_lshl_b32 s56, s56, 10
 s_add_u32 s92, s92, s56
 s_mov_b32 s56, 4718592
 s_mov_b32 s57, 21495808
 s_cmp_ge_u32 s13, 2
 s_cselect_b32 s56, s57, s56
 s_add_u32 s92, s92, s56
 s_mul_i32 s56, s34, 2048
 s_lshl_b32 s57, s13, 10
 s_add_u32 s56, s56, s57
 s_add_u32 s56, s56, 84541440
 s_lshl_b32 s57, s34, 10
 s_add_u32 s57, s57, 84934656
 s_cmp_ge_u32 s13, 2
 s_cselect_b32 s94, s57, s56
 s_mov_b32 s90, 82837504
 s_mov_b32 s91, 82837504
 v_mov_b32 v252, 0
 v_mov_b32 v253, 0
 v_mov_b32 v254, 0
 v_lshrrev_b32 v18, 2, v2
 v_lshlrev_b32 v18, 13, v18
 v_and_b32 v19, 3, v2
 v_lshl_add_u32 v24, v19, 4, v18
 v_lshrrev_b32 v18, 3, v2
 v_lshlrev_b32 v18, 11, v18
 v_and_b32 v19, 7, v2
 v_lshl_add_u32 v25, v19, 4, v18
 s_lshl_b32 s68, s13, 15
 s_add_u32 s68, s68, 24576
 s_lshl_b32 s69, s13, 21
 s_lshl_b32 s56, s34, 6
 s_add_u32 s69, s69, s56
 s_lshl_b32 s70, s35, 2
 s_add_u32 s70, s70, s13
 s_lshl_b32 s70, s70, 18
 s_lshl_b32 s56, s36, 7
 s_add_u32 s70, s70, s56
 v_lshrrev_b32 v21, 2, v16
 v_and_b32 v19, 1, v21
 v_lshrrev_b32 v18, 1, v21
 v_lshl_add_u32 v20, v18, 3, v19
 v_lshrrev_b32 v27, 1, v17
 v_lshl_add_u32 v20, v27, 4, v20
 v_and_b32 v29, 1, v17
 v_lshl_add_u32 v20, v29, 2, v20
 v_lshlrev_b32 v20, 6, v20
 v_and_b32 v26, 3, v16
 v_lshlrev_b32 v26, 3, v26
 v_add_u32 v20, v20, v26
 v_mov_b32 v28, v26
 v_add_u32 v26, s68, v20

 v_lshl_add_u32 v20, v17, 2, v21
 v_lshlrev_b32 v20, 7, v20
 v_add_u32 v20, v20, v28
 v_add_u32 v28, s68, v20
 s_cmp_eq_u32 s38, 0
 s_cbranch_scc1 mk_cs1
 s_waitcnt vmcnt(0)
 s_barrier
 s_cmp_lg_u32 s13, 0
 s_cselect_b32 s38, 0, 1
 s_cbranch_scc1 mk_cs1
 s_mov_b64 exec, 1
 s_cmp_ge_u32 s2, 16
 s_cbranch_scc1 mk_cs_e
 v_mov_b32 v100, 164
 v_mov_b32 v101, 1
 buffer_atomic_add v101, v100, s[20:23], 0 offen sc0
 s_waitcnt vmcnt(0)
 v_readfirstlane_b32 s56, v101
 s_cmp_eq_u32 s56, 15
 s_cbranch_scc0 mk_cs_e
 v_mov_b32 v100, 68
 v_mov_b32 v101, 1
 buffer_store_dword v101, v100, s[20:23], 0 offen sc1
 s_nop 1
mk_cs_e:
 v_mov_b32 v100, 160
 v_mov_b32 v101, 1
 v_mov_b32 v102, 64
 v_mov_b32 v103, 1
 buffer_atomic_add v101, v100, s[20:23], 0 offen sc0
 s_mov_b64 exec, -1
mk_cs1:
 s_mov_b32 s24, s62
 s_and_b32 s25, s63, 0xffff
 s_mov_b32 s26, 0x800000
 s_mov_b32 s27, 0x00020000
 s_add_u32 m0, s68, 0
 s_add_u32 s56, s69, 0
 buffer_load_dwordx4 v24, s[24:27], s56 offen lds
 s_add_u32 m0, s68, 1024
 s_add_u32 s56, s69, 131072
 buffer_load_dwordx4 v24, s[24:27], s56 offen lds
 s_add_u32 m0, s68, 2048
 s_add_u32 s56, s69, 262144
 buffer_load_dwordx4 v24, s[24:27], s56 offen lds
 s_add_u32 m0, s68, 3072
 s_add_u32 s56, s69, 393216
 buffer_load_dwordx4 v24, s[24:27], s56 offen lds
 s_add_u32 m0, s68, 4096
 s_add_u32 s56, s69, 524288
 buffer_load_dwordx4 v24, s[24:27], s56 offen lds
 s_add_u32 m0, s68, 5120
 s_add_u32 s56, s69, 655360
 buffer_load_dwordx4 v24, s[24:27], s56 offen lds
 s_add_u32 m0, s68, 6144
 s_add_u32 s56, s69, 786432
 buffer_load_dwordx4 v24, s[24:27], s56 offen lds
 s_add_u32 m0, s68, 7168
 s_add_u32 s56, s69, 917504
 buffer_load_dwordx4 v24, s[24:27], s56 offen lds
 s_add_u32 m0, s68, 8192
 s_add_u32 s56, s69, 1048576
 buffer_load_dwordx4 v24, s[24:27], s56 offen lds
 s_add_u32 m0, s68, 9216
 s_add_u32 s56, s69, 1179648
 buffer_load_dwordx4 v24, s[24:27], s56 offen lds
 s_add_u32 m0, s68, 10240
 s_add_u32 s56, s69, 1310720
 buffer_load_dwordx4 v24, s[24:27], s56 offen lds
 s_add_u32 m0, s68, 11264
 s_add_u32 s56, s69, 1441792
 buffer_load_dwordx4 v24, s[24:27], s56 offen lds
 s_add_u32 m0, s68, 12288
 s_add_u32 s56, s69, 1572864
 buffer_load_dwordx4 v24, s[24:27], s56 offen lds
 s_add_u32 m0, s68, 13312
 s_add_u32 s56, s69, 1703936
 buffer_load_dwordx4 v24, s[24:27], s56 offen lds
 s_add_u32 m0, s68, 14336
 s_add_u32 s56, s69, 1835008
 buffer_load_dwordx4 v24, s[24:27], s56 offen lds
 s_add_u32 m0, s68, 15360
 s_add_u32 s56, s69, 1966080
 buffer_load_dwordx4 v24, s[24:27], s56 offen lds
 s_mov_b32 s24, s64
 s_and_b32 s25, s65, 0xffff
 s_mov_b32 s26, 0x800000
 s_mov_b32 s27, 0x00020000
 s_add_u32 m0, s68, 16384
 s_add_u32 s56, s69, 0
 buffer_load_dwordx4 v24, s[24:27], s56 offen lds
 s_add_u32 m0, s68, 17408
 s_add_u32 s56, s69, 131072
 buffer_load_dwordx4 v24, s[24:27], s56 offen lds
 s_add_u32 m0, s68, 18432
 s_add_u32 s56, s69, 262144
 buffer_load_dwordx4 v24, s[24:27], s56 offen lds
 s_add_u32 m0, s68, 19456
 s_add_u32 s56, s69, 393216
 buffer_load_dwordx4 v24, s[24:27], s56 offen lds
 s_add_u32 m0, s68, 20480
 s_add_u32 s56, s69, 524288
 buffer_load_dwordx4 v24, s[24:27], s56 offen lds
 s_add_u32 m0, s68, 21504
 s_add_u32 s56, s69, 655360
 buffer_load_dwordx4 v24, s[24:27], s56 offen lds
 s_add_u32 m0, s68, 22528
 s_add_u32 s56, s69, 786432
 buffer_load_dwordx4 v24, s[24:27], s56 offen lds
 s_add_u32 m0, s68, 23552
 s_add_u32 s56, s69, 917504
 buffer_load_dwordx4 v24, s[24:27], s56 offen lds
 s_add_u32 m0, s68, 24576
 s_add_u32 s56, s69, 1048576
 buffer_load_dwordx4 v24, s[24:27], s56 offen lds
 s_add_u32 m0, s68, 25600
 s_add_u32 s56, s69, 1179648
 buffer_load_dwordx4 v24, s[24:27], s56 offen lds
 s_add_u32 m0, s68, 26624
 s_add_u32 s56, s69, 1310720
 buffer_load_dwordx4 v24, s[24:27], s56 offen lds
 s_add_u32 m0, s68, 27648
 s_add_u32 s56, s69, 1441792
 buffer_load_dwordx4 v24, s[24:27], s56 offen lds
 s_add_u32 m0, s68, 28672
 s_add_u32 s56, s69, 1572864
 buffer_load_dwordx4 v24, s[24:27], s56 offen lds
 s_add_u32 m0, s68, 29696
 s_add_u32 s56, s69, 1703936
 buffer_load_dwordx4 v24, s[24:27], s56 offen lds
 s_add_u32 m0, s68, 30720
 s_add_u32 s56, s69, 1835008
 buffer_load_dwordx4 v24, s[24:27], s56 offen lds
 s_add_u32 m0, s68, 31744
 s_add_u32 s56, s69, 1966080
 buffer_load_dwordx4 v24, s[24:27], s56 offen lds
 s_cmp_eq_u32 s38, 0
 s_cbranch_scc1 mk_cs2
 s_waitcnt vmcnt(32)
 v_readfirstlane_b32 s56, v101
 s_cmp_eq_u32 s56, 255
 s_cbranch_scc0 mk_cs2
 s_mov_b64 exec, 1
 buffer_store_dword v103, v102, s[20:23], 0 offen sc1
 s_mov_b64 exec, 15
 v_lshlrev_b32 v100, 2, v2
 s_mov_b32 s56, 0xfc000000
 v_writelane_b32 v101, s56, 0
 s_mov_b32 s56, 0xfff
 v_writelane_b32 v101, s56, 1
 s_mov_b32 s56, 0x0
 v_writelane_b32 v101, s56, 2
 s_mov_b32 s56, 0x1b0000
 v_writelane_b32 v101, s56, 3
 s_mov_b32 s56, 81829888
 buffer_atomic_or v101, v100, s[16:19], s56 offen
 s_mov_b64 exec, -1
 s_waitcnt vmcnt(0)
mk_cs2:
 s_waitcnt vmcnt(16)
 ds_read_b64_tr_b16 a[64:65], v26 offset:0
 ds_read_b64_tr_b16 a[66:67], v26 offset:128
 ds_read_b64_tr_b16 a[68:69], v26 offset:2048
 ds_read_b64_tr_b16 a[70:71], v26 offset:2176
 ds_read_b64_tr_b16 a[72:73], v26 offset:4096
 ds_read_b64_tr_b16 a[74:75], v26 offset:4224
 ds_read_b64_tr_b16 a[76:77], v26 offset:6144
 ds_read_b64_tr_b16 a[78:79], v26 offset:6272
 s_waitcnt lgkmcnt(0)
 ds_read_b64_tr_b16 a[80:81], v26 offset:8192
 ds_read_b64_tr_b16 a[82:83], v26 offset:8320
 ds_read_b64_tr_b16 a[84:85], v26 offset:10240
 ds_read_b64_tr_b16 a[86:87], v26 offset:10368
 ds_read_b64_tr_b16 a[88:89], v26 offset:12288
 ds_read_b64_tr_b16 a[90:91], v26 offset:12416
 ds_read_b64_tr_b16 a[92:93], v26 offset:14336
 ds_read_b64_tr_b16 a[94:95], v26 offset:14464
 s_waitcnt lgkmcnt(0)
 ds_read_b64_tr_b16 a[96:97], v26 offset:32
 ds_read_b64_tr_b16 a[98:99], v26 offset:160
 ds_read_b64_tr_b16 a[100:101], v26 offset:2080
 ds_read_b64_tr_b16 a[102:103], v26 offset:2208
 ds_read_b64_tr_b16 a[104:105], v26 offset:4128
 ds_read_b64_tr_b16 a[106:107], v26 offset:4256
 ds_read_b64_tr_b16 a[108:109], v26 offset:6176
 ds_read_b64_tr_b16 a[110:111], v26 offset:6304
 s_waitcnt lgkmcnt(0)
 ds_read_b64_tr_b16 a[112:113], v26 offset:8224
 ds_read_b64_tr_b16 a[114:115], v26 offset:8352
 ds_read_b64_tr_b16 a[116:117], v26 offset:10272
 ds_read_b64_tr_b16 a[118:119], v26 offset:10400
 ds_read_b64_tr_b16 a[120:121], v26 offset:12320
 ds_read_b64_tr_b16 a[122:123], v26 offset:12448
 ds_read_b64_tr_b16 a[124:125], v26 offset:14368
 ds_read_b64_tr_b16 a[126:127], v26 offset:14496
 s_waitcnt lgkmcnt(0)
 s_mov_b32 s24, s60
 s_and_b32 s25, s61, 0xffff
 s_mov_b32 s26, 0x800000
 s_mov_b32 s27, 0x00020000
 s_add_u32 m0, s68, 0
 s_add_u32 s56, s69, 0
 buffer_load_dwordx4 v24, s[24:27], s56 offen lds
 s_add_u32 m0, s68, 1024
 s_add_u32 s56, s69, 131072
 buffer_load_dwordx4 v24, s[24:27], s56 offen lds
 s_add_u32 m0, s68, 2048
 s_add_u32 s56, s69, 262144
 buffer_load_dwordx4 v24, s[24:27], s56 offen lds
 s_add_u32 m0, s68, 3072
 s_add_u32 s56, s69, 393216
 buffer_load_dwordx4 v24, s[24:27], s56 offen lds
 s_add_u32 m0, s68, 4096
 s_add_u32 s56, s69, 524288
 buffer_load_dwordx4 v24, s[24:27], s56 offen lds
 s_add_u32 m0, s68, 5120
 s_add_u32 s56, s69, 655360
 buffer_load_dwordx4 v24, s[24:27], s56 offen lds
 s_add_u32 m0, s68, 6144
 s_add_u32 s56, s69, 786432
 buffer_load_dwordx4 v24, s[24:27], s56 offen lds
 s_add_u32 m0, s68, 7168
 s_add_u32 s56, s69, 917504
 buffer_load_dwordx4 v24, s[24:27], s56 offen lds
 s_add_u32 m0, s68, 8192
 s_add_u32 s56, s69, 1048576
 buffer_load_dwordx4 v24, s[24:27], s56 offen lds
 s_add_u32 m0, s68, 9216
 s_add_u32 s56, s69, 1179648
 buffer_load_dwordx4 v24, s[24:27], s56 offen lds
 s_add_u32 m0, s68, 10240
 s_add_u32 s56, s69, 1310720
 buffer_load_dwordx4 v24, s[24:27], s56 offen lds
 s_add_u32 m0, s68, 11264
 s_add_u32 s56, s69, 1441792
 buffer_load_dwordx4 v24, s[24:27], s56 offen lds
 s_add_u32 m0, s68, 12288
 s_add_u32 s56, s69, 1572864
 buffer_load_dwordx4 v24, s[24:27], s56 offen lds
 s_add_u32 m0, s68, 13312
 s_add_u32 s56, s69, 1703936
 buffer_load_dwordx4 v24, s[24:27], s56 offen lds
 s_add_u32 m0, s68, 14336
 s_add_u32 s56, s69, 1835008
 buffer_load_dwordx4 v24, s[24:27], s56 offen lds
 s_add_u32 m0, s68, 15360
 s_add_u32 s56, s69, 1966080
 buffer_load_dwordx4 v24, s[24:27], s56 offen lds
 s_waitcnt vmcnt(16)
 ds_read_b64_tr_b16 a[128:129], v26 offset:16384
 ds_read_b64_tr_b16 a[130:131], v26 offset:16512
 ds_read_b64_tr_b16 a[132:133], v26 offset:18432
 ds_read_b64_tr_b16 a[134:135], v26 offset:18560
 ds_read_b64_tr_b16 a[136:137], v26 offset:20480
 ds_read_b64_tr_b16 a[138:139], v26 offset:20608
 ds_read_b64_tr_b16 a[140:141], v26 offset:22528
 ds_read_b64_tr_b16 a[142:143], v26 offset:22656
 s_waitcnt lgkmcnt(0)
 ds_read_b64_tr_b16 a[144:145], v26 offset:24576
 ds_read_b64_tr_b16 a[146:147], v26 offset:24704
 ds_read_b64_tr_b16 a[148:149], v26 offset:26624
 ds_read_b64_tr_b16 a[150:151], v26 offset:26752
 ds_read_b64_tr_b16 a[152:153], v26 offset:28672
 ds_read_b64_tr_b16 a[154:155], v26 offset:28800
 ds_read_b64_tr_b16 a[156:157], v26 offset:30720
 ds_read_b64_tr_b16 a[158:159], v26 offset:30848
 s_waitcnt lgkmcnt(0)
 ds_read_b64_tr_b16 a[160:161], v26 offset:16416
 ds_read_b64_tr_b16 a[162:163], v26 offset:16544
 ds_read_b64_tr_b16 a[164:165], v26 offset:18464
 ds_read_b64_tr_b16 a[166:167], v26 offset:18592
 ds_read_b64_tr_b16 a[168:169], v26 offset:20512
 ds_read_b64_tr_b16 a[170:171], v26 offset:20640
 ds_read_b64_tr_b16 a[172:173], v26 offset:22560
 ds_read_b64_tr_b16 a[174:175], v26 offset:22688
 s_waitcnt lgkmcnt(0)
 ds_read_b64_tr_b16 a[176:177], v26 offset:24608
 ds_read_b64_tr_b16 a[178:179], v26 offset:24736
 ds_read_b64_tr_b16 a[180:181], v26 offset:26656
 ds_read_b64_tr_b16 a[182:183], v26 offset:26784
 ds_read_b64_tr_b16 a[184:185], v26 offset:28704
 ds_read_b64_tr_b16 a[186:187], v26 offset:28832
 ds_read_b64_tr_b16 a[188:189], v26 offset:30752
 ds_read_b64_tr_b16 a[190:191], v26 offset:30880
 s_waitcnt lgkmcnt(0)
 s_mov_b32 s24, s66
 s_and_b32 s25, s67, 0xffff
 s_mov_b32 s26, 0x800000
 s_mov_b32 s27, 0x00020000
 s_add_u32 m0, s68, 16384
 s_add_u32 s56, s70, 0
 buffer_load_dwordx4 v25, s[24:27], s56 offen lds
 s_add_u32 m0, s68, 17408
 s_add_u32 s56, s70, 16384
 buffer_load_dwordx4 v25, s[24:27], s56 offen lds
 s_add_u32 m0, s68, 18432
 s_add_u32 s56, s70, 32768
 buffer_load_dwordx4 v25, s[24:27], s56 offen lds
 s_add_u32 m0, s68, 19456
 s_add_u32 s56, s70, 49152
 buffer_load_dwordx4 v25, s[24:27], s56 offen lds
 s_add_u32 m0, s68, 20480
 s_add_u32 s56, s70, 65536
 buffer_load_dwordx4 v25, s[24:27], s56 offen lds
 s_add_u32 m0, s68, 21504
 s_add_u32 s56, s70, 81920
 buffer_load_dwordx4 v25, s[24:27], s56 offen lds
 s_add_u32 m0, s68, 22528
 s_add_u32 s56, s70, 98304
 buffer_load_dwordx4 v25, s[24:27], s56 offen lds
 s_add_u32 m0, s68, 23552
 s_add_u32 s56, s70, 114688
 buffer_load_dwordx4 v25, s[24:27], s56 offen lds
 s_add_u32 m0, s68, 24576
 s_add_u32 s56, s70, 131072
 buffer_load_dwordx4 v25, s[24:27], s56 offen lds
 s_add_u32 m0, s68, 25600
 s_add_u32 s56, s70, 147456
 buffer_load_dwordx4 v25, s[24:27], s56 offen lds
 s_add_u32 m0, s68, 26624
 s_add_u32 s56, s70, 163840
 buffer_load_dwordx4 v25, s[24:27], s56 offen lds
 s_add_u32 m0, s68, 27648
 s_add_u32 s56, s70, 180224
 buffer_load_dwordx4 v25, s[24:27], s56 offen lds
 s_add_u32 m0, s68, 28672
 s_add_u32 s56, s70, 196608
 buffer_load_dwordx4 v25, s[24:27], s56 offen lds
 s_add_u32 m0, s68, 29696
 s_add_u32 s56, s70, 212992
 buffer_load_dwordx4 v25, s[24:27], s56 offen lds
 s_add_u32 m0, s68, 30720
 s_add_u32 s56, s70, 229376
 buffer_load_dwordx4 v25, s[24:27], s56 offen lds
 s_add_u32 m0, s68, 31744
 s_add_u32 s56, s70, 245760
 buffer_load_dwordx4 v25, s[24:27], s56 offen lds
 s_waitcnt vmcnt(16)
 ds_read_b64_tr_b16 a[0:1], v26 offset:0
 ds_read_b64_tr_b16 a[2:3], v26 offset:128
 ds_read_b64_tr_b16 a[4:5], v26 offset:2048
 ds_read_b64_tr_b16 a[6:7], v26 offset:2176
 ds_read_b64_tr_b16 a[8:9], v26 offset:4096
 ds_read_b64_tr_b16 a[10:11], v26 offset:4224
 ds_read_b64_tr_b16 a[12:13], v26 offset:6144
 ds_read_b64_tr_b16 a[14:15], v26 offset:6272
 s_waitcnt lgkmcnt(0)
 ds_read_b64_tr_b16 a[16:17], v26 offset:8192
 ds_read_b64_tr_b16 a[18:19], v26 offset:8320
 ds_read_b64_tr_b16 a[20:21], v26 offset:10240
 ds_read_b64_tr_b16 a[22:23], v26 offset:10368
 ds_read_b64_tr_b16 a[24:25], v26 offset:12288
 ds_read_b64_tr_b16 a[26:27], v26 offset:12416
 ds_read_b64_tr_b16 a[28:29], v26 offset:14336
 ds_read_b64_tr_b16 a[30:31], v26 offset:14464
 s_waitcnt lgkmcnt(0)
 ds_read_b64_tr_b16 a[32:33], v26 offset:32
 ds_read_b64_tr_b16 a[34:35], v26 offset:160
 ds_read_b64_tr_b16 a[36:37], v26 offset:2080
 ds_read_b64_tr_b16 a[38:39], v26 offset:2208
 ds_read_b64_tr_b16 a[40:41], v26 offset:4128
 ds_read_b64_tr_b16 a[42:43], v26 offset:4256
 ds_read_b64_tr_b16 a[44:45], v26 offset:6176
 ds_read_b64_tr_b16 a[46:47], v26 offset:6304
 s_waitcnt lgkmcnt(0)
 ds_read_b64_tr_b16 a[48:49], v26 offset:8224
 ds_read_b64_tr_b16 a[50:51], v26 offset:8352
 ds_read_b64_tr_b16 a[52:53], v26 offset:10272
 ds_read_b64_tr_b16 a[54:55], v26 offset:10400
 ds_read_b64_tr_b16 a[56:57], v26 offset:12320
 ds_read_b64_tr_b16 a[58:59], v26 offset:12448
 ds_read_b64_tr_b16 a[60:61], v26 offset:14368
 ds_read_b64_tr_b16 a[62:63], v26 offset:14496
 s_waitcnt lgkmcnt(0)
 s_waitcnt vmcnt(0)
 ds_read_b64_tr_b16 a[192:193], v28 offset:16384
 ds_read_b64_tr_b16 a[194:195], v28 offset:18432
 ds_read_b64_tr_b16 a[196:197], v28 offset:20480
 ds_read_b64_tr_b16 a[198:199], v28 offset:22528
 ds_read_b64_tr_b16 a[200:201], v28 offset:24576
 ds_read_b64_tr_b16 a[202:203], v28 offset:26624
 ds_read_b64_tr_b16 a[204:205], v28 offset:28672
 ds_read_b64_tr_b16 a[206:207], v28 offset:30720
 s_waitcnt lgkmcnt(0)
 ds_read_b64_tr_b16 a[208:209], v28 offset:16416
 ds_read_b64_tr_b16 a[210:211], v28 offset:18464
 ds_read_b64_tr_b16 a[212:213], v28 offset:20512
 ds_read_b64_tr_b16 a[214:215], v28 offset:22560
 ds_read_b64_tr_b16 a[216:217], v28 offset:24608
 ds_read_b64_tr_b16 a[218:219], v28 offset:26656
 ds_read_b64_tr_b16 a[220:221], v28 offset:28704
 ds_read_b64_tr_b16 a[222:223], v28 offset:30752
 s_waitcnt lgkmcnt(0)
 ds_read_b64_tr_b16 a[224:225], v28 offset:16448
 ds_read_b64_tr_b16 a[226:227], v28 offset:18496
 ds_read_b64_tr_b16 a[228:229], v28 offset:20544
 ds_read_b64_tr_b16 a[230:231], v28 offset:22592
 ds_read_b64_tr_b16 a[232:233], v28 offset:24640
 ds_read_b64_tr_b16 a[234:235], v28 offset:26688
 ds_read_b64_tr_b16 a[236:237], v28 offset:28736
 ds_read_b64_tr_b16 a[238:239], v28 offset:30784
 s_waitcnt lgkmcnt(0)
 ds_read_b64_tr_b16 a[240:241], v28 offset:16480
 ds_read_b64_tr_b16 a[242:243], v28 offset:18528
 ds_read_b64_tr_b16 a[244:245], v28 offset:20576
 ds_read_b64_tr_b16 a[246:247], v28 offset:22624
 ds_read_b64_tr_b16 a[248:249], v28 offset:24672
 ds_read_b64_tr_b16 a[250:251], v28 offset:26720
 ds_read_b64_tr_b16 a[252:253], v28 offset:28768
 ds_read_b64_tr_b16 a[254:255], v28 offset:30816
 s_waitcnt lgkmcnt(0)
 v_mov_b32 v4, 0
 s_mov_b32 s89, 64
 s_mov_b32 s88, 81807616
 v_mov_b32 v16, 64
 s_mov_b32 s48, 1048576
mk_cw:
 buffer_load_dword v17, v16, s[20:23], 0 offen sc1
 s_sub_u32 s48, s48, 1
 s_cbranch_scc1 mk_end
 s_waitcnt vmcnt(0)
 v_readfirstlane_b32 s56, v17
 s_cmp_lg_u32 s56, 0
 s_cbranch_scc1 mk_cw_ok
 s_sleep 4
 s_branch mk_cw
mk_cw_ok:
 s_mov_b32 s48, 1048576
mk_kv0:
 buffer_load_dword v5, v4, s[16:19], s88 offen sc1
 s_sub_u32 s48, s48, 1
 s_cbranch_scc1 mk_bail
 s_waitcnt vmcnt(0)
 v_readfirstlane_b32 s56, v5
 s_cmp_ge_u32 s56, 64
 s_cbranch_scc1 mk_kv0_ok
 s_sleep 2
 s_branch mk_kv0
mk_kv0_ok:
 buffer_load_dwordx4 v[48:51], v6, s[16:19], s46 offen offset:0 sc1
 buffer_load_dwordx4 v[52:55], v6, s[16:19], s46 offen offset:1024 sc1
 buffer_load_dwordx4 v[56:59], v6, s[16:19], s46 offen offset:2048 sc1
 buffer_load_dwordx4 v[60:63], v6, s[16:19], s46 offen offset:3072 sc1
 buffer_load_dwordx4 v[64:67], v15, s[16:19], s46 offen offset:0 sc1
 buffer_load_dwordx4 v[68:71], v15, s[16:19], s46 offen offset:1024 sc1
 buffer_load_dwordx4 v[72:75], v15, s[16:19], s46 offen offset:2048 sc1
 buffer_load_dwordx4 v[76:79], v15, s[16:19], s46 offen offset:3072 sc1
 buffer_load_dwordx4 v[80:83], v6, s[16:19], s49 offen offset:0 sc1
 buffer_load_dwordx4 v[84:87], v6, s[16:19], s49 offen offset:1024 sc1
 buffer_load_dwordx4 v[88:91], v6, s[16:19], s49 offen offset:2048 sc1
 buffer_load_dwordx4 v[92:95], v6, s[16:19], s49 offen offset:3072 sc1
 buffer_load_dwordx4 v[96:99], v15, s[16:19], s49 offen offset:0 sc1
 buffer_load_dwordx4 v[100:103], v15, s[16:19], s49 offen offset:1024 sc1
 buffer_load_dwordx4 v[104:107], v15, s[16:19], s49 offen offset:2048 sc1
 buffer_load_dwordx4 v[108:111], v15, s[16:19], s49 offen offset:3072 sc1
 s_waitcnt vmcnt(0)
 v_mfma_f32_16x16x32_bf16 v[160:163], v[80:83], a[192:195], 0
 v_mfma_f32_16x16x32_bf16 v[164:167], v[80:83], a[208:211], 0
 v_mfma_f32_16x16x32_bf16 v[168:171], v[80:83], a[224:227], 0
 v_mfma_f32_16x16x32_bf16 v[172:175], v[80:83], a[240:243], 0
 v_mfma_f32_16x16x32_bf16 v[176:179], v[96:99], a[192:195], 0
 v_mfma_f32_16x16x32_bf16 v[180:183], v[96:99], a[208:211], 0
 v_mfma_f32_16x16x32_bf16 v[184:187], v[96:99], a[224:227], 0
 v_mfma_f32_16x16x32_bf16 v[188:191], v[96:99], a[240:243], 0
 MF v[160:163],v[84:87],a[196:199]
 MF v[164:167],v[84:87],a[212:215]
 MF v[168:171],v[84:87],a[228:231]
 MF v[172:175],v[84:87],a[244:247]
 MF v[176:179],v[100:103],a[196:199]
 MF v[180:183],v[100:103],a[212:215]
 MF v[184:187],v[100:103],a[228:231]
 MF v[188:191],v[100:103],a[244:247]
 MF v[160:163],v[88:91],a[200:203]
 MF v[164:167],v[88:91],a[216:219]
 MF v[168:171],v[88:91],a[232:235]
 MF v[172:175],v[88:91],a[248:251]
 MF v[176:179],v[104:107],a[200:203]
 MF v[180:183],v[104:107],a[216:219]
 MF v[184:187],v[104:107],a[232:235]
 MF v[188:191],v[104:107],a[248:251]
 MF v[160:163],v[92:95],a[204:207]
 MF v[164:167],v[92:95],a[220:223]
 MF v[168:171],v[92:95],a[236:239]
 MF v[172:175],v[92:95],a[252:255]
 MF v[176:179],v[108:111],a[204:207]
 MF v[180:183],v[108:111],a[220:223]
 MF v[184:187],v[108:111],a[236:239]
 MF v[188:191],v[108:111],a[252:255]
 s_nop 7
 CV 192,160,161
 CV 194,162,163
 CV 200,164,165
 CV 202,166,167
 CV 208,168,169
 CV 210,170,171
 CV 216,172,173
 CV 218,174,175
 CV 196,176,177
 CV 198,178,179
 CV 204,180,181
 CV 206,182,183
 CV 212,184,185
 CV 214,186,187
 CV 220,188,189
 CV 222,190,191
 s_add_u32 s49, s49, 262144
 v_mov_b32 v112, 0
 v_mov_b32 v113, 0
 v_mov_b32 v114, 0
 v_mov_b32 v115, 0
 v_mov_b32 v116, 0
 v_mov_b32 v117, 0
 v_mov_b32 v118, 0
 v_mov_b32 v119, 0
 v_mov_b32 v120, 0
 v_mov_b32 v121, 0
 v_mov_b32 v122, 0
 v_mov_b32 v123, 0
 v_mov_b32 v124, 0
 v_mov_b32 v125, 0
 v_mov_b32 v126, 0
 v_mov_b32 v127, 0
 v_mov_b32 v128, 0
 v_mov_b32 v129, 0
 v_mov_b32 v130, 0
 v_mov_b32 v131, 0
 v_mov_b32 v132, 0
 v_mov_b32 v133, 0
 v_mov_b32 v134, 0
 v_mov_b32 v135, 0
 s_mov_b32 s47, 0
 s_mov_b32 s39, 8
 v_add_u32 v20, 0, v9
 v_add_u32 v21, 3584, v9
 v_add_u32 v22, 7168, v9
 v_add_u32 v23, 10752, v9
 s_barrier
 buffer_load_dwordx4 v[24:27], v6, s[16:19], s40 offen offset:0 sc1
 buffer_load_dwordx4 v[28:31], v6, s[16:19], s40 offen offset:1024 sc1
 buffer_load_dwordx4 v[32:35], v6, s[16:19], s40 offen offset:2048 sc1
 buffer_load_dwordx4 v[36:39], v6, s[16:19], s40 offen offset:3072 sc1
 s_mov_b32 s48, 1048576
 s_branch mk_loop
mk_redo1:
 s_nop 15
 v_mov_b32 v112, 0
 v_mov_b32 v113, 0
 v_mov_b32 v114, 0
 v_mov_b32 v115, 0
 v_mov_b32 v116, 0
 v_mov_b32 v117, 0
 v_mov_b32 v118, 0
 v_mov_b32 v119, 0
 v_mov_b32 v120, 0
 v_mov_b32 v121, 0
 v_mov_b32 v122, 0
 v_mov_b32 v123, 0
 v_mov_b32 v124, 0
 v_mov_b32 v125, 0
 v_mov_b32 v126, 0
 v_mov_b32 v127, 0
 v_mov_b32 v128, 0
 v_mov_b32 v129, 0
 v_mov_b32 v130, 0
 v_mov_b32 v131, 0
 v_mov_b32 v132, 0
 v_mov_b32 v133, 0
 v_mov_b32 v134, 0
 v_mov_b32 v135, 0
mk_pc:
 buffer_load_dwordx4 v[24:27], v6, s[16:19], s40 offen offset:0 sc1
 buffer_load_dwordx4 v[28:31], v6, s[16:19], s40 offen offset:1024 sc1
 buffer_load_dwordx4 v[32:35], v6, s[16:19], s40 offen offset:2048 sc1
 buffer_load_dwordx4 v[36:39], v6, s[16:19], s40 offen offset:3072 sc1
 s_sub_u32 s48, s48, 1
 s_cbranch_scc1 mk_bail
 s_and_b32 s56, s48, 63
 s_cmp_eq_u32 s56, 0
 s_cbranch_scc0 mk_pc_h
 buffer_wbl2 sc1
mk_pc_h:
mk_loop:
 s_waitcnt vmcnt(0)
 v_max3_u32 v16, v27, v31, v35
 v_max_u32 v16, v16, v39
 v_cmp_eq_u32 vcc, -1, v16
 s_cbranch_vccnz mk_pc
 v_smfmac_f32_16x16x64_bf16 v[112:115], v[24:27], a[0:7], v3
 v_max3_u32 v16, v24, v25, v26
 v_smfmac_f32_16x16x64_bf16 v[112:115], v[28:31], a[8:15], v3
 v_max3_u32 v16, v16, v28, v29
 v_smfmac_f32_16x16x64_bf16 v[112:115], v[32:35], a[16:23], v3
 v_max3_u32 v16, v16, v30, v32
 v_smfmac_f32_16x16x64_bf16 v[112:115], v[36:39], a[24:31], v3
 v_max3_u32 v16, v16, v33, v34
 v_smfmac_f32_16x16x64_bf16 v[116:119], v[24:27], a[32:39], v3
 v_max3_u32 v16, v16, v36, v37
 v_smfmac_f32_16x16x64_bf16 v[116:119], v[28:31], a[40:47], v3
 v_max_u32 v16, v16, v38
 v_smfmac_f32_16x16x64_bf16 v[116:119], v[32:35], a[48:55], v3
 v_cmp_eq_u32 vcc, -1, v16
 v_smfmac_f32_16x16x64_bf16 v[116:119], v[36:39], a[56:63], v3
 s_cbranch_vccnz mk_redo1
 v_smfmac_f32_16x16x64_bf16 v[120:123], v[24:27], a[64:71], v3
 buffer_load_dwordx4 v[80:83], v6, s[16:19], s49 offen offset:0 sc1
 v_smfmac_f32_16x16x64_bf16 v[120:123], v[28:31], a[72:79], v3
 buffer_load_dwordx4 v[84:87], v6, s[16:19], s49 offen offset:1024 sc1
 v_smfmac_f32_16x16x64_bf16 v[120:123], v[32:35], a[80:87], v3
 buffer_load_dwordx4 v[88:91], v6, s[16:19], s49 offen offset:2048 sc1
 v_smfmac_f32_16x16x64_bf16 v[120:123], v[36:39], a[88:95], v3
 buffer_load_dwordx4 v[92:95], v6, s[16:19], s49 offen offset:3072 sc1
 v_smfmac_f32_16x16x64_bf16 v[124:127], v[24:27], a[96:103], v3
 buffer_load_dwordx4 v[96:99], v15, s[16:19], s49 offen offset:0 sc1
 v_smfmac_f32_16x16x64_bf16 v[124:127], v[28:31], a[104:111], v3
 buffer_load_dwordx4 v[100:103], v15, s[16:19], s49 offen offset:1024 sc1
 v_smfmac_f32_16x16x64_bf16 v[124:127], v[32:35], a[112:119], v3
 buffer_load_dwordx4 v[104:107], v15, s[16:19], s49 offen offset:2048 sc1
 v_smfmac_f32_16x16x64_bf16 v[124:127], v[36:39], a[120:127], v3
 buffer_load_dwordx4 v[108:111], v15, s[16:19], s49 offen offset:3072 sc1
 v_smfmac_f32_16x16x64_bf16 v[128:131], v[24:27], a[128:135], v3
 v_permlane32_swap_b32 v112, v116
 v_permlane32_swap_b32 v113, v117
 v_permlane32_swap_b32 v114, v118
 v_smfmac_f32_16x16x64_bf16 v[128:131], v[28:31], a[136:143], v3
 v_permlane32_swap_b32 v115, v119
 v_pk_add_f32 v[112:113], v[112:113], v[116:117]
 v_pk_add_f32 v[114:115], v[114:115], v[118:119]
 v_smfmac_f32_16x16x64_bf16 v[128:131], v[32:35], a[144:151], v3
 ds_write_b32 v7, v112 offset:0
 ds_write_b32 v7, v113 offset:32
 ds_write_b32 v7, v114 offset:64
 v_smfmac_f32_16x16x64_bf16 v[128:131], v[36:39], a[152:159], v3
 ds_write_b32 v7, v115 offset:96
 v_smfmac_f32_16x16x64_bf16 v[132:135], v[24:27], a[160:167], v3
 v_permlane32_swap_b32 v120, v124
 v_permlane32_swap_b32 v121, v125
 v_permlane32_swap_b32 v122, v126
 v_smfmac_f32_16x16x64_bf16 v[132:135], v[28:31], a[168:175], v3
 v_permlane32_swap_b32 v123, v127
 v_pk_add_f32 v[120:121], v[120:121], v[124:125]
 v_pk_add_f32 v[122:123], v[122:123], v[126:127]
 v_smfmac_f32_16x16x64_bf16 v[132:135], v[32:35], a[176:183], v3
 ds_write_b32 v7, v120 offset:1152
 ds_write_b32 v7, v121 offset:1184
 ds_write_b32 v7, v122 offset:1216
 v_smfmac_f32_16x16x64_bf16 v[132:135], v[36:39], a[184:191], v3
 ds_write_b32 v7, v123 offset:1248
 s_nop 6
 v_permlane32_swap_b32 v128, v132
 v_permlane32_swap_b32 v129, v133
 v_permlane32_swap_b32 v130, v134
 v_permlane32_swap_b32 v131, v135
 v_pk_add_f32 v[128:129], v[128:129], v[132:133]
 v_pk_add_f32 v[130:131], v[130:131], v[134:135]
 ds_write_b32 v8, v128 offset:0
 ds_write_b32 v8, v129 offset:32
 ds_write_b32 v8, v130 offset:64
 ds_write_b32 v8, v131 offset:96
 v_mov_b32 v224, 0
 v_mov_b32 v225, 0
 v_mov_b32 v226, 0
 v_mov_b32 v227, 0
 v_mov_b32 v228, 0
 v_mov_b32 v229, 0
 v_mov_b32 v230, 0
 v_mov_b32 v231, 0
 s_waitcnt lgkmcnt(0)
 s_barrier
 s_cmp_eq_u32 s13, 3
 s_cbranch_scc0 mk_s1a
 ds_read2_b64 v[160:163], v20 offset0:0 offset1:36
 ds_read2_b64 v[164:167], v21 offset0:0 offset1:36
 ds_read2_b64 v[168:171], v22 offset0:0 offset1:36
 ds_read2_b64 v[172:175], v23 offset0:0 offset1:36
 s_branch mk_s1b
mk_s1a:
 RB 160,163,9,0
 RB 164,167,9,3584
 RB 168,171,9,7168
 RB 172,175,9,10752
mk_s1b:
 v_mov_b32 v232, 0
 v_mov_b32 v233, 0
 v_mov_b32 v234, 0
 v_mov_b32 v235, 0
 v_mov_b32 v236, 0
 v_mov_b32 v237, 0
 v_mov_b32 v238, 0
 v_mov_b32 v239, 0
 v_mov_b32 v240, 0
 v_mov_b32 v241, 0
 v_mov_b32 v242, 0
 v_mov_b32 v243, 0
 s_waitcnt lgkmcnt(2)
 v_pk_add_f32 v[160:161], v[160:161], v[164:165]
 v_pk_add_f32 v[162:163], v[162:163], v[166:167]
 s_waitcnt lgkmcnt(0)
 v_pk_add_f32 v[168:169], v[168:169], v[172:173]
 v_pk_add_f32 v[170:171], v[170:171], v[174:175]
 v_pk_add_f32 v[160:161], v[160:161], v[168:169]
 v_pk_add_f32 v[162:163], v[162:163], v[170:171]
 CV 252,160,161
 CV 253,162,163
 v_min_u32 v252, -2, v252
 v_min_u32 v253, -2, v253
 buffer_store_dwordx2 v[252:253], v10, s[16:19], s41 offen
 s_mov_b32 s90, s41
 s_cmp_eq_u32 s47, 63
 s_cbranch_scc1 mk_fin
 buffer_load_dwordx4 v[24:27], v6, s[16:19], s42 offen offset:0 sc1
 buffer_load_dwordx4 v[28:31], v6, s[16:19], s42 offen offset:1024 sc1
 buffer_load_dwordx4 v[32:35], v6, s[16:19], s42 offen offset:2048 sc1
 buffer_load_dwordx4 v[36:39], v6, s[16:19], s42 offen offset:3072 sc1
 buffer_load_dwordx4 v[40:43], v15, s[16:19], s42 offen offset:0 sc1
 buffer_load_dwordx4 v[44:47], v15, s[16:19], s42 offen offset:1024 sc1
 s_mov_b32 s48, 1048576
 v_mov_b32 v112, 0
 v_mov_b32 v113, 0
 v_mov_b32 v114, 0
 v_mov_b32 v115, 0
 v_mov_b32 v116, 0
 v_mov_b32 v117, 0
 v_mov_b32 v118, 0
 v_mov_b32 v119, 0
 v_mov_b32 v120, 0
 v_mov_b32 v121, 0
 v_mov_b32 v122, 0
 v_mov_b32 v123, 0
 v_mov_b32 v124, 0
 v_mov_b32 v125, 0
 v_mov_b32 v126, 0
 v_mov_b32 v127, 0
 s_branch mk_pa1
mk_pa:
 buffer_load_dwordx4 v[24:27], v6, s[16:19], s42 offen offset:0 sc1
 buffer_load_dwordx4 v[28:31], v6, s[16:19], s42 offen offset:1024 sc1
 buffer_load_dwordx4 v[32:35], v6, s[16:19], s42 offen offset:2048 sc1
 buffer_load_dwordx4 v[36:39], v6, s[16:19], s42 offen offset:3072 sc1
 buffer_load_dwordx4 v[40:43], v15, s[16:19], s42 offen offset:0 sc1
 buffer_load_dwordx4 v[44:47], v15, s[16:19], s42 offen offset:1024 sc1
 s_sub_u32 s48, s48, 1
 s_cbranch_scc1 mk_bail
 s_and_b32 s56, s48, 63
 s_cmp_eq_u32 s56, 0
 s_cbranch_scc0 mk_pa_h
 buffer_wbl2 sc1
mk_pa_h:
mk_pa1:
 s_waitcnt vmcnt(0)
 v_max3_u32 v16, v27, v31, v35
 v_max3_u32 v16, v16, v39, v43
 v_max_u32 v16, v16, v47
 v_cmp_eq_u32 vcc, -1, v16
 s_cbranch_vccnz mk_pa
 v_mfma_f32_16x16x32_bf16 v[136:139], v[48:51], v[24:27], 0
 v_max3_u32 v16, v24, v25, v26
 v_mfma_f32_16x16x32_bf16 v[140:143], v[64:67], v[24:27], 0
 v_max3_u32 v16, v16, v28, v29
 v_mfma_f32_16x16x32_bf16 v[144:147], v[24:27], v[24:27], 0
 v_max3_u32 v16, v16, v30, v32
 MF v[136:139],v[52:55],v[28:31]
 v_max3_u32 v16, v16, v33, v34
 MF v[140:143],v[68:71],v[28:31]
 v_max3_u32 v16, v16, v36, v37
 MF v[144:147],v[28:31],v[28:31]
 v_max3_u32 v16, v16, v38, v40
 MF v[136:139],v[56:59],v[32:35]
 v_max3_u32 v16, v16, v41, v42
 MF v[140:143],v[72:75],v[32:35]
 v_max3_u32 v16, v16, v44, v45
 MF v[144:147],v[32:35],v[32:35]
 v_max_u32 v16, v16, v46
 MF v[136:139],v[60:63],v[36:39]
 v_cmp_eq_u32 vcc, -1, v16
 MF v[140:143],v[76:79],v[36:39]
 s_cbranch_vccnz mk_pa
 MF v[144:147],v[36:39],v[36:39]
 v_smfmac_f32_16x16x64_bf16 v[112:115], v[40:43], a[192:199], v3
 s_nop 6
 v_max3_f32 v16, v136, v137, v138
 v_max3_f32 v16, v16, v139, v140
 v_max3_f32 v16, v16, v141, v142
 v_max_f32 v16, v16, v143
 v_smfmac_f32_16x16x64_bf16 v[112:115], v[44:47], a[200:207], v3
 s_mov_b64 exec, s[50:51]
 v_max3_f32 v16, v16, v144, v145
 v_max3_f32 v16, v16, v146, v147
 s_mov_b64 exec, -1
 v_mov_b32 v18, v16
 v_smfmac_f32_16x16x64_bf16 v[116:119], v[40:43], a[208:215], v3
 s_nop 0
 v_permlane32_swap_b32 v16, v18
 v_max_f32 v16, v16, v18
 v_mov_b32 v18, v16
 v_smfmac_f32_16x16x64_bf16 v[116:119], v[44:47], a[216:223], v3
 s_nop 0
 v_permlane16_swap_b32 v16, v18
 v_max_f32 v16, v16, v18
 v_pk_add_f32 v[144:145], v[144:145], v[16:17] op_sel_hi:[1,0] neg_lo:[0,1] neg_hi:[0,1]
 v_pk_add_f32 v[146:147], v[146:147], v[16:17] op_sel_hi:[1,0] neg_lo:[0,1] neg_hi:[0,1]
 v_pk_add_f32 v[136:137], v[136:137], v[16:17] op_sel_hi:[1,0] neg_lo:[0,1] neg_hi:[0,1]
 v_pk_add_f32 v[138:139], v[138:139], v[16:17] op_sel_hi:[1,0] neg_lo:[0,1] neg_hi:[0,1]
 v_pk_add_f32 v[140:141], v[140:141], v[16:17] op_sel_hi:[1,0] neg_lo:[0,1] neg_hi:[0,1]
 v_smfmac_f32_16x16x64_bf16 v[120:123], v[40:43], a[224:231], v3
 v_pk_add_f32 v[142:143], v[142:143], v[16:17] op_sel_hi:[1,0] neg_lo:[0,1] neg_hi:[0,1]
 v_pk_mul_f32 v[144:145], v[144:145], s[54:55]
 v_pk_mul_f32 v[146:147], v[146:147], s[54:55]
 v_pk_mul_f32 v[136:137], v[136:137], s[54:55]
 v_pk_mul_f32 v[138:139], v[138:139], s[54:55]
 v_smfmac_f32_16x16x64_bf16 v[120:123], v[44:47], a[232:239], v3
 v_pk_mul_f32 v[140:141], v[140:141], s[54:55]
 v_pk_mul_f32 v[142:143], v[142:143], s[54:55]
 v_exp_f32 v144, v144
 v_exp_f32 v145, v145
 v_exp_f32 v146, v146
 v_smfmac_f32_16x16x64_bf16 v[124:127], v[40:43], a[240:247], v3
 v_exp_f32 v147, v147
 v_exp_f32 v136, v136
 v_exp_f32 v137, v137
 v_exp_f32 v138, v138
 v_exp_f32 v139, v139
 v_smfmac_f32_16x16x64_bf16 v[124:127], v[44:47], a[248:255], v3
 v_exp_f32 v140, v140
 v_exp_f32 v141, v141
 v_exp_f32 v142, v142
 v_exp_f32 v143, v143
 CV 152,144,145
 CV 153,146,147
 s_mov_b64 exec, s[52:53]
 v_mov_b32 v152, 0
 v_mov_b32 v153, 0
 s_mov_b64 exec, -1
 v_mov_b32 v154, v152
 v_mov_b32 v155, v153
 CV 148,136,137
 CV 149,138,139
 CV 150,140,141
 CV 151,142,143
 v_permlane16_swap_b32 v152, v154
 v_permlane16_swap_b32 v153, v155
 CV 197,112,113
 CV 199,114,115
 CV 205,116,117
 CV 207,118,119
 v_mov_b32_dpp v148, v152 row_shr:8 row_mask:0xf bank_mask:0xc
 v_mov_b32_dpp v149, v153 row_shr:8 row_mask:0xf bank_mask:0xc
 v_mov_b32_dpp v150, v154 row_shr:8 row_mask:0xf bank_mask:0xc
 v_mov_b32_dpp v151, v155 row_shr:8 row_mask:0xf bank_mask:0xc
 CV 213,120,121
 CV 215,122,123
 v_smfmac_f32_16x16x64_bf16 v[240:243], v[148:151], v[244:251], v3
 CV 221,124,125
 CV 223,126,127
 v_smfmac_f32_16x16x64_bf16 v[224:227], v[148:151], v[192:199], v3
 v_smfmac_f32_16x16x64_bf16 v[228:231], v[148:151], v[200:207], v3
 v_smfmac_f32_16x16x64_bf16 v[232:235], v[148:151], v[208:215], v3
 v_smfmac_f32_16x16x64_bf16 v[236:239], v[148:151], v[216:223], v3
 s_nop 1
 v_mov_b32 v136, v240
 v_mov_b32 v137, v241
 v_mov_b32 v138, v242
 v_mov_b32 v139, v243
 v_permlane32_swap_b32 v224, v228
 v_permlane32_swap_b32 v240, v136
 v_permlane32_swap_b32 v241, v137
 v_permlane32_swap_b32 v242, v138
 v_permlane32_swap_b32 v243, v139
 v_pk_add_f32 v[240:241], v[240:241], v[136:137]
 v_pk_add_f32 v[242:243], v[242:243], v[138:139]
 v_rcp_f32 v240, v240
 v_rcp_f32 v241, v241
 v_rcp_f32 v242, v242
 v_rcp_f32 v243, v243
 v_permlane32_swap_b32 v225, v229
 v_permlane32_swap_b32 v226, v230
 v_permlane32_swap_b32 v227, v231
 v_pk_add_f32 v[224:225], v[224:225], v[228:229]
 v_pk_add_f32 v[226:227], v[226:227], v[230:231]
 v_pk_mul_f32 v[224:225], v[224:225], v[240:241]
 v_pk_mul_f32 v[226:227], v[226:227], v[242:243]
 ds_write_b32 v11, v224 offset:0
 ds_write_b32 v11, v225 offset:32
 ds_write_b32 v11, v226 offset:64
 ds_write_b32 v11, v227 offset:96
 v_permlane32_swap_b32 v232, v236
 v_permlane32_swap_b32 v233, v237
 v_permlane32_swap_b32 v234, v238
 v_permlane32_swap_b32 v235, v239
 v_pk_add_f32 v[232:233], v[232:233], v[236:237]
 v_pk_add_f32 v[234:235], v[234:235], v[238:239]
 v_pk_mul_f32 v[232:233], v[232:233], v[240:241]
 v_pk_mul_f32 v[234:235], v[234:235], v[242:243]
 ds_write_b32 v11, v232 offset:1280
 ds_write_b32 v11, v233 offset:1312
 ds_write_b32 v11, v234 offset:1344
 ds_write_b32 v11, v235 offset:1376
 s_add_u32 s46, s46, 262144
 s_add_u32 s49, s49, 262144
 s_waitcnt lgkmcnt(0)
 s_barrier
 ds_read_b64 v[136:137], v12 offset:0
 ds_read_b64 v[138:139], v12 offset:2560
 ds_read_b64 v[140:141], v12 offset:5120
 ds_read_b64 v[142:143], v12 offset:7680
 s_mov_b32 s96, 0x11111111
 s_mov_b32 s97, 0x11111111
 s_waitcnt lgkmcnt(2)
 v_pk_add_f32 v[136:137], v[136:137], v[138:139]
 s_waitcnt lgkmcnt(0)
 v_pk_add_f32 v[140:141], v[140:141], v[142:143]
 v_pk_add_f32 v[136:137], v[136:137], v[140:141]
 CV 144,136,137
 v_min_u32 v144, -2, v144
 s_nop 1
 v_mov_b32_dpp v145, v144 quad_perm:[1,1,1,1] row_mask:0xf bank_mask:0xf
 v_mov_b32_dpp v146, v144 quad_perm:[2,2,2,2] row_mask:0xf bank_mask:0xf
 v_mov_b32_dpp v147, v144 quad_perm:[3,3,3,3] row_mask:0xf bank_mask:0xf
 s_mov_b64 exec, s[96:97]
 buffer_store_dwordx4 v[144:147], v13, s[16:19], s43 offen sc1
 s_mov_b64 exec, -1
 v_readfirstlane_b32 s56, v5
 s_cmp_ge_u32 s56, s89
 s_cbranch_scc1 mk_kvn_ok
 s_mov_b32 s48, 1048576
mk_kvn:
 buffer_load_dword v5, v4, s[16:19], s88 offen sc1
 s_sub_u32 s48, s48, 1
 s_cbranch_scc1 mk_bail
 s_waitcnt vmcnt(0)
 v_readfirstlane_b32 s56, v5
 s_cmp_ge_u32 s56, s89
 s_cbranch_scc1 mk_kvn_ok
 s_sleep 2
 s_branch mk_kvn
mk_kvn_ok:
 s_add_u32 s56, s47, 3
 s_min_u32 s56, s56, 63
 s_lshr_b32 s57, s56, 3
 s_add_u32 s57, s57, 1
 s_lshr_b32 s56, s56, 2
 s_add_u32 s58, s56, 146
 s_cmp_lt_u32 s56, 4
 s_cselect_b32 s89, 64, 32
 s_cselect_b32 s56, s58, s57
 s_lshl_b32 s56, s56, 7
 s_add_u32 s88, s56, 81788928
 s_bitcmp1_b32 s13, 0
 s_cbranch_scc0 mk_nowt
 v_mov_b32 v156, v252
 v_mov_b32 v157, v253
 v_mov_b32_dpp v158, v252 quad_perm:[1,1,3,3] row_mask:0xf bank_mask:0xf
 v_mov_b32_dpp v159, v253 quad_perm:[1,1,3,3] row_mask:0xf bank_mask:0xf
 s_mov_b32 exec_lo, 0x55555555
 s_mov_b32 exec_hi, 0x55555555
 buffer_store_dwordx4 v[156:159], v10, s[16:19], s90 offen sc1
 s_mov_b64 exec, -1
mk_nowt:
 v_mfma_f32_16x16x32_bf16 v[160:163], v[80:83], a[192:195], 0
 buffer_load_dwordx4 v[48:51], v6, s[16:19], s46 offen offset:0 sc1
 v_mfma_f32_16x16x32_bf16 v[164:167], v[80:83], a[208:211], 0
 buffer_load_dwordx4 v[52:55], v6, s[16:19], s46 offen offset:1024 sc1
 v_mfma_f32_16x16x32_bf16 v[168:171], v[80:83], a[224:227], 0
 buffer_load_dwordx4 v[56:59], v6, s[16:19], s46 offen offset:2048 sc1
 v_mfma_f32_16x16x32_bf16 v[172:175], v[80:83], a[240:243], 0
 buffer_load_dwordx4 v[60:63], v6, s[16:19], s46 offen offset:3072 sc1
 v_mfma_f32_16x16x32_bf16 v[176:179], v[96:99], a[192:195], 0
 buffer_load_dwordx4 v[64:67], v15, s[16:19], s46 offen offset:0 sc1
 v_mfma_f32_16x16x32_bf16 v[180:183], v[96:99], a[208:211], 0
 buffer_load_dwordx4 v[68:71], v15, s[16:19], s46 offen offset:1024 sc1
 v_mfma_f32_16x16x32_bf16 v[184:187], v[96:99], a[224:227], 0
 buffer_load_dwordx4 v[72:75], v15, s[16:19], s46 offen offset:2048 sc1
 v_mfma_f32_16x16x32_bf16 v[188:191], v[96:99], a[240:243], 0
 buffer_load_dwordx4 v[76:79], v15, s[16:19], s46 offen offset:3072 sc1
 MF v[160:163],v[84:87],a[196:199]
 buffer_load_dwordx4 v[156:159], v6, s[16:19], s92 offen sc1
 MF v[164:167],v[84:87],a[212:215]
 buffer_load_dwordx4 v[156:159], v6, s[16:19], s94 offen sc1
 MF v[168:171],v[84:87],a[228:231]
 buffer_load_dword v5, v4, s[16:19], s88 offen sc1
 MF v[172:175],v[84:87],a[244:247]
 MF v[176:179],v[100:103],a[196:199]
 MF v[180:183],v[100:103],a[212:215]
 MF v[184:187],v[100:103],a[228:231]
 MF v[188:191],v[100:103],a[244:247]
 MF v[160:163],v[88:91],a[200:203]
 MF v[164:167],v[88:91],a[216:219]
 MF v[168:171],v[88:91],a[232:235]
 MF v[172:175],v[88:91],a[248:251]
 MF v[176:179],v[104:107],a[200:203]
 MF v[180:183],v[104:107],a[216:219]
 MF v[184:187],v[104:107],a[232:235]
 MF v[188:191],v[104:107],a[248:251]
 MF v[160:163],v[92:95],a[204:207]
 MF v[164:167],v[92:95],a[220:223]
 MF v[168:171],v[92:95],a[236:239]
 MF v[172:175],v[92:95],a[252:255]
 MF v[176:179],v[108:111],a[204:207]
 MF v[180:183],v[108:111],a[220:223]
 MF v[184:187],v[108:111],a[236:239]
 MF v[188:191],v[108:111],a[252:255]
 buffer_load_dword v136, v13, s[16:19], s44 offen offset:0 sc1
 buffer_load_dword v137, v13, s[16:19], s44 offen offset:1024 sc1
 buffer_load_dword v138, v13, s[16:19], s44 offen offset:2048 sc1
 buffer_load_dword v139, v13, s[16:19], s44 offen offset:3072 sc1
 buffer_load_dword v140, v13, s[16:19], s93 offen offset:0 sc1
 buffer_load_dword v141, v13, s[16:19], s93 offen offset:1024 sc1
 buffer_load_dword v142, v13, s[16:19], s93 offen offset:2048 sc1
 buffer_load_dword v143, v13, s[16:19], s93 offen offset:3072 sc1
 s_mov_b32 s48, 1048576
 v_mov_b32 v112, 0
 v_mov_b32 v113, 0
 v_mov_b32 v114, 0
 v_mov_b32 v115, 0
 v_mov_b32 v116, 0
 v_mov_b32 v117, 0
 v_mov_b32 v118, 0
 v_mov_b32 v119, 0
 v_mov_b32 v120, 0
 v_mov_b32 v121, 0
 v_mov_b32 v122, 0
 v_mov_b32 v123, 0
 v_mov_b32 v124, 0
 v_mov_b32 v125, 0
 v_mov_b32 v126, 0
 v_mov_b32 v127, 0
 v_mov_b32 v128, 0
 v_mov_b32 v129, 0
 v_mov_b32 v130, 0
 v_mov_b32 v131, 0
 v_mov_b32 v132, 0
 v_mov_b32 v133, 0
 v_mov_b32 v134, 0
 v_mov_b32 v135, 0
 s_add_u32 s40, s40, 524288
 s_add_u32 s41, s41, 524288
 s_add_u32 s42, s42, 524288
 s_add_u32 s43, s43, 524288
 s_add_u32 s94, s94, 524288
 s_add_u32 s92, s92, 262144
 s_add_u32 s47, s47, 1
 s_nop 3
 CV 192,160,161
 CV 194,162,163
 CV 200,164,165
 CV 202,166,167
 CV 208,168,169
 CV 210,170,171
 CV 216,172,173
 CV 218,174,175
 CV 196,176,177
 CV 198,178,179
 CV 204,180,181
 CV 206,182,183
 CV 212,184,185
 CV 214,186,187
 CV 220,188,189
 CV 222,190,191
 s_branch mk_pb1
mk_pb:
 buffer_load_dword v136, v13, s[16:19], s44 offen offset:0 sc1
 buffer_load_dword v137, v13, s[16:19], s44 offen offset:1024 sc1
 buffer_load_dword v138, v13, s[16:19], s44 offen offset:2048 sc1
 buffer_load_dword v139, v13, s[16:19], s44 offen offset:3072 sc1
 buffer_load_dword v140, v13, s[16:19], s93 offen offset:0 sc1
 buffer_load_dword v141, v13, s[16:19], s93 offen offset:1024 sc1
 buffer_load_dword v142, v13, s[16:19], s93 offen offset:2048 sc1
 buffer_load_dword v143, v13, s[16:19], s93 offen offset:3072 sc1
 s_sub_u32 s48, s48, 1
 s_cbranch_scc1 mk_bail
 s_and_b32 s56, s48, 63
 s_cmp_eq_u32 s56, 0
 s_cbranch_scc0 mk_pb_h
 buffer_wbl2 sc1
mk_pb_h:
mk_pb1:
 s_waitcnt vmcnt(0)
 v_max3_u32 v16, v136, v137, v138
 v_max3_u32 v16, v16, v139, v140
 v_max3_u32 v16, v16, v141, v142
 v_max_u32 v16, v16, v143
 v_cmp_eq_u32 vcc, -1, v16
 s_cbranch_vccnz mk_pb
 v_lshlrev_b32 v148, 16, v136
 v_and_b32 v149, s95, v136
 v_lshlrev_b32 v144, 16, v137
 v_and_b32 v145, s95, v137
 v_pk_add_f32 v[148:149], v[148:149], v[144:145]
 v_lshlrev_b32 v150, 16, v138
 v_and_b32 v151, s95, v138
 v_lshlrev_b32 v144, 16, v139
 v_and_b32 v145, s95, v139
 v_pk_add_f32 v[150:151], v[150:151], v[144:145]
 v_lshlrev_b32 v152, 16, v140
 v_and_b32 v153, s95, v140
 v_lshlrev_b32 v144, 16, v141
 v_and_b32 v145, s95, v141
 v_pk_add_f32 v[152:153], v[152:153], v[144:145]
 v_lshlrev_b32 v154, 16, v142
 v_and_b32 v155, s95, v142
 v_lshlrev_b32 v144, 16, v143
 v_and_b32 v145, s95, v143
 v_pk_add_f32 v[154:155], v[154:155], v[144:145]
 v_pk_add_f32 v[148:149], v[148:149], v[150:151]
 v_pk_add_f32 v[152:153], v[152:153], v[154:155]
 v_pk_add_f32 v[148:149], v[148:149], v[152:153]
 CV 254,148,149
 v_min_u32 v254, -2, v254
 buffer_store_dword v254, v13, s[16:19], s45 offen
 s_sleep 4
 buffer_load_dwordx4 v[24:27], v6, s[16:19], s40 offen offset:0 sc1
 buffer_load_dwordx4 v[28:31], v6, s[16:19], s40 offen offset:1024 sc1
 buffer_load_dwordx4 v[32:35], v6, s[16:19], s40 offen offset:2048 sc1
 buffer_load_dwordx4 v[36:39], v6, s[16:19], s40 offen offset:3072 sc1
 s_mov_b32 s91, s45
 s_add_u32 s44, s44, 524288
 s_add_u32 s93, s93, 524288
 s_add_u32 s45, s45, 524288
 s_mov_b32 s48, 1048576
 s_branch mk_loop
mk_bail:
 v_mov_b32 v16, 48
 v_mov_b32 v17, 1
 s_mov_b64 exec, 1
 buffer_atomic_add v17, v16, s[20:23], 0 offen
 s_mov_b64 exec, -1
 s_branch mk_end
mk_fin:
 buffer_store_dwordx2 v[252:253], v10, s[16:19], s90 offen sc1
 buffer_store_dword v254, v13, s[16:19], s91 offen sc1
 s_barrier
mk_fin2:
 s_mov_b64 exec, -1
 s_add_u32 s14, s34, 128
 s_mov_b32 s81, 0
 s_branch mk_wentry
mk_end:
 s_endpgm
.p2align 4
.type main_tasks,@object
main_tasks:
    .long 0x4103a09, 0x1012d10, 0x4103b19, 0x1012e10, 0x4103c29, 0x1012f10, 0x4103d39, 0x1013010
    .long 0x4103e49, 0x1013110, 0x4103f59, 0x1013210, 0x4104069, 0x1013910, 0x4104179, 0x1013a10
    .long 0x4104289, 0x1013b10, 0x8204399, 0x13c20, 0x82044a9, 0x13d20, 0x82045b9, 0x13e20
    .long 0x82046c9, 0x13f20, 0x82047d9, 0x15720, 0x82048e9, 0x11020, 0x82049f9, 0x11120
    .long 0x103058ea, 0x11240, 0x204059f3, 0x11380, 0x98668eb, 0x11420, 0x98e69fb, 0x11520
    .long 0xf8078ec, 0x11638, 0xf8079fc, 0x11738, 0x103088ed, 0x11840, 0x1c4089f5, 0x11970
    .long 0x98639ee, 0x0, 0x98c39fe, 0x0, 0x8209201, 0x0, 0x8229201, 0x0
    .long 0x8209311, 0x0, 0x8229311, 0x0, 0x8209421, 0x0, 0x8229421, 0x0
    .long 0x8209531, 0x0, 0x8229531, 0x0, 0x4100322, 0x12c20, 0x4110322, 0x12c20
    .long 0x4100432, 0x17220, 0x4110432, 0x17220, 0x4128a08, 0x30010, 0x4100542, 0x17520
    .long 0x4110542, 0x17520, 0x4128b18, 0x30210, 0x4100652, 0x17620, 0x4110652, 0x17620
    .long 0x4128c28, 0x30410, 0x3804a04, 0x13308, 0x3804b14, 0x13408, 0x3804c24, 0x13508
    .long 0x3804d34, 0x13608, 0x3804e44, 0x13708, 0x3804f54, 0x13808, 0x3805a0b, 0x1014010
    .long 0x3805a1b, 0x1014010, 0x3805c2b, 0x1014110, 0x3805c3b, 0x1014110, 0x3805e4b, 0x1014210
    .long 0x3805e5b, 0x1014210, 0x5825064, 0x14310, 0x5825174, 0x14410, 0x5825284, 0x14510
    .long 0x5825394, 0x14610, 0x58254a4, 0x14710, 0x58255b4, 0x14810, 0x58256c4, 0x14910
    .long 0x9806a06, 0x1034a1c, 0x9806c16, 0x1034c1c, 0x9806e26, 0x1034e1c, 0x382606b, 0x1015008
    .long 0x382617b, 0x1015108, 0x382628b, 0x1015208, 0x982639b, 0x15320, 0x98264ab, 0x15420
    .long 0x98265bb, 0x15520, 0x98266cb, 0x15620, 0x3807a07, 0x16208, 0x3807b17, 0x16308
    .long 0x3807c27, 0x16408, 0x3807d37, 0x16508, 0x3807e47, 0x16608, 0x3807f57, 0x16708
    .long 0x9807066, 0x1591c, 0x9807176, 0x15a1c, 0x9807286, 0x15b1c, 0x9807396, 0x15c1c
    .long 0x98074a6, 0x15d1c, 0x98075b6, 0x15e1c, 0x98076c6, 0x15f1c, 0x103057da, 0x15840
    .long 0x98667db, 0x16020, 0x5828067, 0x16810, 0x5828177, 0x16910, 0x5828287, 0x16a10
    .long 0x5828397, 0x16b10, 0x58284a7, 0x16c10, 0x58285b7, 0x16d10, 0x58286c7, 0x16e10
    .long 0xf8077dc, 0x16138, 0x103087dd, 0x16f40, 0x380390e, 0x1000000, 0x380391e, 0x1000000
    .long 0x380392e, 0x1000000, 0x380393e, 0x1000000, 0x380394e, 0x1000000, 0x380395e, 0x1000000
    .long 0x382396e, 0x1000000, 0x382397e, 0x1000000, 0x382398e, 0x1000000, 0x982399e, 0x0
    .long 0x98239ae, 0x0, 0x98239be, 0x0, 0x98239ce, 0x0, 0x98639de, 0x0
    .long 0x4100762, 0x17720, 0x4110762, 0x17720, 0x4128d38, 0x30610, 0x4100872, 0x17820
    .long 0x4110872, 0x17820, 0x4128e48, 0x30810, 0x4128f58, 0x30a10, 0x4129068, 0x30c10
    .long 0x4129178, 0x30e10, 0x0, 0x0, 0x0, 0x0, 0x0, 0x0
    .long 0x0, 0x0, 0x0, 0x0, 0x0, 0x0, 0x0, 0x0
.size main_tasks, 1024
.section .rodata,"a"
.p2align 6
.amdhsa_kernel sequential_preLN__memory_aug_recurrent_mem_tr__dense_activation_silu__prompt_kernel
  .amdhsa_next_free_vgpr 512
  .amdhsa_next_free_sgpr 102
  .amdhsa_accum_offset 256
  .amdhsa_group_segment_fixed_size 0
  .amdhsa_kernarg_size 104
  .amdhsa_user_sgpr_count 2
  .amdhsa_user_sgpr_kernarg_segment_ptr 1
  .amdhsa_system_sgpr_workgroup_id_x 1
.end_amdhsa_kernel
```
